```python
import torch

def _softmax(x, axis=-1):
    return torch.softmax(x, dim=axis)
def _gelu(x):
    return torch.nn.functional.gelu(x, approximate="tanh")
def _silu(x):
    return torch.nn.functional.silu(x)
def _sigmoid(x):
    return torch.sigmoid(x)
def _layernorm(x, axis=-1, eps=1e-5):
    m = x.mean(dim=axis, keepdim=True)
    v = x.var(dim=axis, keepdim=True, unbiased=False)
    return (x - m) / torch.sqrt(v + eps)
def _scatter_add(tgt, idx, src, axis=0):
    return tgt.clone().index_add_(axis, idx, src)
def _segment_sum(src, seg, n):
    out = torch.zeros((n,) + src.shape[1:], dtype=src.dtype)
    return out.index_add_(0, seg, src)
def _pad(x, pw):
    flat = tuple(v for pair in reversed(pw) for v in pair)
    return torch.nn.functional.pad(x, flat)

kernel_name = 'recurrent_scan__compressed_kv_cla__dense_activation_squared_relu__prompt'

def setup_inputs():

    _w = (lambda a: (lambda t: t.to(torch.bfloat16) if t.is_floating_point() else t)(torch.as_tensor(a)))
    def _A_setup():
        B, H, Sq, Sk, D, M = 1, 16, 2048, 2048, 256, 448
        Dc = 4 * D
        return {
            "x": _w((lambda *s: torch.randn(*s, dtype=torch.bfloat16) * 0.05)(B, Sq, M)),
            "c_kv": _w((lambda *s: torch.randn(*s, dtype=torch.bfloat16) * 0.2)(B, Sk, Dc)),
            "w_q": _w((lambda *s: torch.randn(*s, dtype=torch.bfloat16) * 3.2)(M, H, D) * (M ** -0.5)),
            "w_uk": _w((lambda *s: torch.randn(*s, dtype=torch.bfloat16) * 3.2)(Dc, H, D) * (Dc ** -0.5)),
            "w_uv": _w((lambda *s: torch.randn(*s, dtype=torch.bfloat16) * 0.2)(Dc, H, D) * (Dc ** -0.5)),
            "w_o": _w((lambda *s: torch.randn(*s, dtype=torch.bfloat16) * 0.2)(H, D, M) * ((H * D) ** -0.5)),
        }
    _A_in = _A_setup()

    def _B_setup():
        B, S, D, F = 1, 2048, 448, 1792
        return {
            "x": _w((lambda *s: torch.randn(*s, dtype=torch.bfloat16) * 0.05)(B, S, D)),
            "w1": _w((lambda *s: torch.randn(*s, dtype=torch.bfloat16) * 0.1)(D, F)),
            "b1": _w((lambda *s: torch.randn(*s, dtype=torch.bfloat16) * 0.8)(F)),
            "w2": _w((lambda *s: torch.randn(*s, dtype=torch.bfloat16) * 0.1)(F, D)),
            "b2": _w((lambda *s: torch.randn(*s, dtype=torch.bfloat16) * 6.4)(D)),
        }
    _B_in = _B_setup()

    return {
        "A_x": _A_in["x"],
        "A_c_kv": _A_in["c_kv"],
        "A_w_q": _A_in["w_q"],
        "A_w_uk": _A_in["w_uk"],
        "A_w_uv": _A_in["w_uv"],
        "A_w_o": _A_in["w_o"],
        "B_x": _B_in["x"],
        "B_w1": _B_in["w1"],
        "B_b1": _B_in["b1"],
        "B_w2": _B_in["w2"],
        "B_b2": _B_in["b2"],
    }

def reference(A_x, A_c_kv, A_w_q, A_w_uk, A_w_uv, A_w_o, B_x, B_w1, B_b1, B_w2, B_b2):
    def _A_ref(x, c_kv, w_q, w_uk, w_uv, w_o):
        B, Sq, M = x.shape[0], x.shape[1], x.shape[2]
        Sk = c_kv.shape[1]
        H, D = w_q.shape[1], w_q.shape[2]
        q = torch.einsum("bqm,mhd->bhqd", x, w_q)
        k = torch.einsum("bkc,chd->bhkd", c_kv, w_uk)
        v = torch.einsum("bkc,chd->bhkd", c_kv, w_uv)
        scores = torch.einsum("bhqd,bhkd->bhqk", q, k) * (D ** -0.5)
        off = Sk - Sq
        qi = torch.arange(Sq)[:, None]
        kj = torch.arange(Sk)[None, :]
        cmask = kj <= (qi + off)
        scores = torch.where(cmask[None, None], scores, -1e9)
        p = _softmax(scores, axis=-1)
        ctx = torch.einsum("bhqk,bhkd->bhqd", p, v)
        return torch.einsum("bhqd,hdm->bqm", ctx, w_o)

    def _B_ref(x, w1, b1, w2, b2):
        h = torch.einsum("bsd,df->bsf", x, w1) + b1
        zero = torch.zeros_like(h)
        r = torch.where(h > zero, h, zero)
        h = r * r
        out = torch.einsum("bsf,fd->bsd", h, w2) + b2
        return out

    x = A_x
    xn = _layernorm(x, axis=-1)
    s = _A_ref(xn, A_c_kv, A_w_q, A_w_uk, A_w_uv, A_w_o)
    g = _silu(_B_ref(xn, B_w1, B_b1, B_w2, B_b2))
    return x + s * g
```

```asm
; @launch grid=(256,1,1) block=(256,1,1) lds=163840
.amdgcn_target "amdgcn-amd-amdhsa--gfx950"
.text
.macro Zvaa d, a, b
v_mfma_f32_16x16x32_bf16 v[\d:\d+3], a[\a:\a+3], a[\b:\b+3], 0
.endm
.macro RD d, v, o
ds_read_b128 a[\d:\d+3], v\v offset:\o
.endm
.macro Mvaa d, a, b
v_mfma_f32_16x16x32_bf16 v[\d:\d+3], a[\a:\a+3], a[\b:\b+3], v[\d:\d+3]
.endm
.macro Zaaa d, a, b
v_mfma_f32_16x16x32_bf16 a[\d:\d+3], a[\a:\a+3], a[\b:\b+3], 0
.endm
.macro Maaa d, a, b
v_mfma_f32_16x16x32_bf16 a[\d:\d+3], a[\a:\a+3], a[\b:\b+3], a[\d:\d+3]
.endm
.macro RT d, v, o
ds_read_b64_tr_b16 a[\d:\d+1], v\v offset:\o
.endm
.macro Nvaa d, a, b, c
v_mfma_f32_16x16x32_bf16 v[\d:\d+3], a[\a:\a+3], a[\b:\b+3], v[\c:\c+3]
.endm
.macro Zvav d, a, b
v_mfma_f32_16x16x32_bf16 v[\d:\d+3], a[\a:\a+3], v[\b:\b+3], 0
.endm
.macro Mvav d, a, b
v_mfma_f32_16x16x32_bf16 v[\d:\d+3], a[\a:\a+3], v[\b:\b+3], v[\d:\d+3]
.endm
.macro Zvva d, a, b
v_mfma_f32_16x16x32_bf16 v[\d:\d+3], v[\a:\a+3], a[\b:\b+3], 0
.endm
.macro Mvva d, a, b
v_mfma_f32_16x16x32_bf16 v[\d:\d+3], v[\a:\a+3], a[\b:\b+3], v[\d:\d+3]
.endm
.macro Zvvv d, a, b
v_mfma_f32_16x16x32_bf16 v[\d:\d+3], v[\a:\a+3], v[\b:\b+3], 0
.endm
.macro Mvvv d, a, b
v_mfma_f32_16x16x32_bf16 v[\d:\d+3], v[\a:\a+3], v[\b:\b+3], v[\d:\d+3]
.endm
.p2align 12
L_gemmV:
s_waitcnt vmcnt(14) lgkmcnt(0)
s_barrier
s_add_u32 s29, s30, 131200
s_and_b32 s29, s29, 133119
Zvaa 128,96,64
s_add_u32 m0, s33, 8192
RD 0,20,8192
Mvaa 128,100,68
buffer_load_dwordx4 v12, s[8:11], s29 offen offset:0 lds
Zvaa 132,100,76
RD 4,21,8192
Mvaa 132,96,72
Zvaa 160,96,80
RD 8,20,10240
Mvaa 160,100,84
buffer_load_dwordx4 v13, s[8:11], s29 offen offset:1024 lds
Zvaa 168,100,92
RD 12,21,10240
Mvaa 168,96,88
Zvaa 252,104,64
RD 16,20,12288
Mvaa 252,108,68
buffer_load_dwordx4 v14, s[8:11], s29 offen offset:2048 lds
Zvaa 248,108,76
s_load_dwordx2 s[56:57], s[0:1], 40
RD 20,21,12288
Mvaa 248,104,72
Zaaa 208,104,80
RD 24,20,14336
Maaa 208,108,84
buffer_load_dwordx4 v15, s[8:11], s29 offen offset:3072 lds
Zaaa 212,108,92
RD 28,21,14336
Maaa 212,104,88
s_add_u32 s76, s37, 524544
s_and_b32 s76, s76, 8388607
Zvaa 136,112,64
s_add_u32 m0, s34, 114688
RT 32,22,16384
Mvaa 136,116,68
buffer_load_dwordx4 v16, s[12:15], s76 offen offset:0 lds
Zvaa 140,116,76
RT 34,22,18432
Mvaa 140,112,72
Zvaa 56,112,80
RT 36,22,17408
Mvaa 56,116,84
buffer_load_dwordx4 v17, s[12:15], s76 offen offset:1024 lds
Zvaa 60,116,92
RT 38,22,19456
Mvaa 60,112,88
Zvaa 244,120,64
RT 40,23,16384
Mvaa 244,124,68
buffer_load_dwordx4 v18, s[12:15], s76 offen offset:2048 lds
Zvaa 240,124,76
RT 42,23,18432
Mvaa 240,120,72
Zaaa 216,120,80
RT 44,23,17408
Maaa 216,124,84
buffer_load_dwordx4 v19, s[12:15], s76 offen offset:3072 lds
Zaaa 220,124,92
RT 46,23,19456
Maaa 220,120,88
s_add_u32 s29, s30, 256
s_and_b32 s29, s29, 133119
s_waitcnt lgkmcnt(8)
Zvaa 144,0,64
s_add_u32 m0, s33, 65536
RT 48,24,16384
Mvaa 144,4,68
buffer_load_dwordx4 v12, s[8:11], s29 offen offset:0 lds
Zvaa 148,4,76
RT 50,24,18432
Mvaa 148,0,72
Zvaa 80,0,80
RT 52,24,17408
Mvaa 80,4,84
buffer_load_dwordx4 v13, s[8:11], s29 offen offset:1024 lds
Zvaa 84,4,92
RT 54,24,19456
Mvaa 84,0,88
Zaaa 224,8,64
RT 56,25,16384
Maaa 224,12,68
buffer_load_dwordx4 v14, s[8:11], s29 offen offset:2048 lds
Zaaa 228,12,76
RT 58,25,18432
Maaa 228,8,72
Zaaa 232,8,80
RT 60,25,17408
Maaa 232,12,84
buffer_load_dwordx4 v15, s[8:11], s29 offen offset:3072 lds
Zaaa 236,12,92
RT 62,25,19456
Maaa 236,8,88
s_add_u32 s76, s37, 1048576
s_and_b32 s76, s76, 8388607
Zvaa 152,16,64
s_add_u32 m0, s34, 32768
v_add_u32 v20, -131072, v20
v_add_u32 v21, -131072, v21
Mvaa 152,20,68
buffer_load_dwordx4 v16, s[12:15], s76 offen offset:0 lds
Zvaa 156,20,76
v_xor_b32 v22, 0x10000, v22
v_xor_b32 v23, 0x10000, v23
Mvaa 156,16,72
Zvaa 104,16,80
v_xor_b32 v24, 0x10000, v24
v_xor_b32 v25, 0x10000, v25
Mvaa 104,20,84
buffer_load_dwordx4 v17, s[12:15], s76 offen offset:1024 lds
Zvaa 108,20,92
Mvaa 108,16,88
Zaaa 240,24,64
Maaa 240,28,68
buffer_load_dwordx4 v18, s[12:15], s76 offen offset:2048 lds
Zaaa 244,28,76
Maaa 244,24,72
Zaaa 248,24,80
Maaa 248,28,84
buffer_load_dwordx4 v19, s[12:15], s76 offen offset:3072 lds
Zaaa 252,28,92
Maaa 252,24,88
s_mov_b32 s58, 3670016
s_waitcnt vmcnt(18) lgkmcnt(0)
s_barrier
s_add_u32 s29, s30, 131328
s_and_b32 s29, s29, 133119
Zvaa 164,96,32
s_add_u32 m0, s33, 73728
RT 64,22,0
v_mov_b64 v[38:39], 0
Mvaa 164,100,36
buffer_load_dwordx4 v12, s[8:11], s29 offen offset:0 lds
Zvaa 172,100,44
RT 66,22,2048
v_mov_b64 v[40:41], 0
Mvaa 172,96,40
Zvaa 48,96,48
RT 68,22,1024
Mvaa 48,100,52
buffer_load_dwordx4 v13, s[8:11], s29 offen offset:1024 lds
Zvaa 52,100,60
RT 70,22,3072
Mvaa 52,96,56
Zvaa 236,104,32
RD 96,20,0
Mvaa 236,108,36
buffer_load_dwordx4 v14, s[8:11], s29 offen offset:2048 lds
Zvaa 232,108,44
RD 100,21,0
Mvaa 232,104,40
Zvaa 228,104,48
RT 72,23,0
Mvaa 228,108,52
buffer_load_dwordx4 v15, s[8:11], s29 offen offset:3072 lds
Zvaa 224,108,60
RT 74,23,2048
Mvaa 224,104,56
s_add_u32 s76, s37, 1048832
s_and_b32 s76, s76, 8388607
Zvaa 64,112,32
s_add_u32 m0, s34, 49152
RD 104,20,2048
Mvaa 64,116,36
buffer_load_dwordx4 v16, s[12:15], s76 offen offset:0 lds
Zvaa 68,116,44
RD 108,21,2048
Mvaa 68,112,40
Zvaa 72,112,48
RT 76,23,1024
Mvaa 72,116,52
buffer_load_dwordx4 v17, s[12:15], s76 offen offset:1024 lds
Zvaa 76,116,60
RT 78,23,3072
Mvaa 76,112,56
Zvaa 220,120,32
RD 112,20,4096
Mvaa 220,124,36
buffer_load_dwordx4 v18, s[12:15], s76 offen offset:2048 lds
Zvaa 216,124,44
RD 116,21,4096
Mvaa 216,120,40
Zvaa 212,120,48
RT 80,24,0
Mvaa 212,124,52
buffer_load_dwordx4 v19, s[12:15], s76 offen offset:3072 lds
Zvaa 208,124,60
RT 82,24,2048
Mvaa 208,120,56
s_add_u32 s29, s30, 384
s_and_b32 s29, s29, 133119
Zvaa 88,0,32
s_add_u32 m0, s33, 131072
RD 120,20,6144
Mvaa 88,4,36
buffer_load_dwordx4 v12, s[8:11], s29 offen offset:0 lds
Zvaa 92,4,44
RD 124,21,6144
Mvaa 92,0,40
Zvaa 96,0,48
RT 84,24,1024
Mvaa 96,4,52
buffer_load_dwordx4 v13, s[8:11], s29 offen offset:1024 lds
Zvaa 100,4,60
RT 86,24,3072
Mvaa 100,0,56
Zvaa 204,8,32
RT 88,25,0
Mvaa 204,12,36
buffer_load_dwordx4 v14, s[8:11], s29 offen offset:2048 lds
Zvaa 200,12,44
RT 90,25,2048
Mvaa 200,8,40
Zvaa 196,8,48
RT 92,25,1024
Mvaa 196,12,52
buffer_load_dwordx4 v15, s[8:11], s29 offen offset:3072 lds
Zvaa 192,12,60
RT 94,25,3072
Mvaa 192,8,56
s_add_u32 s76, s30, 131456
s_and_b32 s76, s76, 133119
Zvaa 112,16,32
s_add_u32 m0, s33, 139264
Mvaa 112,20,36
buffer_load_dwordx4 v12, s[8:11], s76 offen offset:0 lds
Zvaa 116,20,44
Mvaa 116,16,40
Zvaa 120,16,48
Mvaa 120,20,52
buffer_load_dwordx4 v13, s[8:11], s76 offen offset:1024 lds
Zvaa 124,20,60
Mvaa 124,16,56
Zvaa 188,24,32
Mvaa 188,28,36
buffer_load_dwordx4 v14, s[8:11], s76 offen offset:2048 lds
Zvaa 184,28,44
Mvaa 184,24,40
Zvaa 180,24,48
Mvaa 180,28,52
buffer_load_dwordx4 v15, s[8:11], s76 offen offset:3072 lds
Zvaa 176,28,60
Mvaa 176,24,56
s_bitcmp1_b32 s24, 1
s_cbranch_scc1 LH_V4
s_bitcmp1_b32 s24, 0
s_cbranch_scc1 LA_V4
s_call_b64 s[48:49], LP0
s_branch LR_V4
LA_V4:
s_call_b64 s[48:49], LP1
s_branch LR_V4
LH_V4:
s_bitcmp1_b32 s24, 0
s_cbranch_scc1 LB_V4
s_call_b64 s[48:49], LP2
s_branch LR_V4
LB_V4:
s_call_b64 s[48:49], LP3
LR_V4:
s_waitcnt vmcnt(24) lgkmcnt(0)
s_barrier
s_add_u32 s29, s37, 1572864
s_and_b32 s29, s29, 8388607
Mvaa 128,96,64
s_add_u32 m0, s34, 98304
RD 0,20,8192
Mvaa 128,100,68
buffer_load_dwordx4 v16, s[12:15], s29 offen offset:0 lds
Mvaa 132,100,76
RD 4,21,8192
Mvaa 132,96,72
Mvaa 160,96,80
s_mov_b32 s78, 0
RD 8,20,10240
Mvaa 160,100,84
buffer_load_dwordx2 a[160:161], v2, s[52:55], s78 offen nt
Mvaa 168,100,92
RD 12,21,10240
Mvaa 168,96,88
Mvaa 252,104,64
RD 16,20,12288
Mvaa 252,108,68
buffer_load_dwordx4 v17, s[12:15], s29 offen offset:1024 lds
Mvaa 248,108,76
RD 20,21,12288
Mvaa 248,104,72
Maaa 208,104,80
s_mov_b32 s78, 3584
RD 24,20,14336
Maaa 208,108,84
buffer_load_dwordx2 a[162:163], v2, s[52:55], s78 offen nt
Maaa 212,108,92
RD 28,21,14336
Maaa 212,104,88
Mvaa 136,112,64
RT 32,22,16384
Mvaa 136,116,68
buffer_load_dwordx4 v18, s[12:15], s29 offen offset:2048 lds
Mvaa 140,116,76
RT 34,22,18432
Mvaa 140,112,72
Mvaa 56,112,80
s_mov_b32 s78, 7168
RT 36,22,17408
Mvaa 56,116,84
buffer_load_dwordx2 a[164:165], v2, s[52:55], s78 offen nt
Mvaa 60,116,92
RT 38,22,19456
Mvaa 60,112,88
Mvaa 244,120,64
RT 40,23,16384
Mvaa 244,124,68
buffer_load_dwordx4 v19, s[12:15], s29 offen offset:3072 lds
Mvaa 240,124,76
RT 42,23,18432
Mvaa 240,120,72
Maaa 216,120,80
RT 44,23,17408
Maaa 216,124,84
buffer_store_dwordx4 v[38:41], v5, s[4:7], s72 offen sc1
Maaa 220,124,92
s_waitcnt vmcnt(50)
RT 46,23,19456
Maaa 220,120,88
s_add_u32 s76, s30, 512
s_and_b32 s76, s76, 133119
s_waitcnt lgkmcnt(8)
Mvaa 144,0,64
s_add_u32 m0, s33, 0
RT 48,24,16384
v_accvgpr_read_b32 v29, a176
Mvaa 144,4,68
buffer_load_dwordx4 v12, s[8:11], s76 offen offset:0 lds
Mvaa 148,4,76
RT 50,24,18432
v_lshlrev_b32 v30, 16, v29
Mvaa 148,0,72
v_and_b32 v31, 0xffff0000, v29
v_accvgpr_read_b32 v29, a177
Mvaa 80,0,80
s_mov_b32 s78, 10752
RT 52,24,17408
v_lshlrev_b32 v32, 16, v29
Mvaa 80,4,84
buffer_load_dwordx2 a[166:167], v2, s[52:55], s78 offen nt
Mvaa 84,4,92
RT 54,24,19456
v_and_b32 v33, 0xffff0000, v29
Mvaa 84,0,88
v_accvgpr_read_b32 v29, a178
v_lshlrev_b32 v34, 16, v29
Maaa 224,8,64
RT 56,25,16384
v_and_b32 v35, 0xffff0000, v29
Maaa 224,12,68
buffer_load_dwordx4 v13, s[8:11], s76 offen offset:1024 lds
Maaa 228,12,76
RT 58,25,18432
v_accvgpr_read_b32 v29, a179
Maaa 228,8,72
v_lshlrev_b32 v36, 16, v29
v_and_b32 v37, 0xffff0000, v29
Maaa 232,8,80
s_add_u32 s78, s73, 0
RT 60,25,17408
v_accvgpr_read_b32 v29, a180
Maaa 232,12,84
buffer_load_dwordx2 a[168:169], v2, s[52:55], s78 offen nt
Maaa 236,12,92
RT 62,25,19456
v_lshlrev_b32 v38, 16, v29
Maaa 236,8,88
v_and_b32 v39, 0xffff0000, v29
v_accvgpr_read_b32 v29, a181
Mvaa 152,16,64
v_add_u32 v20, 65536, v20
v_add_u32 v21, 65536, v21
Mvaa 152,20,68
buffer_load_dwordx4 v14, s[8:11], s76 offen offset:2048 lds
Mvaa 156,20,76
v_xor_b32 v22, 0x10000, v22
v_xor_b32 v23, 0x10000, v23
Mvaa 156,16,72
v_lshlrev_b32 v40, 16, v29
v_and_b32 v41, 0xffff0000, v29
Mvaa 104,16,80
s_add_u32 s78, s73, 3584
v_xor_b32 v24, 0x10000, v24
v_xor_b32 v25, 0x10000, v25
Mvaa 104,20,84
buffer_load_dwordx2 a[170:171], v2, s[52:55], s78 offen nt
Mvaa 108,20,92
v_accvgpr_read_b32 v29, a182
v_lshlrev_b32 v42, 16, v29
Mvaa 108,16,88
v_and_b32 v43, 0xffff0000, v29
v_accvgpr_read_b32 v29, a183
Maaa 240,24,64
v_lshlrev_b32 v44, 16, v29
v_and_b32 v45, 0xffff0000, v29
Maaa 240,28,68
buffer_load_dwordx4 v15, s[8:11], s76 offen offset:3072 lds
Maaa 244,28,76
v_add_f32 v46, v30, v31
v_add_f32 v47, v32, v33
Maaa 244,24,72
v_add_f32 v46, v46, v34
v_add_f32 v47, v47, v35
Maaa 248,24,80
v_add_f32 v46, v46, v36
v_add_f32 v47, v47, v37
Maaa 248,28,84
v_add_f32 v46, v46, v38
v_add_f32 v47, v47, v39
Maaa 252,28,92
v_add_f32 v46, v46, v40
v_add_f32 v47, v47, v41
Maaa 252,24,88
v_add_f32 v46, v46, v42
v_add_f32 v47, v47, v43
s_bitcmp1_b32 s24, 1
s_cbranch_scc1 LH_V5
s_bitcmp1_b32 s24, 0
s_cbranch_scc1 LA_V5
s_call_b64 s[48:49], LP4
s_branch LR_V5
LA_V5:
s_call_b64 s[48:49], LP5
s_branch LR_V5
LH_V5:
s_bitcmp1_b32 s24, 0
s_cbranch_scc1 LB_V5
s_call_b64 s[48:49], LP6
s_branch LR_V5
LB_V5:
s_call_b64 s[48:49], LP7
LR_V5:
s_waitcnt vmcnt(31) lgkmcnt(0)
s_barrier
s_add_u32 s29, s37, 1573120
s_and_b32 s29, s29, 8388607
Mvaa 164,96,32
s_add_u32 m0, s34, 114688
RT 64,22,0
v_add_f32 v46, v46, v44
Mvaa 164,100,36
buffer_load_dwordx4 v16, s[12:15], s29 offen offset:0 lds
Mvaa 172,100,44
RT 66,22,2048
v_add_f32 v47, v47, v45
Mvaa 172,96,40
v_accvgpr_read_b32 v29, a184
v_lshlrev_b32 v7, 16, v29
Mvaa 48,96,48
s_add_u32 s78, s73, 7168
RT 68,22,1024
v_and_b32 v29, 0xffff0000, v29
Mvaa 48,100,52
buffer_load_dwordx2 a[172:173], v2, s[52:55], s78 offen nt
Mvaa 52,100,60
RT 70,22,3072
v_add_f32 v46, v46, v7
Mvaa 52,96,56
v_add_f32 v47, v47, v29
v_accvgpr_read_b32 v29, a185
Mvaa 236,104,32
RD 96,20,0
v_lshlrev_b32 v7, 16, v29
Mvaa 236,108,36
buffer_load_dwordx4 v17, s[12:15], s29 offen offset:1024 lds
Mvaa 232,108,44
RD 100,21,0
v_and_b32 v29, 0xffff0000, v29
Mvaa 232,104,40
v_add_f32 v46, v46, v7
v_add_f32 v47, v47, v29
Mvaa 228,104,48
RT 72,23,0
v_accvgpr_read_b32 v29, a186
Mvaa 228,108,52
v_lshlrev_b32 v7, 16, v29
v_and_b32 v29, 0xffff0000, v29
Mvaa 224,108,60
RT 74,23,2048
v_add_f32 v46, v46, v7
Mvaa 224,104,56
v_add_f32 v47, v47, v29
v_accvgpr_read_b32 v29, a187
Mvaa 64,112,32
RD 104,20,2048
v_lshlrev_b32 v7, 16, v29
Mvaa 64,116,36
buffer_load_dwordx4 v18, s[12:15], s29 offen offset:2048 lds
Mvaa 68,116,44
RD 108,21,2048
v_and_b32 v29, 0xffff0000, v29
Mvaa 68,112,40
v_add_f32 v46, v46, v7
v_add_f32 v47, v47, v29
Mvaa 72,112,48
RT 76,23,1024
v_accvgpr_read_b32 v29, a188
Mvaa 72,116,52
v_lshlrev_b32 v7, 16, v29
v_and_b32 v29, 0xffff0000, v29
Mvaa 76,116,60
RT 78,23,3072
v_add_f32 v46, v46, v7
Mvaa 76,112,56
v_add_f32 v47, v47, v29
v_accvgpr_read_b32 v29, a189
Mvaa 220,120,32
RD 112,20,4096
v_lshlrev_b32 v7, 16, v29
Mvaa 220,124,36
buffer_load_dwordx4 v19, s[12:15], s29 offen offset:3072 lds
Mvaa 216,124,44
RD 116,21,4096
v_and_b32 v29, 0xffff0000, v29
Mvaa 216,120,40
v_add_f32 v46, v46, v7
v_add_f32 v47, v47, v29
Mvaa 212,120,48
RT 80,24,0
v_accvgpr_read_b32 v29, a190
Mvaa 212,124,52
v_lshlrev_b32 v7, 16, v29
v_and_b32 v29, 0xffff0000, v29
Mvaa 208,124,60
RT 82,24,2048
v_add_f32 v46, v46, v7
Mvaa 208,120,56
s_add_u32 s76, s30, 131584
s_and_b32 s76, s76, 133119
v_add_f32 v47, v47, v29
v_accvgpr_read_b32 v29, a191
Mvaa 88,0,32
s_add_u32 m0, s33, 8192
RD 120,20,6144
v_lshlrev_b32 v7, 16, v29
Mvaa 88,4,36
buffer_load_dwordx4 v12, s[8:11], s76 offen offset:0 lds
Mvaa 92,4,44
RD 124,21,6144
v_and_b32 v29, 0xffff0000, v29
Mvaa 92,0,40
v_add_f32 v46, v46, v7
v_add_f32 v47, v47, v29
Mvaa 96,0,48
s_add_u32 s78, s73, 10752
RT 84,24,1024
v_add_f32 v46, v46, v47
Mvaa 96,4,52
buffer_load_dwordx2 a[174:175], v2, s[52:55], s78 offen nt
Mvaa 100,4,60
RT 86,24,3072
v_add_f32_dpp v46, v46, v46 row_ror:8 row_mask:0xf bank_mask:0xf
Mvaa 100,0,56
Mvaa 204,8,32
RT 88,25,0
s_branch LOP0
LP0:
s_setpc_b64 s[48:49]
LOP0:
v_add_f32_dpp v46, v46, v46 row_ror:4 row_mask:0xf bank_mask:0xf
Mvaa 204,12,36
buffer_load_dwordx4 v13, s[8:11], s76 offen offset:1024 lds
Mvaa 200,12,44
RT 90,25,2048
v_mov_b32 v7, v46
Mvaa 200,8,40
Mvaa 196,8,48
RT 92,25,1024
v_permlane16_swap_b32 v46, v7
Mvaa 196,12,52
v_add_f32 v46, v46, v7
v_mov_b32 v7, v46
Mvaa 192,12,60
RT 94,25,3072
Mvaa 192,8,56
v_permlane32_swap_b32 v46, v7
Mvaa 112,16,32
v_add_f32 v46, v46, v7
v_mul_f32 v46, 0x3b124925, v46
Mvaa 112,20,36
buffer_load_dwordx4 v14, s[8:11], s76 offen offset:2048 lds
Mvaa 116,20,44
v_sub_f32 v29, v30, v46
v_mul_f32 v47, v29, v29
Mvaa 116,16,40
v_sub_f32 v29, v31, v46
v_fma_f32 v47, v29, v29, v47
Mvaa 120,16,48
v_sub_f32 v29, v32, v46
v_fma_f32 v47, v29, v29, v47
Mvaa 120,20,52
v_sub_f32 v29, v33, v46
v_fma_f32 v47, v29, v29, v47
Mvaa 124,20,60
v_sub_f32 v29, v34, v46
v_fma_f32 v47, v29, v29, v47
Mvaa 124,16,56
v_sub_f32 v29, v35, v46
v_fma_f32 v47, v29, v29, v47
Mvaa 188,24,32
v_sub_f32 v29, v36, v46
v_fma_f32 v47, v29, v29, v47
Mvaa 188,28,36
buffer_load_dwordx4 v15, s[8:11], s76 offen offset:3072 lds
Mvaa 184,28,44
v_sub_f32 v29, v37, v46
v_fma_f32 v47, v29, v29, v47
Mvaa 184,24,40
v_sub_f32 v29, v38, v46
v_fma_f32 v47, v29, v29, v47
Mvaa 180,24,48
v_sub_f32 v29, v39, v46
v_fma_f32 v47, v29, v29, v47
Mvaa 180,28,52
v_sub_f32 v29, v40, v46
v_fma_f32 v47, v29, v29, v47
Mvaa 176,28,60
v_sub_f32 v29, v41, v46
v_fma_f32 v47, v29, v29, v47
Mvaa 176,24,56
v_sub_f32 v29, v42, v46
v_fma_f32 v47, v29, v29, v47
s_cmp_eq_u32 s60, 0
s_cbranch_scc0 L_tpbV3
s_bitcmp1_b32 s24, 1
s_cbranch_scc1 LH_aV6
s_bitcmp1_b32 s24, 0
s_cbranch_scc1 LA_aV6
s_call_b64 s[48:49], LP16
s_branch LR_aV6
LA_aV6:
s_call_b64 s[48:49], LP17
s_branch LR_aV6
LH_aV6:
s_bitcmp1_b32 s24, 0
s_cbranch_scc1 LB_aV6
s_call_b64 s[48:49], LP18
s_branch LR_aV6
LB_aV6:
s_call_b64 s[48:49], LP19
LR_aV6:
s_branch L_tpeV3
L_tpbV3:
s_bitcmp1_b32 s24, 1
s_cbranch_scc1 LH_bV7
s_bitcmp1_b32 s24, 0
s_cbranch_scc1 LA_bV7
s_call_b64 s[48:49], LP25
s_branch LR_bV7
LA_bV7:
s_call_b64 s[48:49], LP26
s_branch LR_bV7
LH_bV7:
s_bitcmp1_b32 s24, 0
s_cbranch_scc1 LB_bV7
s_call_b64 s[48:49], LP27
s_branch LR_bV7
LB_bV7:
s_call_b64 s[48:49], LP28
LR_bV7:
L_tpeV3:
s_waitcnt vmcnt(33) lgkmcnt(0)
s_barrier
s_add_u32 s29, s37, 2097152
s_and_b32 s29, s29, 8388607
Mvaa 128,96,64
s_add_u32 m0, s34, 32768
RD 0,20,8192
v_sub_f32 v29, v43, v46
Mvaa 128,100,68
buffer_load_dwordx4 v16, s[12:15], s29 offen offset:0 lds
Mvaa 132,100,76
RD 4,21,8192
v_fma_f32 v47, v29, v29, v47
Mvaa 132,96,72
v_sub_f32 v29, v44, v46
v_fma_f32 v47, v29, v29, v47
Mvaa 160,96,80
s_mov_b32 s78, 0
RD 8,20,10240
v_sub_f32 v29, v45, v46
Mvaa 160,100,84
buffer_load_dwordx2 a[128:129], v26, s[16:19], s78 offen nt
Mvaa 168,100,92
RD 12,21,10240
v_fma_f32 v47, v29, v29, v47
Mvaa 168,96,88
v_accvgpr_read_b32 v29, a184
v_lshlrev_b32 v7, 16, v29
Mvaa 252,104,64
RD 16,20,12288
v_and_b32 v29, 0xffff0000, v29
Mvaa 252,108,68
buffer_load_dwordx4 v17, s[12:15], s29 offen offset:1024 lds
Mvaa 248,108,76
RD 20,21,12288
v_sub_f32 v7, v7, v46
Mvaa 248,104,72
v_sub_f32 v29, v29, v46
v_fma_f32 v47, v7, v7, v47
Maaa 208,104,80
RD 24,20,14336
v_fma_f32 v47, v29, v29, v47
Maaa 208,108,84
v_accvgpr_read_b32 v29, a185
v_lshlrev_b32 v7, 16, v29
Maaa 212,108,92
RD 28,21,14336
v_and_b32 v29, 0xffff0000, v29
Maaa 212,104,88
v_sub_f32 v7, v7, v46
v_sub_f32 v29, v29, v46
Mvaa 136,112,64
RT 32,22,16384
v_fma_f32 v47, v7, v7, v47
Mvaa 136,116,68
buffer_load_dwordx4 v18, s[12:15], s29 offen offset:2048 lds
Mvaa 140,116,76
RT 34,22,18432
v_fma_f32 v47, v29, v29, v47
Mvaa 140,112,72
v_accvgpr_read_b32 v29, a186
v_lshlrev_b32 v7, 16, v29
Mvaa 56,112,80
s_mov_b32 s78, 8192
RT 36,22,17408
v_and_b32 v29, 0xffff0000, v29
Mvaa 56,116,84
buffer_load_dwordx2 a[130:131], v26, s[16:19], s78 offen nt
Mvaa 60,116,92
RT 38,22,19456
v_sub_f32 v7, v7, v46
Mvaa 60,112,88
v_sub_f32 v29, v29, v46
v_fma_f32 v47, v7, v7, v47
Mvaa 244,120,64
RT 40,23,16384
v_fma_f32 v47, v29, v29, v47
Mvaa 244,124,68
buffer_load_dwordx4 v19, s[12:15], s29 offen offset:3072 lds
Mvaa 240,124,76
RT 42,23,18432
v_accvgpr_read_b32 v29, a187
Mvaa 240,120,72
v_lshlrev_b32 v7, 16, v29
v_and_b32 v29, 0xffff0000, v29
Maaa 216,120,80
RT 44,23,17408
v_sub_f32 v7, v7, v46
Maaa 216,124,84
v_sub_f32 v29, v29, v46
v_fma_f32 v47, v7, v7, v47
Maaa 220,124,92
RT 46,23,19456
v_fma_f32 v47, v29, v29, v47
Maaa 220,120,88
s_add_u32 s76, s30, 640
s_and_b32 s76, s76, 133119
s_waitcnt lgkmcnt(8)
v_accvgpr_read_b32 v29, a188
Mvaa 144,0,64
s_add_u32 m0, s33, 65536
RT 48,24,16384
v_lshlrev_b32 v7, 16, v29
Mvaa 144,4,68
buffer_load_dwordx4 v12, s[8:11], s76 offen offset:0 lds
Mvaa 148,4,76
RT 50,24,18432
v_and_b32 v29, 0xffff0000, v29
Mvaa 148,0,72
v_sub_f32 v7, v7, v46
v_sub_f32 v29, v29, v46
Mvaa 80,0,80
s_mov_b32 s78, 16384
RT 52,24,17408
v_fma_f32 v47, v7, v7, v47
Mvaa 80,4,84
buffer_load_dwordx2 a[132:133], v26, s[16:19], s78 offen nt
Mvaa 84,4,92
RT 54,24,19456
v_fma_f32 v47, v29, v29, v47
Mvaa 84,0,88
v_accvgpr_read_b32 v29, a189
v_lshlrev_b32 v7, 16, v29
Maaa 224,8,64
RT 56,25,16384
v_and_b32 v29, 0xffff0000, v29
Maaa 224,12,68
buffer_load_dwordx4 v13, s[8:11], s76 offen offset:1024 lds
Maaa 228,12,76
RT 58,25,18432
v_sub_f32 v7, v7, v46
Maaa 228,8,72
v_sub_f32 v29, v29, v46
v_fma_f32 v47, v7, v7, v47
Maaa 232,8,80
RT 60,25,17408
v_fma_f32 v47, v29, v29, v47
Maaa 232,12,84
v_accvgpr_read_b32 v29, a190
v_lshlrev_b32 v7, 16, v29
Maaa 236,12,92
RT 62,25,19456
v_and_b32 v29, 0xffff0000, v29
Maaa 236,8,88
v_sub_f32 v7, v7, v46
v_sub_f32 v29, v29, v46
Mvaa 152,16,64
v_add_u32 v20, 65536, v20
v_add_u32 v21, 65536, v21
Mvaa 152,20,68
buffer_load_dwordx4 v14, s[8:11], s76 offen offset:2048 lds
Mvaa 156,20,76
v_xor_b32 v22, 0x10000, v22
v_xor_b32 v23, 0x10000, v23
Mvaa 156,16,72
v_fma_f32 v47, v7, v7, v47
v_fma_f32 v47, v29, v29, v47
Mvaa 104,16,80
s_mov_b32 s78, 24576
v_xor_b32 v24, 0x10000, v24
v_xor_b32 v25, 0x10000, v25
Mvaa 104,20,84
buffer_load_dwordx2 a[134:135], v26, s[16:19], s78 offen nt
Mvaa 108,20,92
v_accvgpr_read_b32 v29, a191
v_lshlrev_b32 v7, 16, v29
Mvaa 108,16,88
v_and_b32 v29, 0xffff0000, v29
v_sub_f32 v7, v7, v46
Maaa 240,24,64
v_sub_f32 v29, v29, v46
v_fma_f32 v47, v7, v7, v47
Maaa 240,28,68
buffer_load_dwordx4 v15, s[8:11], s76 offen offset:3072 lds
Maaa 244,28,76
v_fma_f32 v47, v29, v29, v47
v_cndmask_b32 v47, 0, v47, s[84:85]
Maaa 244,24,72
Maaa 248,24,80
v_add_f32_dpp v47, v47, v47 row_ror:8 row_mask:0xf bank_mask:0xf
Maaa 248,28,84
Maaa 252,28,92
v_add_f32_dpp v47, v47, v47 row_ror:4 row_mask:0xf bank_mask:0xf
v_mov_b32 v7, v47
Maaa 252,24,88
s_waitcnt vmcnt(30) lgkmcnt(0)
s_barrier
s_add_u32 s29, s37, 2097408
s_and_b32 s29, s29, 8388607
Mvaa 164,96,32
s_add_u32 m0, s34, 49152
RT 64,22,0
v_permlane16_swap_b32 v47, v7
Mvaa 164,100,36
buffer_load_dwordx4 v16, s[12:15], s29 offen offset:0 lds
Mvaa 172,100,44
RT 66,22,2048
v_add_f32 v47, v47, v7
Mvaa 172,96,40
v_mov_b32 v7, v47
Mvaa 48,96,48
s_mov_b32 s78, 32768
RT 68,22,1024
Mvaa 48,100,52
buffer_load_dwordx2 a[136:137], v26, s[16:19], s78 offen nt
Mvaa 52,100,60
RT 70,22,3072
v_permlane32_swap_b32 v47, v7
Mvaa 52,96,56
v_add_f32 v47, v47, v7
v_mul_f32 v47, 0x3b124925, v47
Mvaa 236,104,32
RD 96,20,0
v_cvt_pk_bf16_f32 v29, v46, v47
Mvaa 236,108,36
buffer_load_dwordx4 v17, s[12:15], s29 offen offset:1024 lds
Mvaa 232,108,44
RD 100,21,0
v_lshlrev_b32 v46, 16, v29
Mvaa 232,104,40
v_and_b32 v47, 0xffff0000, v29
v_add_f32 v47, 0x3727c5ac, v47
Mvaa 228,104,48
RT 72,23,0
v_cvt_pk_bf16_f32 v47, v47, v47
Mvaa 228,108,52
v_lshlrev_b32 v47, 16, v47
Mvaa 224,108,60
RT 74,23,2048
Mvaa 224,104,56
v_sqrt_f32 v47, v47
Mvaa 64,112,32
RD 104,20,2048
v_cvt_pk_bf16_f32 v47, v47, v47
Mvaa 64,116,36
buffer_load_dwordx4 v18, s[12:15], s29 offen offset:2048 lds
Mvaa 68,116,44
RD 108,21,2048
v_lshlrev_b32 v47, 16, v47
Mvaa 68,112,40
v_rcp_f32 v47, v47
Mvaa 72,112,48
s_mov_b32 s78, 40960
RT 76,23,1024
v_sub_f32 v30, v30, v46
Mvaa 72,116,52
buffer_load_dwordx2 a[138:139], v26, s[16:19], s78 offen nt
Mvaa 76,116,60
RT 78,23,3072
v_sub_f32 v31, v31, v46
Mvaa 76,112,56
v_sub_f32 v32, v32, v46
v_sub_f32 v33, v33, v46
Mvaa 220,120,32
RD 112,20,4096
v_sub_f32 v34, v34, v46
Mvaa 220,124,36
buffer_load_dwordx4 v19, s[12:15], s29 offen offset:3072 lds
Mvaa 216,124,44
RD 116,21,4096
v_sub_f32 v35, v35, v46
Mvaa 216,120,40
v_sub_f32 v36, v36, v46
v_sub_f32 v37, v37, v46
Mvaa 212,120,48
RT 80,24,0
v_sub_f32 v38, v38, v46
Mvaa 212,124,52
v_sub_f32 v39, v39, v46
v_sub_f32 v40, v40, v46
Mvaa 208,124,60
RT 82,24,2048
v_sub_f32 v41, v41, v46
Mvaa 208,120,56
s_add_u32 s76, s30, 131712
s_and_b32 s76, s76, 133119
v_sub_f32 v42, v42, v46
v_sub_f32 v43, v43, v46
Mvaa 88,0,32
s_add_u32 m0, s33, 73728
RD 120,20,6144
v_sub_f32 v44, v44, v46
Mvaa 88,4,36
buffer_load_dwordx4 v12, s[8:11], s76 offen offset:0 lds
Mvaa 92,4,44
RD 124,21,6144
v_sub_f32 v45, v45, v46
Mvaa 92,0,40
v_mul_f32 v47, 0x30800000, v47
v_cvt_pk_bf16_f32 v29, v30, v31
Mvaa 96,0,48
s_mov_b32 s78, 49152
RT 84,24,1024
v_lshlrev_b32 v30, 16, v29
Mvaa 96,4,52
buffer_load_dwordx2 a[140:141], v26, s[16:19], s78 offen nt
Mvaa 100,4,60
RT 86,24,3072
v_and_b32 v31, 0xffff0000, v29
Mvaa 100,0,56
v_mul_f32 v30, v30, v47
v_mul_f32 v31, v31, v47
Mvaa 204,8,32
RT 88,25,0
v_cvt_pk_bf16_f32 v30, v30, v31
Mvaa 204,12,36
buffer_load_dwordx4 v13, s[8:11], s76 offen offset:1024 lds
Mvaa 200,12,44
RT 90,25,2048
v_cvt_pk_bf16_f32 v29, v32, v33
Mvaa 200,8,40
v_lshlrev_b32 v32, 16, v29
v_and_b32 v33, 0xffff0000, v29
Mvaa 196,8,48
RT 92,25,1024
v_mul_f32 v32, v32, v47
Mvaa 196,12,52
v_mul_f32 v33, v33, v47
v_cvt_pk_bf16_f32 v31, v32, v33
Mvaa 192,12,60
RT 94,25,3072
v_cvt_pk_bf16_f32 v29, v34, v35
Mvaa 192,8,56
v_lshlrev_b32 v34, 16, v29
v_and_b32 v35, 0xffff0000, v29
Mvaa 112,16,32
v_mul_f32 v34, v34, v47
v_mul_f32 v35, v35, v47
Mvaa 112,20,36
buffer_load_dwordx4 v14, s[8:11], s76 offen offset:2048 lds
Mvaa 116,20,44
v_cvt_pk_bf16_f32 v32, v34, v35
v_cvt_pk_bf16_f32 v29, v36, v37
Mvaa 116,16,40
v_lshlrev_b32 v36, 16, v29
v_and_b32 v37, 0xffff0000, v29
Mvaa 120,16,48
s_mov_b32 s78, 57344
v_mul_f32 v36, v36, v47
v_mul_f32 v37, v37, v47
Mvaa 120,20,52
buffer_load_dwordx2 a[142:143], v26, s[16:19], s78 offen nt
Mvaa 124,20,60
v_cvt_pk_bf16_f32 v33, v36, v37
v_cvt_pk_bf16_f32 v29, v38, v39
Mvaa 124,16,56
v_lshlrev_b32 v38, 16, v29
v_and_b32 v39, 0xffff0000, v29
Mvaa 188,24,32
v_mul_f32 v38, v38, v47
v_mul_f32 v39, v39, v47
Mvaa 188,28,36
buffer_load_dwordx4 v15, s[8:11], s76 offen offset:3072 lds
Mvaa 184,28,44
v_cvt_pk_bf16_f32 v34, v38, v39
v_cvt_pk_bf16_f32 v29, v40, v41
Mvaa 184,24,40
v_lshlrev_b32 v40, 16, v29
v_and_b32 v41, 0xffff0000, v29
Mvaa 180,24,48
v_mul_f32 v40, v40, v47
v_mul_f32 v41, v41, v47
Mvaa 180,28,52
v_cvt_pk_bf16_f32 v35, v40, v41
v_cvt_pk_bf16_f32 v29, v42, v43
Mvaa 176,28,60
v_lshlrev_b32 v42, 16, v29
v_and_b32 v43, 0xffff0000, v29
Mvaa 176,24,56
s_waitcnt vmcnt(41)
v_mul_f32 v42, v42, v47
v_mul_f32 v43, v43, v47
s_waitcnt vmcnt(29) lgkmcnt(0)
s_barrier
s_add_u32 s29, s37, 2621440
s_and_b32 s29, s29, 8388607
Mvaa 128,96,64
s_add_u32 m0, s34, 98304
RD 0,20,8192
v_cvt_pk_bf16_f32 v36, v42, v43
Mvaa 128,100,68
buffer_load_dwordx4 v16, s[12:15], s29 offen offset:0 lds
Mvaa 132,100,76
RD 4,21,8192
v_cvt_pk_bf16_f32 v29, v44, v45
Mvaa 132,96,72
v_lshlrev_b32 v44, 16, v29
v_and_b32 v45, 0xffff0000, v29
Mvaa 160,96,80
RD 8,20,10240
v_mul_f32 v44, v44, v47
Mvaa 160,100,84
v_mul_f32 v45, v45, v47
v_cvt_pk_bf16_f32 v37, v44, v45
Mvaa 168,100,92
RD 12,21,10240
Mvaa 168,96,88
Mvaa 252,104,64
RD 16,20,12288
Mvaa 252,108,68
buffer_load_dwordx4 v17, s[12:15], s29 offen offset:1024 lds
Mvaa 248,108,76
RD 20,21,12288
Mvaa 248,104,72
Maaa 208,104,80
RD 24,20,14336
Maaa 208,108,84
Maaa 212,108,92
RD 28,21,14336
Maaa 212,104,88
Mvaa 136,112,64
RT 32,22,16384
Mvaa 136,116,68
buffer_load_dwordx4 v18, s[12:15], s29 offen offset:2048 lds
Mvaa 140,116,76
RT 34,22,18432
Mvaa 140,112,72
Mvaa 56,112,80
RT 36,22,17408
Mvaa 56,116,84
Mvaa 60,116,92
RT 38,22,19456
Mvaa 60,112,88
Mvaa 244,120,64
RT 40,23,16384
Mvaa 244,124,68
buffer_load_dwordx4 v19, s[12:15], s29 offen offset:3072 lds
Mvaa 240,124,76
RT 42,23,18432
Mvaa 240,120,72
Maaa 216,120,80
RT 44,23,17408
Maaa 216,124,84
Maaa 220,124,92
RT 46,23,19456
Maaa 220,120,88
s_add_u32 s76, s30, 768
s_and_b32 s76, s76, 133119
s_waitcnt lgkmcnt(8)
Mvaa 144,0,64
s_add_u32 m0, s33, 131072
RT 48,24,16384
Mvaa 144,4,68
buffer_load_dwordx4 v12, s[8:11], s76 offen offset:0 lds
Mvaa 148,4,76
RT 50,24,18432
Mvaa 148,0,72
Mvaa 80,0,80
RT 52,24,17408
Mvaa 80,4,84
Mvaa 84,4,92
RT 54,24,19456
Mvaa 84,0,88
Maaa 224,8,64
RT 56,25,16384
Maaa 224,12,68
buffer_load_dwordx4 v13, s[8:11], s76 offen offset:1024 lds
Maaa 228,12,76
RT 58,25,18432
Maaa 228,8,72
Maaa 232,8,80
RT 60,25,17408
Maaa 232,12,84
Maaa 236,12,92
RT 62,25,19456
Maaa 236,8,88
Mvaa 152,16,64
v_add_u32 v20, -131072, v20
v_add_u32 v21, -131072, v21
Mvaa 152,20,68
buffer_load_dwordx4 v14, s[8:11], s76 offen offset:2048 lds
Mvaa 156,20,76
v_xor_b32 v22, 0x10000, v22
v_xor_b32 v23, 0x10000, v23
Mvaa 156,16,72
Mvaa 104,16,80
v_xor_b32 v24, 0x10000, v24
v_xor_b32 v25, 0x10000, v25
Mvaa 104,20,84
Mvaa 108,20,92
Mvaa 108,16,88
Maaa 240,24,64
Maaa 240,28,68
buffer_load_dwordx4 v15, s[8:11], s76 offen offset:3072 lds
Maaa 244,28,76
Maaa 244,24,72
Maaa 248,24,80
s_branch LOP1
LP1:
s_setpc_b64 s[48:49]
LOP1:
Maaa 248,28,84
buffer_store_byte v9, v8, s[20:23], s38 offen sc1
Maaa 252,28,92
Maaa 252,24,88
s_waitcnt vmcnt(27) lgkmcnt(0)
s_barrier
s_add_u32 s29, s37, 2621696
s_and_b32 s29, s29, 8388607
Mvaa 164,96,32
s_add_u32 m0, s34, 114688
RT 64,22,0
Mvaa 164,100,36
buffer_load_dwordx4 v16, s[12:15], s29 offen offset:0 lds
Mvaa 172,100,44
RT 66,22,2048
Mvaa 172,96,40
Mvaa 48,96,48
RT 68,22,1024
Mvaa 48,100,52
Mvaa 52,100,60
RT 70,22,3072
Mvaa 52,96,56
Mvaa 236,104,32
RD 96,20,0
Mvaa 236,108,36
buffer_load_dwordx4 v17, s[12:15], s29 offen offset:1024 lds
Mvaa 232,108,44
RD 100,21,0
Mvaa 232,104,40
Mvaa 228,104,48
RT 72,23,0
Mvaa 228,108,52
Mvaa 224,108,60
RT 74,23,2048
Mvaa 224,104,56
Mvaa 64,112,32
RD 104,20,2048
Mvaa 64,116,36
buffer_load_dwordx4 v18, s[12:15], s29 offen offset:2048 lds
Mvaa 68,116,44
RD 108,21,2048
Mvaa 68,112,40
Mvaa 72,112,48
RT 76,23,1024
Mvaa 72,116,52
Mvaa 76,116,60
RT 78,23,3072
Mvaa 76,112,56
Mvaa 220,120,32
RD 112,20,4096
Mvaa 220,124,36
buffer_load_dwordx4 v19, s[12:15], s29 offen offset:3072 lds
Mvaa 216,124,44
RD 116,21,4096
Mvaa 216,120,40
Mvaa 212,120,48
RT 80,24,0
Mvaa 212,124,52
Mvaa 208,124,60
RT 82,24,2048
Mvaa 208,120,56
s_add_u32 s76, s30, 131840
s_and_b32 s76, s76, 133119
Mvaa 88,0,32
s_add_u32 m0, s33, 139264
RD 120,20,6144
Mvaa 88,4,36
buffer_load_dwordx4 v12, s[8:11], s76 offen offset:0 lds
Mvaa 92,4,44
RD 124,21,6144
Mvaa 92,0,40
Mvaa 96,0,48
RT 84,24,1024
Mvaa 96,4,52
Mvaa 100,4,60
RT 86,24,3072
Mvaa 100,0,56
Mvaa 204,8,32
RT 88,25,0
Mvaa 204,12,36
buffer_load_dwordx4 v13, s[8:11], s76 offen offset:1024 lds
Mvaa 200,12,44
RT 90,25,2048
Mvaa 200,8,40
Mvaa 196,8,48
RT 92,25,1024
Mvaa 196,12,52
Mvaa 192,12,60
RT 94,25,3072
Mvaa 192,8,56
Mvaa 112,16,32
Mvaa 112,20,36
buffer_load_dwordx4 v14, s[8:11], s76 offen offset:2048 lds
Mvaa 116,20,44
Mvaa 116,16,40
Mvaa 120,16,48
Mvaa 120,20,52
Mvaa 124,20,60
Mvaa 124,16,56
Mvaa 188,24,32
Mvaa 188,28,36
buffer_load_dwordx4 v15, s[8:11], s76 offen offset:3072 lds
Mvaa 184,28,44
Mvaa 184,24,40
Mvaa 180,24,48
Mvaa 180,28,52
Mvaa 176,28,60
Mvaa 176,24,56
s_waitcnt vmcnt(23) lgkmcnt(0)
s_barrier
s_add_u32 s29, s37, 3145728
s_and_b32 s29, s29, 8388607
Mvaa 128,96,64
s_add_u32 m0, s34, 32768
RD 0,20,8192
Mvaa 128,100,68
buffer_load_dwordx4 v16, s[12:15], s29 offen offset:0 lds
Mvaa 132,100,76
s_waitcnt vmcnt(19)
RD 4,21,8192
Mvaa 132,96,72
Mvaa 160,96,80
RD 8,20,10240
Mvaa 160,100,84
buffer_store_dwordx4 v[30:33], v28, s[4:7], s69 offen sc1
Mvaa 168,100,92
RD 12,21,10240
Mvaa 168,96,88
Mvaa 252,104,64
RD 16,20,12288
Mvaa 252,108,68
buffer_load_dwordx4 v17, s[12:15], s29 offen offset:1024 lds
Mvaa 248,108,76
RD 20,21,12288
Mvaa 248,104,72
Maaa 208,104,80
RD 24,20,14336
Maaa 208,108,84
buffer_store_dwordx4 v[34:37], v28, s[4:7], s69 offen offset:3584 sc1
Maaa 212,108,92
s_waitcnt vmcnt(48)
RD 28,21,14336
Maaa 212,104,88
Mvaa 136,112,64
RT 32,22,16384
v_accvgpr_read_b32 v30, a160
Mvaa 136,116,68
buffer_load_dwordx4 v18, s[12:15], s29 offen offset:2048 lds
Mvaa 140,116,76
RT 34,22,18432
v_accvgpr_read_b32 v31, a162
Mvaa 140,112,72
v_accvgpr_read_b32 v32, a164
v_accvgpr_read_b32 v33, a166
Mvaa 56,112,80
RT 36,22,17408
v_accvgpr_read_b32 v34, a168
Mvaa 56,116,84
v_accvgpr_read_b32 v35, a170
v_accvgpr_read_b32 v36, a172
Mvaa 60,116,92
RT 38,22,19456
v_accvgpr_read_b32 v37, a174
Mvaa 60,112,88
v_perm_b32 v38, v31, v30, s45
v_perm_b32 v39, v33, v32, s45
Mvaa 244,120,64
RT 40,23,16384
v_perm_b32 v40, v35, v34, s45
Mvaa 244,124,68
buffer_load_dwordx4 v19, s[12:15], s29 offen offset:3072 lds
Mvaa 240,124,76
RT 42,23,18432
v_perm_b32 v41, v37, v36, s45
Mvaa 240,120,72
Maaa 216,120,80
RT 44,23,17408
Maaa 216,124,84
buffer_store_dwordx4 v[38:41], v27, s[4:7], s68 offen sc1
Maaa 220,124,92
RT 46,23,19456
v_add_u32 v27, s74, v27
Maaa 220,120,88
s_add_u32 s76, s30, 896
s_and_b32 s76, s76, 133119
s_waitcnt lgkmcnt(8)
v_perm_b32 v42, v31, v30, s46
Mvaa 144,0,64
s_add_u32 m0, s33, 0
RT 48,24,16384
v_perm_b32 v43, v33, v32, s46
Mvaa 144,4,68
buffer_load_dwordx4 v12, s[8:11], s76 offen offset:0 lds
Mvaa 148,4,76
RT 50,24,18432
v_perm_b32 v44, v35, v34, s46
Mvaa 148,0,72
v_perm_b32 v45, v37, v36, s46
Mvaa 80,0,80
RT 52,24,17408
Mvaa 80,4,84
buffer_store_dwordx4 v[42:45], v27, s[4:7], s68 offen sc1
Mvaa 84,4,92
RT 54,24,19456
v_add_u32 v27, s74, v27
Mvaa 84,0,88
Maaa 224,8,64
RT 56,25,16384
v_accvgpr_read_b32 v30, a161
Maaa 224,12,68
buffer_load_dwordx4 v13, s[8:11], s76 offen offset:1024 lds
Maaa 228,12,76
RT 58,25,18432
v_accvgpr_read_b32 v31, a163
Maaa 228,8,72
v_accvgpr_read_b32 v32, a165
v_accvgpr_read_b32 v33, a167
Maaa 232,8,80
RT 60,25,17408
v_accvgpr_read_b32 v34, a169
Maaa 232,12,84
v_accvgpr_read_b32 v35, a171
v_accvgpr_read_b32 v36, a173
Maaa 236,12,92
RT 62,25,19456
v_accvgpr_read_b32 v37, a175
Maaa 236,8,88
v_perm_b32 v38, v31, v30, s45
v_perm_b32 v39, v33, v32, s45
Mvaa 152,16,64
v_add_u32 v20, 65536, v20
v_add_u32 v21, 65536, v21
Mvaa 152,20,68
buffer_load_dwordx4 v14, s[8:11], s76 offen offset:2048 lds
Mvaa 156,20,76
v_xor_b32 v22, 0x10000, v22
v_xor_b32 v23, 0x10000, v23
Mvaa 156,16,72
v_perm_b32 v40, v35, v34, s45
v_perm_b32 v41, v37, v36, s45
Mvaa 104,16,80
v_xor_b32 v24, 0x10000, v24
v_xor_b32 v25, 0x10000, v25
Mvaa 104,20,84
buffer_store_dwordx4 v[38:41], v27, s[4:7], s68 offen sc1
Mvaa 108,20,92
v_add_u32 v27, s74, v27
v_perm_b32 v42, v31, v30, s46
Mvaa 108,16,88
v_perm_b32 v43, v33, v32, s46
v_perm_b32 v44, v35, v34, s46
Maaa 240,24,64
v_perm_b32 v45, v37, v36, s46
Maaa 240,28,68
buffer_load_dwordx4 v15, s[8:11], s76 offen offset:3072 lds
Maaa 244,28,76
Maaa 244,24,72
Maaa 248,24,80
Maaa 248,28,84
buffer_store_dwordx4 v[42:45], v27, s[4:7], s68 offen sc1
Maaa 252,28,92
v_add_u32 v27, s74, v27
Maaa 252,24,88
s_waitcnt vmcnt(32)
s_waitcnt vmcnt(27) lgkmcnt(0)
s_barrier
s_add_u32 s29, s37, 3145984
s_and_b32 s29, s29, 8388607
Mvaa 164,96,32
s_add_u32 m0, s34, 49152
s_mov_b32 s73, 0x4cb8aa3b
RT 64,22,0
Mvaa 164,100,36
buffer_load_dwordx4 v16, s[12:15], s29 offen offset:0 lds
Mvaa 172,100,44
RT 66,22,2048
v_accvgpr_read_b32 v30, a128
Mvaa 172,96,40
v_accvgpr_read_b32 v31, a130
v_lshlrev_b32 v32, 16, v30
Mvaa 48,96,48
RT 68,22,1024
v_lshlrev_b32 v33, 16, v31
Mvaa 48,100,52
v_and_b32 v30, 0xffff0000, v30
v_and_b32 v31, 0xffff0000, v31
Mvaa 52,100,60
RT 70,22,3072
v_mul_f32 v30, s73, v30
Mvaa 52,96,56
v_mul_f32 v31, s73, v31
v_mul_f32 v32, s73, v32
Mvaa 236,104,32
RD 96,20,0
v_mul_f32 v33, s73, v33
Mvaa 236,108,36
buffer_load_dwordx4 v17, s[12:15], s29 offen offset:1024 lds
Mvaa 232,108,44
RD 100,21,0
v_cvt_pk_bf16_f32 v38, v32, v33
Mvaa 232,104,40
v_cvt_pk_bf16_f32 v42, v30, v31
v_accvgpr_read_b32 v34, a132
Mvaa 228,104,48
RT 72,23,0
v_accvgpr_read_b32 v35, a134
Mvaa 228,108,52
v_lshlrev_b32 v36, 16, v34
v_lshlrev_b32 v37, 16, v35
Mvaa 224,108,60
RT 74,23,2048
v_and_b32 v34, 0xffff0000, v34
Mvaa 224,104,56
v_and_b32 v35, 0xffff0000, v35
v_mul_f32 v34, s73, v34
Mvaa 64,112,32
RD 104,20,2048
v_mul_f32 v35, s73, v35
Mvaa 64,116,36
buffer_load_dwordx4 v18, s[12:15], s29 offen offset:2048 lds
Mvaa 68,116,44
RD 108,21,2048
v_mul_f32 v36, s73, v36
Mvaa 68,112,40
v_mul_f32 v37, s73, v37
v_cvt_pk_bf16_f32 v39, v36, v37
Mvaa 72,112,48
RT 76,23,1024
v_cvt_pk_bf16_f32 v43, v34, v35
Mvaa 72,116,52
v_accvgpr_read_b32 v30, a136
v_accvgpr_read_b32 v31, a138
Mvaa 76,116,60
RT 78,23,3072
v_lshlrev_b32 v32, 16, v30
Mvaa 76,112,56
v_lshlrev_b32 v33, 16, v31
v_and_b32 v30, 0xffff0000, v30
Mvaa 220,120,32
RD 112,20,4096
v_and_b32 v31, 0xffff0000, v31
Mvaa 220,124,36
buffer_load_dwordx4 v19, s[12:15], s29 offen offset:3072 lds
Mvaa 216,124,44
RD 116,21,4096
v_mul_f32 v30, s73, v30
Mvaa 216,120,40
v_mul_f32 v31, s73, v31
v_mul_f32 v32, s73, v32
Mvaa 212,120,48
RT 80,24,0
v_mul_f32 v33, s73, v33
Mvaa 212,124,52
v_cvt_pk_bf16_f32 v40, v32, v33
v_cvt_pk_bf16_f32 v44, v30, v31
Mvaa 208,124,60
RT 82,24,2048
v_accvgpr_read_b32 v34, a140
Mvaa 208,120,56
s_add_u32 s76, s30, 131968
s_and_b32 s76, s76, 133119
v_accvgpr_read_b32 v35, a142
v_lshlrev_b32 v36, 16, v34
Mvaa 88,0,32
s_add_u32 m0, s33, 8192
RD 120,20,6144
v_lshlrev_b32 v37, 16, v35
Mvaa 88,4,36
buffer_load_dwordx4 v12, s[8:11], s76 offen offset:0 lds
Mvaa 92,4,44
RD 124,21,6144
v_and_b32 v34, 0xffff0000, v34
Mvaa 92,0,40
v_and_b32 v35, 0xffff0000, v35
v_mul_f32 v34, s73, v34
Mvaa 96,0,48
RT 84,24,1024
v_mul_f32 v35, s73, v35
Mvaa 96,4,52
v_mul_f32 v36, s73, v36
v_mul_f32 v37, s73, v37
Mvaa 100,4,60
RT 86,24,3072
v_cvt_pk_bf16_f32 v41, v36, v37
Mvaa 100,0,56
v_cvt_pk_bf16_f32 v45, v34, v35
Mvaa 204,8,32
RT 88,25,0
Mvaa 204,12,36
buffer_load_dwordx4 v13, s[8:11], s76 offen offset:1024 lds
Mvaa 200,12,44
RT 90,25,2048
Mvaa 200,8,40
Mvaa 196,8,48
RT 92,25,1024
Mvaa 196,12,52
buffer_store_dwordx4 v[38:41], v5, s[4:7], s66 offen offset:0 sc1
Mvaa 192,12,60
RT 94,25,3072
Mvaa 192,8,56
Mvaa 112,16,32
Mvaa 112,20,36
buffer_load_dwordx4 v14, s[8:11], s76 offen offset:2048 lds
Mvaa 116,20,44
Mvaa 116,16,40
Mvaa 120,16,48
Mvaa 120,20,52
buffer_store_dwordx4 v[42:45], v5, s[4:7], s66 offen offset:2048 sc1
Mvaa 124,20,60
v_accvgpr_read_b32 v30, a129
v_accvgpr_read_b32 v31, a131
Mvaa 124,16,56
v_lshlrev_b32 v32, 16, v30
v_lshlrev_b32 v33, 16, v31
Mvaa 188,24,32
v_and_b32 v30, 0xffff0000, v30
v_and_b32 v31, 0xffff0000, v31
Mvaa 188,28,36
buffer_load_dwordx4 v15, s[8:11], s76 offen offset:3072 lds
Mvaa 184,28,44
v_mul_f32 v30, s73, v30
v_mul_f32 v31, s73, v31
Mvaa 184,24,40
v_mul_f32 v32, s73, v32
v_mul_f32 v33, s73, v33
Mvaa 180,24,48
v_cvt_pk_bf16_f32 v38, v32, v33
v_cvt_pk_bf16_f32 v42, v30, v31
Mvaa 180,28,52
v_accvgpr_read_b32 v34, a133
v_accvgpr_read_b32 v35, a135
Mvaa 176,28,60
v_lshlrev_b32 v36, 16, v34
v_lshlrev_b32 v37, 16, v35
Mvaa 176,24,56
v_and_b32 v34, 0xffff0000, v34
v_and_b32 v35, 0xffff0000, v35
s_waitcnt vmcnt(28) lgkmcnt(0)
s_barrier
s_add_u32 s29, s37, 3670016
s_and_b32 s29, s29, 8388607
Mvaa 128,96,64
s_add_u32 m0, s34, 98304
RD 0,20,8192
v_mul_f32 v34, s73, v34
Mvaa 128,100,68
buffer_load_dwordx4 v16, s[12:15], s29 offen offset:0 lds
Mvaa 132,100,76
RD 4,21,8192
v_mul_f32 v35, s73, v35
Mvaa 132,96,72
v_mul_f32 v36, s73, v36
v_mul_f32 v37, s73, v37
Mvaa 160,96,80
RD 8,20,10240
v_cvt_pk_bf16_f32 v39, v36, v37
Mvaa 160,100,84
v_cvt_pk_bf16_f32 v43, v34, v35
v_accvgpr_read_b32 v30, a137
Mvaa 168,100,92
RD 12,21,10240
v_accvgpr_read_b32 v31, a139
Mvaa 168,96,88
v_lshlrev_b32 v32, 16, v30
v_lshlrev_b32 v33, 16, v31
Mvaa 252,104,64
RD 16,20,12288
v_and_b32 v30, 0xffff0000, v30
Mvaa 252,108,68
buffer_load_dwordx4 v17, s[12:15], s29 offen offset:1024 lds
Mvaa 248,108,76
RD 20,21,12288
v_and_b32 v31, 0xffff0000, v31
Mvaa 248,104,72
v_mul_f32 v30, s73, v30
v_mul_f32 v31, s73, v31
Maaa 208,104,80
RD 24,20,14336
v_mul_f32 v32, s73, v32
Maaa 208,108,84
v_mul_f32 v33, s73, v33
v_cvt_pk_bf16_f32 v40, v32, v33
Maaa 212,108,92
RD 28,21,14336
v_cvt_pk_bf16_f32 v44, v30, v31
Maaa 212,104,88
v_accvgpr_read_b32 v34, a141
v_accvgpr_read_b32 v35, a143
Mvaa 136,112,64
RT 32,22,16384
v_lshlrev_b32 v36, 16, v34
Mvaa 136,116,68
buffer_load_dwordx4 v18, s[12:15], s29 offen offset:2048 lds
Mvaa 140,116,76
RT 34,22,18432
v_lshlrev_b32 v37, 16, v35
Mvaa 140,112,72
v_and_b32 v34, 0xffff0000, v34
v_and_b32 v35, 0xffff0000, v35
Mvaa 56,112,80
RT 36,22,17408
v_mul_f32 v34, s73, v34
Mvaa 56,116,84
v_mul_f32 v35, s73, v35
v_mul_f32 v36, s73, v36
Mvaa 60,116,92
RT 38,22,19456
v_mul_f32 v37, s73, v37
Mvaa 60,112,88
v_cvt_pk_bf16_f32 v41, v36, v37
v_cvt_pk_bf16_f32 v45, v34, v35
Mvaa 244,120,64
s_add_u32 s66, s66, 4096
RT 40,23,16384
Mvaa 244,124,68
buffer_load_dwordx4 v19, s[12:15], s29 offen offset:3072 lds
Mvaa 240,124,76
RT 42,23,18432
Mvaa 240,120,72
Maaa 216,120,80
RT 44,23,17408
Maaa 216,124,84
buffer_store_dwordx4 v[38:41], v5, s[4:7], s66 offen offset:0 sc1
Maaa 220,124,92
RT 46,23,19456
Maaa 220,120,88
s_add_u32 s76, s30, 1024
s_and_b32 s76, s76, 133119
s_waitcnt lgkmcnt(8)
Mvaa 144,0,64
s_add_u32 m0, s33, 65536
RT 48,24,16384
Mvaa 144,4,68
buffer_load_dwordx4 v12, s[8:11], s76 offen offset:0 lds
Mvaa 148,4,76
RT 50,24,18432
Mvaa 148,0,72
Mvaa 80,0,80
RT 52,24,17408
Mvaa 80,4,84
buffer_store_dwordx4 v[42:45], v5, s[4:7], s66 offen offset:2048 sc1
Mvaa 84,4,92
RT 54,24,19456
Mvaa 84,0,88
s_branch LOP2
LP2:
s_setpc_b64 s[48:49]
LOP2:
Maaa 224,8,64
RT 56,25,16384
Maaa 224,12,68
buffer_load_dwordx4 v13, s[8:11], s76 offen offset:1024 lds
Maaa 228,12,76
RT 58,25,18432
Maaa 228,8,72
Maaa 232,8,80
RT 60,25,17408
Maaa 232,12,84
Maaa 236,12,92
RT 62,25,19456
Maaa 236,8,88
Mvaa 152,16,64
v_add_u32 v20, 65536, v20
v_add_u32 v21, 65536, v21
Mvaa 152,20,68
buffer_load_dwordx4 v14, s[8:11], s76 offen offset:2048 lds
Mvaa 156,20,76
v_xor_b32 v22, 0x10000, v22
v_xor_b32 v23, 0x10000, v23
Mvaa 156,16,72
Mvaa 104,16,80
v_xor_b32 v24, 0x10000, v24
v_xor_b32 v25, 0x10000, v25
Mvaa 104,20,84
Mvaa 108,20,92
Mvaa 108,16,88
Maaa 240,24,64
Maaa 240,28,68
buffer_load_dwordx4 v15, s[8:11], s76 offen offset:3072 lds
Maaa 244,28,76
Maaa 244,24,72
Maaa 248,24,80
Maaa 248,28,84
buffer_load_dword v7, v10, s[20:23], s35 offen sc1
Maaa 252,28,92
Maaa 252,24,88
s_waitcnt vmcnt(29) lgkmcnt(0)
s_barrier
s_add_u32 s29, s37, 3670272
s_and_b32 s29, s29, 8388607
Mvaa 164,96,32
s_add_u32 m0, s34, 114688
RT 64,22,0
Mvaa 164,100,36
buffer_load_dwordx4 v16, s[12:15], s29 offen offset:0 lds
Mvaa 172,100,44
RT 66,22,2048
Mvaa 172,96,40
Mvaa 48,96,48
RT 68,22,1024
Mvaa 48,100,52
Mvaa 52,100,60
RT 70,22,3072
Mvaa 52,96,56
Mvaa 236,104,32
RD 96,20,0
Mvaa 236,108,36
buffer_load_dwordx4 v17, s[12:15], s29 offen offset:1024 lds
Mvaa 232,108,44
RD 100,21,0
Mvaa 232,104,40
Mvaa 228,104,48
RT 72,23,0
Mvaa 228,108,52
Mvaa 224,108,60
RT 74,23,2048
Mvaa 224,104,56
Mvaa 64,112,32
RD 104,20,2048
Mvaa 64,116,36
buffer_load_dwordx4 v18, s[12:15], s29 offen offset:2048 lds
Mvaa 68,116,44
RD 108,21,2048
Mvaa 68,112,40
Mvaa 72,112,48
RT 76,23,1024
Mvaa 72,116,52
Mvaa 76,116,60
RT 78,23,3072
Mvaa 76,112,56
Mvaa 220,120,32
RD 112,20,4096
Mvaa 220,124,36
buffer_load_dwordx4 v19, s[12:15], s29 offen offset:3072 lds
Mvaa 216,124,44
RD 116,21,4096
Mvaa 216,120,40
Mvaa 212,120,48
RT 80,24,0
Mvaa 212,124,52
Mvaa 208,124,60
RT 82,24,2048
Mvaa 208,120,56
s_add_u32 s76, s30, 132096
s_and_b32 s76, s76, 133119
Mvaa 88,0,32
s_add_u32 m0, s33, 73728
RD 120,20,6144
Mvaa 88,4,36
buffer_load_dwordx4 v12, s[8:11], s76 offen offset:0 lds
Mvaa 92,4,44
RD 124,21,6144
Mvaa 92,0,40
Mvaa 96,0,48
RT 84,24,1024
Mvaa 96,4,52
Mvaa 100,4,60
RT 86,24,3072
Mvaa 100,0,56
Mvaa 204,8,32
RT 88,25,0
Mvaa 204,12,36
buffer_load_dwordx4 v13, s[8:11], s76 offen offset:1024 lds
Mvaa 200,12,44
RT 90,25,2048
Mvaa 200,8,40
Mvaa 196,8,48
RT 92,25,1024
Mvaa 196,12,52
Mvaa 192,12,60
RT 94,25,3072
Mvaa 192,8,56
Mvaa 112,16,32
Mvaa 112,20,36
buffer_load_dwordx4 v14, s[8:11], s76 offen offset:2048 lds
Mvaa 116,20,44
Mvaa 116,16,40
Mvaa 120,16,48
Mvaa 120,20,52
Mvaa 124,20,60
Mvaa 124,16,56
Mvaa 188,24,32
Mvaa 188,28,36
buffer_load_dwordx4 v15, s[8:11], s76 offen offset:3072 lds
Mvaa 184,28,44
Mvaa 184,24,40
Mvaa 180,24,48
Mvaa 180,28,52
Mvaa 176,28,60
Mvaa 176,24,56
s_waitcnt vmcnt(25) lgkmcnt(0)
s_barrier
s_add_u32 s29, s37, 4194304
s_and_b32 s29, s29, 8388607
Mvaa 128,96,64
s_add_u32 m0, s34, 32768
RD 0,20,8192
Mvaa 128,100,68
buffer_load_dwordx4 v16, s[12:15], s29 offen offset:0 lds
Mvaa 132,100,76
RD 4,21,8192
Mvaa 132,96,72
Mvaa 160,96,80
RD 8,20,10240
Mvaa 160,100,84
Mvaa 168,100,92
RD 12,21,10240
Mvaa 168,96,88
Mvaa 252,104,64
RD 16,20,12288
Mvaa 252,108,68
buffer_load_dwordx4 v17, s[12:15], s29 offen offset:1024 lds
Mvaa 248,108,76
RD 20,21,12288
Mvaa 248,104,72
Maaa 208,104,80
RD 24,20,14336
Maaa 208,108,84
Maaa 212,108,92
RD 28,21,14336
Maaa 212,104,88
Mvaa 136,112,64
RT 32,22,16384
Mvaa 136,116,68
buffer_load_dwordx4 v18, s[12:15], s29 offen offset:2048 lds
Mvaa 140,116,76
RT 34,22,18432
Mvaa 140,112,72
Mvaa 56,112,80
RT 36,22,17408
Mvaa 56,116,84
Mvaa 60,116,92
RT 38,22,19456
Mvaa 60,112,88
Mvaa 244,120,64
RT 40,23,16384
Mvaa 244,124,68
buffer_load_dwordx4 v19, s[12:15], s29 offen offset:3072 lds
Mvaa 240,124,76
RT 42,23,18432
Mvaa 240,120,72
Maaa 216,120,80
RT 44,23,17408
Maaa 216,124,84
Maaa 220,124,92
RT 46,23,19456
Maaa 220,120,88
s_add_u32 s76, s30, 1152
s_and_b32 s76, s76, 133119
s_waitcnt lgkmcnt(8)
Mvaa 144,0,64
s_add_u32 m0, s33, 131072
RT 48,24,16384
Mvaa 144,4,68
buffer_load_dwordx4 v12, s[8:11], s76 offen offset:0 lds
Mvaa 148,4,76
RT 50,24,18432
Mvaa 148,0,72
Mvaa 80,0,80
RT 52,24,17408
Mvaa 80,4,84
Mvaa 84,4,92
RT 54,24,19456
Mvaa 84,0,88
Maaa 224,8,64
RT 56,25,16384
Maaa 224,12,68
buffer_load_dwordx4 v13, s[8:11], s76 offen offset:1024 lds
Maaa 228,12,76
RT 58,25,18432
Maaa 228,8,72
Maaa 232,8,80
RT 60,25,17408
Maaa 232,12,84
Maaa 236,12,92
RT 62,25,19456
Maaa 236,8,88
Mvaa 152,16,64
v_add_u32 v20, -131072, v20
v_add_u32 v21, -131072, v21
Mvaa 152,20,68
buffer_load_dwordx4 v14, s[8:11], s76 offen offset:2048 lds
Mvaa 156,20,76
v_xor_b32 v22, 0x10000, v22
v_xor_b32 v23, 0x10000, v23
Mvaa 156,16,72
Mvaa 104,16,80
v_xor_b32 v24, 0x10000, v24
v_xor_b32 v25, 0x10000, v25
Mvaa 104,20,84
Mvaa 108,20,92
s_waitcnt vmcnt(15)
Mvaa 108,16,88
s_cmp_eq_u32 s24, 0
s_cselect_b32 s77, 0x01010101, 0
Maaa 240,24,64
v_cmp_ne_u32 vcc, s77, v7
Maaa 240,28,68
buffer_load_dwordx4 v15, s[8:11], s76 offen offset:3072 lds
Maaa 244,28,76
Maaa 244,24,72
Maaa 248,24,80
s_cbranch_vccnz L_zwaitV
L_zokV:
Maaa 248,28,84
Maaa 252,28,92
Maaa 252,24,88
s_waitcnt vmcnt(23) lgkmcnt(0)
s_barrier
s_add_u32 s29, s37, 4194560
s_and_b32 s29, s29, 8388607
Mvaa 164,96,32
s_add_u32 m0, s34, 49152
RT 64,22,0
Mvaa 164,100,36
buffer_load_dwordx4 v16, s[12:15], s29 offen offset:0 lds
Mvaa 172,100,44
RT 66,22,2048
Mvaa 172,96,40
Mvaa 48,96,48
RT 68,22,1024
Mvaa 48,100,52
Mvaa 52,100,60
RT 70,22,3072
Mvaa 52,96,56
Mvaa 236,104,32
RD 96,20,0
Mvaa 236,108,36
buffer_load_dwordx4 v17, s[12:15], s29 offen offset:1024 lds
Mvaa 232,108,44
RD 100,21,0
Mvaa 232,104,40
Mvaa 228,104,48
RT 72,23,0
Mvaa 228,108,52
Mvaa 224,108,60
RT 74,23,2048
Mvaa 224,104,56
Mvaa 64,112,32
RD 104,20,2048
Mvaa 64,116,36
buffer_load_dwordx4 v18, s[12:15], s29 offen offset:2048 lds
Mvaa 68,116,44
RD 108,21,2048
Mvaa 68,112,40
Mvaa 72,112,48
RT 76,23,1024
Mvaa 72,116,52
Mvaa 76,116,60
RT 78,23,3072
Mvaa 76,112,56
Mvaa 220,120,32
RD 112,20,4096
Mvaa 220,124,36
buffer_load_dwordx4 v19, s[12:15], s29 offen offset:3072 lds
Mvaa 216,124,44
RD 116,21,4096
Mvaa 216,120,40
Mvaa 212,120,48
RT 80,24,0
Mvaa 212,124,52
Mvaa 208,124,60
RT 82,24,2048
Mvaa 208,120,56
s_add_u32 s76, s30, 132224
s_and_b32 s76, s76, 133119
Mvaa 88,0,32
s_add_u32 m0, s33, 139264
RD 120,20,6144
Mvaa 88,4,36
buffer_load_dwordx4 v12, s[8:11], s76 offen offset:0 lds
Mvaa 92,4,44
RD 124,21,6144
Mvaa 92,0,40
Mvaa 96,0,48
RT 84,24,1024
Mvaa 96,4,52
Mvaa 100,4,60
RT 86,24,3072
Mvaa 100,0,56
Mvaa 204,8,32
RT 88,25,0
Mvaa 204,12,36
buffer_load_dwordx4 v13, s[8:11], s76 offen offset:1024 lds
Mvaa 200,12,44
RT 90,25,2048
Mvaa 200,8,40
Mvaa 196,8,48
RT 92,25,1024
Mvaa 196,12,52
Mvaa 192,12,60
RT 94,25,3072
Mvaa 192,8,56
Mvaa 112,16,32
Mvaa 112,20,36
buffer_load_dwordx4 v14, s[8:11], s76 offen offset:2048 lds
Mvaa 116,20,44
Mvaa 116,16,40
Mvaa 120,16,48
Mvaa 120,20,52
Mvaa 124,20,60
Mvaa 124,16,56
Mvaa 188,24,32
Mvaa 188,28,36
buffer_load_dwordx4 v15, s[8:11], s76 offen offset:3072 lds
Mvaa 184,28,44
Mvaa 184,24,40
Mvaa 180,24,48
s_mov_b32 s78, 0
Mvaa 180,28,52
buffer_load_dwordx2 a[192:193], v6, s[56:59], s78 offen offset:0 nt
Mvaa 176,28,60
Mvaa 176,24,56
s_waitcnt vmcnt(21) lgkmcnt(0)
s_barrier
s_add_u32 s29, s37, 4718592
s_and_b32 s29, s29, 8388607
Mvaa 128,96,64
s_add_u32 m0, s34, 98304
RD 0,20,8192
Mvaa 128,100,68
buffer_load_dwordx4 v16, s[12:15], s29 offen offset:0 lds
Mvaa 132,100,76
RD 4,21,8192
Mvaa 132,96,72
Mvaa 160,96,80
s_mov_b32 s78, 0
RD 8,20,10240
Mvaa 160,100,84
buffer_load_dwordx2 a[194:195], v6, s[56:59], s78 offen offset:896 nt
Mvaa 168,100,92
RD 12,21,10240
Mvaa 168,96,88
Mvaa 252,104,64
RD 16,20,12288
Mvaa 252,108,68
buffer_load_dwordx4 v17, s[12:15], s29 offen offset:1024 lds
Mvaa 248,108,76
s_load_dwordx2 s[16:17], s[0:1], 64
RD 20,21,12288
Mvaa 248,104,72
Maaa 208,104,80
RD 24,20,14336
Maaa 208,108,84
Maaa 212,108,92
RD 28,21,14336
Maaa 212,104,88
Mvaa 136,112,64
RT 32,22,16384
Mvaa 136,116,68
buffer_load_dwordx4 v18, s[12:15], s29 offen offset:2048 lds
Mvaa 140,116,76
RT 34,22,18432
Mvaa 140,112,72
Mvaa 56,112,80
s_mov_b32 s78, 0
RT 36,22,17408
Mvaa 56,116,84
buffer_load_dwordx2 a[196:197], v6, s[56:59], s78 offen offset:1792 nt
Mvaa 60,116,92
RT 38,22,19456
Mvaa 60,112,88
Mvaa 244,120,64
RT 40,23,16384
Mvaa 244,124,68
buffer_load_dwordx4 v19, s[12:15], s29 offen offset:3072 lds
Mvaa 240,124,76
RT 42,23,18432
Mvaa 240,120,72
Maaa 216,120,80
RT 44,23,17408
Maaa 216,124,84
Maaa 220,124,92
RT 46,23,19456
Maaa 220,120,88
s_add_u32 s76, s30, 1280
s_and_b32 s76, s76, 133119
s_waitcnt lgkmcnt(8)
Mvaa 144,0,64
s_add_u32 m0, s33, 0
RT 48,24,16384
Mvaa 144,4,68
buffer_load_dwordx4 v12, s[8:11], s76 offen offset:0 lds
Mvaa 148,4,76
RT 50,24,18432
Mvaa 148,0,72
Mvaa 80,0,80
s_mov_b32 s78, 0
RT 52,24,17408
Mvaa 80,4,84
buffer_load_dwordx2 a[198:199], v6, s[56:59], s78 offen offset:2688 nt
Mvaa 84,4,92
RT 54,24,19456
Mvaa 84,0,88
Maaa 224,8,64
RT 56,25,16384
Maaa 224,12,68
buffer_load_dwordx4 v13, s[8:11], s76 offen offset:1024 lds
Maaa 228,12,76
RT 58,25,18432
Maaa 228,8,72
Maaa 232,8,80
RT 60,25,17408
Maaa 232,12,84
Maaa 236,12,92
RT 62,25,19456
Maaa 236,8,88
Mvaa 152,16,64
v_add_u32 v20, 65536, v20
v_add_u32 v21, 65536, v21
Mvaa 152,20,68
buffer_load_dwordx4 v14, s[8:11], s76 offen offset:2048 lds
Mvaa 156,20,76
v_xor_b32 v22, 0x10000, v22
v_xor_b32 v23, 0x10000, v23
Mvaa 156,16,72
Mvaa 104,16,80
s_mov_b32 s78, 14336
v_xor_b32 v24, 0x10000, v24
v_xor_b32 v25, 0x10000, v25
Mvaa 104,20,84
buffer_load_dwordx2 a[200:201], v6, s[56:59], s78 offen offset:0 nt
Mvaa 108,20,92
Mvaa 108,16,88
Maaa 240,24,64
Maaa 240,28,68
buffer_load_dwordx4 v15, s[8:11], s76 offen offset:3072 lds
Maaa 244,28,76
Maaa 244,24,72
s_mov_b32 s18, 3584
Maaa 248,24,80
Maaa 248,28,84
Maaa 252,28,92
Maaa 252,24,88
s_waitcnt vmcnt(41)
s_waitcnt vmcnt(25) lgkmcnt(0)
s_barrier
s_add_u32 s29, s37, 4718848
s_and_b32 s29, s29, 8388607
Mvaa 164,96,32
s_add_u32 m0, s34, 114688
RT 64,22,0
Mvaa 164,100,36
buffer_load_dwordx4 v16, s[12:15], s29 offen offset:0 lds
Mvaa 172,100,44
RT 66,22,2048
Mvaa 172,96,40
Mvaa 48,96,48
s_mov_b32 s78, 14336
RT 68,22,1024
Mvaa 48,100,52
buffer_load_dwordx2 a[202:203], v6, s[56:59], s78 offen offset:896 nt
Mvaa 52,100,60
RT 70,22,3072
Mvaa 52,96,56
Mvaa 236,104,32
RD 96,20,0
Mvaa 236,108,36
buffer_load_dwordx4 v17, s[12:15], s29 offen offset:1024 lds
Mvaa 232,108,44
RD 100,21,0
Mvaa 232,104,40
Mvaa 228,104,48
RT 72,23,0
Mvaa 228,108,52
Mvaa 224,108,60
RT 74,23,2048
Mvaa 224,104,56
Mvaa 64,112,32
RD 104,20,2048
Mvaa 64,116,36
s_branch LOP3
LP3:
s_setpc_b64 s[48:49]
LOP3:
buffer_load_dwordx4 v18, s[12:15], s29 offen offset:2048 lds
Mvaa 68,116,44
RD 108,21,2048
Mvaa 68,112,40
Mvaa 72,112,48
s_mov_b32 s78, 14336
RT 76,23,1024
Mvaa 72,116,52
buffer_load_dwordx2 a[204:205], v6, s[56:59], s78 offen offset:1792 nt
Mvaa 76,116,60
RT 78,23,3072
Mvaa 76,112,56
Mvaa 220,120,32
RD 112,20,4096
Mvaa 220,124,36
buffer_load_dwordx4 v19, s[12:15], s29 offen offset:3072 lds
Mvaa 216,124,44
RD 116,21,4096
Mvaa 216,120,40
Mvaa 212,120,48
RT 80,24,0
Mvaa 212,124,52
Mvaa 208,124,60
RT 82,24,2048
Mvaa 208,120,56
s_add_u32 s76, s30, 132352
s_and_b32 s76, s76, 133119
Mvaa 88,0,32
s_add_u32 m0, s33, 8192
RD 120,20,6144
Mvaa 88,4,36
buffer_load_dwordx4 v12, s[8:11], s76 offen offset:0 lds
Mvaa 92,4,44
RD 124,21,6144
Mvaa 92,0,40
Mvaa 96,0,48
s_mov_b32 s78, 14336
RT 84,24,1024
Mvaa 96,4,52
buffer_load_dwordx2 a[206:207], v6, s[56:59], s78 offen offset:2688 nt
Mvaa 100,4,60
RT 86,24,3072
Mvaa 100,0,56
Mvaa 204,8,32
RT 88,25,0
Mvaa 204,12,36
buffer_load_dwordx4 v13, s[8:11], s76 offen offset:1024 lds
Mvaa 200,12,44
RT 90,25,2048
Mvaa 200,8,40
Mvaa 196,8,48
RT 92,25,1024
Mvaa 196,12,52
Mvaa 192,12,60
RT 94,25,3072
Mvaa 192,8,56
Mvaa 112,16,32
Mvaa 112,20,36
buffer_load_dwordx4 v14, s[8:11], s76 offen offset:2048 lds
Mvaa 116,20,44
Mvaa 116,16,40
Mvaa 120,16,48
Mvaa 120,20,52
Mvaa 124,20,60
Mvaa 124,16,56
s_add_u32 s35, s35, 14684160
Mvaa 188,24,32
Mvaa 188,28,36
buffer_load_dwordx4 v15, s[8:11], s76 offen offset:3072 lds
Mvaa 184,28,44
s_lshl2_add_u32 s77, s2, s35
Mvaa 184,24,40
Mvaa 180,24,48
Mvaa 180,28,52
buffer_store_dword v9, v8, s[4:7], s77 offen sc1
Mvaa 176,28,60
Mvaa 176,24,56
s_waitcnt vmcnt(29) lgkmcnt(0)
s_barrier
s_add_u32 s29, s37, 5242880
s_and_b32 s29, s29, 8388607
Mvaa 128,96,64
s_add_u32 m0, s34, 32768
RD 0,20,8192
Mvaa 128,100,68
buffer_load_dwordx4 v16, s[12:15], s29 offen offset:0 lds
Mvaa 132,100,76
RD 4,21,8192
Mvaa 132,96,72
Mvaa 160,96,80
RD 8,20,10240
Mvaa 160,100,84
Mvaa 168,100,92
RD 12,21,10240
Mvaa 168,96,88
Mvaa 252,104,64
RD 16,20,12288
Mvaa 252,108,68
buffer_load_dwordx4 v17, s[12:15], s29 offen offset:1024 lds
Mvaa 248,108,76
RD 20,21,12288
Mvaa 248,104,72
Maaa 208,104,80
RD 24,20,14336
Maaa 208,108,84
Maaa 212,108,92
RD 28,21,14336
Maaa 212,104,88
Mvaa 136,112,64
RT 32,22,16384
Mvaa 136,116,68
buffer_load_dwordx4 v18, s[12:15], s29 offen offset:2048 lds
Mvaa 140,116,76
RT 34,22,18432
Mvaa 140,112,72
Mvaa 56,112,80
RT 36,22,17408
Mvaa 56,116,84
Mvaa 60,116,92
RT 38,22,19456
Mvaa 60,112,88
Mvaa 244,120,64
RT 40,23,16384
Mvaa 244,124,68
buffer_load_dwordx4 v19, s[12:15], s29 offen offset:3072 lds
Mvaa 240,124,76
RT 42,23,18432
Mvaa 240,120,72
Maaa 216,120,80
RT 44,23,17408
Maaa 216,124,84
Maaa 220,124,92
RT 46,23,19456
Maaa 220,120,88
s_add_u32 s76, s30, 1408
s_and_b32 s76, s76, 133119
s_waitcnt lgkmcnt(8)
Mvaa 144,0,64
s_add_u32 m0, s33, 65536
RT 48,24,16384
Mvaa 144,4,68
buffer_load_dwordx4 v12, s[8:11], s76 offen offset:0 lds
Mvaa 148,4,76
RT 50,24,18432
Mvaa 148,0,72
Mvaa 80,0,80
RT 52,24,17408
Mvaa 80,4,84
Mvaa 84,4,92
RT 54,24,19456
Mvaa 84,0,88
Maaa 224,8,64
RT 56,25,16384
Maaa 224,12,68
buffer_load_dwordx4 v13, s[8:11], s76 offen offset:1024 lds
Maaa 228,12,76
RT 58,25,18432
Maaa 228,8,72
Maaa 232,8,80
RT 60,25,17408
Maaa 232,12,84
Maaa 236,12,92
RT 62,25,19456
Maaa 236,8,88
Mvaa 152,16,64
v_add_u32 v20, 65536, v20
v_add_u32 v21, 65536, v21
Mvaa 152,20,68
buffer_load_dwordx4 v14, s[8:11], s76 offen offset:2048 lds
Mvaa 156,20,76
v_xor_b32 v22, 0x10000, v22
v_xor_b32 v23, 0x10000, v23
Mvaa 156,16,72
Mvaa 104,16,80
v_xor_b32 v24, 0x10000, v24
v_xor_b32 v25, 0x10000, v25
Mvaa 104,20,84
Mvaa 108,20,92
Mvaa 108,16,88
Maaa 240,24,64
Maaa 240,28,68
buffer_load_dwordx4 v15, s[8:11], s76 offen offset:3072 lds
Maaa 244,28,76
Maaa 244,24,72
Maaa 248,24,80
Maaa 248,28,84
Maaa 252,28,92
Maaa 252,24,88
s_waitcnt vmcnt(26) lgkmcnt(0)
s_barrier
s_add_u32 s29, s37, 5243136
s_and_b32 s29, s29, 8388607
Mvaa 164,96,32
s_add_u32 m0, s34, 49152
RT 64,22,0
Mvaa 164,100,36
buffer_load_dwordx4 v16, s[12:15], s29 offen offset:0 lds
Mvaa 172,100,44
RT 66,22,2048
Mvaa 172,96,40
Mvaa 48,96,48
RT 68,22,1024
Mvaa 48,100,52
Mvaa 52,100,60
RT 70,22,3072
Mvaa 52,96,56
Mvaa 236,104,32
RD 96,20,0
Mvaa 236,108,36
buffer_load_dwordx4 v17, s[12:15], s29 offen offset:1024 lds
Mvaa 232,108,44
RD 100,21,0
Mvaa 232,104,40
Mvaa 228,104,48
RT 72,23,0
Mvaa 228,108,52
Mvaa 224,108,60
RT 74,23,2048
Mvaa 224,104,56
Mvaa 64,112,32
RD 104,20,2048
Mvaa 64,116,36
buffer_load_dwordx4 v18, s[12:15], s29 offen offset:2048 lds
Mvaa 68,116,44
RD 108,21,2048
Mvaa 68,112,40
Mvaa 72,112,48
RT 76,23,1024
Mvaa 72,116,52
Mvaa 76,116,60
RT 78,23,3072
Mvaa 76,112,56
Mvaa 220,120,32
RD 112,20,4096
Mvaa 220,124,36
buffer_load_dwordx4 v19, s[12:15], s29 offen offset:3072 lds
Mvaa 216,124,44
RD 116,21,4096
Mvaa 216,120,40
Mvaa 212,120,48
RT 80,24,0
Mvaa 212,124,52
Mvaa 208,124,60
RT 82,24,2048
Mvaa 208,120,56
s_add_u32 s76, s30, 132480
s_and_b32 s76, s76, 133119
Mvaa 88,0,32
s_add_u32 m0, s33, 73728
RD 120,20,6144
Mvaa 88,4,36
buffer_load_dwordx4 v12, s[8:11], s76 offen offset:0 lds
Mvaa 92,4,44
RD 124,21,6144
Mvaa 92,0,40
Mvaa 96,0,48
RT 84,24,1024
Mvaa 96,4,52
Mvaa 100,4,60
RT 86,24,3072
Mvaa 100,0,56
Mvaa 204,8,32
RT 88,25,0
Mvaa 204,12,36
buffer_load_dwordx4 v13, s[8:11], s76 offen offset:1024 lds
Mvaa 200,12,44
RT 90,25,2048
Mvaa 200,8,40
Mvaa 196,8,48
RT 92,25,1024
Mvaa 196,12,52
Mvaa 192,12,60
RT 94,25,3072
Mvaa 192,8,56
Mvaa 112,16,32
Mvaa 112,20,36
buffer_load_dwordx4 v14, s[8:11], s76 offen offset:2048 lds
Mvaa 116,20,44
s_waitcnt vmcnt(19)
Mvaa 116,16,40
Mvaa 120,16,48
v_accvgpr_read_b32 v30, a192
v_accvgpr_read_b32 v31, a194
Mvaa 120,20,52
v_accvgpr_read_b32 v32, a196
v_accvgpr_read_b32 v33, a198
Mvaa 124,20,60
v_accvgpr_read_b32 v34, a200
v_accvgpr_read_b32 v35, a202
Mvaa 124,16,56
v_accvgpr_read_b32 v36, a204
v_accvgpr_read_b32 v37, a206
Mvaa 188,24,32
v_perm_b32 v38, v31, v30, s45
v_perm_b32 v39, v33, v32, s45
Mvaa 188,28,36
buffer_load_dwordx4 v15, s[8:11], s76 offen offset:3072 lds
Mvaa 184,28,44
v_perm_b32 v40, v35, v34, s45
v_perm_b32 v41, v37, v36, s45
Mvaa 184,24,40
Mvaa 180,24,48
Mvaa 180,28,52
buffer_store_dwordx4 v[38:41], v5, s[4:7], s67 offen offset:0 sc1
Mvaa 176,28,60
v_perm_b32 v42, v31, v30, s46
v_perm_b32 v43, v33, v32, s46
Mvaa 176,24,56
v_perm_b32 v44, v35, v34, s46
v_perm_b32 v45, v37, v36, s46
s_waitcnt vmcnt(23) lgkmcnt(0)
s_barrier
s_add_u32 s29, s37, 5767168
s_and_b32 s29, s29, 8388607
Mvaa 128,96,64
s_add_u32 m0, s34, 98304
RD 0,20,8192
Mvaa 128,100,68
buffer_load_dwordx4 v16, s[12:15], s29 offen offset:0 lds
Mvaa 132,100,76
RD 4,21,8192
Mvaa 132,96,72
Mvaa 160,96,80
RD 8,20,10240
Mvaa 160,100,84
buffer_store_dwordx4 v[42:45], v5, s[4:7], s67 offen offset:1024 sc1
Mvaa 168,100,92
RD 12,21,10240
Mvaa 168,96,88
v_accvgpr_read_b32 v30, a193
v_accvgpr_read_b32 v31, a195
Mvaa 252,104,64
RD 16,20,12288
v_accvgpr_read_b32 v32, a197
Mvaa 252,108,68
buffer_load_dwordx4 v17, s[12:15], s29 offen offset:1024 lds
Mvaa 248,108,76
RD 20,21,12288
v_accvgpr_read_b32 v33, a199
Mvaa 248,104,72
v_accvgpr_read_b32 v34, a201
v_accvgpr_read_b32 v35, a203
Maaa 208,104,80
RD 24,20,14336
v_accvgpr_read_b32 v36, a205
Maaa 208,108,84
v_accvgpr_read_b32 v37, a207
v_perm_b32 v38, v31, v30, s45
Maaa 212,108,92
RD 28,21,14336
v_perm_b32 v39, v33, v32, s45
Maaa 212,104,88
v_perm_b32 v40, v35, v34, s45
v_perm_b32 v41, v37, v36, s45
Mvaa 136,112,64
RT 32,22,16384
Mvaa 136,116,68
buffer_load_dwordx4 v18, s[12:15], s29 offen offset:2048 lds
Mvaa 140,116,76
RT 34,22,18432
Mvaa 140,112,72
Mvaa 56,112,80
RT 36,22,17408
Mvaa 56,116,84
buffer_store_dwordx4 v[38:41], v5, s[4:7], s67 offen offset:2048 sc1
Mvaa 60,116,92
RT 38,22,19456
v_perm_b32 v42, v31, v30, s46
Mvaa 60,112,88
v_perm_b32 v43, v33, v32, s46
v_perm_b32 v44, v35, v34, s46
Mvaa 244,120,64
RT 40,23,16384
v_perm_b32 v45, v37, v36, s46
Mvaa 244,124,68
buffer_load_dwordx4 v19, s[12:15], s29 offen offset:3072 lds
Mvaa 240,124,76
RT 42,23,18432
Mvaa 240,120,72
Maaa 216,120,80
RT 44,23,17408
Maaa 216,124,84
buffer_store_dwordx4 v[42:45], v5, s[4:7], s67 offen offset:3072 sc1
Maaa 220,124,92
RT 46,23,19456
v_add_u32 v2, s3, v5
Maaa 220,120,88
s_add_u32 s76, s30, 1536
s_and_b32 s76, s76, 133119
s_waitcnt lgkmcnt(8)
v_mov_b32 v6, v5
Mvaa 144,0,64
s_add_u32 m0, s33, 131072
RT 48,24,16384
v_lshrrev_b32 v30, 4, v1
Mvaa 144,4,68
buffer_load_dwordx4 v12, s[8:11], s76 offen offset:0 lds
Mvaa 148,4,76
RT 50,24,18432
v_lshlrev_b32 v30, 2, v30
Mvaa 148,0,72
v_and_b32 v31, 15, v1
v_sub_u32 v30, v31, v30
Mvaa 80,0,80
RT 52,24,17408
v_cmp_gt_i32 s[52:53], 0, v30
Mvaa 80,4,84
v_cmp_gt_i32 s[54:55], 1, v30
v_cmp_gt_i32 s[56:57], 2, v30
Mvaa 84,4,92
RT 54,24,19456
v_cmp_gt_i32 s[58:59], 3, v30
Mvaa 84,0,88
Maaa 224,8,64
RT 56,25,16384
Maaa 224,12,68
buffer_load_dwordx4 v13, s[8:11], s76 offen offset:1024 lds
Maaa 228,12,76
RT 58,25,18432
Maaa 228,8,72
Maaa 232,8,80
RT 60,25,17408
Maaa 232,12,84
Maaa 236,12,92
RT 62,25,19456
Maaa 236,8,88
Mvaa 152,16,64
v_add_u32 v20, -131072, v20
v_add_u32 v21, -131072, v21
Mvaa 152,20,68
buffer_load_dwordx4 v14, s[8:11], s76 offen offset:2048 lds
Mvaa 156,20,76
v_xor_b32 v22, 0x10000, v22
v_xor_b32 v23, 0x10000, v23
Mvaa 156,16,72
Mvaa 104,16,80
v_xor_b32 v24, 0x10000, v24
v_xor_b32 v25, 0x10000, v25
Mvaa 104,20,84
Mvaa 108,20,92
Mvaa 108,16,88
Maaa 240,24,64
Maaa 240,28,68
buffer_load_dwordx4 v15, s[8:11], s76 offen offset:3072 lds
Maaa 244,28,76
Maaa 244,24,72
Maaa 248,24,80
Maaa 248,28,84
Maaa 252,28,92
Maaa 252,24,88
s_waitcnt vmcnt(24) lgkmcnt(0)
s_barrier
s_add_u32 s29, s37, 5767424
s_and_b32 s29, s29, 8388607
Mvaa 164,96,32
s_add_u32 m0, s34, 114688
s_mul_i32 s79, s25, 7
RT 64,22,0
Mvaa 164,100,36
buffer_load_dwordx4 v16, s[12:15], s29 offen offset:0 lds
Mvaa 172,100,44
s_and_b32 s82, s26, 7
RT 66,22,2048
Mvaa 172,96,40
s_add_u32 s79, s79, s82
Mvaa 48,96,48
s_lshr_b32 s79, s79, 4
RT 68,22,1024
Mvaa 48,100,52
s_lshl_b32 s79, s79, 9
Mvaa 52,100,60
RT 70,22,3072
v_lshlrev_b32 v32, 3, v1
Mvaa 52,96,56
Mvaa 236,104,32
RD 96,20,0
Mvaa 236,108,36
buffer_load_dwordx4 v17, s[12:15], s29 offen offset:1024 lds
Mvaa 232,108,44
RD 100,21,0
Mvaa 232,104,40
Mvaa 228,104,48
RT 72,23,0
Mvaa 228,108,52
buffer_load_dwordx2 v[30:31], v32, s[16:19], s79 offen
Mvaa 224,108,60
RT 74,23,2048
Mvaa 224,104,56
Mvaa 64,112,32
RD 104,20,2048
Mvaa 64,116,36
buffer_load_dwordx4 v18, s[12:15], s29 offen offset:2048 lds
Mvaa 68,116,44
RD 108,21,2048
Mvaa 68,112,40
Mvaa 72,112,48
RT 76,23,1024
Mvaa 72,116,52
Mvaa 76,116,60
RT 78,23,3072
Mvaa 76,112,56
Mvaa 220,120,32
RD 112,20,4096
Mvaa 220,124,36
buffer_load_dwordx4 v19, s[12:15], s29 offen offset:3072 lds
Mvaa 216,124,44
RD 116,21,4096
Mvaa 216,120,40
Mvaa 212,120,48
RT 80,24,0
Mvaa 212,124,52
Mvaa 208,124,60
RT 82,24,2048
Mvaa 208,120,56
s_add_u32 s76, s30, 132608
s_and_b32 s76, s76, 133119
Mvaa 88,0,32
s_add_u32 m0, s33, 139264
RD 120,20,6144
Mvaa 88,4,36
buffer_load_dwordx4 v12, s[8:11], s76 offen offset:0 lds
Mvaa 92,4,44
RD 124,21,6144
s_branch LOP4
LP4:
s_setpc_b64 s[48:49]
LOP4:
Mvaa 92,0,40
Mvaa 96,0,48
RT 84,24,1024
Mvaa 96,4,52
Mvaa 100,4,60
RT 86,24,3072
Mvaa 100,0,56
Mvaa 204,8,32
RT 88,25,0
Mvaa 204,12,36
buffer_load_dwordx4 v13, s[8:11], s76 offen offset:1024 lds
Mvaa 200,12,44
RT 90,25,2048
Mvaa 200,8,40
Mvaa 196,8,48
RT 92,25,1024
Mvaa 196,12,52
Mvaa 192,12,60
RT 94,25,3072
Mvaa 192,8,56
Mvaa 112,16,32
Mvaa 112,20,36
buffer_load_dwordx4 v14, s[8:11], s76 offen offset:2048 lds
Mvaa 116,20,44
Mvaa 116,16,40
Mvaa 120,16,48
Mvaa 120,20,52
Mvaa 124,20,60
Mvaa 124,16,56
Mvaa 188,24,32
Mvaa 188,28,36
buffer_load_dwordx4 v15, s[8:11], s76 offen offset:3072 lds
Mvaa 184,28,44
Mvaa 184,24,40
Mvaa 180,24,48
Mvaa 180,28,52
Mvaa 176,28,60
Mvaa 176,24,56
s_waitcnt vmcnt(25) lgkmcnt(0)
s_barrier
s_add_u32 s29, s37, 6291456
s_and_b32 s29, s29, 8388607
Mvaa 128,96,64
s_add_u32 m0, s34, 32768
RD 0,20,8192
Mvaa 128,100,68
buffer_load_dwordx4 v16, s[12:15], s29 offen offset:0 lds
Mvaa 132,100,76
RD 4,21,8192
Mvaa 132,96,72
Mvaa 160,96,80
RD 8,20,10240
Mvaa 160,100,84
Mvaa 168,100,92
RD 12,21,10240
Mvaa 168,96,88
Mvaa 252,104,64
RD 16,20,12288
Mvaa 252,108,68
buffer_load_dwordx4 v17, s[12:15], s29 offen offset:1024 lds
Mvaa 248,108,76
RD 20,21,12288
Mvaa 248,104,72
Maaa 208,104,80
RD 24,20,14336
Maaa 208,108,84
Maaa 212,108,92
RD 28,21,14336
Maaa 212,104,88
Mvaa 136,112,64
RT 32,22,16384
Mvaa 136,116,68
buffer_load_dwordx4 v18, s[12:15], s29 offen offset:2048 lds
Mvaa 140,116,76
RT 34,22,18432
Mvaa 140,112,72
Mvaa 56,112,80
RT 36,22,17408
Mvaa 56,116,84
Mvaa 60,116,92
RT 38,22,19456
Mvaa 60,112,88
Mvaa 244,120,64
RT 40,23,16384
Mvaa 244,124,68
buffer_load_dwordx4 v19, s[12:15], s29 offen offset:3072 lds
Mvaa 240,124,76
RT 42,23,18432
Mvaa 240,120,72
Maaa 216,120,80
RT 44,23,17408
Maaa 216,124,84
Maaa 220,124,92
RT 46,23,19456
Maaa 220,120,88
s_add_u32 s76, s30, 1664
s_and_b32 s76, s76, 133119
s_waitcnt lgkmcnt(8)
Mvaa 144,0,64
s_add_u32 m0, s33, 0
RT 48,24,16384
Mvaa 144,4,68
buffer_load_dwordx4 v12, s[8:11], s76 offen offset:0 lds
Mvaa 148,4,76
RT 50,24,18432
Mvaa 148,0,72
Mvaa 80,0,80
RT 52,24,17408
Mvaa 80,4,84
Mvaa 84,4,92
RT 54,24,19456
Mvaa 84,0,88
Maaa 224,8,64
RT 56,25,16384
Maaa 224,12,68
buffer_load_dwordx4 v13, s[8:11], s76 offen offset:1024 lds
Maaa 228,12,76
RT 58,25,18432
Maaa 228,8,72
Maaa 232,8,80
RT 60,25,17408
Maaa 232,12,84
Maaa 236,12,92
RT 62,25,19456
Maaa 236,8,88
Mvaa 152,16,64
v_add_u32 v20, 65536, v20
v_add_u32 v21, 65536, v21
Mvaa 152,20,68
buffer_load_dwordx4 v14, s[8:11], s76 offen offset:2048 lds
Mvaa 156,20,76
v_xor_b32 v22, 0x10000, v22
v_xor_b32 v23, 0x10000, v23
Mvaa 156,16,72
Mvaa 104,16,80
v_xor_b32 v24, 0x10000, v24
v_xor_b32 v25, 0x10000, v25
Mvaa 104,20,84
Mvaa 108,20,92
Mvaa 108,16,88
Maaa 240,24,64
Maaa 240,28,68
buffer_load_dwordx4 v15, s[8:11], s76 offen offset:3072 lds
Maaa 244,28,76
Maaa 244,24,72
Maaa 248,24,80
Maaa 248,28,84
buffer_load_dwordx4 v[38:41], v5, s[4:7], s35 offen sc1
Maaa 252,28,92
Maaa 252,24,88
s_waitcnt vmcnt(23) lgkmcnt(0)
s_barrier
s_add_u32 s29, s37, 6291712
s_and_b32 s29, s29, 8388607
Mvaa 164,96,32
s_add_u32 m0, s34, 49152
RT 64,22,0
Mvaa 164,100,36
buffer_load_dwordx4 v16, s[12:15], s29 offen offset:0 lds
Mvaa 172,100,44
RT 66,22,2048
Mvaa 172,96,40
Mvaa 48,96,48
RT 68,22,1024
Mvaa 48,100,52
Mvaa 52,100,60
RT 70,22,3072
Mvaa 52,96,56
Mvaa 236,104,32
s_waitcnt vmcnt(16)
RD 96,20,0
Mvaa 236,108,36
buffer_load_dwordx4 v17, s[12:15], s29 offen offset:1024 lds
Mvaa 232,108,44
s_lshl2_add_u32 s79, s2, s24
RD 100,21,0
Mvaa 232,104,40
s_lshl_b32 s79, s79, 9
Mvaa 228,104,48
s_add_u32 s79, s79, 15728640
RT 72,23,0
Mvaa 228,108,52
v_lshlrev_b32 v33, 16, v30
Mvaa 224,108,60
RT 74,23,2048
v_and_b32 v34, 0xffff0000, v30
Mvaa 224,104,56
v_mul_f32 v33, 0x30800000, v33
Mvaa 64,112,32
RD 104,20,2048
v_mul_f32 v34, 0x30800000, v34
Mvaa 64,116,36
buffer_load_dwordx4 v18, s[12:15], s29 offen offset:2048 lds
Mvaa 68,116,44
RD 108,21,2048
v_cvt_pk_bf16_f32 v30, v33, v34
Mvaa 68,112,40
v_lshlrev_b32 v33, 16, v31
Mvaa 72,112,48
RT 76,23,1024
v_and_b32 v34, 0xffff0000, v31
Mvaa 72,116,52
v_mul_f32 v33, 0x30800000, v33
Mvaa 76,116,60
RT 78,23,3072
v_mul_f32 v34, 0x30800000, v34
Mvaa 76,112,56
v_cvt_pk_bf16_f32 v31, v33, v34
Mvaa 220,120,32
RD 112,20,4096
Mvaa 220,124,36
buffer_load_dwordx4 v19, s[12:15], s29 offen offset:3072 lds
Mvaa 216,124,44
RD 116,21,4096
Mvaa 216,120,40
Mvaa 212,120,48
RT 80,24,0
Mvaa 212,124,52
buffer_store_dwordx2 v[30:31], v32, s[4:7], s79 offen sc1
Mvaa 208,124,60
RT 82,24,2048
Mvaa 208,120,56
s_add_u32 s76, s30, 132736
s_and_b32 s76, s76, 133119
Mvaa 88,0,32
s_add_u32 m0, s33, 8192
RD 120,20,6144
Mvaa 88,4,36
buffer_load_dwordx4 v12, s[8:11], s76 offen offset:0 lds
Mvaa 92,4,44
RD 124,21,6144
Mvaa 92,0,40
Mvaa 96,0,48
RT 84,24,1024
Mvaa 96,4,52
Mvaa 100,4,60
RT 86,24,3072
Mvaa 100,0,56
Mvaa 204,8,32
RT 88,25,0
Mvaa 204,12,36
buffer_load_dwordx4 v13, s[8:11], s76 offen offset:1024 lds
Mvaa 200,12,44
RT 90,25,2048
Mvaa 200,8,40
Mvaa 196,8,48
RT 92,25,1024
Mvaa 196,12,52
Mvaa 192,12,60
RT 94,25,3072
Mvaa 192,8,56
Mvaa 112,16,32
Mvaa 112,20,36
buffer_load_dwordx4 v14, s[8:11], s76 offen offset:2048 lds
Mvaa 116,20,44
Mvaa 116,16,40
Mvaa 120,16,48
Mvaa 120,20,52
Mvaa 124,20,60
Mvaa 124,16,56
Mvaa 188,24,32
Mvaa 188,28,36
buffer_load_dwordx4 v15, s[8:11], s76 offen offset:3072 lds
Mvaa 184,28,44
Mvaa 184,24,40
Mvaa 180,24,48
Mvaa 180,28,52
Mvaa 176,28,60
Mvaa 176,24,56
s_waitcnt vmcnt(22) lgkmcnt(0)
s_barrier
s_add_u32 s29, s37, 6815744
s_and_b32 s29, s29, 8388607
Mvaa 128,96,64
s_add_u32 m0, s34, 98304
RD 0,20,8192
Mvaa 128,100,68
buffer_load_dwordx4 v16, s[12:15], s29 offen offset:0 lds
Mvaa 132,100,76
RD 4,21,8192
Mvaa 132,96,72
Mvaa 160,96,80
RD 8,20,10240
Mvaa 160,100,84
Mvaa 168,100,92
RD 12,21,10240
Mvaa 168,96,88
Mvaa 252,104,64
RD 16,20,12288
Mvaa 252,108,68
buffer_load_dwordx4 v17, s[12:15], s29 offen offset:1024 lds
Mvaa 248,108,76
RD 20,21,12288
Mvaa 248,104,72
Maaa 208,104,80
RD 24,20,14336
Maaa 208,108,84
Maaa 212,108,92
RD 28,21,14336
Maaa 212,104,88
Mvaa 136,112,64
RT 32,22,16384
Mvaa 136,116,68
buffer_load_dwordx4 v18, s[12:15], s29 offen offset:2048 lds
Mvaa 140,116,76
RT 34,22,18432
Mvaa 140,112,72
Mvaa 56,112,80
RT 36,22,17408
Mvaa 56,116,84
Mvaa 60,116,92
RT 38,22,19456
Mvaa 60,112,88
Mvaa 244,120,64
RT 40,23,16384
Mvaa 244,124,68
buffer_load_dwordx4 v19, s[12:15], s29 offen offset:3072 lds
Mvaa 240,124,76
RT 42,23,18432
Mvaa 240,120,72
Maaa 216,120,80
RT 44,23,17408
Maaa 216,124,84
Maaa 220,124,92
RT 46,23,19456
Maaa 220,120,88
s_add_u32 s76, s30, 1792
s_and_b32 s76, s76, 133119
s_waitcnt lgkmcnt(8)
Mvaa 144,0,64
s_add_u32 m0, s33, 65536
RT 48,24,16384
Mvaa 144,4,68
buffer_load_dwordx4 v12, s[8:11], s76 offen offset:0 lds
Mvaa 148,4,76
RT 50,24,18432
Mvaa 148,0,72
Mvaa 80,0,80
RT 52,24,17408
Mvaa 80,4,84
Mvaa 84,4,92
RT 54,24,19456
Mvaa 84,0,88
Maaa 224,8,64
RT 56,25,16384
Maaa 224,12,68
buffer_load_dwordx4 v13, s[8:11], s76 offen offset:1024 lds
Maaa 228,12,76
RT 58,25,18432
Maaa 228,8,72
Maaa 232,8,80
RT 60,25,17408
Maaa 232,12,84
Maaa 236,12,92
RT 62,25,19456
Maaa 236,8,88
Mvaa 152,16,64
v_add_u32 v20, 65536, v20
v_add_u32 v21, 65536, v21
Mvaa 152,20,68
buffer_load_dwordx4 v14, s[8:11], s76 offen offset:2048 lds
Mvaa 156,20,76
s_waitcnt vmcnt(16)
v_xor_b32 v22, 0x10000, v22
v_xor_b32 v23, 0x10000, v23
Mvaa 156,16,72
s_cmp_eq_u32 s24, 0
s_cselect_b32 s77, 1, 0
Mvaa 104,16,80
v_xor_b32 v24, 0x10000, v24
v_xor_b32 v25, 0x10000, v25
Mvaa 104,20,84
Mvaa 108,20,92
v_and_b32 v38, v38, v39
v_and_b32 v40, v40, v41
Mvaa 108,16,88
v_and_b32 v38, v38, v40
v_cmp_ne_u32 vcc, s77, v38
Maaa 240,24,64
v_lshrrev_b32 v46, 4, v1
v_lshlrev_b32 v46, 5, v46
Maaa 240,28,68
buffer_load_dwordx4 v15, s[8:11], s76 offen offset:3072 lds
Maaa 244,28,76
Maaa 244,24,72
Maaa 248,24,80
s_cbranch_vccnz L_prepwaitV
L_prepokV:
Maaa 248,28,84
Maaa 252,28,92
Maaa 252,24,88
s_waitcnt vmcnt(22) lgkmcnt(0)
s_barrier
s_add_u32 s29, s37, 6816000
s_and_b32 s29, s29, 8388607
Mvaa 164,96,32
s_add_u32 m0, s34, 114688
s_mov_b32 s84, 0x11111111
RT 64,22,0
Mvaa 164,100,36
buffer_load_dwordx4 v16, s[12:15], s29 offen offset:0 lds
Mvaa 172,100,44
s_mov_b32 s85, 0x32765432
RT 66,22,2048
Mvaa 172,96,40
s_lshl_b32 s44, s25, 3
Mvaa 48,96,48
s_add_u32 s78, s39, 0
s_and_b32 s43, s26, 7
RT 68,22,1024
Mvaa 48,100,52
buffer_load_dwordx4 a[128:131], v5, s[4:7], s78 offen sc1
Mvaa 52,100,60
s_add_u32 s44, s44, s43
RT 70,22,3072
Mvaa 52,96,56
s_lshl_b32 s44, s44, 2
Mvaa 236,104,32
s_add_u32 s44, s44, s24
RD 96,20,0
Mvaa 236,108,36
buffer_load_dwordx4 v17, s[12:15], s29 offen offset:1024 lds
Mvaa 232,108,44
s_mul_i32 s66, s44, 17408
RD 100,21,0
Mvaa 232,104,40
s_add_u32 s66, s66, 54525952
Mvaa 228,104,48
s_mul_i32 s67, s44, 19456
RT 72,23,0
Mvaa 228,108,52
s_add_u32 s67, s67, 63963136
Mvaa 224,108,60
s_lshl_b32 s72, s44, 5
RT 74,23,2048
Mvaa 224,104,56
s_add_u32 s72, s72, 14696448
Mvaa 64,112,32
s_mul_i32 s42, s24, 28672
RD 104,20,2048
Mvaa 64,116,36
buffer_load_dwordx4 v18, s[12:15], s29 offen offset:2048 lds
Mvaa 68,116,44
s_add_u32 s42, s42, 75497472
RD 108,21,2048
Mvaa 68,112,40
s_mul_i32 s44, s25, 7
Mvaa 72,112,48
s_add_u32 s78, s39, 57344
s_add_u32 s44, s44, s43
RT 76,23,1024
Mvaa 72,116,52
buffer_load_dwordx4 a[132:135], v5, s[4:7], s78 offen sc1
Mvaa 76,116,60
s_lshr_b32 s43, s44, 4
RT 78,23,3072
Mvaa 76,112,56
s_and_b32 s73, s44, 15
Mvaa 220,120,32
s_lshl2_add_u32 s79, s2, s24
RD 112,20,4096
Mvaa 220,124,36
buffer_load_dwordx4 v19, s[12:15], s29 offen offset:3072 lds
Mvaa 216,124,44
s_lshl_b32 s79, s79, 9
RD 116,21,4096
Mvaa 216,120,40
s_add_u32 s79, s79, 15728640
Mvaa 212,120,48
s_mul_i32 s68, s73, 2661376
RT 80,24,0
Mvaa 212,124,52
s_add_u32 s68, s68, s42
Mvaa 208,124,60
s_mul_i32 s44, s43, 115712
RT 82,24,2048
Mvaa 208,120,56
s_add_u32 s76, s30, 132864
s_and_b32 s76, s76, 133119
s_add_u32 s68, s68, s44
Mvaa 88,0,32
s_add_u32 m0, s33, 73728
s_add_u32 s68, s68, 1851392
RD 120,20,6144
Mvaa 88,4,36
buffer_load_dwordx4 v12, s[8:11], s76 offen offset:0 lds
Mvaa 92,4,44
s_lshl_b32 s73, s73, 9
RD 124,21,6144
Mvaa 92,0,40
s_lshl_b32 s44, s43, 2
Mvaa 96,0,48
s_add_u32 s73, s73, s44
RT 84,24,1024
Mvaa 96,4,52
s_lshl_b32 s44, s24, 7
Mvaa 100,4,60
s_add_u32 s44, s44, 14688256
RT 86,24,3072
Mvaa 100,0,56
s_add_u32 s73, s73, s44
Mvaa 204,8,32
s_add_u32 s73, s73, 64
RT 88,25,0
Mvaa 204,12,36
buffer_load_dwordx4 v13, s[8:11], s76 offen offset:1024 lds
Mvaa 200,12,44
s_lshr_b32 s43, s26, 3
RT 90,25,2048
Mvaa 200,8,40
s_mul_i32 s43, s43, 7
Mvaa 196,8,48
s_xor_b32 s43, s43, 7
RT 92,25,1024
Mvaa 196,12,52
s_xor_b32 s43, s43, s26
Mvaa 192,12,60
s_mul_i32 s69, s43, 2661376
RT 94,25,3072
Mvaa 192,8,56
s_add_u32 s69, s69, s42
Mvaa 112,16,32
s_mul_i32 s42, s25, 115712
Mvaa 112,20,36
buffer_load_dwordx4 v14, s[8:11], s76 offen offset:2048 lds
Mvaa 116,20,44
s_add_u32 s69, s69, s42
Mvaa 116,16,40
s_lshl_b32 s74, s43, 9
Mvaa 120,16,48
s_add_u32 s78, s39, 1024
s_add_u32 s74, s74, s44
Mvaa 120,20,52
buffer_load_dwordx4 a[136:139], v5, s[4:7], s78 offen sc1
Mvaa 124,20,60
s_lshl_b32 s42, s25, 2
Mvaa 124,16,56
s_add_u32 s74, s74, s42
Mvaa 188,24,32
s_lshr_b32 s43, s61, 1
Mvaa 188,28,36
s_branch LOP5
LP5:
s_setpc_b64 s[48:49]
LOP5:
buffer_load_dwordx4 v15, s[8:11], s76 offen offset:3072 lds
Mvaa 184,28,44
s_sub_u32 s43, s43, 1
Mvaa 184,24,40
s_lshl_b32 s44, s26, 2
Mvaa 180,24,48
s_add_u32 s78, s39, 58368
s_lshr_b64 s[80:81], s[84:85], s44
Mvaa 180,28,52
buffer_load_dwordx4 a[140:143], v5, s[4:7], s78 offen sc1
Mvaa 176,28,60
s_and_b32 s44, s80, 15
Mvaa 176,24,56
s_cmp_eq_u32 s60, 1
s_cselect_b32 s66, 2130706432, s66
s_waitcnt vmcnt(25) lgkmcnt(0)
s_barrier
s_add_u32 s29, s37, 7340032
s_and_b32 s29, s29, 8388607
Mvaa 128,96,64
s_add_u32 m0, s34, 32768
s_cmp_eq_u32 s60, 0
s_cselect_b32 s73, s73, 2130706432
RD 0,20,8192
Mvaa 128,100,68
buffer_load_dwordx4 v16, s[12:15], s29 offen offset:0 lds
Mvaa 132,100,76
s_cmp_eq_u32 s24, 0
s_cselect_b32 s77, 0, 0x40000000
s_cselect_b32 s38, 1, 0
s_or_b32 s72, s72, s77
RD 4,21,8192
Mvaa 132,96,72
Mvaa 160,96,80
RD 8,20,10240
Mvaa 160,100,84
Mvaa 168,100,92
RD 12,21,10240
Mvaa 168,96,88
Mvaa 252,104,64
RD 16,20,12288
Mvaa 252,108,68
buffer_load_dwordx4 v17, s[12:15], s29 offen offset:1024 lds
Mvaa 248,108,76
RD 20,21,12288
Mvaa 248,104,72
Maaa 208,104,80
RD 24,20,14336
Maaa 208,108,84
Maaa 212,108,92
RD 28,21,14336
Maaa 212,104,88
Mvaa 136,112,64
RT 32,22,16384
Mvaa 136,116,68
buffer_load_dwordx4 v18, s[12:15], s29 offen offset:2048 lds
Mvaa 140,116,76
RT 34,22,18432
Mvaa 140,112,72
Mvaa 56,112,80
s_add_u32 s78, s39, 2048
RT 36,22,17408
Mvaa 56,116,84
buffer_load_dwordx4 a[144:147], v5, s[4:7], s78 offen sc1
Mvaa 60,116,92
RT 38,22,19456
Mvaa 60,112,88
Mvaa 244,120,64
RT 40,23,16384
Mvaa 244,124,68
buffer_load_dwordx4 v19, s[12:15], s29 offen offset:3072 lds
Mvaa 240,124,76
RT 42,23,18432
Mvaa 240,120,72
Maaa 216,120,80
RT 44,23,17408
Maaa 216,124,84
Maaa 220,124,92
RT 46,23,19456
Maaa 220,120,88
s_add_u32 s76, s30, 1920
s_and_b32 s76, s76, 133119
s_waitcnt lgkmcnt(8)
Mvaa 144,0,64
s_add_u32 m0, s33, 131072
RT 48,24,16384
Mvaa 144,4,68
buffer_load_dwordx4 v12, s[8:11], s76 offen offset:0 lds
Mvaa 148,4,76
RT 50,24,18432
Mvaa 148,0,72
Mvaa 80,0,80
RT 52,24,17408
Mvaa 80,4,84
Mvaa 84,4,92
RT 54,24,19456
Mvaa 84,0,88
Maaa 224,8,64
RT 56,25,16384
Maaa 224,12,68
buffer_load_dwordx4 v13, s[8:11], s76 offen offset:1024 lds
Maaa 228,12,76
RT 58,25,18432
Maaa 228,8,72
Maaa 232,8,80
s_add_u32 s78, s39, 59392
RT 60,25,17408
Maaa 232,12,84
buffer_load_dwordx4 a[148:151], v5, s[4:7], s78 offen sc1
Maaa 236,12,92
RT 62,25,19456
Maaa 236,8,88
Mvaa 152,16,64
v_add_u32 v20, -131072, v20
v_add_u32 v21, -131072, v21
Mvaa 152,20,68
buffer_load_dwordx4 v14, s[8:11], s76 offen offset:2048 lds
Mvaa 156,20,76
v_xor_b32 v22, 0x10000, v22
v_xor_b32 v23, 0x10000, v23
Mvaa 156,16,72
Mvaa 104,16,80
v_xor_b32 v24, 0x10000, v24
v_xor_b32 v25, 0x10000, v25
Mvaa 104,20,84
Mvaa 108,20,92
Mvaa 108,16,88
Maaa 240,24,64
Maaa 240,28,68
buffer_load_dwordx4 v15, s[8:11], s76 offen offset:3072 lds
Maaa 244,28,76
Maaa 244,24,72
Maaa 248,24,80
s_add_u32 s78, s39, 3072
Maaa 248,28,84
buffer_load_dwordx4 a[152:155], v5, s[4:7], s78 offen sc1
Maaa 252,28,92
Maaa 252,24,88
s_waitcnt vmcnt(27) lgkmcnt(0)
s_barrier
s_add_u32 s29, s37, 7340288
s_and_b32 s29, s29, 8388607
Mvaa 164,96,32
s_add_u32 m0, s34, 49152
RT 64,22,0
Mvaa 164,100,36
buffer_load_dwordx4 v16, s[12:15], s29 offen offset:0 lds
Mvaa 172,100,44
RT 66,22,2048
Mvaa 172,96,40
Mvaa 48,96,48
RT 68,22,1024
Mvaa 48,100,52
Mvaa 52,100,60
RT 70,22,3072
Mvaa 52,96,56
Mvaa 236,104,32
RD 96,20,0
Mvaa 236,108,36
buffer_load_dwordx4 v17, s[12:15], s29 offen offset:1024 lds
Mvaa 232,108,44
RD 100,21,0
Mvaa 232,104,40
Mvaa 228,104,48
RT 72,23,0
Mvaa 228,108,52
Mvaa 224,108,60
RT 74,23,2048
Mvaa 224,104,56
Mvaa 64,112,32
RD 104,20,2048
Mvaa 64,116,36
buffer_load_dwordx4 v18, s[12:15], s29 offen offset:2048 lds
Mvaa 68,116,44
RD 108,21,2048
Mvaa 68,112,40
Mvaa 72,112,48
s_add_u32 s78, s39, 60416
RT 76,23,1024
Mvaa 72,116,52
buffer_load_dwordx4 a[156:159], v5, s[4:7], s78 offen sc1
Mvaa 76,116,60
RT 78,23,3072
Mvaa 76,112,56
Mvaa 220,120,32
RD 112,20,4096
Mvaa 220,124,36
buffer_load_dwordx4 v19, s[12:15], s29 offen offset:3072 lds
Mvaa 216,124,44
RD 116,21,4096
Mvaa 216,120,40
Mvaa 212,120,48
RT 80,24,0
Mvaa 212,124,52
Mvaa 208,124,60
RT 82,24,2048
Mvaa 208,120,56
s_add_u32 s76, s30, 132992
s_and_b32 s76, s76, 133119
Mvaa 88,0,32
s_add_u32 m0, s33, 139264
RD 120,20,6144
Mvaa 88,4,36
buffer_load_dwordx4 v12, s[8:11], s76 offen offset:0 lds
Mvaa 92,4,44
RD 124,21,6144
Mvaa 92,0,40
Mvaa 96,0,48
RT 84,24,1024
Mvaa 96,4,52
Mvaa 100,4,60
RT 86,24,3072
Mvaa 100,0,56
Mvaa 204,8,32
RT 88,25,0
Mvaa 204,12,36
buffer_load_dwordx4 v13, s[8:11], s76 offen offset:1024 lds
Mvaa 200,12,44
RT 90,25,2048
Mvaa 200,8,40
Mvaa 196,8,48
s_add_u32 s78, s39, 4096
RT 92,25,1024
Mvaa 196,12,52
buffer_load_dwordx4 a[160:163], v5, s[4:7], s78 offen sc1
Mvaa 192,12,60
RT 94,25,3072
Mvaa 192,8,56
Mvaa 112,16,32
Mvaa 112,20,36
buffer_load_dwordx4 v14, s[8:11], s76 offen offset:2048 lds
Mvaa 116,20,44
Mvaa 116,16,40
Mvaa 120,16,48
Mvaa 120,20,52
Mvaa 124,20,60
Mvaa 124,16,56
Mvaa 188,24,32
Mvaa 188,28,36
buffer_load_dwordx4 v15, s[8:11], s76 offen offset:3072 lds
Mvaa 184,28,44
Mvaa 184,24,40
Mvaa 180,24,48
s_add_u32 s78, s39, 61440
Mvaa 180,28,52
buffer_load_dwordx4 a[164:167], v5, s[4:7], s78 offen sc1
Mvaa 176,28,60
Mvaa 176,24,56
s_waitcnt vmcnt(28) lgkmcnt(0)
s_barrier
s_add_u32 s29, s37, 7864320
s_and_b32 s29, s29, 8388607
Mvaa 128,96,64
s_add_u32 m0, s34, 98304
RD 0,20,8192
Mvaa 128,100,68
buffer_load_dwordx4 v16, s[12:15], s29 offen offset:0 lds
Mvaa 132,100,76
RD 4,21,8192
Mvaa 132,96,72
Mvaa 160,96,80
RD 8,20,10240
Mvaa 160,100,84
buffer_load_dwordx4 v17, s[12:15], s29 offen offset:1024 lds
Mvaa 168,100,92
RD 12,21,10240
Mvaa 168,96,88
Mvaa 252,104,64
RD 16,20,12288
Mvaa 252,108,68
buffer_load_dwordx4 v18, s[12:15], s29 offen offset:2048 lds
Mvaa 248,108,76
RD 20,21,12288
Mvaa 248,104,72
Maaa 208,104,80
RD 24,20,14336
Maaa 208,108,84
buffer_load_dwordx4 v19, s[12:15], s29 offen offset:3072 lds
Maaa 212,108,92
RD 28,21,14336
Maaa 212,104,88
Mvaa 136,112,64
s_add_u32 s78, s39, 5120
RT 32,22,16384
Mvaa 136,116,68
buffer_load_dwordx4 a[168:171], v5, s[4:7], s78 offen sc1
Mvaa 140,116,76
RT 34,22,18432
Mvaa 140,112,72
Mvaa 56,112,80
RT 36,22,17408
Mvaa 56,116,84
Mvaa 60,116,92
RT 38,22,19456
Mvaa 60,112,88
Mvaa 244,120,64
RT 40,23,16384
Mvaa 244,124,68
Mvaa 240,124,76
RT 42,23,18432
Mvaa 240,120,72
Maaa 216,120,80
RT 44,23,17408
Maaa 216,124,84
Maaa 220,124,92
RT 46,23,19456
Maaa 220,120,88
s_waitcnt lgkmcnt(8)
Mvaa 144,0,64
s_add_u32 s78, s39, 62464
RT 48,24,16384
Mvaa 144,4,68
buffer_load_dwordx4 a[172:175], v5, s[4:7], s78 offen sc1
Mvaa 148,4,76
RT 50,24,18432
Mvaa 148,0,72
Mvaa 80,0,80
RT 52,24,17408
Mvaa 80,4,84
Mvaa 84,4,92
RT 54,24,19456
Mvaa 84,0,88
Maaa 224,8,64
RT 56,25,16384
Maaa 224,12,68
Maaa 228,12,76
RT 58,25,18432
Maaa 228,8,72
Maaa 232,8,80
RT 60,25,17408
Maaa 232,12,84
Maaa 236,12,92
RT 62,25,19456
Maaa 236,8,88
Mvaa 152,16,64
s_add_u32 s78, s39, 6144
v_add_u32 v20, 65536, v20
v_add_u32 v21, 65536, v21
Mvaa 152,20,68
buffer_load_dwordx4 a[176:179], v5, s[4:7], s78 offen sc1
Mvaa 156,20,76
v_xor_b32 v22, 0x10000, v22
v_xor_b32 v23, 0x10000, v23
Mvaa 156,16,72
Mvaa 104,16,80
v_xor_b32 v24, 0x10000, v24
v_xor_b32 v25, 0x10000, v25
Mvaa 104,20,84
Mvaa 108,20,92
Mvaa 108,16,88
Maaa 240,24,64
Maaa 240,28,68
Maaa 244,28,76
Maaa 244,24,72
Maaa 248,24,80
Maaa 248,28,84
Maaa 252,28,92
Maaa 252,24,88
s_waitcnt vmcnt(24) lgkmcnt(0)
s_barrier
s_add_u32 s29, s37, 7864576
s_and_b32 s29, s29, 8388607
Mvaa 164,96,32
s_add_u32 m0, s34, 114688
RT 64,22,0
Mvaa 164,100,36
buffer_load_dwordx4 v16, s[12:15], s29 offen offset:0 lds
Mvaa 172,100,44
RT 66,22,2048
Mvaa 172,96,40
Mvaa 48,96,48
RT 68,22,1024
Mvaa 48,100,52
buffer_load_dwordx4 v17, s[12:15], s29 offen offset:1024 lds
Mvaa 52,100,60
RT 70,22,3072
Mvaa 52,96,56
Mvaa 236,104,32
RD 96,20,0
Mvaa 236,108,36
buffer_load_dwordx4 v18, s[12:15], s29 offen offset:2048 lds
Mvaa 232,108,44
RD 100,21,0
Mvaa 232,104,40
Mvaa 228,104,48
RT 72,23,0
Mvaa 228,108,52
buffer_load_dwordx4 v19, s[12:15], s29 offen offset:3072 lds
Mvaa 224,108,60
RT 74,23,2048
Mvaa 224,104,56
s_add_u32 s76, s63, 0
Mvaa 64,112,32
s_add_u32 m0, s34, 0
RD 104,20,2048
Mvaa 64,116,36
buffer_load_dwordx4 v2, s[4:7], s76 offen offset:0 sc1 lds
Mvaa 68,116,44
RD 108,21,2048
Mvaa 68,112,40
Mvaa 72,112,48
RT 76,23,1024
Mvaa 72,116,52
buffer_load_dwordx4 v2, s[4:7], s76 offen offset:1024 sc1 lds
Mvaa 76,116,60
RT 78,23,3072
Mvaa 76,112,56
Mvaa 220,120,32
RD 112,20,4096
Mvaa 220,124,36
buffer_load_dwordx4 v2, s[4:7], s76 offen offset:2048 sc1 lds
Mvaa 216,124,44
RD 116,21,4096
Mvaa 216,120,40
Mvaa 212,120,48
RT 80,24,0
Mvaa 212,124,52
buffer_load_dwordx4 v2, s[4:7], s76 offen offset:3072 sc1 lds
Mvaa 208,124,60
RT 82,24,2048
Mvaa 208,120,56
s_add_u32 s29, s63, 16384
Mvaa 88,0,32
s_add_u32 m0, s34, 16384
RD 120,20,6144
Mvaa 88,4,36
buffer_load_dwordx4 v2, s[4:7], s29 offen offset:0 sc1 lds
Mvaa 92,4,44
RD 124,21,6144
Mvaa 92,0,40
Mvaa 96,0,48
RT 84,24,1024
Mvaa 96,4,52
buffer_load_dwordx4 v2, s[4:7], s29 offen offset:1024 sc1 lds
Mvaa 100,4,60
RT 86,24,3072
Mvaa 100,0,56
Mvaa 204,8,32
RT 88,25,0
Mvaa 204,12,36
buffer_load_dwordx4 v2, s[4:7], s29 offen offset:2048 sc1 lds
Mvaa 200,12,44
RT 90,25,2048
Mvaa 200,8,40
Mvaa 196,8,48
RT 92,25,1024
Mvaa 196,12,52
buffer_load_dwordx4 v2, s[4:7], s29 offen offset:3072 sc1 lds
Mvaa 192,12,60
RT 94,25,3072
Mvaa 192,8,56
Mvaa 112,16,32
s_add_u32 s78, s39, 63488
Mvaa 112,20,36
buffer_load_dwordx4 a[180:183], v5, s[4:7], s78 offen sc1
Mvaa 116,20,44
Mvaa 116,16,40
Mvaa 120,16,48
s_add_u32 s78, s39, 7168
Mvaa 120,20,52
buffer_load_dwordx4 a[184:187], v5, s[4:7], s78 offen sc1
Mvaa 124,20,60
Mvaa 124,16,56
Mvaa 188,24,32
s_add_u32 s78, s39, 64512
Mvaa 188,28,36
buffer_load_dwordx4 a[188:191], v5, s[4:7], s78 offen sc1
Mvaa 184,28,44
Mvaa 184,24,40
Mvaa 180,24,48
Mvaa 180,28,52
Mvaa 176,28,60
Mvaa 176,24,56
s_waitcnt vmcnt(63)
s_waitcnt vmcnt(28) lgkmcnt(0)
s_barrier
s_add_u32 s29, s63, 32768
Mvaa 128,96,64
s_add_u32 m0, s34, 32768
RD 0,20,8192
Mvaa 128,100,68
buffer_load_dwordx4 v2, s[4:7], s29 offen offset:0 sc1 lds
Mvaa 132,100,76
RD 4,21,8192
Mvaa 132,96,72
Mvaa 160,96,80
RD 8,20,10240
Mvaa 160,100,84
buffer_load_dwordx4 v2, s[4:7], s29 offen offset:1024 sc1 lds
Mvaa 168,100,92
RD 12,21,10240
Mvaa 168,96,88
Mvaa 252,104,64
RD 16,20,12288
Mvaa 252,108,68
buffer_load_dwordx4 v2, s[4:7], s29 offen offset:2048 sc1 lds
Mvaa 248,108,76
RD 20,21,12288
Mvaa 248,104,72
Maaa 208,104,80
RD 24,20,14336
Maaa 208,108,84
buffer_load_dwordx4 v2, s[4:7], s29 offen offset:3072 sc1 lds
Maaa 212,108,92
RD 28,21,14336
Maaa 212,104,88
Mvaa 136,112,64
s_add_u32 s78, s39, 8192
RT 32,22,16384
Mvaa 136,116,68
buffer_load_dwordx4 a[192:195], v5, s[4:7], s78 offen sc1
Mvaa 140,116,76
RT 34,22,18432
Mvaa 140,112,72
Mvaa 56,112,80
RT 36,22,17408
Mvaa 56,116,84
Mvaa 60,116,92
RT 38,22,19456
Mvaa 60,112,88
Mvaa 244,120,64
RT 40,23,16384
Mvaa 244,124,68
Mvaa 240,124,76
s_branch LOP6
LP6:
s_setpc_b64 s[48:49]
LOP6:
RT 42,23,18432
Mvaa 240,120,72
Maaa 216,120,80
s_add_u32 s78, s39, 65536
RT 44,23,17408
Maaa 216,124,84
buffer_load_dwordx4 a[196:199], v5, s[4:7], s78 offen sc1
Maaa 220,124,92
RT 46,23,19456
Maaa 220,120,88
s_waitcnt lgkmcnt(8)
Mvaa 144,0,64
RT 48,24,16384
Mvaa 144,4,68
Mvaa 148,4,76
RT 50,24,18432
Mvaa 148,0,72
Mvaa 80,0,80
RT 52,24,17408
Mvaa 80,4,84
Mvaa 84,4,92
RT 54,24,19456
Mvaa 84,0,88
Maaa 224,8,64
s_add_u32 s78, s39, 9216
RT 56,25,16384
Maaa 224,12,68
buffer_load_dwordx4 a[200:203], v5, s[4:7], s78 offen sc1
Maaa 228,12,76
RT 58,25,18432
Maaa 228,8,72
Maaa 232,8,80
RT 60,25,17408
Maaa 232,12,84
Maaa 236,12,92
RT 62,25,19456
Maaa 236,8,88
Mvaa 152,16,64
v_add_u32 v20, 65536, v20
v_add_u32 v21, 65536, v21
Mvaa 152,20,68
Mvaa 156,20,76
v_xor_b32 v22, 0x10000, v22
v_xor_b32 v23, 0x10000, v23
Mvaa 156,16,72
Mvaa 104,16,80
v_xor_b32 v24, 0x10000, v24
v_xor_b32 v25, 0x10000, v25
Mvaa 104,20,84
Mvaa 108,20,92
Mvaa 108,16,88
Maaa 240,24,64
Maaa 240,28,68
Maaa 244,28,76
Maaa 244,24,72
Maaa 248,24,80
s_add_u32 s78, s39, 66560
Maaa 248,28,84
buffer_load_dwordx4 a[204:207], v5, s[4:7], s78 offen sc1
Maaa 252,28,92
Maaa 252,24,88
s_waitcnt vmcnt(26) lgkmcnt(0)
s_barrier
s_add_u32 s29, s63, 49152
Mvaa 164,96,32
s_add_u32 m0, s34, 49152
RT 64,22,0
Mvaa 164,100,36
buffer_load_dwordx4 v2, s[4:7], s29 offen offset:0 sc1 lds
Mvaa 172,100,44
RT 66,22,2048
Mvaa 172,96,40
Mvaa 48,96,48
RT 68,22,1024
Mvaa 48,100,52
buffer_load_dwordx4 v2, s[4:7], s29 offen offset:1024 sc1 lds
Mvaa 52,100,60
RT 70,22,3072
Mvaa 52,96,56
Mvaa 236,104,32
RD 96,20,0
Mvaa 236,108,36
buffer_load_dwordx4 v2, s[4:7], s29 offen offset:2048 sc1 lds
Mvaa 232,108,44
RD 100,21,0
Mvaa 232,104,40
Mvaa 228,104,48
RT 72,23,0
Mvaa 228,108,52
buffer_load_dwordx4 v2, s[4:7], s29 offen offset:3072 sc1 lds
Mvaa 224,108,60
RT 74,23,2048
Mvaa 224,104,56
s_add_u32 s76, s63, 65536
Mvaa 64,112,32
s_add_u32 m0, s34, 65536
RD 104,20,2048
Mvaa 64,116,36
buffer_load_dwordx4 v2, s[4:7], s76 offen offset:0 sc1 lds
Mvaa 68,116,44
RD 108,21,2048
Mvaa 68,112,40
Mvaa 72,112,48
RT 76,23,1024
Mvaa 72,116,52
buffer_load_dwordx4 v2, s[4:7], s76 offen offset:1024 sc1 lds
Mvaa 76,116,60
RT 78,23,3072
Mvaa 76,112,56
Mvaa 220,120,32
RD 112,20,4096
Mvaa 220,124,36
buffer_load_dwordx4 v2, s[4:7], s76 offen offset:2048 sc1 lds
Mvaa 216,124,44
RD 116,21,4096
Mvaa 216,120,40
Mvaa 212,120,48
RT 80,24,0
Mvaa 212,124,52
buffer_load_dwordx4 v2, s[4:7], s76 offen offset:3072 sc1 lds
Mvaa 208,124,60
RT 82,24,2048
Mvaa 208,120,56
s_add_u32 s29, s63, 81920
Mvaa 88,0,32
s_add_u32 m0, s34, 81920
RD 120,20,6144
Mvaa 88,4,36
buffer_load_dwordx4 v2, s[4:7], s29 offen offset:0 sc1 lds
Mvaa 92,4,44
RD 124,21,6144
Mvaa 92,0,40
Mvaa 96,0,48
RT 84,24,1024
Mvaa 96,4,52
buffer_load_dwordx4 v2, s[4:7], s29 offen offset:1024 sc1 lds
Mvaa 100,4,60
RT 86,24,3072
Mvaa 100,0,56
Mvaa 204,8,32
RT 88,25,0
Mvaa 204,12,36
buffer_load_dwordx4 v2, s[4:7], s29 offen offset:2048 sc1 lds
Mvaa 200,12,44
RT 90,25,2048
Mvaa 200,8,40
Mvaa 196,8,48
RT 92,25,1024
Mvaa 196,12,52
buffer_load_dwordx4 v2, s[4:7], s29 offen offset:3072 sc1 lds
Mvaa 192,12,60
RT 94,25,3072
Mvaa 192,8,56
Mvaa 112,16,32
Mvaa 112,20,36
buffer_load_dwordx4 v[12:15], v46, s[4:7], s79 offen offset:0 sc1
Mvaa 116,20,44
Mvaa 116,16,40
Mvaa 120,16,48
Mvaa 120,20,52
buffer_load_dwordx4 v[16:19], v46, s[4:7], s79 offen offset:16 sc1
Mvaa 124,20,60
Mvaa 124,16,56
Mvaa 188,24,32
Mvaa 188,28,36
buffer_load_dwordx4 v[28:31], v46, s[4:7], s79 offen offset:128 sc1
Mvaa 184,28,44
Mvaa 184,24,40
Mvaa 180,24,48
Mvaa 180,28,52
buffer_load_dwordx4 v[32:35], v46, s[4:7], s79 offen offset:144 sc1
Mvaa 176,28,60
Mvaa 176,24,56
s_waitcnt vmcnt(35) lgkmcnt(0)
s_barrier
s_add_u32 s29, s63, 98304
Mvaa 128,96,64
s_add_u32 m0, s34, 98304
RD 0,20,8192
Mvaa 128,100,68
buffer_load_dwordx4 v2, s[4:7], s29 offen offset:0 sc1 lds
Mvaa 132,100,76
RD 4,21,8192
Mvaa 132,96,72
Mvaa 160,96,80
RD 8,20,10240
v_cvt_pk_bf16_f32 v128, v128, v129
Mvaa 160,100,84
buffer_load_dwordx4 v2, s[4:7], s29 offen offset:1024 sc1 lds
Mvaa 168,100,92
RD 12,21,10240
v_cvt_pk_bf16_f32 v129, v130, v131
Mvaa 168,96,88
v_cvt_pk_bf16_f32 v132, v132, v133
v_cvt_pk_bf16_f32 v133, v134, v135
Mvaa 252,104,64
RD 16,20,12288
v_cvt_pk_bf16_f32 v160, v160, v161
Mvaa 252,108,68
buffer_load_dwordx4 v2, s[4:7], s29 offen offset:2048 sc1 lds
Mvaa 248,108,76
RD 20,21,12288
v_cvt_pk_bf16_f32 v161, v162, v163
Mvaa 248,104,72
v_cvt_pk_bf16_f32 v168, v168, v169
v_cvt_pk_bf16_f32 v169, v170, v171
Maaa 208,104,80
RD 24,20,14336
v_cvt_pk_bf16_f32 v130, v252, v253
Maaa 208,108,84
buffer_load_dwordx4 v2, s[4:7], s29 offen offset:3072 sc1 lds
Maaa 212,108,92
RD 28,21,14336
v_cvt_pk_bf16_f32 v131, v254, v255
Maaa 212,104,88
v_cvt_pk_bf16_f32 v134, v248, v249
v_cvt_pk_bf16_f32 v135, v250, v251
Mvaa 136,112,64
RT 32,22,16384
v_accvgpr_read_b32 v162, a208
Mvaa 136,116,68
buffer_load_dwordx4 v[36:39], v46, s[4:7], s79 offen offset:256 sc1
Mvaa 140,116,76
RT 34,22,18432
v_accvgpr_read_b32 v163, a209
Mvaa 140,112,72
v_accvgpr_read_b32 v47, a211
v_cvt_pk_bf16_f32 v162, v162, v163
Mvaa 56,112,80
RT 36,22,17408
v_accvgpr_read_b32 v163, a210
Mvaa 56,116,84
buffer_load_dwordx4 v[40:43], v46, s[4:7], s79 offen offset:272 sc1
Mvaa 60,116,92
RT 38,22,19456
v_cvt_pk_bf16_f32 v163, v163, v47
Mvaa 60,112,88
v_accvgpr_read_b32 v170, a212
v_accvgpr_read_b32 v171, a213
Mvaa 244,120,64
s_add_u32 s78, s64, 0
RT 40,23,16384
v_accvgpr_read_b32 v47, a215
Mvaa 244,124,68
buffer_store_dwordx4 v[128:131], v5, s[4:7], s78 offen sc1
Mvaa 240,124,76
RT 42,23,18432
v_cvt_pk_bf16_f32 v170, v170, v171
Mvaa 240,120,72
v_accvgpr_read_b32 v171, a214
v_cvt_pk_bf16_f32 v171, v171, v47
Maaa 216,120,80
RT 44,23,17408
v_cvt_pk_bf16_f32 v136, v136, v137
Maaa 216,124,84
v_cvt_pk_bf16_f32 v137, v138, v139
v_cvt_pk_bf16_f32 v140, v140, v141
Maaa 220,124,92
RT 46,23,19456
v_cvt_pk_bf16_f32 v141, v142, v143
Maaa 220,120,88
s_waitcnt lgkmcnt(8)
v_cvt_pk_bf16_f32 v56, v56, v57
v_cvt_pk_bf16_f32 v57, v58, v59
Mvaa 144,0,64
s_add_u32 s78, s64, 1024
RT 48,24,16384
v_cvt_pk_bf16_f32 v60, v60, v61
Mvaa 144,4,68
buffer_store_dwordx4 v[132:135], v5, s[4:7], s78 offen sc1
Mvaa 148,4,76
RT 50,24,18432
v_cvt_pk_bf16_f32 v61, v62, v63
Mvaa 148,0,72
v_cvt_pk_bf16_f32 v138, v244, v245
v_cvt_pk_bf16_f32 v139, v246, v247
Mvaa 80,0,80
RT 52,24,17408
v_cvt_pk_bf16_f32 v142, v240, v241
Mvaa 80,4,84
v_cvt_pk_bf16_f32 v143, v242, v243
v_accvgpr_read_b32 v58, a216
Mvaa 84,4,92
RT 54,24,19456
v_accvgpr_read_b32 v59, a217
Mvaa 84,0,88
v_accvgpr_read_b32 v47, a219
v_cvt_pk_bf16_f32 v58, v58, v59
Maaa 224,8,64
s_add_u32 s78, s64, 17408
RT 56,25,16384
v_accvgpr_read_b32 v59, a218
Maaa 224,12,68
buffer_store_dwordx4 v[136:139], v5, s[4:7], s78 offen sc1
Maaa 228,12,76
RT 58,25,18432
v_cvt_pk_bf16_f32 v59, v59, v47
Maaa 228,8,72
v_accvgpr_read_b32 v62, a220
v_accvgpr_read_b32 v63, a221
Maaa 232,8,80
RT 60,25,17408
v_accvgpr_read_b32 v47, a223
Maaa 232,12,84
v_cvt_pk_bf16_f32 v62, v62, v63
v_accvgpr_read_b32 v63, a222
Maaa 236,12,92
RT 62,25,19456
v_cvt_pk_bf16_f32 v63, v63, v47
Maaa 236,8,88
v_cvt_pk_bf16_f32 v144, v144, v145
v_cvt_pk_bf16_f32 v145, v146, v147
Mvaa 152,16,64
s_add_u32 s78, s64, 18432
v_cvt_pk_bf16_f32 v148, v148, v149
v_cvt_pk_bf16_f32 v149, v150, v151
Mvaa 152,20,68
buffer_store_dwordx4 v[140:143], v5, s[4:7], s78 offen sc1
Mvaa 156,20,76
v_cvt_pk_bf16_f32 v80, v80, v81
v_cvt_pk_bf16_f32 v81, v82, v83
Mvaa 156,16,72
v_cvt_pk_bf16_f32 v84, v84, v85
v_cvt_pk_bf16_f32 v85, v86, v87
Mvaa 104,16,80
v_accvgpr_read_b32 v146, a224
v_accvgpr_read_b32 v147, a225
Mvaa 104,20,84
v_accvgpr_read_b32 v47, a227
v_cvt_pk_bf16_f32 v146, v146, v147
Mvaa 108,20,92
v_accvgpr_read_b32 v147, a226
v_cvt_pk_bf16_f32 v147, v147, v47
Mvaa 108,16,88
v_accvgpr_read_b32 v150, a228
v_accvgpr_read_b32 v151, a229
Maaa 240,24,64
s_add_u32 s78, s64, 34816
v_accvgpr_read_b32 v47, a231
v_cvt_pk_bf16_f32 v150, v150, v151
Maaa 240,28,68
buffer_store_dwordx4 v[144:147], v5, s[4:7], s78 offen sc1
Maaa 244,28,76
v_accvgpr_read_b32 v151, a230
v_cvt_pk_bf16_f32 v151, v151, v47
Maaa 244,24,72
v_accvgpr_read_b32 v82, a232
v_accvgpr_read_b32 v83, a233
Maaa 248,24,80
s_add_u32 s78, s64, 35840
v_accvgpr_read_b32 v47, a235
v_cvt_pk_bf16_f32 v82, v82, v83
Maaa 248,28,84
buffer_store_dwordx4 v[148:151], v5, s[4:7], s78 offen sc1
Maaa 252,28,92
v_accvgpr_read_b32 v83, a234
v_cvt_pk_bf16_f32 v83, v83, v47
Maaa 252,24,88
v_accvgpr_read_b32 v86, a236
v_accvgpr_read_b32 v87, a237
s_waitcnt vmcnt(39) lgkmcnt(0)
s_barrier
s_add_u32 s29, s63, 114688
Mvaa 164,96,32
s_add_u32 m0, s34, 114688
RD 64,6,0
v_accvgpr_read_b32 v47, a239
Mvaa 164,100,36
buffer_load_dwordx4 v2, s[4:7], s29 offen offset:0 sc1 lds
Mvaa 172,100,44
RD 68,6,1024
v_cvt_pk_bf16_f32 v86, v86, v87
Mvaa 172,96,40
v_accvgpr_read_b32 v87, a238
v_cvt_pk_bf16_f32 v87, v87, v47
Mvaa 48,96,48
RD 72,6,2048
v_cvt_pk_bf16_f32 v152, v152, v153
Mvaa 48,100,52
buffer_load_dwordx4 v2, s[4:7], s29 offen offset:1024 sc1 lds
Mvaa 52,100,60
RD 76,6,3072
v_cvt_pk_bf16_f32 v153, v154, v155
Mvaa 52,96,56
v_cvt_pk_bf16_f32 v156, v156, v157
v_cvt_pk_bf16_f32 v157, v158, v159
Mvaa 236,104,32
RD 80,6,4096
v_cvt_pk_bf16_f32 v104, v104, v105
Mvaa 236,108,36
buffer_load_dwordx4 v2, s[4:7], s29 offen offset:2048 sc1 lds
Mvaa 232,108,44
RD 84,6,5120
v_cvt_pk_bf16_f32 v105, v106, v107
Mvaa 232,104,40
v_cvt_pk_bf16_f32 v108, v108, v109
v_cvt_pk_bf16_f32 v109, v110, v111
Mvaa 228,104,48
RD 88,6,6144
v_accvgpr_read_b32 v154, a240
Mvaa 228,108,52
buffer_load_dwordx4 v2, s[4:7], s29 offen offset:3072 sc1 lds
Mvaa 224,108,60
RD 92,6,7168
v_accvgpr_read_b32 v155, a241
Mvaa 224,104,56
v_accvgpr_read_b32 v47, a243
v_cvt_pk_bf16_f32 v154, v154, v155
Mvaa 64,112,32
RD 96,6,8192
v_accvgpr_read_b32 v155, a242
Mvaa 64,116,36
buffer_load_dwordx4 v[20:23], v46, s[4:7], s79 offen offset:384 sc1
Mvaa 68,116,44
RD 100,6,9216
v_cvt_pk_bf16_f32 v155, v155, v47
Mvaa 68,112,40
v_accvgpr_read_b32 v158, a244
v_accvgpr_read_b32 v159, a245
Mvaa 72,112,48
RD 104,6,10240
v_accvgpr_read_b32 v47, a247
Mvaa 72,116,52
buffer_load_dwordx4 v[24:27], v46, s[4:7], s79 offen offset:400 sc1
Mvaa 76,116,60
RD 108,6,11264
v_cvt_pk_bf16_f32 v158, v158, v159
Mvaa 76,112,56
v_accvgpr_read_b32 v159, a246
v_cvt_pk_bf16_f32 v159, v159, v47
Mvaa 220,120,32
s_add_u32 s78, s64, 52224
v_accvgpr_read_b32 v106, a248
v_accvgpr_read_b32 v107, a249
Mvaa 220,124,36
buffer_store_dwordx4 v[152:155], v5, s[4:7], s78 offen sc1
Mvaa 216,124,44
v_accvgpr_read_b32 v47, a251
v_cvt_pk_bf16_f32 v106, v106, v107
Mvaa 216,120,40
v_accvgpr_read_b32 v107, a250
v_cvt_pk_bf16_f32 v107, v107, v47
Mvaa 212,120,48
v_accvgpr_read_b32 v110, a252
v_accvgpr_read_b32 v111, a253
Mvaa 212,124,52
v_accvgpr_read_b32 v47, a255
v_cvt_pk_bf16_f32 v110, v110, v111
Mvaa 208,124,60
s_mov_b32 s29, 4
v_accvgpr_read_b32 v111, a254
v_cvt_pk_bf16_f32 v111, v111, v47
Mvaa 208,120,56
s_add_u32 s30, s3, 131072
v_cvt_pk_bf16_f32 v164, v164, v165
v_cvt_pk_bf16_f32 v165, v166, v167
Mvaa 88,0,32
s_add_u32 s78, s64, 53248
s_add_u32 s32, s63, 131072
v_cvt_pk_bf16_f32 v172, v172, v173
Mvaa 88,4,36
buffer_store_dwordx4 v[156:159], v5, s[4:7], s78 offen sc1
Mvaa 92,4,44
s_mov_b32 s36, -131072
v_cvt_pk_bf16_f32 v173, v174, v175
v_cvt_pk_bf16_f32 v48, v48, v49
Mvaa 92,0,40
s_mov_b32 s33, -131072
v_cvt_pk_bf16_f32 v49, v50, v51
v_cvt_pk_bf16_f32 v52, v52, v53
Mvaa 96,0,48
s_mov_b32 s34, 32768
v_cvt_pk_bf16_f32 v53, v54, v55
v_cvt_pk_bf16_f32 v166, v236, v237
Mvaa 96,4,52
s_mov_b32 m0, s30
v_cvt_pk_bf16_f32 v167, v238, v239
v_cvt_pk_bf16_f32 v174, v232, v233
Mvaa 100,4,60
v_cvt_pk_bf16_f32 v175, v234, v235
v_cvt_pk_bf16_f32 v50, v228, v229
Mvaa 100,0,56
v_cvt_pk_bf16_f32 v51, v230, v231
v_cvt_pk_bf16_f32 v54, v224, v225
Mvaa 204,8,32
s_add_u32 s78, s64, 2048
v_cvt_pk_bf16_f32 v55, v226, v227
v_cvt_pk_bf16_f32 v64, v64, v65
Mvaa 204,12,36
buffer_store_dwordx4 v[160:163], v5, s[4:7], s78 offen sc1
Mvaa 200,12,44
v_cvt_pk_bf16_f32 v65, v66, v67
v_cvt_pk_bf16_f32 v68, v68, v69
Mvaa 200,8,40
v_cvt_pk_bf16_f32 v69, v70, v71
v_cvt_pk_bf16_f32 v72, v72, v73
Mvaa 196,8,48
v_cvt_pk_bf16_f32 v73, v74, v75
v_cvt_pk_bf16_f32 v76, v76, v77
Mvaa 196,12,52
v_cvt_pk_bf16_f32 v77, v78, v79
v_cvt_pk_bf16_f32 v66, v220, v221
Mvaa 192,12,60
v_cvt_pk_bf16_f32 v67, v222, v223
v_cvt_pk_bf16_f32 v70, v216, v217
Mvaa 192,8,56
v_cvt_pk_bf16_f32 v71, v218, v219
v_cvt_pk_bf16_f32 v74, v212, v213
Mvaa 112,16,32
s_add_u32 s78, s65, 0
v_cvt_pk_bf16_f32 v75, v214, v215
v_cvt_pk_bf16_f32 v78, v208, v209
Mvaa 112,20,36
buffer_store_dwordx4 v[164:167], v5, s[4:7], s78 offen sc1
Mvaa 116,20,44
v_cvt_pk_bf16_f32 v79, v210, v211
v_cvt_pk_bf16_f32 v88, v88, v89
s_branch LOP7
LP7:
s_setpc_b64 s[48:49]
LOP7:
Mvaa 116,16,40
v_cvt_pk_bf16_f32 v89, v90, v91
v_cvt_pk_bf16_f32 v92, v92, v93
Mvaa 120,16,48
v_cvt_pk_bf16_f32 v93, v94, v95
v_cvt_pk_bf16_f32 v96, v96, v97
Mvaa 120,20,52
v_cvt_pk_bf16_f32 v97, v98, v99
v_cvt_pk_bf16_f32 v100, v100, v101
Mvaa 124,20,60
v_cvt_pk_bf16_f32 v101, v102, v103
v_cvt_pk_bf16_f32 v90, v204, v205
Mvaa 124,16,56
v_cvt_pk_bf16_f32 v91, v206, v207
v_cvt_pk_bf16_f32 v94, v200, v201
Mvaa 188,24,32
s_add_u32 s78, s64, 3072
v_cvt_pk_bf16_f32 v95, v202, v203
v_cvt_pk_bf16_f32 v98, v196, v197
Mvaa 188,28,36
buffer_store_dwordx4 v[168:171], v5, s[4:7], s78 offen sc1
Mvaa 184,28,44
v_cvt_pk_bf16_f32 v99, v198, v199
v_cvt_pk_bf16_f32 v102, v192, v193
Mvaa 184,24,40
v_cvt_pk_bf16_f32 v103, v194, v195
v_cvt_pk_bf16_f32 v112, v112, v113
Mvaa 180,24,48
s_add_u32 s78, s65, 1024
v_cvt_pk_bf16_f32 v113, v114, v115
v_cvt_pk_bf16_f32 v116, v116, v117
Mvaa 180,28,52
buffer_store_dwordx4 v[172:175], v5, s[4:7], s78 offen sc1
Mvaa 176,28,60
v_cvt_pk_bf16_f32 v117, v118, v119
v_cvt_pk_bf16_f32 v120, v120, v121
Mvaa 176,24,56
v_cvt_pk_bf16_f32 v121, v122, v123
v_cvt_pk_bf16_f32 v124, v124, v125
s_nop 7
v_cvt_pk_bf16_f32 v125, v126, v127
v_cvt_pk_bf16_f32 v114, v188, v189
v_cvt_pk_bf16_f32 v115, v190, v191
v_cvt_pk_bf16_f32 v118, v184, v185
v_cvt_pk_bf16_f32 v119, v186, v187
v_cvt_pk_bf16_f32 v122, v180, v181
v_cvt_pk_bf16_f32 v123, v182, v183
v_cvt_pk_bf16_f32 v126, v176, v177
v_cvt_pk_bf16_f32 v127, v178, v179
s_waitcnt vmcnt(18) lgkmcnt(8)
s_cmp_eq_u32 s60, 0
s_cbranch_scc0 L_P1B
s_branch L_P1A
L_zwaitV:
s_mov_b32 s80, 0
L_zwait2V:
s_sleep 4
buffer_load_dword v7, v10, s[20:23], 0 offen sc1
s_add_u32 s80, s80, 1
s_waitcnt vmcnt(0)
v_cmp_ne_u32 vcc, s77, v7
s_cmp_ge_u32 s80, 0x10000
s_cbranch_scc1 L_zokV
s_nop 2
s_cbranch_vccnz L_zwait2V
s_branch L_zokV
L_prepwaitV:
s_mov_b32 s80, 0
L_prepwait2V:
s_sleep 4
buffer_load_dwordx4 v[38:41], v5, s[4:7], s35 offen sc1
s_add_u32 s80, s80, 1
s_waitcnt vmcnt(0)
v_and_b32 v38, v38, v39
v_and_b32 v40, v40, v41
v_and_b32 v38, v38, v40
v_cmp_ne_u32 vcc, s77, v38
s_cmp_ge_u32 s80, 0x10000
s_cbranch_scc1 L_prepokV
s_nop 2
s_cbranch_vccnz L_prepwait2V
s_branch L_prepokV
L_cold:
L_e15:
s_add_u32 s78, s65, 34816
buffer_store_dwordx4 v[88:91], v5, s[4:7], s78 offen sc1
s_add_u32 s78, s65, 35840
buffer_store_dwordx4 v[92:95], v5, s[4:7], s78 offen sc1
s_add_u32 s78, s65, 36864
buffer_store_dwordx4 v[96:99], v5, s[4:7], s78 offen sc1
s_add_u32 s78, s65, 37888
buffer_store_dwordx4 v[100:103], v5, s[4:7], s78 offen sc1
s_add_u32 s78, s64, 54272
buffer_store_dwordx4 v[104:107], v5, s[4:7], s78 offen sc1
s_add_u32 s78, s64, 55296
buffer_store_dwordx4 v[108:111], v5, s[4:7], s78 offen sc1
s_add_u32 s78, s65, 52224
buffer_store_dwordx4 v[112:115], v5, s[4:7], s78 offen sc1
s_add_u32 s78, s65, 53248
buffer_store_dwordx4 v[116:119], v5, s[4:7], s78 offen sc1
s_add_u32 s78, s65, 54272
buffer_store_dwordx4 v[120:123], v5, s[4:7], s78 offen sc1
s_add_u32 s78, s65, 55296
buffer_store_dwordx4 v[124:127], v5, s[4:7], s78 offen sc1
v_accvgpr_write_b32 a50, v34
v_accvgpr_write_b32 a51, v35
v_cvt_pk_bf16_f32 v36, v194, v202
v_cvt_pk_bf16_f32 v37, v210, v218
v_cvt_pk_bf16_f32 v38, v195, v203
v_cvt_pk_bf16_f32 v39, v211, v219
v_accvgpr_write_b32 a20, v36
v_accvgpr_write_b32 a21, v37
v_accvgpr_write_b32 a22, v38
v_accvgpr_write_b32 a23, v39
v_cvt_pk_bf16_f32 v40, v198, v206
v_cvt_pk_bf16_f32 v41, v214, v222
v_cvt_pk_bf16_f32 v42, v199, v207
v_cvt_pk_bf16_f32 v43, v215, v223
v_accvgpr_write_b32 a52, v40
v_accvgpr_write_b32 a53, v41
v_accvgpr_write_b32 a54, v42
v_accvgpr_write_b32 a55, v43
v_cvt_pk_bf16_f32 v28, v224, v232
v_cvt_pk_bf16_f32 v29, v240, v248
v_cvt_pk_bf16_f32 v30, v225, v233
v_cvt_pk_bf16_f32 v31, v241, v249
v_accvgpr_write_b32 a24, v28
v_accvgpr_write_b32 a25, v29
v_accvgpr_write_b32 a26, v30
v_accvgpr_write_b32 a27, v31
v_cvt_pk_bf16_f32 v32, v228, v236
v_cvt_pk_bf16_f32 v33, v244, v252
v_cvt_pk_bf16_f32 v34, v229, v237
v_cvt_pk_bf16_f32 v35, v245, v253
v_accvgpr_write_b32 a56, v32
v_accvgpr_write_b32 a57, v33
v_accvgpr_write_b32 a58, v34
v_accvgpr_write_b32 a59, v35
v_cvt_pk_bf16_f32 v36, v226, v234
v_cvt_pk_bf16_f32 v37, v242, v250
v_cvt_pk_bf16_f32 v38, v227, v235
v_cvt_pk_bf16_f32 v39, v243, v251
v_accvgpr_write_b32 a28, v36
v_accvgpr_write_b32 a29, v37
v_accvgpr_write_b32 a30, v38
v_accvgpr_write_b32 a31, v39
v_cvt_pk_bf16_f32 v40, v230, v238
v_cvt_pk_bf16_f32 v41, v246, v254
v_cvt_pk_bf16_f32 v42, v231, v239
v_cvt_pk_bf16_f32 v43, v247, v255
v_accvgpr_write_b32 a60, v40
v_accvgpr_write_b32 a61, v41
v_accvgpr_write_b32 a62, v42
v_accvgpr_write_b32 a63, v43
s_add_u32 m0, s30, 16384
s_nop 0
s_add_u32 s30, s30, s36
s_cmp_ge_u32 s30, 131072
s_cselect_b32 s36, s33, s34
v_add_u32 v6, s36, v6
s_nop 0
s_add_u32 s29, s29, 1
v_readlane_b32 s32, v3, s29
s_nop 4
s_mov_b32 m0, s30
s_nop 0
s_add_u32 m0, s30, 16384
s_nop 0
v_readlane_b32 s31, v4, s29
s_nop 4
s_add_u32 s30, s30, s36
s_cmp_ge_u32 s30, 131072
s_cselect_b32 s36, s33, s34
v_add_u32 v6, s36, v6
s_nop 0
s_add_u32 s29, s29, 1
v_readlane_b32 s32, v3, s29
s_nop 4
s_mov_b32 m0, s30
s_nop 0
s_add_u32 m0, s30, 16384
s_nop 0
v_readlane_b32 s31, v4, s29
s_nop 4
s_add_u32 s30, s30, s36
s_cmp_ge_u32 s30, 131072
s_cselect_b32 s36, s33, s34
v_add_u32 v6, s36, v6
s_nop 0
s_add_u32 s29, s29, 1
v_readlane_b32 s32, v3, s29
s_nop 4
s_mov_b32 m0, s30
s_nop 0
s_waitcnt vmcnt(10)
v_cmp_ne_u32 s[80:81], s38, v7
s_nop 4
s_cmp_lg_u64 s[80:81], 0
s_cbranch_scc1 L_pw_kvbx
L_po_kvbx:
s_barrier
v_min_u32 v10, 1, v1
s_nop 0
v_lshlrev_b32 v10, 2, v10
s_nop 0
buffer_load_dwordx4 v2, s[4:7], s32 offen offset:0 sc1 lds
v_add_u32 v10, 128, v10
s_nop 0
buffer_load_dwordx4 v2, s[4:7], s32 offen offset:1024 sc1 lds
buffer_load_dwordx4 v2, s[4:7], s32 offen offset:2048 sc1 lds
buffer_load_dwordx4 v2, s[4:7], s32 offen offset:3072 sc1 lds
s_add_u32 m0, s30, 16384
s_nop 0
v_readlane_b32 s31, v4, s29
s_nop 4
s_add_u32 s30, s30, s36
s_cmp_ge_u32 s30, 131072
buffer_load_dwordx4 v2, s[4:7], s31 offen offset:0 sc1 lds
s_cselect_b32 s36, s33, s34
v_add_u32 v6, s36, v6
s_nop 0
s_add_u32 s29, s29, 1
buffer_load_dwordx4 v2, s[4:7], s31 offen offset:1024 sc1 lds
buffer_load_dwordx4 v2, s[4:7], s31 offen offset:2048 sc1 lds
v_readlane_b32 s32, v3, s29
s_nop 4
buffer_load_dwordx4 v2, s[4:7], s31 offen offset:3072 sc1 lds
s_mov_b32 m0, s30
s_nop 0
buffer_load_dwordx4 v2, s[4:7], s32 offen offset:0 sc1 lds
buffer_load_dwordx4 v2, s[4:7], s32 offen offset:1024 sc1 lds
buffer_load_dwordx4 v2, s[4:7], s32 offen offset:2048 sc1 lds
buffer_load_dwordx4 v2, s[4:7], s32 offen offset:3072 sc1 lds
s_add_u32 m0, s30, 16384
s_nop 0
v_readlane_b32 s31, v4, s29
s_nop 4
s_add_u32 s30, s30, s36
s_cmp_ge_u32 s30, 131072
buffer_load_dwordx4 v2, s[4:7], s31 offen offset:0 sc1 lds
s_cselect_b32 s36, s33, s34
v_add_u32 v6, s36, v6
s_nop 0
s_add_u32 s29, s29, 1
buffer_load_dwordx4 v2, s[4:7], s31 offen offset:1024 sc1 lds
buffer_load_dwordx4 v2, s[4:7], s31 offen offset:2048 sc1 lds
v_readlane_b32 s32, v3, s29
s_nop 4
buffer_load_dwordx4 v2, s[4:7], s31 offen offset:3072 sc1 lds
s_mov_b32 m0, s30
s_nop 0
s_waitcnt vmcnt(16)
s_barrier
buffer_store_dword v9, v8, s[4:7], s70 offen sc1
v_min_u32 v63, 6, v1
s_nop 0
buffer_load_dwordx4 v2, s[4:7], s32 offen offset:0 sc1 lds
v_lshl_add_u32 v63, v63, 2, 64
s_nop 0
v_lshrrev_b32 v61, 4, v1
s_nop 0
v_mul_u32_u24 v61, 115456, v61
s_nop 0
v_add_u32 v61, v61, v5
s_nop 0
v_cmp_gt_u32 s[80:81], 48, v1
s_nop 4
s_lshr_b32 s65, s2, 2
buffer_load_dwordx4 v2, s[4:7], s32 offen offset:1024 sc1 lds
v_cndmask_b32 v62, v8, v61, s[80:81]
s_nop 0
s_lshl_b32 s65, s65, 7
s_add_u32 s65, s65, 14688256
s_lshr_b32 s80, s2, 4
s_mul_i32 s64, s80, 2661376
s_bfe_u32 s80, s2, 0x20002
s_mul_i32 s81, s80, 28672
buffer_load_dwordx4 v2, s[4:7], s32 offen offset:2048 sc1 lds
s_add_u32 s64, s64, s81
s_and_b32 s80, s80, 2
s_xor_b32 s80, s80, s2
s_and_b32 s80, s80, 3
s_lshl2_add_u32 s80, s24, s80
s_lshl_b32 s81, s80, 11
s_add_u32 s64, s64, s81
buffer_load_dwordx4 v2, s[4:7], s32 offen offset:3072 sc1 lds
s_add_u32 s64, s64, 77348864
s_add_u32 m0, s30, 16384
s_nop 0
v_readlane_b32 s31, v4, s29
s_nop 4
s_cmp_lt_u32 s80, 14
s_cselect_b32 s64, s64, 2130706432
s_cmp_lt_u32 s60, 2
s_cselect_b32 s42, 2, s24
s_add_u32 s30, s30, s36
s_cmp_lt_u32 s42, 2
s_cselect_b32 s42, 2, 64
s_sub_u32 s41, s42, 1
s_cmp_ge_u32 s30, 131072
buffer_load_dwordx4 v2, s[4:7], s31 offen offset:0 sc1 lds
s_cselect_b32 s36, s33, s34
v_add_u32 v6, s36, v6
s_nop 0
s_add_u32 s29, s29, 1
buffer_load_dwordx4 v2, s[4:7], s31 offen offset:1024 sc1 lds
buffer_load_dwordx4 v2, s[4:7], s31 offen offset:2048 sc1 lds
v_readlane_b32 s32, v3, s29
s_nop 4
buffer_load_dwordx4 v2, s[4:7], s31 offen offset:3072 sc1 lds
s_and_b32 s72, s72, 0x3fffffff
s_add_u32 s72, s72, 16
s_mov_b32 m0, s30
s_nop 0
buffer_load_dwordx4 v2, s[4:7], s32 offen offset:0 sc1 lds
buffer_load_dwordx4 v2, s[4:7], s32 offen offset:1024 sc1 lds
buffer_load_dwordx4 v2, s[4:7], s32 offen offset:2048 sc1 lds
buffer_load_dwordx4 v2, s[4:7], s32 offen offset:3072 sc1 lds
s_add_u32 m0, s30, 16384
s_nop 0
v_readlane_b32 s31, v4, s29
s_nop 4
s_add_u32 s30, s30, s36
s_cmp_ge_u32 s30, 131072
buffer_load_dwordx4 v2, s[4:7], s31 offen offset:0 sc1 lds
s_cselect_b32 s36, s33, s34
s_waitcnt vmcnt(22)
s_barrier
v_add_u32 v6, s36, v6
s_nop 0
RD 64,6,0
RD 68,6,1024
s_add_u32 s29, s29, 1
RD 72,6,2048
buffer_load_dwordx4 v2, s[4:7], s31 offen offset:1024 sc1 lds
RD 76,6,3072
RD 80,6,4096
RD 84,6,5120
RD 88,6,6144
buffer_load_dwordx4 v2, s[4:7], s31 offen offset:2048 sc1 lds
RD 92,6,7168
v_readlane_b32 s32, v3, s29
s_nop 4
RD 96,6,8192
RD 100,6,9216
RD 104,6,10240
buffer_load_dwordx4 v2, s[4:7], s31 offen offset:3072 sc1 lds
RD 108,6,11264
s_mov_b32 m0, s30
s_nop 0
v_min_u32 v63, 11, v1
v_lshlrev_b32 v63, 2, v63
v_add_u32 v63, 128, v63
s_lshl_b32 s65, s25, 8
s_add_u32 s65, s65, 14680064
s_sub_u32 s44, s43, 4
s_waitcnt lgkmcnt(0)
s_branch L_e15j
L_kv3:
s_waitcnt vmcnt(9)
v_cmp_ne_u32 vcc, 1, v7
s_mov_b32 s44, 3
s_nop 3
s_cbranch_vccnz L_pw_kv3
L_po_kv3:
v_min_u32 v63, 6, v1
v_lshl_add_u32 v63, v63, 2, 64
s_lshr_b32 s65, s2, 2
s_lshl_b32 s65, s65, 7
s_add_u32 s65, s65, 14688256
s_branch L_steady0
L_pw_kvbx:
s_mov_b32 s77, 0
L_pw2_kvbx:
buffer_load_dword v7, v10, s[4:7], s71 offen sc1
s_add_u32 s77, s77, 1
s_waitcnt vmcnt(0)
v_cmp_ne_u32 s[80:81], 1, v7
s_cmp_ge_u32 s77, 0x10000
s_cbranch_scc1 L_po_kvbx
s_sleep 4
s_cmp_lg_u64 s[80:81], 0
s_cbranch_scc1 L_pw2_kvbx
s_branch L_po_kvbx
L_pw_kv3:
s_mov_b32 s77, 0
L_pw2_kv3:
buffer_load_dword v7, v63, s[4:7], s65 offen sc1
s_add_u32 s77, s77, 1
s_waitcnt vmcnt(0)
v_cmp_ne_u32 s[80:81], 1, v7
s_cmp_ge_u32 s77, 0x10000
s_cbranch_scc1 L_po_kv3
s_sleep 4
s_cmp_lg_u64 s[80:81], 0
s_cbranch_scc1 L_pw2_kv3
s_branch L_po_kv3
L_fchk_fa1:
s_call_b64 s[48:49], L_fchk
s_branch L_fok_fa1
L_dorare_pa0:
s_call_b64 s[48:49], L_rare1
s_branch L_norare_pa0
L_dorare_pa1:
s_call_b64 s[48:49], L_rare0
s_branch L_norare_pa1
L_dorare_pa2:
s_call_b64 s[48:49], L_rare1
s_branch L_norare_pa2
L_dorare_pa3:
s_call_b64 s[48:49], L_rare0
s_branch L_norare_pa3
L_dorare_pa4:
s_call_b64 s[48:49], L_rare1
s_branch L_norare_pa4
L_dorare_pa5:
s_call_b64 s[48:49], L_rare0
s_branch L_norare_pa5
L_dorare_pa6:
s_call_b64 s[48:49], L_rare1
s_branch L_norare_pa6
L_dorare_pa7:
s_call_b64 s[48:49], L_rare0
s_branch L_norare_pa7
L_dorare_pa8:
s_call_b64 s[48:49], L_rare1
s_branch L_norare_pa8
L_dorare_pa9:
s_call_b64 s[48:49], L_rare0
s_branch L_norare_pa9
L_fchk_fa2:
s_call_b64 s[48:49], L_fchk
s_branch L_fok_fa2
L_dorare_z0:
s_call_b64 s[48:49], L_rare1
s_branch L_norare_z0
L_dorare_s10:
s_call_b64 s[48:49], L_rare1
s_branch L_norare_s10
L_dorare_s00:
s_call_b64 s[48:49], L_rare0
s_branch L_norare_s00
L_dorare_gv10:
s_call_b64 s[48:49], L_rare1
s_branch L_norare_gv10
L_dorare_gv00:
s_call_b64 s[48:49], L_rare0
s_branch L_norare_gv00
L_dorare_pt1:
s_call_b64 s[48:49], L_rare1
s_branch L_norare_pt1
L_dorare_pt0:
s_call_b64 s[48:49], L_rare0
s_branch L_norare_pt0
L_dorare_ln:
s_call_b64 s[48:49], L_rare1
s_branch L_norare_ln
L_dorare_h10:
s_call_b64 s[48:49], L_rare1
s_branch L_norare_h10
L_dorare_h00:
s_call_b64 s[48:49], L_rareh0
s_branch L_norare_h00
L_dorare_lh0:
s_call_b64 s[48:49], L_rareh1
s_branch L_norare_lh0
L_fchk_fb:
s_call_b64 s[48:49], L_fchk
s_branch L_fok_fb
L_dorare_z1:
s_call_b64 s[48:49], L_rare1
s_branch L_norare_z1
L_dorare_s11:
s_call_b64 s[48:49], L_rare1
s_branch L_norare_s11
L_dorare_s01:
s_call_b64 s[48:49], L_rare0
s_branch L_norare_s01
L_dorare_gv11:
s_call_b64 s[48:49], L_rare1
s_branch L_norare_gv11
L_dorare_gv01:
s_call_b64 s[48:49], L_rare0
s_branch L_norare_gv01
L_dorare_h11:
s_call_b64 s[48:49], L_rare1
s_branch L_norare_h11
L_dorare_h01:
s_call_b64 s[48:49], L_rareh0
s_branch L_norare_h01
L_dorare_lh1:
s_call_b64 s[48:49], L_rareh1
s_branch L_norare_lh1
L_fchk:
v_mov_b32 v20, v122
v_mov_b32 v12, v20
s_nop 1
v_permlane16_swap_b32 v20, v12
s_nop 0
v_add_f32 v20, v20, v12
v_mov_b32 v12, v20
s_nop 1
v_permlane32_swap_b32 v20, v12
s_nop 0
v_add_f32 v20, v20, v12
v_subrev_u32 v20, 0x2b800000, v20
v_mov_b32 v21, v124
v_mov_b32 v12, v21
s_nop 1
v_permlane16_swap_b32 v21, v12
s_nop 0
v_add_f32 v21, v21, v12
v_mov_b32 v12, v21
s_nop 1
v_permlane32_swap_b32 v21, v12
s_nop 0
v_add_f32 v21, v21, v12
v_subrev_u32 v21, 0x2b800000, v21
v_max_u32 v20, v20, v21
v_cmp_lt_u32 vcc, 0x28000000, v20
s_nop 4
s_cbranch_vccnz L_rare0
L_fret:
s_setpc_b64 s[48:49]
L_rare0:
s_nop 7
v_max3_f32 v20, v64, v65, v66
v_max3_f32 v20, v20, v67, v72
v_max3_f32 v20, v20, v73, v74
v_max_f32 v20, v20, v75
v_mov_b32 v12, v20
s_nop 1
v_permlane16_swap_b32 v20, v12
s_nop 0
v_max_f32 v20, v20, v12
v_mov_b32 v12, v20
s_nop 1
v_permlane32_swap_b32 v20, v12
s_nop 0
v_max_f32 v20, v20, v12
v_max_f32 v20, s45, v20
v_max_f32 v22, 0, v20
v_exp_f32 v22, -v22
v_sub_f32 v112, v112, v20
v_sub_f32 v113, v113, v20
v_sub_f32 v114, v114, v20
v_sub_f32 v115, v115, v20
v_sub_f32 v64, v64, v20
v_sub_f32 v65, v65, v20
v_sub_f32 v66, v66, v20
v_sub_f32 v67, v67, v20
v_sub_f32 v72, v72, v20
v_sub_f32 v73, v73, v20
v_sub_f32 v74, v74, v20
v_sub_f32 v75, v75, v20
v_sub_f32 v80, v80, v20
v_sub_f32 v81, v81, v20
v_sub_f32 v82, v82, v20
v_sub_f32 v83, v83, v20
v_sub_f32 v88, v88, v20
v_sub_f32 v89, v89, v20
v_sub_f32 v90, v90, v20
v_sub_f32 v91, v91, v20
v_mul_f32 v120, v22, v120
v_max3_f32 v21, v68, v69, v70
v_max3_f32 v21, v21, v71, v76
v_max3_f32 v21, v21, v77, v78
v_max_f32 v21, v21, v79
v_mov_b32 v12, v21
s_nop 1
v_permlane16_swap_b32 v21, v12
s_nop 0
v_max_f32 v21, v21, v12
v_mov_b32 v12, v21
s_nop 1
v_permlane32_swap_b32 v21, v12
s_nop 0
v_max_f32 v21, v21, v12
v_max_f32 v21, s45, v21
v_max_f32 v23, 0, v21
v_exp_f32 v23, -v23
v_sub_f32 v116, v116, v21
v_sub_f32 v117, v117, v21
v_sub_f32 v118, v118, v21
v_sub_f32 v119, v119, v21
v_sub_f32 v68, v68, v21
v_sub_f32 v69, v69, v21
v_sub_f32 v70, v70, v21
v_sub_f32 v71, v71, v21
v_sub_f32 v76, v76, v21
v_sub_f32 v77, v77, v21
v_sub_f32 v78, v78, v21
v_sub_f32 v79, v79, v21
v_sub_f32 v84, v84, v21
v_sub_f32 v85, v85, v21
v_sub_f32 v86, v86, v21
v_sub_f32 v87, v87, v21
v_sub_f32 v92, v92, v21
v_sub_f32 v93, v93, v21
v_sub_f32 v94, v94, v21
v_sub_f32 v95, v95, v21
v_mul_f32 v121, v23, v121
v_exp_f32 v12, v64
v_exp_f32 v13, v65
v_exp_f32 v14, v66
v_add_f32 v122, v12, v13
v_exp_f32 v15, v67
v_cvt_pk_bf16_f32 v96, v12, v13
v_exp_f32 v16, v68
v_add_f32 v123, v14, v15
v_exp_f32 v17, v69
v_cvt_pk_bf16_f32 v97, v14, v15
v_exp_f32 v18, v70
v_add_f32 v124, v16, v17
v_exp_f32 v19, v71
v_cvt_pk_bf16_f32 v100, v16, v17
v_exp_f32 v12, v72
v_add_f32 v125, v18, v19
v_exp_f32 v13, v73
v_cvt_pk_bf16_f32 v101, v18, v19
v_exp_f32 v14, v74
v_add_f32 v122, v122, v12
v_exp_f32 v15, v75
v_add_f32 v122, v122, v13
v_cvt_pk_bf16_f32 v98, v12, v13
v_exp_f32 v16, v76
v_add_f32 v123, v123, v14
v_exp_f32 v17, v77
v_add_f32 v123, v123, v15
v_cvt_pk_bf16_f32 v99, v14, v15
v_exp_f32 v18, v78
v_add_f32 v124, v124, v16
v_exp_f32 v19, v79
v_add_f32 v124, v124, v17
v_cvt_pk_bf16_f32 v102, v16, v17
s_nop 0
v_add_f32 v125, v125, v18
v_add_f32 v125, v125, v19
v_cvt_pk_bf16_f32 v103, v18, v19
v_add_f32 v122, v122, v123
v_add_f32 v124, v124, v125
s_cmp_eq_u32 s46, 1
s_cbranch_scc1 L_rare_ret0
v_mul_f32 v128, v22, v128
v_mul_f32 v129, v22, v129
v_mul_f32 v130, v22, v130
v_mul_f32 v131, v22, v131
v_mul_f32 v132, v23, v132
v_mul_f32 v133, v23, v133
v_mul_f32 v134, v23, v134
v_mul_f32 v135, v23, v135
v_mul_f32 v136, v22, v136
v_mul_f32 v137, v22, v137
v_mul_f32 v138, v22, v138
v_mul_f32 v139, v22, v139
v_mul_f32 v140, v23, v140
v_mul_f32 v141, v23, v141
v_mul_f32 v142, v23, v142
v_mul_f32 v143, v23, v143
v_mul_f32 v144, v22, v144
v_mul_f32 v145, v22, v145
v_mul_f32 v146, v22, v146
v_mul_f32 v147, v22, v147
v_mul_f32 v148, v23, v148
v_mul_f32 v149, v23, v149
v_mul_f32 v150, v23, v150
v_mul_f32 v151, v23, v151
v_mul_f32 v152, v22, v152
v_mul_f32 v153, v22, v153
v_mul_f32 v154, v22, v154
v_mul_f32 v155, v22, v155
v_mul_f32 v156, v23, v156
v_mul_f32 v157, v23, v157
v_mul_f32 v158, v23, v158
v_mul_f32 v159, v23, v159
v_mul_f32 v160, v22, v160
v_mul_f32 v161, v22, v161
v_mul_f32 v162, v22, v162
v_mul_f32 v163, v22, v163
v_mul_f32 v164, v23, v164
v_mul_f32 v165, v23, v165
v_mul_f32 v166, v23, v166
v_mul_f32 v167, v23, v167
v_mul_f32 v168, v22, v168
v_mul_f32 v169, v22, v169
v_mul_f32 v170, v22, v170
v_mul_f32 v171, v22, v171
v_mul_f32 v172, v23, v172
v_mul_f32 v173, v23, v173
v_mul_f32 v174, v23, v174
v_mul_f32 v175, v23, v175
v_mul_f32 v176, v22, v176
v_mul_f32 v177, v22, v177
v_mul_f32 v178, v22, v178
v_mul_f32 v179, v22, v179
v_mul_f32 v180, v23, v180
v_mul_f32 v181, v23, v181
v_mul_f32 v182, v23, v182
v_mul_f32 v183, v23, v183
v_mul_f32 v184, v22, v184
v_mul_f32 v185, v22, v185
v_mul_f32 v186, v22, v186
v_mul_f32 v187, v22, v187
v_mul_f32 v188, v23, v188
v_mul_f32 v189, v23, v189
v_mul_f32 v190, v23, v190
v_mul_f32 v191, v23, v191
v_mul_f32 v192, v22, v192
v_mul_f32 v193, v22, v193
v_mul_f32 v194, v22, v194
v_mul_f32 v195, v22, v195
v_mul_f32 v196, v23, v196
v_mul_f32 v197, v23, v197
v_mul_f32 v198, v23, v198
v_mul_f32 v199, v23, v199
v_mul_f32 v200, v22, v200
v_mul_f32 v201, v22, v201
v_mul_f32 v202, v22, v202
v_mul_f32 v203, v22, v203
v_mul_f32 v204, v23, v204
v_mul_f32 v205, v23, v205
v_mul_f32 v206, v23, v206
v_mul_f32 v207, v23, v207
v_mul_f32 v208, v22, v208
v_mul_f32 v209, v22, v209
v_mul_f32 v210, v22, v210
v_mul_f32 v211, v22, v211
v_mul_f32 v212, v23, v212
v_mul_f32 v213, v23, v213
v_mul_f32 v214, v23, v214
v_mul_f32 v215, v23, v215
v_mul_f32 v216, v22, v216
v_mul_f32 v217, v22, v217
v_mul_f32 v218, v22, v218
v_mul_f32 v219, v22, v219
v_mul_f32 v220, v23, v220
v_mul_f32 v221, v23, v221
v_mul_f32 v222, v23, v222
v_mul_f32 v223, v23, v223
v_mul_f32 v224, v22, v224
v_mul_f32 v225, v22, v225
v_mul_f32 v226, v22, v226
v_mul_f32 v227, v22, v227
v_mul_f32 v228, v23, v228
v_mul_f32 v229, v23, v229
v_mul_f32 v230, v23, v230
v_mul_f32 v231, v23, v231
v_mul_f32 v232, v22, v232
v_mul_f32 v233, v22, v233
v_mul_f32 v234, v22, v234
v_mul_f32 v235, v22, v235
v_mul_f32 v236, v23, v236
v_mul_f32 v237, v23, v237
v_mul_f32 v238, v23, v238
v_mul_f32 v239, v23, v239
v_mul_f32 v240, v22, v240
v_mul_f32 v241, v22, v241
v_mul_f32 v242, v22, v242
v_mul_f32 v243, v22, v243
v_mul_f32 v244, v23, v244
v_mul_f32 v245, v23, v245
v_mul_f32 v246, v23, v246
v_mul_f32 v247, v23, v247
v_mul_f32 v248, v22, v248
v_mul_f32 v249, v22, v249
v_mul_f32 v250, v22, v250
v_mul_f32 v251, v22, v251
v_mul_f32 v252, v23, v252
v_mul_f32 v253, v23, v253
v_mul_f32 v254, v23, v254
v_mul_f32 v255, v23, v255
L_rare_ret0:
s_cmp_lg_u32 s43, s44
s_nop 0
s_setpc_b64 s[48:49]
L_rare1:
s_nop 7
v_max3_f32 v20, v80, v81, v82
v_max3_f32 v20, v20, v83, v88
v_max3_f32 v20, v20, v89, v90
v_max_f32 v20, v20, v91
v_mov_b32 v12, v20
s_nop 1
v_permlane16_swap_b32 v20, v12
s_nop 0
v_max_f32 v20, v20, v12
v_mov_b32 v12, v20
s_nop 1
v_permlane32_swap_b32 v20, v12
s_nop 0
v_max_f32 v20, v20, v12
v_max_f32 v20, s45, v20
v_max_f32 v22, 0, v20
v_exp_f32 v22, -v22
v_sub_f32 v112, v112, v20
v_sub_f32 v113, v113, v20
v_sub_f32 v114, v114, v20
v_sub_f32 v115, v115, v20
v_sub_f32 v64, v64, v20
v_sub_f32 v65, v65, v20
v_sub_f32 v66, v66, v20
v_sub_f32 v67, v67, v20
v_sub_f32 v72, v72, v20
v_sub_f32 v73, v73, v20
v_sub_f32 v74, v74, v20
v_sub_f32 v75, v75, v20
v_sub_f32 v80, v80, v20
v_sub_f32 v81, v81, v20
v_sub_f32 v82, v82, v20
v_sub_f32 v83, v83, v20
v_sub_f32 v88, v88, v20
v_sub_f32 v89, v89, v20
v_sub_f32 v90, v90, v20
v_sub_f32 v91, v91, v20
v_mul_f32 v120, v22, v120
v_max3_f32 v21, v84, v85, v86
v_max3_f32 v21, v21, v87, v92
v_max3_f32 v21, v21, v93, v94
v_max_f32 v21, v21, v95
v_mov_b32 v12, v21
s_nop 1
v_permlane16_swap_b32 v21, v12
s_nop 0
v_max_f32 v21, v21, v12
v_mov_b32 v12, v21
s_nop 1
v_permlane32_swap_b32 v21, v12
s_nop 0
v_max_f32 v21, v21, v12
v_max_f32 v21, s45, v21
v_max_f32 v23, 0, v21
v_exp_f32 v23, -v23
v_sub_f32 v116, v116, v21
v_sub_f32 v117, v117, v21
v_sub_f32 v118, v118, v21
v_sub_f32 v119, v119, v21
v_sub_f32 v68, v68, v21
v_sub_f32 v69, v69, v21
v_sub_f32 v70, v70, v21
v_sub_f32 v71, v71, v21
v_sub_f32 v76, v76, v21
v_sub_f32 v77, v77, v21
v_sub_f32 v78, v78, v21
v_sub_f32 v79, v79, v21
v_sub_f32 v84, v84, v21
v_sub_f32 v85, v85, v21
v_sub_f32 v86, v86, v21
v_sub_f32 v87, v87, v21
v_sub_f32 v92, v92, v21
v_sub_f32 v93, v93, v21
v_sub_f32 v94, v94, v21
v_sub_f32 v95, v95, v21
v_mul_f32 v121, v23, v121
v_exp_f32 v12, v80
v_exp_f32 v13, v81
v_exp_f32 v14, v82
v_add_f32 v122, v12, v13
v_exp_f32 v15, v83
v_cvt_pk_bf16_f32 v104, v12, v13
v_exp_f32 v16, v84
v_add_f32 v123, v14, v15
v_exp_f32 v17, v85
v_cvt_pk_bf16_f32 v105, v14, v15
v_exp_f32 v18, v86
v_add_f32 v124, v16, v17
v_exp_f32 v19, v87
v_cvt_pk_bf16_f32 v108, v16, v17
v_exp_f32 v12, v88
v_add_f32 v125, v18, v19
v_exp_f32 v13, v89
v_cvt_pk_bf16_f32 v109, v18, v19
v_exp_f32 v14, v90
v_add_f32 v122, v122, v12
v_exp_f32 v15, v91
v_add_f32 v122, v122, v13
v_cvt_pk_bf16_f32 v106, v12, v13
v_exp_f32 v16, v92
v_add_f32 v123, v123, v14
v_exp_f32 v17, v93
v_add_f32 v123, v123, v15
v_cvt_pk_bf16_f32 v107, v14, v15
v_exp_f32 v18, v94
v_add_f32 v124, v124, v16
v_exp_f32 v19, v95
v_add_f32 v124, v124, v17
v_cvt_pk_bf16_f32 v110, v16, v17
s_nop 0
v_add_f32 v125, v125, v18
v_add_f32 v125, v125, v19
v_cvt_pk_bf16_f32 v111, v18, v19
v_add_f32 v122, v122, v123
v_add_f32 v124, v124, v125
s_cmp_eq_u32 s46, 1
s_cbranch_scc1 L_rare_ret1
v_mul_f32 v128, v22, v128
v_mul_f32 v129, v22, v129
v_mul_f32 v130, v22, v130
v_mul_f32 v131, v22, v131
v_mul_f32 v132, v23, v132
v_mul_f32 v133, v23, v133
v_mul_f32 v134, v23, v134
v_mul_f32 v135, v23, v135
v_mul_f32 v136, v22, v136
v_mul_f32 v137, v22, v137
v_mul_f32 v138, v22, v138
v_mul_f32 v139, v22, v139
v_mul_f32 v140, v23, v140
v_mul_f32 v141, v23, v141
v_mul_f32 v142, v23, v142
v_mul_f32 v143, v23, v143
v_mul_f32 v144, v22, v144
v_mul_f32 v145, v22, v145
v_mul_f32 v146, v22, v146
v_mul_f32 v147, v22, v147
v_mul_f32 v148, v23, v148
v_mul_f32 v149, v23, v149
v_mul_f32 v150, v23, v150
v_mul_f32 v151, v23, v151
v_mul_f32 v152, v22, v152
v_mul_f32 v153, v22, v153
v_mul_f32 v154, v22, v154
v_mul_f32 v155, v22, v155
v_mul_f32 v156, v23, v156
v_mul_f32 v157, v23, v157
v_mul_f32 v158, v23, v158
v_mul_f32 v159, v23, v159
v_mul_f32 v160, v22, v160
v_mul_f32 v161, v22, v161
v_mul_f32 v162, v22, v162
v_mul_f32 v163, v22, v163
v_mul_f32 v164, v23, v164
v_mul_f32 v165, v23, v165
v_mul_f32 v166, v23, v166
v_mul_f32 v167, v23, v167
v_mul_f32 v168, v22, v168
v_mul_f32 v169, v22, v169
v_mul_f32 v170, v22, v170
v_mul_f32 v171, v22, v171
v_mul_f32 v172, v23, v172
v_mul_f32 v173, v23, v173
v_mul_f32 v174, v23, v174
v_mul_f32 v175, v23, v175
v_mul_f32 v176, v22, v176
v_mul_f32 v177, v22, v177
v_mul_f32 v178, v22, v178
v_mul_f32 v179, v22, v179
v_mul_f32 v180, v23, v180
v_mul_f32 v181, v23, v181
v_mul_f32 v182, v23, v182
v_mul_f32 v183, v23, v183
v_mul_f32 v184, v22, v184
v_mul_f32 v185, v22, v185
v_mul_f32 v186, v22, v186
v_mul_f32 v187, v22, v187
v_mul_f32 v188, v23, v188
v_mul_f32 v189, v23, v189
v_mul_f32 v190, v23, v190
v_mul_f32 v191, v23, v191
v_mul_f32 v192, v22, v192
v_mul_f32 v193, v22, v193
v_mul_f32 v194, v22, v194
v_mul_f32 v195, v22, v195
v_mul_f32 v196, v23, v196
v_mul_f32 v197, v23, v197
v_mul_f32 v198, v23, v198
v_mul_f32 v199, v23, v199
v_mul_f32 v200, v22, v200
v_mul_f32 v201, v22, v201
v_mul_f32 v202, v22, v202
v_mul_f32 v203, v22, v203
v_mul_f32 v204, v23, v204
v_mul_f32 v205, v23, v205
v_mul_f32 v206, v23, v206
v_mul_f32 v207, v23, v207
v_mul_f32 v208, v22, v208
v_mul_f32 v209, v22, v209
v_mul_f32 v210, v22, v210
v_mul_f32 v211, v22, v211
v_mul_f32 v212, v23, v212
v_mul_f32 v213, v23, v213
v_mul_f32 v214, v23, v214
v_mul_f32 v215, v23, v215
v_mul_f32 v216, v22, v216
v_mul_f32 v217, v22, v217
v_mul_f32 v218, v22, v218
v_mul_f32 v219, v22, v219
v_mul_f32 v220, v23, v220
v_mul_f32 v221, v23, v221
v_mul_f32 v222, v23, v222
v_mul_f32 v223, v23, v223
v_mul_f32 v224, v22, v224
v_mul_f32 v225, v22, v225
v_mul_f32 v226, v22, v226
v_mul_f32 v227, v22, v227
v_mul_f32 v228, v23, v228
v_mul_f32 v229, v23, v229
v_mul_f32 v230, v23, v230
v_mul_f32 v231, v23, v231
v_mul_f32 v232, v22, v232
v_mul_f32 v233, v22, v233
v_mul_f32 v234, v22, v234
v_mul_f32 v235, v22, v235
v_mul_f32 v236, v23, v236
v_mul_f32 v237, v23, v237
v_mul_f32 v238, v23, v238
v_mul_f32 v239, v23, v239
v_mul_f32 v240, v22, v240
v_mul_f32 v241, v22, v241
v_mul_f32 v242, v22, v242
v_mul_f32 v243, v22, v243
v_mul_f32 v244, v23, v244
v_mul_f32 v245, v23, v245
v_mul_f32 v246, v23, v246
v_mul_f32 v247, v23, v247
v_mul_f32 v248, v22, v248
v_mul_f32 v249, v22, v249
v_mul_f32 v250, v22, v250
v_mul_f32 v251, v22, v251
v_mul_f32 v252, v23, v252
v_mul_f32 v253, v23, v253
v_mul_f32 v254, v23, v254
v_mul_f32 v255, v23, v255
L_rare_ret1:
s_cmp_lg_u32 s43, s44
s_nop 0
s_setpc_b64 s[48:49]
L_rareh0:
s_nop 7
v_max3_f32 v21, v68, v69, v70
v_max3_f32 v21, v21, v71, v76
v_max3_f32 v21, v21, v77, v78
v_max_f32 v21, v21, v79
v_mov_b32 v12, v21
s_nop 1
v_permlane16_swap_b32 v21, v12
s_nop 0
v_max_f32 v21, v21, v12
v_mov_b32 v12, v21
s_nop 1
v_permlane32_swap_b32 v21, v12
s_nop 0
v_max_f32 v21, v21, v12
v_max_f32 v21, s45, v21
v_max_f32 v23, 0, v21
v_exp_f32 v23, -v23
v_sub_f32 v116, v116, v21
v_sub_f32 v117, v117, v21
v_sub_f32 v118, v118, v21
v_sub_f32 v119, v119, v21
v_sub_f32 v68, v68, v21
v_sub_f32 v69, v69, v21
v_sub_f32 v70, v70, v21
v_sub_f32 v71, v71, v21
v_sub_f32 v76, v76, v21
v_sub_f32 v77, v77, v21
v_sub_f32 v78, v78, v21
v_sub_f32 v79, v79, v21
v_sub_f32 v84, v84, v21
v_sub_f32 v85, v85, v21
v_sub_f32 v86, v86, v21
v_sub_f32 v87, v87, v21
v_sub_f32 v92, v92, v21
v_sub_f32 v93, v93, v21
v_sub_f32 v94, v94, v21
v_sub_f32 v95, v95, v21
v_mul_f32 v121, v23, v121
v_exp_f32 v12, v68
v_exp_f32 v13, v69
v_exp_f32 v14, v70
v_add_f32 v124, v12, v13
v_exp_f32 v15, v71
v_cvt_pk_bf16_f32 v100, v12, v13
v_exp_f32 v16, v76
v_add_f32 v125, v14, v15
v_exp_f32 v17, v77
v_cvt_pk_bf16_f32 v101, v14, v15
v_exp_f32 v18, v78
v_add_f32 v124, v124, v16
v_exp_f32 v19, v79
v_add_f32 v124, v124, v17
v_cvt_pk_bf16_f32 v102, v16, v17
s_nop 0
v_add_f32 v125, v125, v18
v_add_f32 v125, v125, v19
v_cvt_pk_bf16_f32 v103, v18, v19
v_add_f32 v124, v124, v125
s_cmp_eq_u32 s46, 1
s_cbranch_scc1 L_rare_reth0
v_mul_f32 v132, v23, v132
v_mul_f32 v133, v23, v133
v_mul_f32 v134, v23, v134
v_mul_f32 v135, v23, v135
v_mul_f32 v140, v23, v140
v_mul_f32 v141, v23, v141
v_mul_f32 v142, v23, v142
v_mul_f32 v143, v23, v143
v_mul_f32 v148, v23, v148
v_mul_f32 v149, v23, v149
v_mul_f32 v150, v23, v150
v_mul_f32 v151, v23, v151
v_mul_f32 v156, v23, v156
v_mul_f32 v157, v23, v157
v_mul_f32 v158, v23, v158
v_mul_f32 v159, v23, v159
v_mul_f32 v164, v23, v164
v_mul_f32 v165, v23, v165
v_mul_f32 v166, v23, v166
v_mul_f32 v167, v23, v167
v_mul_f32 v172, v23, v172
v_mul_f32 v173, v23, v173
v_mul_f32 v174, v23, v174
v_mul_f32 v175, v23, v175
v_mul_f32 v180, v23, v180
v_mul_f32 v181, v23, v181
v_mul_f32 v182, v23, v182
v_mul_f32 v183, v23, v183
v_mul_f32 v188, v23, v188
v_mul_f32 v189, v23, v189
v_mul_f32 v190, v23, v190
v_mul_f32 v191, v23, v191
v_mul_f32 v196, v23, v196
v_mul_f32 v197, v23, v197
v_mul_f32 v198, v23, v198
v_mul_f32 v199, v23, v199
v_mul_f32 v204, v23, v204
v_mul_f32 v205, v23, v205
v_mul_f32 v206, v23, v206
v_mul_f32 v207, v23, v207
v_mul_f32 v212, v23, v212
v_mul_f32 v213, v23, v213
v_mul_f32 v214, v23, v214
v_mul_f32 v215, v23, v215
v_mul_f32 v220, v23, v220
v_mul_f32 v221, v23, v221
v_mul_f32 v222, v23, v222
v_mul_f32 v223, v23, v223
v_mul_f32 v228, v23, v228
v_mul_f32 v229, v23, v229
v_mul_f32 v230, v23, v230
v_mul_f32 v231, v23, v231
v_mul_f32 v236, v23, v236
v_mul_f32 v237, v23, v237
v_mul_f32 v238, v23, v238
v_mul_f32 v239, v23, v239
v_mul_f32 v244, v23, v244
v_mul_f32 v245, v23, v245
v_mul_f32 v246, v23, v246
v_mul_f32 v247, v23, v247
v_mul_f32 v252, v23, v252
v_mul_f32 v253, v23, v253
v_mul_f32 v254, v23, v254
v_mul_f32 v255, v23, v255
L_rare_reth0:
s_cmp_lg_u32 s43, s44
s_nop 0
s_setpc_b64 s[48:49]
L_rareh1:
s_nop 7
v_max3_f32 v21, v84, v85, v86
v_max3_f32 v21, v21, v87, v92
v_max3_f32 v21, v21, v93, v94
v_max_f32 v21, v21, v95
v_mov_b32 v12, v21
s_nop 1
v_permlane16_swap_b32 v21, v12
s_nop 0
v_max_f32 v21, v21, v12
v_mov_b32 v12, v21
s_nop 1
v_permlane32_swap_b32 v21, v12
s_nop 0
v_max_f32 v21, v21, v12
v_max_f32 v21, s45, v21
v_max_f32 v23, 0, v21
v_exp_f32 v23, -v23
v_sub_f32 v116, v116, v21
v_sub_f32 v117, v117, v21
v_sub_f32 v118, v118, v21
v_sub_f32 v119, v119, v21
v_sub_f32 v68, v68, v21
v_sub_f32 v69, v69, v21
v_sub_f32 v70, v70, v21
v_sub_f32 v71, v71, v21
v_sub_f32 v76, v76, v21
v_sub_f32 v77, v77, v21
v_sub_f32 v78, v78, v21
v_sub_f32 v79, v79, v21
v_sub_f32 v84, v84, v21
v_sub_f32 v85, v85, v21
v_sub_f32 v86, v86, v21
v_sub_f32 v87, v87, v21
v_sub_f32 v92, v92, v21
v_sub_f32 v93, v93, v21
v_sub_f32 v94, v94, v21
v_sub_f32 v95, v95, v21
v_mul_f32 v121, v23, v121
v_exp_f32 v12, v84
v_exp_f32 v13, v85
v_exp_f32 v14, v86
v_add_f32 v124, v12, v13
v_exp_f32 v15, v87
v_cvt_pk_bf16_f32 v108, v12, v13
v_exp_f32 v16, v92
v_add_f32 v125, v14, v15
v_exp_f32 v17, v93
v_cvt_pk_bf16_f32 v109, v14, v15
v_exp_f32 v18, v94
v_add_f32 v124, v124, v16
v_exp_f32 v19, v95
v_add_f32 v124, v124, v17
v_cvt_pk_bf16_f32 v110, v16, v17
s_nop 0
v_add_f32 v125, v125, v18
v_add_f32 v125, v125, v19
v_cvt_pk_bf16_f32 v111, v18, v19
v_add_f32 v124, v124, v125
s_cmp_eq_u32 s46, 1
s_cbranch_scc1 L_rare_reth1
v_mul_f32 v132, v23, v132
v_mul_f32 v133, v23, v133
v_mul_f32 v134, v23, v134
v_mul_f32 v135, v23, v135
v_mul_f32 v140, v23, v140
v_mul_f32 v141, v23, v141
v_mul_f32 v142, v23, v142
v_mul_f32 v143, v23, v143
v_mul_f32 v148, v23, v148
v_mul_f32 v149, v23, v149
v_mul_f32 v150, v23, v150
v_mul_f32 v151, v23, v151
v_mul_f32 v156, v23, v156
v_mul_f32 v157, v23, v157
v_mul_f32 v158, v23, v158
v_mul_f32 v159, v23, v159
v_mul_f32 v164, v23, v164
v_mul_f32 v165, v23, v165
v_mul_f32 v166, v23, v166
v_mul_f32 v167, v23, v167
v_mul_f32 v172, v23, v172
v_mul_f32 v173, v23, v173
v_mul_f32 v174, v23, v174
v_mul_f32 v175, v23, v175
v_mul_f32 v180, v23, v180
v_mul_f32 v181, v23, v181
v_mul_f32 v182, v23, v182
v_mul_f32 v183, v23, v183
v_mul_f32 v188, v23, v188
v_mul_f32 v189, v23, v189
v_mul_f32 v190, v23, v190
v_mul_f32 v191, v23, v191
v_mul_f32 v196, v23, v196
v_mul_f32 v197, v23, v197
v_mul_f32 v198, v23, v198
v_mul_f32 v199, v23, v199
v_mul_f32 v204, v23, v204
v_mul_f32 v205, v23, v205
v_mul_f32 v206, v23, v206
v_mul_f32 v207, v23, v207
v_mul_f32 v212, v23, v212
v_mul_f32 v213, v23, v213
v_mul_f32 v214, v23, v214
v_mul_f32 v215, v23, v215
v_mul_f32 v220, v23, v220
v_mul_f32 v221, v23, v221
v_mul_f32 v222, v23, v222
v_mul_f32 v223, v23, v223
v_mul_f32 v228, v23, v228
v_mul_f32 v229, v23, v229
v_mul_f32 v230, v23, v230
v_mul_f32 v231, v23, v231
v_mul_f32 v236, v23, v236
v_mul_f32 v237, v23, v237
v_mul_f32 v238, v23, v238
v_mul_f32 v239, v23, v239
v_mul_f32 v244, v23, v244
v_mul_f32 v245, v23, v245
v_mul_f32 v246, v23, v246
v_mul_f32 v247, v23, v247
v_mul_f32 v252, v23, v252
v_mul_f32 v253, v23, v253
v_mul_f32 v254, v23, v254
v_mul_f32 v255, v23, v255
L_rare_reth1:
s_cmp_lg_u32 s43, s44
s_nop 0
s_setpc_b64 s[48:49]
L_slowcomb:
s_nop 7
v_min_f32 v18, v112, v56
v_sub_f32 v20, v18, v112
v_sub_f32 v22, v18, v56
v_exp_f32 v20, v20
v_exp_f32 v22, v22
s_nop 0
v_mul_f32 v120, v20, v120
v_mul_f32 v58, v22, v58
v_min_f32 v18, v116, v57
v_sub_f32 v21, v18, v116
v_sub_f32 v23, v18, v57
v_exp_f32 v21, v21
v_exp_f32 v23, v23
s_nop 0
v_mul_f32 v121, v21, v121
v_mul_f32 v59, v23, v59
v_mul_f32 v128, v20, v128
v_mul_f32 v129, v20, v129
v_mul_f32 v130, v20, v130
v_mul_f32 v131, v20, v131
v_mul_f32 v132, v21, v132
v_mul_f32 v133, v21, v133
v_mul_f32 v134, v21, v134
v_mul_f32 v135, v21, v135
v_mul_f32 v136, v20, v136
v_mul_f32 v137, v20, v137
v_mul_f32 v138, v20, v138
v_mul_f32 v139, v20, v139
v_mul_f32 v140, v21, v140
v_mul_f32 v141, v21, v141
v_mul_f32 v142, v21, v142
v_mul_f32 v143, v21, v143
v_mul_f32 v144, v20, v144
v_mul_f32 v145, v20, v145
v_mul_f32 v146, v20, v146
v_mul_f32 v147, v20, v147
v_mul_f32 v148, v21, v148
v_mul_f32 v149, v21, v149
v_mul_f32 v150, v21, v150
v_mul_f32 v151, v21, v151
v_mul_f32 v152, v20, v152
v_mul_f32 v153, v20, v153
v_mul_f32 v154, v20, v154
v_mul_f32 v155, v20, v155
v_mul_f32 v156, v21, v156
v_mul_f32 v157, v21, v157
v_mul_f32 v158, v21, v158
v_mul_f32 v159, v21, v159
v_mul_f32 v160, v20, v160
v_mul_f32 v161, v20, v161
v_mul_f32 v162, v20, v162
v_mul_f32 v163, v20, v163
v_mul_f32 v164, v21, v164
v_mul_f32 v165, v21, v165
v_mul_f32 v166, v21, v166
v_mul_f32 v167, v21, v167
v_mul_f32 v168, v20, v168
v_mul_f32 v169, v20, v169
v_mul_f32 v170, v20, v170
v_mul_f32 v171, v20, v171
v_mul_f32 v172, v21, v172
v_mul_f32 v173, v21, v173
v_mul_f32 v174, v21, v174
v_mul_f32 v175, v21, v175
v_mul_f32 v176, v20, v176
v_mul_f32 v177, v20, v177
v_mul_f32 v178, v20, v178
v_mul_f32 v179, v20, v179
v_mul_f32 v180, v21, v180
v_mul_f32 v181, v21, v181
v_mul_f32 v182, v21, v182
v_mul_f32 v183, v21, v183
v_mul_f32 v184, v20, v184
v_mul_f32 v185, v20, v185
v_mul_f32 v186, v20, v186
v_mul_f32 v187, v20, v187
v_mul_f32 v188, v21, v188
v_mul_f32 v189, v21, v189
v_mul_f32 v190, v21, v190
v_mul_f32 v191, v21, v191
v_mul_f32 v192, v20, v192
v_mul_f32 v193, v20, v193
v_mul_f32 v194, v20, v194
v_mul_f32 v195, v20, v195
v_mul_f32 v196, v21, v196
v_mul_f32 v197, v21, v197
v_mul_f32 v198, v21, v198
v_mul_f32 v199, v21, v199
v_mul_f32 v200, v20, v200
v_mul_f32 v201, v20, v201
v_mul_f32 v202, v20, v202
v_mul_f32 v203, v20, v203
v_mul_f32 v204, v21, v204
v_mul_f32 v205, v21, v205
v_mul_f32 v206, v21, v206
v_mul_f32 v207, v21, v207
v_mul_f32 v208, v20, v208
v_mul_f32 v209, v20, v209
v_mul_f32 v210, v20, v210
v_mul_f32 v211, v20, v211
v_mul_f32 v212, v21, v212
v_mul_f32 v213, v21, v213
v_mul_f32 v214, v21, v214
v_mul_f32 v215, v21, v215
v_mul_f32 v216, v20, v216
v_mul_f32 v217, v20, v217
v_mul_f32 v218, v20, v218
v_mul_f32 v219, v20, v219
v_mul_f32 v220, v21, v220
v_mul_f32 v221, v21, v221
v_mul_f32 v222, v21, v222
v_mul_f32 v223, v21, v223
v_mul_f32 v224, v20, v224
v_mul_f32 v225, v20, v225
v_mul_f32 v226, v20, v226
v_mul_f32 v227, v20, v227
v_mul_f32 v228, v21, v228
v_mul_f32 v229, v21, v229
v_mul_f32 v230, v21, v230
v_mul_f32 v231, v21, v231
v_mul_f32 v232, v20, v232
v_mul_f32 v233, v20, v233
v_mul_f32 v234, v20, v234
v_mul_f32 v235, v20, v235
v_mul_f32 v236, v21, v236
v_mul_f32 v237, v21, v237
v_mul_f32 v238, v21, v238
v_mul_f32 v239, v21, v239
v_mul_f32 v240, v20, v240
v_mul_f32 v241, v20, v241
v_mul_f32 v242, v20, v242
v_mul_f32 v243, v20, v243
v_mul_f32 v244, v21, v244
v_mul_f32 v245, v21, v245
v_mul_f32 v246, v21, v246
v_mul_f32 v247, v21, v247
v_mul_f32 v248, v20, v248
v_mul_f32 v249, v20, v249
v_mul_f32 v250, v20, v250
v_mul_f32 v251, v20, v251
v_mul_f32 v252, v21, v252
v_mul_f32 v253, v21, v253
v_mul_f32 v254, v21, v254
v_mul_f32 v255, v21, v255
v_accvgpr_read_b32 v12, a128
v_lshlrev_b32 v13, 16, v12
v_and_b32 v12, 0xffff0000, v12
v_mul_f32 v13, v22, v13
v_mul_f32 v12, v22, v12
v_cvt_pk_bf16_f32 v12, v13, v12
v_accvgpr_write_b32 a128, v12
v_accvgpr_read_b32 v12, a129
v_lshlrev_b32 v13, 16, v12
v_and_b32 v12, 0xffff0000, v12
v_mul_f32 v13, v22, v13
v_mul_f32 v12, v22, v12
v_cvt_pk_bf16_f32 v12, v13, v12
v_accvgpr_write_b32 a129, v12
v_accvgpr_read_b32 v12, a130
v_lshlrev_b32 v13, 16, v12
v_and_b32 v12, 0xffff0000, v12
v_mul_f32 v13, v22, v13
v_mul_f32 v12, v22, v12
v_cvt_pk_bf16_f32 v12, v13, v12
v_accvgpr_write_b32 a130, v12
v_accvgpr_read_b32 v12, a131
v_lshlrev_b32 v13, 16, v12
v_and_b32 v12, 0xffff0000, v12
v_mul_f32 v13, v22, v13
v_mul_f32 v12, v22, v12
v_cvt_pk_bf16_f32 v12, v13, v12
v_accvgpr_write_b32 a131, v12
v_accvgpr_read_b32 v12, a132
v_lshlrev_b32 v13, 16, v12
v_and_b32 v12, 0xffff0000, v12
v_mul_f32 v13, v23, v13
v_mul_f32 v12, v23, v12
v_cvt_pk_bf16_f32 v12, v13, v12
v_accvgpr_write_b32 a132, v12
v_accvgpr_read_b32 v12, a133
v_lshlrev_b32 v13, 16, v12
v_and_b32 v12, 0xffff0000, v12
v_mul_f32 v13, v23, v13
v_mul_f32 v12, v23, v12
v_cvt_pk_bf16_f32 v12, v13, v12
v_accvgpr_write_b32 a133, v12
v_accvgpr_read_b32 v12, a134
v_lshlrev_b32 v13, 16, v12
v_and_b32 v12, 0xffff0000, v12
v_mul_f32 v13, v23, v13
v_mul_f32 v12, v23, v12
v_cvt_pk_bf16_f32 v12, v13, v12
v_accvgpr_write_b32 a134, v12
v_accvgpr_read_b32 v12, a135
v_lshlrev_b32 v13, 16, v12
v_and_b32 v12, 0xffff0000, v12
v_mul_f32 v13, v23, v13
v_mul_f32 v12, v23, v12
v_cvt_pk_bf16_f32 v12, v13, v12
v_accvgpr_write_b32 a135, v12
v_accvgpr_read_b32 v12, a136
v_lshlrev_b32 v13, 16, v12
v_and_b32 v12, 0xffff0000, v12
v_mul_f32 v13, v22, v13
v_mul_f32 v12, v22, v12
v_cvt_pk_bf16_f32 v12, v13, v12
v_accvgpr_write_b32 a136, v12
v_accvgpr_read_b32 v12, a137
v_lshlrev_b32 v13, 16, v12
v_and_b32 v12, 0xffff0000, v12
v_mul_f32 v13, v22, v13
v_mul_f32 v12, v22, v12
v_cvt_pk_bf16_f32 v12, v13, v12
v_accvgpr_write_b32 a137, v12
v_accvgpr_read_b32 v12, a138
v_lshlrev_b32 v13, 16, v12
v_and_b32 v12, 0xffff0000, v12
v_mul_f32 v13, v22, v13
v_mul_f32 v12, v22, v12
v_cvt_pk_bf16_f32 v12, v13, v12
v_accvgpr_write_b32 a138, v12
v_accvgpr_read_b32 v12, a139
v_lshlrev_b32 v13, 16, v12
v_and_b32 v12, 0xffff0000, v12
v_mul_f32 v13, v22, v13
v_mul_f32 v12, v22, v12
v_cvt_pk_bf16_f32 v12, v13, v12
v_accvgpr_write_b32 a139, v12
v_accvgpr_read_b32 v12, a140
v_lshlrev_b32 v13, 16, v12
v_and_b32 v12, 0xffff0000, v12
v_mul_f32 v13, v23, v13
v_mul_f32 v12, v23, v12
v_cvt_pk_bf16_f32 v12, v13, v12
v_accvgpr_write_b32 a140, v12
v_accvgpr_read_b32 v12, a141
v_lshlrev_b32 v13, 16, v12
v_and_b32 v12, 0xffff0000, v12
v_mul_f32 v13, v23, v13
v_mul_f32 v12, v23, v12
v_cvt_pk_bf16_f32 v12, v13, v12
v_accvgpr_write_b32 a141, v12
v_accvgpr_read_b32 v12, a142
v_lshlrev_b32 v13, 16, v12
v_and_b32 v12, 0xffff0000, v12
v_mul_f32 v13, v23, v13
v_mul_f32 v12, v23, v12
v_cvt_pk_bf16_f32 v12, v13, v12
v_accvgpr_write_b32 a142, v12
v_accvgpr_read_b32 v12, a143
v_lshlrev_b32 v13, 16, v12
v_and_b32 v12, 0xffff0000, v12
v_mul_f32 v13, v23, v13
v_mul_f32 v12, v23, v12
v_cvt_pk_bf16_f32 v12, v13, v12
v_accvgpr_write_b32 a143, v12
v_accvgpr_read_b32 v12, a144
v_lshlrev_b32 v13, 16, v12
v_and_b32 v12, 0xffff0000, v12
v_mul_f32 v13, v22, v13
v_mul_f32 v12, v22, v12
v_cvt_pk_bf16_f32 v12, v13, v12
v_accvgpr_write_b32 a144, v12
v_accvgpr_read_b32 v12, a145
v_lshlrev_b32 v13, 16, v12
v_and_b32 v12, 0xffff0000, v12
v_mul_f32 v13, v22, v13
v_mul_f32 v12, v22, v12
v_cvt_pk_bf16_f32 v12, v13, v12
v_accvgpr_write_b32 a145, v12
v_accvgpr_read_b32 v12, a146
v_lshlrev_b32 v13, 16, v12
v_and_b32 v12, 0xffff0000, v12
v_mul_f32 v13, v22, v13
v_mul_f32 v12, v22, v12
v_cvt_pk_bf16_f32 v12, v13, v12
v_accvgpr_write_b32 a146, v12
v_accvgpr_read_b32 v12, a147
v_lshlrev_b32 v13, 16, v12
v_and_b32 v12, 0xffff0000, v12
v_mul_f32 v13, v22, v13
v_mul_f32 v12, v22, v12
v_cvt_pk_bf16_f32 v12, v13, v12
v_accvgpr_write_b32 a147, v12
v_accvgpr_read_b32 v12, a148
v_lshlrev_b32 v13, 16, v12
v_and_b32 v12, 0xffff0000, v12
v_mul_f32 v13, v23, v13
v_mul_f32 v12, v23, v12
v_cvt_pk_bf16_f32 v12, v13, v12
v_accvgpr_write_b32 a148, v12
v_accvgpr_read_b32 v12, a149
v_lshlrev_b32 v13, 16, v12
v_and_b32 v12, 0xffff0000, v12
v_mul_f32 v13, v23, v13
v_mul_f32 v12, v23, v12
v_cvt_pk_bf16_f32 v12, v13, v12
v_accvgpr_write_b32 a149, v12
v_accvgpr_read_b32 v12, a150
v_lshlrev_b32 v13, 16, v12
v_and_b32 v12, 0xffff0000, v12
v_mul_f32 v13, v23, v13
v_mul_f32 v12, v23, v12
v_cvt_pk_bf16_f32 v12, v13, v12
v_accvgpr_write_b32 a150, v12
v_accvgpr_read_b32 v12, a151
v_lshlrev_b32 v13, 16, v12
v_and_b32 v12, 0xffff0000, v12
v_mul_f32 v13, v23, v13
v_mul_f32 v12, v23, v12
v_cvt_pk_bf16_f32 v12, v13, v12
v_accvgpr_write_b32 a151, v12
v_accvgpr_read_b32 v12, a152
v_lshlrev_b32 v13, 16, v12
v_and_b32 v12, 0xffff0000, v12
v_mul_f32 v13, v22, v13
v_mul_f32 v12, v22, v12
v_cvt_pk_bf16_f32 v12, v13, v12
v_accvgpr_write_b32 a152, v12
v_accvgpr_read_b32 v12, a153
v_lshlrev_b32 v13, 16, v12
v_and_b32 v12, 0xffff0000, v12
v_mul_f32 v13, v22, v13
v_mul_f32 v12, v22, v12
v_cvt_pk_bf16_f32 v12, v13, v12
v_accvgpr_write_b32 a153, v12
v_accvgpr_read_b32 v12, a154
v_lshlrev_b32 v13, 16, v12
v_and_b32 v12, 0xffff0000, v12
v_mul_f32 v13, v22, v13
v_mul_f32 v12, v22, v12
v_cvt_pk_bf16_f32 v12, v13, v12
v_accvgpr_write_b32 a154, v12
v_accvgpr_read_b32 v12, a155
v_lshlrev_b32 v13, 16, v12
v_and_b32 v12, 0xffff0000, v12
v_mul_f32 v13, v22, v13
v_mul_f32 v12, v22, v12
v_cvt_pk_bf16_f32 v12, v13, v12
v_accvgpr_write_b32 a155, v12
v_accvgpr_read_b32 v12, a156
v_lshlrev_b32 v13, 16, v12
v_and_b32 v12, 0xffff0000, v12
v_mul_f32 v13, v23, v13
v_mul_f32 v12, v23, v12
v_cvt_pk_bf16_f32 v12, v13, v12
v_accvgpr_write_b32 a156, v12
v_accvgpr_read_b32 v12, a157
v_lshlrev_b32 v13, 16, v12
v_and_b32 v12, 0xffff0000, v12
v_mul_f32 v13, v23, v13
v_mul_f32 v12, v23, v12
v_cvt_pk_bf16_f32 v12, v13, v12
v_accvgpr_write_b32 a157, v12
v_accvgpr_read_b32 v12, a158
v_lshlrev_b32 v13, 16, v12
v_and_b32 v12, 0xffff0000, v12
v_mul_f32 v13, v23, v13
v_mul_f32 v12, v23, v12
v_cvt_pk_bf16_f32 v12, v13, v12
v_accvgpr_write_b32 a158, v12
v_accvgpr_read_b32 v12, a159
v_lshlrev_b32 v13, 16, v12
v_and_b32 v12, 0xffff0000, v12
v_mul_f32 v13, v23, v13
v_mul_f32 v12, v23, v12
v_cvt_pk_bf16_f32 v12, v13, v12
v_accvgpr_write_b32 a159, v12
v_accvgpr_read_b32 v12, a160
v_lshlrev_b32 v13, 16, v12
v_and_b32 v12, 0xffff0000, v12
v_mul_f32 v13, v22, v13
v_mul_f32 v12, v22, v12
v_cvt_pk_bf16_f32 v12, v13, v12
v_accvgpr_write_b32 a160, v12
v_accvgpr_read_b32 v12, a161
v_lshlrev_b32 v13, 16, v12
v_and_b32 v12, 0xffff0000, v12
v_mul_f32 v13, v22, v13
v_mul_f32 v12, v22, v12
v_cvt_pk_bf16_f32 v12, v13, v12
v_accvgpr_write_b32 a161, v12
v_accvgpr_read_b32 v12, a162
v_lshlrev_b32 v13, 16, v12
v_and_b32 v12, 0xffff0000, v12
v_mul_f32 v13, v22, v13
v_mul_f32 v12, v22, v12
v_cvt_pk_bf16_f32 v12, v13, v12
v_accvgpr_write_b32 a162, v12
v_accvgpr_read_b32 v12, a163
v_lshlrev_b32 v13, 16, v12
v_and_b32 v12, 0xffff0000, v12
v_mul_f32 v13, v22, v13
v_mul_f32 v12, v22, v12
v_cvt_pk_bf16_f32 v12, v13, v12
v_accvgpr_write_b32 a163, v12
v_accvgpr_read_b32 v12, a164
v_lshlrev_b32 v13, 16, v12
v_and_b32 v12, 0xffff0000, v12
v_mul_f32 v13, v23, v13
v_mul_f32 v12, v23, v12
v_cvt_pk_bf16_f32 v12, v13, v12
v_accvgpr_write_b32 a164, v12
v_accvgpr_read_b32 v12, a165
v_lshlrev_b32 v13, 16, v12
v_and_b32 v12, 0xffff0000, v12
v_mul_f32 v13, v23, v13
v_mul_f32 v12, v23, v12
v_cvt_pk_bf16_f32 v12, v13, v12
v_accvgpr_write_b32 a165, v12
v_accvgpr_read_b32 v12, a166
v_lshlrev_b32 v13, 16, v12
v_and_b32 v12, 0xffff0000, v12
v_mul_f32 v13, v23, v13
v_mul_f32 v12, v23, v12
v_cvt_pk_bf16_f32 v12, v13, v12
v_accvgpr_write_b32 a166, v12
v_accvgpr_read_b32 v12, a167
v_lshlrev_b32 v13, 16, v12
v_and_b32 v12, 0xffff0000, v12
v_mul_f32 v13, v23, v13
v_mul_f32 v12, v23, v12
v_cvt_pk_bf16_f32 v12, v13, v12
v_accvgpr_write_b32 a167, v12
v_accvgpr_read_b32 v12, a168
v_lshlrev_b32 v13, 16, v12
v_and_b32 v12, 0xffff0000, v12
v_mul_f32 v13, v22, v13
v_mul_f32 v12, v22, v12
v_cvt_pk_bf16_f32 v12, v13, v12
v_accvgpr_write_b32 a168, v12
v_accvgpr_read_b32 v12, a169
v_lshlrev_b32 v13, 16, v12
v_and_b32 v12, 0xffff0000, v12
v_mul_f32 v13, v22, v13
v_mul_f32 v12, v22, v12
v_cvt_pk_bf16_f32 v12, v13, v12
v_accvgpr_write_b32 a169, v12
v_accvgpr_read_b32 v12, a170
v_lshlrev_b32 v13, 16, v12
v_and_b32 v12, 0xffff0000, v12
v_mul_f32 v13, v22, v13
v_mul_f32 v12, v22, v12
v_cvt_pk_bf16_f32 v12, v13, v12
v_accvgpr_write_b32 a170, v12
v_accvgpr_read_b32 v12, a171
v_lshlrev_b32 v13, 16, v12
v_and_b32 v12, 0xffff0000, v12
v_mul_f32 v13, v22, v13
v_mul_f32 v12, v22, v12
v_cvt_pk_bf16_f32 v12, v13, v12
v_accvgpr_write_b32 a171, v12
v_accvgpr_read_b32 v12, a172
v_lshlrev_b32 v13, 16, v12
v_and_b32 v12, 0xffff0000, v12
v_mul_f32 v13, v23, v13
v_mul_f32 v12, v23, v12
v_cvt_pk_bf16_f32 v12, v13, v12
v_accvgpr_write_b32 a172, v12
v_accvgpr_read_b32 v12, a173
v_lshlrev_b32 v13, 16, v12
v_and_b32 v12, 0xffff0000, v12
v_mul_f32 v13, v23, v13
v_mul_f32 v12, v23, v12
v_cvt_pk_bf16_f32 v12, v13, v12
v_accvgpr_write_b32 a173, v12
v_accvgpr_read_b32 v12, a174
v_lshlrev_b32 v13, 16, v12
v_and_b32 v12, 0xffff0000, v12
v_mul_f32 v13, v23, v13
v_mul_f32 v12, v23, v12
v_cvt_pk_bf16_f32 v12, v13, v12
v_accvgpr_write_b32 a174, v12
v_accvgpr_read_b32 v12, a175
v_lshlrev_b32 v13, 16, v12
v_and_b32 v12, 0xffff0000, v12
v_mul_f32 v13, v23, v13
v_mul_f32 v12, v23, v12
v_cvt_pk_bf16_f32 v12, v13, v12
v_accvgpr_write_b32 a175, v12
v_accvgpr_read_b32 v12, a176
v_lshlrev_b32 v13, 16, v12
v_and_b32 v12, 0xffff0000, v12
v_mul_f32 v13, v22, v13
v_mul_f32 v12, v22, v12
v_cvt_pk_bf16_f32 v12, v13, v12
v_accvgpr_write_b32 a176, v12
v_accvgpr_read_b32 v12, a177
v_lshlrev_b32 v13, 16, v12
v_and_b32 v12, 0xffff0000, v12
v_mul_f32 v13, v22, v13
v_mul_f32 v12, v22, v12
v_cvt_pk_bf16_f32 v12, v13, v12
v_accvgpr_write_b32 a177, v12
v_accvgpr_read_b32 v12, a178
v_lshlrev_b32 v13, 16, v12
v_and_b32 v12, 0xffff0000, v12
v_mul_f32 v13, v22, v13
v_mul_f32 v12, v22, v12
v_cvt_pk_bf16_f32 v12, v13, v12
v_accvgpr_write_b32 a178, v12
v_accvgpr_read_b32 v12, a179
v_lshlrev_b32 v13, 16, v12
v_and_b32 v12, 0xffff0000, v12
v_mul_f32 v13, v22, v13
v_mul_f32 v12, v22, v12
v_cvt_pk_bf16_f32 v12, v13, v12
v_accvgpr_write_b32 a179, v12
v_accvgpr_read_b32 v12, a180
v_lshlrev_b32 v13, 16, v12
v_and_b32 v12, 0xffff0000, v12
v_mul_f32 v13, v23, v13
v_mul_f32 v12, v23, v12
v_cvt_pk_bf16_f32 v12, v13, v12
v_accvgpr_write_b32 a180, v12
v_accvgpr_read_b32 v12, a181
v_lshlrev_b32 v13, 16, v12
v_and_b32 v12, 0xffff0000, v12
v_mul_f32 v13, v23, v13
v_mul_f32 v12, v23, v12
v_cvt_pk_bf16_f32 v12, v13, v12
v_accvgpr_write_b32 a181, v12
v_accvgpr_read_b32 v12, a182
v_lshlrev_b32 v13, 16, v12
v_and_b32 v12, 0xffff0000, v12
v_mul_f32 v13, v23, v13
v_mul_f32 v12, v23, v12
v_cvt_pk_bf16_f32 v12, v13, v12
v_accvgpr_write_b32 a182, v12
v_accvgpr_read_b32 v12, a183
v_lshlrev_b32 v13, 16, v12
v_and_b32 v12, 0xffff0000, v12
v_mul_f32 v13, v23, v13
v_mul_f32 v12, v23, v12
v_cvt_pk_bf16_f32 v12, v13, v12
v_accvgpr_write_b32 a183, v12
v_accvgpr_read_b32 v12, a184
v_lshlrev_b32 v13, 16, v12
v_and_b32 v12, 0xffff0000, v12
v_mul_f32 v13, v22, v13
v_mul_f32 v12, v22, v12
v_cvt_pk_bf16_f32 v12, v13, v12
v_accvgpr_write_b32 a184, v12
v_accvgpr_read_b32 v12, a185
v_lshlrev_b32 v13, 16, v12
v_and_b32 v12, 0xffff0000, v12
v_mul_f32 v13, v22, v13
v_mul_f32 v12, v22, v12
v_cvt_pk_bf16_f32 v12, v13, v12
v_accvgpr_write_b32 a185, v12
v_accvgpr_read_b32 v12, a186
v_lshlrev_b32 v13, 16, v12
v_and_b32 v12, 0xffff0000, v12
v_mul_f32 v13, v22, v13
v_mul_f32 v12, v22, v12
v_cvt_pk_bf16_f32 v12, v13, v12
v_accvgpr_write_b32 a186, v12
v_accvgpr_read_b32 v12, a187
v_lshlrev_b32 v13, 16, v12
v_and_b32 v12, 0xffff0000, v12
v_mul_f32 v13, v22, v13
v_mul_f32 v12, v22, v12
v_cvt_pk_bf16_f32 v12, v13, v12
v_accvgpr_write_b32 a187, v12
v_accvgpr_read_b32 v12, a188
v_lshlrev_b32 v13, 16, v12
v_and_b32 v12, 0xffff0000, v12
v_mul_f32 v13, v23, v13
v_mul_f32 v12, v23, v12
v_cvt_pk_bf16_f32 v12, v13, v12
v_accvgpr_write_b32 a188, v12
v_accvgpr_read_b32 v12, a189
v_lshlrev_b32 v13, 16, v12
v_and_b32 v12, 0xffff0000, v12
v_mul_f32 v13, v23, v13
v_mul_f32 v12, v23, v12
v_cvt_pk_bf16_f32 v12, v13, v12
v_accvgpr_write_b32 a189, v12
v_accvgpr_read_b32 v12, a190
v_lshlrev_b32 v13, 16, v12
v_and_b32 v12, 0xffff0000, v12
v_mul_f32 v13, v23, v13
v_mul_f32 v12, v23, v12
v_cvt_pk_bf16_f32 v12, v13, v12
v_accvgpr_write_b32 a190, v12
v_accvgpr_read_b32 v12, a191
v_lshlrev_b32 v13, 16, v12
v_and_b32 v12, 0xffff0000, v12
v_mul_f32 v13, v23, v13
v_mul_f32 v12, v23, v12
v_cvt_pk_bf16_f32 v12, v13, v12
v_accvgpr_write_b32 a191, v12
s_nop 1
s_branch L_comb
.p2align 12
.globl recurrent_scan__compressed_kv_cla__dense_activation_squared_relu__prompt_kernel
.p2align 8
.type recurrent_scan__compressed_kv_cla__dense_activation_squared_relu__prompt_kernel,@function
recurrent_scan__compressed_kv_cla__dense_activation_squared_relu__prompt_kernel:
s_cmp_ge_u32 s2, 256
s_cbranch_scc0 L_go
s_endpgm
L_go:
s_load_dwordx2 s[8:9], s[0:1], 8
s_load_dwordx4 s[76:79], s[0:1], 24
s_load_dwordx2 s[4:5], s[0:1], 104
s_load_dwordx2 s[56:57], s[0:1], 0
s_load_dwordx2 s[20:21], s[0:1], 96
s_load_dwordx2 s[52:53], s[0:1], 56
s_load_dwordx2 s[48:49], s[0:1], 72
s_load_dwordx2 s[82:83], s[0:1], 16
v_and_b32 v1, 63, v0
v_lshrrev_b32 v30, 6, v0
v_lshlrev_b32 v5, 4, v1
v_readfirstlane_b32 s24, v30
s_and_b32 s3, s2, 7
s_lshl_b32 s3, s3, 1
s_lshr_b32 s26, s2, 4
s_bfe_u32 s28, s2, 0x10003
s_add_u32 s25, s3, s28
s_and_b32 s43, s26, 1
s_add_u32 s43, s43, s3
s_lshr_b32 s45, s2, 1
s_xor_b32 s44, s2, s45
s_bfe_u32 s44, s44, 0x10005
s_lshl_b32 s44, s44, 2
s_lshr_b32 s45, s2, 6
s_xor_b32 s45, s45, 2
s_or_b32 s44, s44, s45
s_cmp_lt_u32 s26, 8
s_cselect_b32 s45, 2, 0
s_xor_b32 s25, s25, s45
s_and_b32 s45, s24, 1
s_lshr_b32 s46, s24, 1
v_lshrrev_b32 v30, 3, v1
s_lshl_b32 s29, s44, 8
s_lshl_b32 s30, s24, 6
s_lshl_b32 s33, s45, 5
s_sub_u32 s30, s30, s33
s_lshl_b32 s33, s30, 7
s_add_u32 s29, s29, s30
v_add_u32 v30, s29, v30
v_lshlrev_b32 v30, 11, v30
v_and_b32 v31, 7, v1
v_lshrrev_b32 v32, 4, v1
v_xor_b32 v33, v31, v32
v_lshl_add_u32 v33, v33, 4, v30
v_xor_b32 v34, 4, v32
v_xor_b32 v34, v31, v34
v_lshl_add_u32 v34, v34, 4, v30
v_add_u32 v12, 4096, v33
v_add_u32 v13, 19456, v34
v_add_u32 v14, 34816, v33
v_add_u32 v15, 50176, v34
v_bfe_u32 v30, v1, 3, 2
v_lshlrev_b32 v31, 13, v30
v_lshrrev_b32 v32, 5, v1
v_lshl_add_u32 v31, v32, 7, v31
v_lshrrev_b32 v32, 1, v30
v_lshlrev_b32 v32, 2, v32
v_and_b32 v33, 7, v1
v_xor_b32 v32, v32, v33
s_lshl_b32 s29, s45, 1
v_xor_b32 v32, s29, v32
v_lshl_add_u32 v31, v32, 4, v31
s_lshl_b32 s29, s43, 9
s_lshl_b32 s30, s24, 16
s_add_u32 s29, s29, s30
v_add_u32 v31, s29, v31
v_add_u32 v16, 4096, v31
v_add_u32 v17, 265216, v31
v_add_u32 v18, 34816, v31
v_add_u32 v19, 295936, v31
s_mul_i32 s30, s3, 256
s_mul_i32 s29, s44, 512
s_add_u32 s30, s30, s29
s_and_b32 s30, s30, 0x7ff
s_lshl_b32 s34, s24, 12
s_mov_b32 s10, 4198400
s_mov_b32 s11, 0x20000
s_mov_b32 s14, 8392704
s_mov_b32 s15, 0x20000
s_waitcnt lgkmcnt(0)
s_sub_u32 s8, s8, 4096
s_subb_u32 s9, s9, 0
s_cmp_eq_u32 s28, 0
s_cselect_b32 s12, s76, s78
s_cselect_b32 s13, s77, s79
s_sub_u32 s12, s12, 4096
s_subb_u32 s13, s13, 0
s_lshl_b32 s37, s30, 12
s_add_u32 m0, s33, 131072
s_add_u32 s29, s30, 0
s_and_b32 s29, s29, 133119
buffer_load_dwordx4 v12, s[8:11], s29 offen offset:0 lds
s_lshl_b32 s39, s2, 2
s_add_u32 s39, s39, s24
s_mov_b32 s58, 1835008
s_mov_b32 s59, 0x20000
v_and_b32 v35, 3, v1
v_lshrrev_b32 v36, 2, v1
v_mul_u32_u24 v37, 896, v35
v_lshl_add_u32 v37, v36, 4, v37
v_cmp_gt_u32 s[84:85], 14, v36
v_mov_b32 v38, 2130706432
s_lshr_b32 s32, s39, 1
s_mul_i32 s32, s32, 3584
s_mul_i32 s31, s45, 448
buffer_load_dwordx4 v13, s[8:11], s29 offen offset:1024 lds
s_add_u32 s32, s32, s31
v_cndmask_b32 v41, v38, v37, s[84:85]
s_getpc_b64 s[16:17]
L_pc:
s_sub_u32 s16, s16, L_pc - L_gemmV
s_subb_u32 s17, s17, 0
s_mov_b32 s18, L_codeend - L_gemmV
s_mov_b32 s19, 0x20000
s_lshr_b32 s31, s2, 3
s_lshl_b32 s31, s31, 2
s_add_u32 s31, s31, s24
s_lshl_b32 s31, s31, 10
s_mov_b32 s6, 268435456
buffer_load_dwordx4 v14, s[8:11], s29 offen offset:2048 lds
s_mov_b32 s7, 0x20000
v_and_b32 v30, 15, v1
v_lshrrev_b32 v31, 4, v1
v_lshlrev_b32 v32, 3, v30
v_and_b32 v33, 64, v32
v_lshl_add_u32 v33, v35, 4, v33
v_and_b32 v34, 4, v1
v_lshl_add_u32 v33, v34, 1, v33
s_mov_b32 s22, 16
s_mov_b32 s23, 0x20000
v_mul_u32_u24 v6, 3584, v31
v_add_u32 v6, v6, v33
buffer_load_dwordx4 v15, s[8:11], s29 offen offset:3072 lds
s_lshl_b32 s36, s44, 1
s_add_u32 s36, s36, s28
s_lshl_b32 s36, s36, 2
s_add_u32 s36, s36, s24
s_mul_i32 s77, s36, 9363
s_lshr_b32 s77, s77, 16
s_mul_i32 s78, s77, 7
s_sub_u32 s78, s36, s78
s_lshl_b32 s79, s43, 3
s_add_u32 s77, s77, s79
s_mul_i32 s79, s77, 28672
s_lshl_b32 s80, s78, 7
s_add_u32 s79, s79, s80
s_add_u32 m0, s34, 32768
s_add_u32 s29, s37, 0
s_and_b32 s29, s29, 8388607
buffer_load_dwordx4 v16, s[12:15], s29 offen offset:0 lds
s_cmp_lt_u32 s36, 56
s_cselect_b32 s79, s79, 2130706432
v_add_u32 v6, s79, v6
s_mul_i32 s79, s78, 753664
s_lshl_b32 s80, s77, 12
s_add_u32 s79, s79, s80
s_add_u32 s67, s79, 8617984
s_cmp_lt_u32 s36, 56
s_cselect_b32 s67, s67, 2130706432
s_lshr_b32 s77, s39, 2
s_mul_i32 s77, s77, 9363
s_lshr_b32 s77, s77, 16
buffer_load_dwordx4 v17, s[12:15], s29 offen offset:1024 lds
s_mul_i32 s78, s77, 28
s_sub_u32 s78, s39, s78
s_mul_i32 s73, s77, 114688
s_lshl_b32 s80, s78, 7
s_add_u32 s73, s73, s80
s_lshr_b32 s79, s78, 2
s_mul_i32 s79, s79, 229376
s_lshr_b32 s80, s77, 1
s_lshl_b32 s80, s80, 15
s_add_u32 s79, s79, s80
s_and_b32 s80, s78, 3
s_lshl_b32 s80, s80, 13
s_add_u32 s79, s79, s80
buffer_load_dwordx4 v18, s[12:15], s29 offen offset:2048 lds
s_and_b32 s80, s77, 1
s_lshl_b32 s80, s80, 10
s_add_u32 s79, s79, s80
s_add_u32 s74, s79, 6291456
s_sub_u32 s81, s39, 392
s_and_b32 s81, s81, 1023
s_mul_i32 s77, s81, 9363
s_lshr_b32 s77, s77, 16
s_mul_i32 s78, s77, 7
s_sub_u32 s78, s81, s78
s_mul_i32 s79, s78, 753664
s_lshl_b32 s80, s77, 12
buffer_load_dwordx4 v19, s[12:15], s29 offen offset:3072 lds
s_add_u32 s79, s79, s80
s_add_u32 s68, s79, 8388608
s_cmp_lt_u32 s39, 784
s_cselect_b32 s68, s68, 2130706432
s_lshr_b32 s79, s77, 1
s_mul_i32 s79, s79, 57344
s_and_b32 s80, s77, 1
s_mul_i32 s80, s80, 1792
s_add_u32 s79, s79, s80
s_lshl_b32 s80, s78, 7
s_add_u32 s79, s79, s80
s_mov_b32 s54, 1605632
s_mov_b32 s55, 0x20000
s_add_u32 m0, s33, 139264
s_add_u32 s29, s30, 131072
s_and_b32 s29, s29, 133119
buffer_load_dwordx4 v12, s[8:11], s29 offen offset:0 lds
s_cmp_lt_u32 s39, 392
s_cselect_b32 s52, s52, s48
s_cselect_b32 s53, s53, s49
s_cselect_b32 s79, s73, s79
s_cselect_b32 s68, s74, s68
s_cselect_b32 s73, 16, 1
s_cselect_b32 s74, 2, 1
s_cselect_b64 vcc, -1, 0
s_mul_i32 s73, s73, 896
s_mul_i32 s80, s74, 14336
s_lshl_b32 s74, s74, 10
v_mul_u32_u24 v2, s80, v31
buffer_load_dwordx4 v13, s[8:11], s29 offen offset:1024 lds
v_cndmask_b32 v32, v33, v32, vcc
v_add3_u32 v2, v2, v32, s79
v_lshlrev_b32 v39, 8, v36
v_lshl_add_u32 v39, v35, 4, v39
v_cndmask_b32 v28, v38, v39, s[84:85]
s_lshr_b32 s79, s39, 3
s_mul_i32 s79, s79, 14336
s_and_b32 s80, s39, 6
s_lshl_b32 s80, s80, 5
s_add_u32 s69, s79, s80
s_mul_i32 s80, s45, 7168
s_add_u32 s69, s69, s80
s_xor_b32 s80, s39, 320
buffer_load_dwordx4 v14, s[8:11], s29 offen offset:2048 lds
s_lshl_b32 s72, s80, 10
s_add_u32 s72, s72, 14680064
s_cmp_lt_u32 s80, 32
s_cselect_b32 s72, s72, 2130706432
v_cmp_eq_u32 vcc, 0, v1
v_mov_b32 v9, 1
v_and_b32 v10, 3, v1
v_lshlrev_b32 v10, 2, v10
v_cndmask_b32 v8, v38, v1, vcc
s_mov_b32 s48, s82
s_mov_b32 s49, s83
s_lshr_b32 s77, s36, 2
buffer_load_dwordx4 v15, s[8:11], s29 offen offset:3072 lds
s_lshl_b32 s78, s43, 2
s_add_u32 s78, s78, s24
s_lshl_b32 s79, s77, 18
s_lshl_b32 s80, s78, 7
s_add_u32 s79, s79, s80
v_and_b32 v26, 3, v1
v_lshlrev_b32 v26, 5, v26
v_bfe_u32 v39, v1, 2, 2
v_lshl_add_u32 v26, v39, 3, v26
v_lshl_add_u32 v26, v31, 16, v26
v_add_u32 v26, s79, v26
v_mov_b32 v27, v5
s_lshr_b32 s79, s78, 2
s_add_u32 m0, s34, 49152
s_add_u32 s29, s37, 256
s_and_b32 s29, s29, 8388607
buffer_load_dwordx4 v16, s[12:15], s29 offen offset:0 lds
s_mul_i32 s79, s79, 229376
s_lshr_b32 s80, s77, 1
s_lshl_b32 s80, s80, 15
s_add_u32 s79, s79, s80
s_and_b32 s80, s78, 3
s_lshl_b32 s80, s80, 13
s_add_u32 s79, s79, s80
s_and_b32 s80, s77, 1
s_lshl_b32 s80, s80, 10
s_add_u32 s79, s79, s80
s_add_u32 s66, s79, 2097152
s_cmp_lt_u32 s36, 56
s_cselect_b32 s66, s66, 2130706432
buffer_load_dwordx4 v17, s[12:15], s29 offen offset:1024 lds
v_bfe_u32 v32, v1, 1, 3
s_lshl_b32 s79, s45, 14
s_add_u32 s79, s79, 131072
v_lshlrev_b32 v30, 7, v30
v_add_u32 v30, s79, v30
v_or_b32 v33, 0, v31
v_xor_b32 v33, v33, v32
v_lshl_add_u32 v20, v33, 4, v30
v_or_b32 v33, 4, v31
v_xor_b32 v33, v33, v32
v_lshl_add_u32 v21, v33, 4, v30
v_lshlrev_b32 v30, 12, v31
buffer_load_dwordx4 v18, s[12:15], s29 offen offset:2048 lds
v_bfe_u32 v32, v1, 2, 2
v_lshl_add_u32 v30, v32, 7, v30
v_and_b32 v33, 3, v1
v_lshl_add_u32 v30, v33, 3, v30
s_lshl_b32 s79, s46, 9
s_add_u32 s79, s79, 32768
v_add_u32 v30, s79, v30
v_lshrrev_b32 v32, 1, v32
v_lshlrev_b32 v32, 6, v32
v_and_b32 v33, 1, v31
v_lshlrev_b32 v33, 5, v33
v_or_b32 v32, v32, v33
v_xor_b32 v33, 0, v32
buffer_load_dwordx4 v19, s[12:15], s29 offen offset:3072 lds
v_add_u32 v22, v33, v30
v_xor_b32 v33, 32, v32
v_add_u32 v23, v33, v30
v_xor_b32 v33, 64, v32
v_add_u32 v24, v33, v30
v_xor_b32 v33, 96, v32
v_add_u32 v25, v33, v30
s_mul_i32 s64, s43, 1115136
s_mul_i32 s79, s44, 139264
s_add_u32 s64, s64, s79
s_mul_i32 s79, s45, 69632
s_add_u32 s64, s64, s79
buffer_load_dwordx4 a[176:179], v41, s[56:59], s32 offen
s_add_u32 s80, s28, 12
s_lshl_b32 s79, s46, 12
s_add_u32 s64, s64, s79
s_mul_i32 s79, s28, 18882560
s_add_u32 s64, s64, s79
s_add_u32 s64, s64, 16777216
s_lshr_b32 s65, 8192, 0
s_add_u32 s65, s65, s64
s_lshl_b32 s70, s43, 8
s_lshr_b32 s79, s44, 2
s_and_b32 s80, s44, 3
s_lshl_b32 s80, s80, 1
s_or_b32 s79, s79, s80
buffer_load_dwordx4 a[180:183], v41, s[56:59], s32 offen offset:224
s_cmp_ge_u32 s79, 2
s_cselect_b32 s80, 112, 0
s_add_u32 s70, s70, s80
s_lshl_b32 s79, s79, 3
s_add_u32 s70, s70, s79
s_lshl_b32 s79, s28, 2
s_add_u32 s70, s70, s79
s_add_u32 s70, s70, 14680064
s_lshl_b32 s71, s25, 8
s_add_u32 s71, s71, 14680064
s_xor_b32 s79, s2, 80
s_cmp_eq_u32 s24, 0
s_cselect_b32 s70, s70, 2130706432
s_cselect_b32 s71, s71, 2130706432
s_cselect_b32 s38, s79, 2130706432
s_cselect_b32 s35, 0, 2130706432
s_xor_b32 s32, s32, 448
buffer_load_dwordx4 a[184:187], v41, s[56:59], s32 offen
s_or_b32 s27, s26, 8
s_mul_i32 s77, s25, 229376
s_add_u32 s77, s77, 2097152
s_mov_b32 s63, s77
s_mov_b32 s42, s27
s_mov_b32 s79, 32768
s_bitcmp1_b32 s25, 1
s_cselect_b32 s41, 32, 36
s_cselect_b32 s80, 2, 2
buffer_load_dwordx4 a[188:191], v41, s[56:59], s32 offen offset:224
s_cmp_eq_u32 s27, 15
s_cselect_b32 s80, s80, 0
s_add_u32 s41, s41, s80
s_cmp_eq_u32 s27, 8
s_cselect_b32 s80, 36, 64
s_min_u32 s41, s41, s80
s_cmp_ge_u32 s26, 8
s_cbranch_scc1 L_typeA
s_mov_b32 s60, 2
s_sub_u32 s78, s77, 163840
s_sub_u32 s40, 15, s27
s_lshl_b32 s61, s27, 2
s_sub_u32 s62, 64, s61
s_add_u32 s61, s61, 4
s_sub_u32 s61, s61, s41
s_add_u32 s80, s61, 14
s_add_u32 s83, s80, s62
s_branch L_typedone
L_typeA:
s_mov_b32 s61, s41
s_add_u32 s83, s41, 14
s_mov_b32 s62, 2
s_mov_b32 s41, 0
s_mov_b32 s80, 100
s_mov_b32 s40, 0x4000
s_mov_b32 s60, 1
s_mov_b32 s78, 2130706432
s_cmp_eq_u32 s26, 15
s_cbranch_scc1 L_typedone
s_mov_b32 s60, 0
s_mul_i32 s42, s25, 7
s_add_u32 s42, s42, s26
s_sub_u32 s42, s42, 8
s_lshr_b32 s76, s42, 4
s_and_b32 s42, s42, 15
s_mul_i32 s63, s76, 229376
s_add_u32 s63, s63, 6291456
s_lshl_b32 s78, s76, 15
s_add_u32 s78, s78, 8388608
s_mov_b32 s79, 753664
L_typedone:
s_add_u32 m0, s33, 0
s_add_u32 s29, s30, 128
s_and_b32 s29, s29, 133119
buffer_load_dwordx4 v12, s[8:11], s29 offen offset:0 lds
s_mul_i32 s81, s25, 1115136
buffer_load_dwordx4 v13, s[8:11], s29 offen offset:1024 lds
s_add_u32 s82, s81, 35659776
buffer_load_dwordx4 v14, s[8:11], s29 offen offset:2048 lds
s_add_u32 s81, s81, 16777216
v_mov_b32 v3, 2130706432
v_subrev_u32 v30, 0, v1
v_cmp_gt_u32 vcc, 7, v30
v_mul_u32_u24 v31, 32768, v30
buffer_load_dwordx4 v15, s[8:11], s29 offen offset:3072 lds
v_add_u32 v31, s63, v31
v_cndmask_b32 v3, v3, v31, vcc
v_subrev_u32 v30, 7, v1
v_cmp_gt_u32 vcc, 7, v30
v_mul_u32_u24 v31, s79, v30
v_add_u32 v31, s78, v31
v_cndmask_b32 v3, v3, v31, vcc
s_lshl_b32 s76, s25, 15
s_add_u32 s76, s76, 8617984
v_subrev_u32 v30, s83, v1
v_cmp_gt_u32 vcc, 7, v30
v_mul_u32_u24 v31, 753664, v30
v_add_u32 v31, s76, v31
s_add_u32 m0, s34, 98304
s_add_u32 s29, s37, 524288
s_and_b32 s29, s29, 8388607
buffer_load_dwordx4 v16, s[12:15], s29 offen offset:0 lds
v_cndmask_b32 v3, v3, v31, vcc
v_add_u32 v4, 16384, v3
s_cmp_eq_u32 s60, 0
s_cselect_b32 s76, 32, 4128
v_lshrrev_b32 v30, v1, s76
s_lshl_b32 s76, s76, 1
v_lshrrev_b32 v31, v1, s76
v_cmp_gt_u32 vcc, 14, v1
v_and_b32 v30, 1, v30
v_and_b32 v31, 1, v31
v_cndmask_b32 v30, 0, v30, vcc
v_cndmask_b32 v31, 0, v31, vcc
buffer_load_dwordx4 v17, s[12:15], s29 offen offset:1024 lds
v_lshl_add_u32 v4, v30, 14, v4
v_lshlrev_b32 v31, 14, v31
v_sub_u32 v3, v3, v31
v_subrev_u32 v30, 14, v1
v_add_u32 v31, s41, v30
v_mul_u32_u24 v31, 17408, v31
s_sub_u32 s76, s61, 1
v_cmp_eq_u32 vcc, s76, v30
v_add_u32 v32, s81, v31
v_add_u32 v32, 17408, v32
v_add_u32 v33, s82, v31
v_cndmask_b32 v32, v32, v33, vcc
v_cmp_gt_u32 vcc, s61, v30
buffer_load_dwordx4 v18, s[12:15], s29 offen offset:2048 lds
s_nop 1
v_cndmask_b32 v4, v4, v32, vcc
v_subrev_u32 v30, 14, v1
v_add_u32 v31, s41, v30
v_mul_u32_u24 v31, 17408, v31
v_cmp_eq_u32 vcc, 0, v30
v_add_u32 v32, s82, v31
v_subrev_u32 v32, 17408, v32
v_add_u32 v33, s81, v31
v_cndmask_b32 v32, v32, v33, vcc
v_cmp_gt_u32 vcc, s61, v30
s_nop 1
buffer_load_dwordx4 v19, s[12:15], s29 offen offset:3072 lds
v_cndmask_b32 v3, v3, v32, vcc
v_subrev_u32 v30, s80, v1
v_mov_b32 v31, v30
v_mul_u32_u24 v31, 17408, v31
s_sub_u32 s76, s62, 1
v_cmp_eq_u32 vcc, s76, v30
v_add_u32 v32, s81, v31
v_add_u32 v32, 17408, v32
v_add_u32 v33, s82, v31
v_cndmask_b32 v32, v32, v33, vcc
v_cmp_gt_u32 vcc, s62, v30
s_nop 1
v_cndmask_b32 v4, v4, v32, vcc
buffer_load_dwordx4 a[200:203], v5, s[16:19], s31 offen
v_subrev_u32 v30, s80, v1
v_mov_b32 v31, v30
v_mul_u32_u24 v31, 17408, v31
v_cmp_eq_u32 vcc, 0, v30
v_add_u32 v32, s82, v31
v_subrev_u32 v32, 17408, v32
v_add_u32 v33, s81, v31
v_cndmask_b32 v32, v32, v33, vcc
v_cmp_gt_u32 vcc, s62, v30
s_nop 1
v_cndmask_b32 v3, v3, v32, vcc
s_lshl3_add_u32 s39, s42, s24
s_add_u32 s31, s31, 131072
buffer_load_dwordx4 a[204:207], v5, s[16:19], s31 offen
s_mul_i32 s39, s39, 14336
s_lshl3_add_u32 s40, s40, s24
s_mul_i32 s40, s40, 14336
s_lshl_b32 s3, s24, 12
s_mov_b32 s45, 0x05040100
s_mov_b32 s46, 0x07060302
s_mov_b32 s16, s48
s_mov_b32 s17, s49
s_mov_b32 s18, 3670016
s_waitcnt vmcnt(22)
s_barrier
RT 64,22,0
RT 66,22,2048
RT 68,22,1024
RT 70,22,3072
RD 96,20,0
RD 100,21,0
RT 72,23,0
RT 74,23,2048
RD 104,20,2048
RD 108,21,2048
RT 76,23,1024
RT 78,23,3072
RD 112,20,4096
RD 116,21,4096
RT 80,24,0
RT 82,24,2048
RD 120,20,6144
RD 124,21,6144
RT 84,24,1024
RT 86,24,3072
RT 88,25,0
RT 90,25,2048
RT 92,25,1024
RT 94,25,3072
s_cmp_eq_u32 s28, 0
s_cbranch_scc0 L_gemmV
L_gK:
s_waitcnt vmcnt(14) lgkmcnt(0)
s_barrier
s_add_u32 s29, s30, 131200
s_and_b32 s29, s29, 133119
Zvaa 128,64,96
s_add_u32 m0, s33, 8192
RD 0,20,8192
Mvaa 128,68,100
buffer_load_dwordx4 v12, s[8:11], s29 offen offset:0 lds
Zvaa 252,76,100
RD 4,21,8192
Mvaa 252,72,96
Zvaa 132,80,96
RD 8,20,10240
Mvaa 132,84,100
buffer_load_dwordx4 v13, s[8:11], s29 offen offset:1024 lds
Zvaa 248,92,100
RD 12,21,10240
Mvaa 248,88,96
Zvaa 164,64,104
RD 16,20,12288
Mvaa 164,68,108
buffer_load_dwordx4 v14, s[8:11], s29 offen offset:2048 lds
Zaaa 208,76,108
s_load_dwordx2 s[56:57], s[0:1], 40
RD 20,21,12288
Maaa 208,72,104
Zvaa 172,80,104
RD 24,20,14336
Mvaa 172,84,108
buffer_load_dwordx4 v15, s[8:11], s29 offen offset:3072 lds
Zaaa 212,92,108
RD 28,21,14336
Maaa 212,88,104
s_add_u32 s76, s37, 524544
s_and_b32 s76, s76, 8388607
Zvaa 136,64,112
s_add_u32 m0, s34, 114688
RT 32,22,16384
Mvaa 136,68,116
buffer_load_dwordx4 v16, s[12:15], s76 offen offset:0 lds
Zvaa 244,76,116
RT 34,22,18432
Mvaa 244,72,112
Zvaa 140,80,112
RT 36,22,17408
Mvaa 140,84,116
buffer_load_dwordx4 v17, s[12:15], s76 offen offset:1024 lds
Zvaa 240,92,116
RT 38,22,19456
Mvaa 240,88,112
Zvaa 64,64,120
RT 40,23,16384
Mvaa 64,68,124
buffer_load_dwordx4 v18, s[12:15], s76 offen offset:2048 lds
Zaaa 216,76,124
RT 42,23,18432
Maaa 216,72,120
Zvaa 68,80,120
RT 44,23,17408
Mvaa 68,84,124
buffer_load_dwordx4 v19, s[12:15], s76 offen offset:3072 lds
Zaaa 220,92,124
RT 46,23,19456
Maaa 220,88,120
s_add_u32 s29, s30, 256
s_and_b32 s29, s29, 133119
s_waitcnt lgkmcnt(8)
Zvaa 144,64,0
s_add_u32 m0, s33, 65536
RT 48,24,16384
Mvaa 144,68,4
buffer_load_dwordx4 v12, s[8:11], s29 offen offset:0 lds
Zaaa 224,76,4
RT 50,24,18432
Maaa 224,72,0
Zvaa 148,80,0
RT 52,24,17408
Mvaa 148,84,4
buffer_load_dwordx4 v13, s[8:11], s29 offen offset:1024 lds
Zaaa 228,92,4
RT 54,24,19456
Maaa 228,88,0
Zvaa 88,64,8
RT 56,25,16384
Mvaa 88,68,12
buffer_load_dwordx4 v14, s[8:11], s29 offen offset:2048 lds
Zaaa 232,76,12
RT 58,25,18432
Maaa 232,72,8
Zvaa 92,80,8
RT 60,25,17408
Mvaa 92,84,12
buffer_load_dwordx4 v15, s[8:11], s29 offen offset:3072 lds
Zaaa 236,92,12
RT 62,25,19456
Maaa 236,88,8
s_add_u32 s76, s37, 1048576
s_and_b32 s76, s76, 8388607
Zvaa 152,64,16
s_add_u32 m0, s34, 32768
v_add_u32 v20, -131072, v20
v_add_u32 v21, -131072, v21
Mvaa 152,68,20
buffer_load_dwordx4 v16, s[12:15], s76 offen offset:0 lds
Zaaa 240,76,20
v_xor_b32 v22, 0x10000, v22
v_xor_b32 v23, 0x10000, v23
Maaa 240,72,16
Zvaa 156,80,16
v_xor_b32 v24, 0x10000, v24
v_xor_b32 v25, 0x10000, v25
Mvaa 156,84,20
buffer_load_dwordx4 v17, s[12:15], s76 offen offset:1024 lds
Zaaa 244,92,20
Maaa 244,88,16
Zvaa 112,64,24
Mvaa 112,68,28
buffer_load_dwordx4 v18, s[12:15], s76 offen offset:2048 lds
Zaaa 248,76,28
Maaa 248,72,24
Zvaa 116,80,24
Mvaa 116,84,28
buffer_load_dwordx4 v19, s[12:15], s76 offen offset:3072 lds
Zaaa 252,92,28
Maaa 252,88,24
s_mov_b32 s58, 3670016
s_waitcnt vmcnt(18) lgkmcnt(0)
s_barrier
s_add_u32 s29, s30, 131328
s_and_b32 s29, s29, 133119
Zvaa 160,32,96
s_add_u32 m0, s33, 73728
RT 64,22,0
v_mov_b64 v[38:39], 0
Mvaa 160,36,100
buffer_load_dwordx4 v12, s[8:11], s29 offen offset:0 lds
s_nop 0
s_nop 0
Zvaa 236,44,100
RT 66,22,2048
v_mov_b64 v[40:41], 0
Mvaa 236,40,96
Zvaa 168,48,96
RT 68,22,1024
Mvaa 168,52,100
buffer_load_dwordx4 v13, s[8:11], s29 offen offset:1024 lds
Zvaa 232,60,100
RT 70,22,3072
Mvaa 232,56,96
Zvaa 48,32,104
RD 96,20,0
Mvaa 48,36,108
buffer_load_dwordx4 v14, s[8:11], s29 offen offset:2048 lds
Zvaa 228,44,108
RD 100,21,0
Mvaa 228,40,104
Zvaa 52,48,104
RT 72,23,0
Mvaa 52,52,108
buffer_load_dwordx4 v15, s[8:11], s29 offen offset:3072 lds
Zvaa 224,60,108
RT 74,23,2048
Mvaa 224,56,104
s_add_u32 s76, s37, 1048832
s_and_b32 s76, s76, 8388607
Zvaa 56,32,112
s_add_u32 m0, s34, 49152
RD 104,20,2048
Mvaa 56,36,116
buffer_load_dwordx4 v16, s[12:15], s76 offen offset:0 lds
Zvaa 220,44,116
RD 108,21,2048
Mvaa 220,40,112
Zvaa 60,48,112
RT 76,23,1024
Mvaa 60,52,116
buffer_load_dwordx4 v17, s[12:15], s76 offen offset:1024 lds
Zvaa 216,60,116
RT 78,23,3072
Mvaa 216,56,112
Zvaa 72,32,120
RD 112,20,4096
Mvaa 72,36,124
buffer_load_dwordx4 v18, s[12:15], s76 offen offset:2048 lds
Zvaa 212,44,124
RD 116,21,4096
Mvaa 212,40,120
Zvaa 76,48,120
RT 80,24,0
Mvaa 76,52,124
buffer_load_dwordx4 v19, s[12:15], s76 offen offset:3072 lds
Zvaa 208,60,124
RT 82,24,2048
Mvaa 208,56,120
s_add_u32 s29, s30, 384
s_and_b32 s29, s29, 133119
Zvaa 80,32,0
s_add_u32 m0, s33, 131072
RD 120,20,6144
Mvaa 80,36,4
buffer_load_dwordx4 v12, s[8:11], s29 offen offset:0 lds
Zvaa 204,44,4
RD 124,21,6144
Mvaa 204,40,0
Zvaa 84,48,0
RT 84,24,1024
Mvaa 84,52,4
buffer_load_dwordx4 v13, s[8:11], s29 offen offset:1024 lds
Zvaa 200,60,4
RT 86,24,3072
Mvaa 200,56,0
Zvaa 96,32,8
RT 88,25,0
Mvaa 96,36,12
buffer_load_dwordx4 v14, s[8:11], s29 offen offset:2048 lds
Zvaa 196,44,12
RT 90,25,2048
Mvaa 196,40,8
Zvaa 100,48,8
RT 92,25,1024
Mvaa 100,52,12
buffer_load_dwordx4 v15, s[8:11], s29 offen offset:3072 lds
Zvaa 192,60,12
RT 94,25,3072
Mvaa 192,56,8
s_add_u32 s76, s30, 131456
s_and_b32 s76, s76, 133119
Zvaa 104,32,16
s_add_u32 m0, s33, 139264
Mvaa 104,36,20
buffer_load_dwordx4 v12, s[8:11], s76 offen offset:0 lds
Zvaa 188,44,20
Mvaa 188,40,16
Zvaa 108,48,16
Mvaa 108,52,20
buffer_load_dwordx4 v13, s[8:11], s76 offen offset:1024 lds
Zvaa 184,60,20
Mvaa 184,56,16
Zvaa 120,32,24
Mvaa 120,36,28
buffer_load_dwordx4 v14, s[8:11], s76 offen offset:2048 lds
Zvaa 180,44,28
Mvaa 180,40,24
Zvaa 124,48,24
Mvaa 124,52,28
buffer_load_dwordx4 v15, s[8:11], s76 offen offset:3072 lds
Zvaa 176,60,28
Mvaa 176,56,24
s_bitcmp1_b32 s24, 1
s_cbranch_scc1 LH_K0
s_bitcmp1_b32 s24, 0
s_cbranch_scc1 LA_K0
s_call_b64 s[48:49], LP9
s_branch LR_K0
LA_K0:
s_call_b64 s[48:49], LP10
s_branch LR_K0
LH_K0:
s_bitcmp1_b32 s24, 0
s_cbranch_scc1 LB_K0
s_call_b64 s[48:49], LP11
s_branch LR_K0
LB_K0:
s_call_b64 s[48:49], LP12
LR_K0:
s_waitcnt vmcnt(24) lgkmcnt(0)
s_barrier
s_add_u32 s29, s37, 1572864
s_and_b32 s29, s29, 8388607
Mvaa 128,64,96
s_add_u32 m0, s34, 98304
RD 0,20,8192
Mvaa 128,68,100
buffer_load_dwordx4 v16, s[12:15], s29 offen offset:0 lds
Mvaa 252,76,100
RD 4,21,8192
Mvaa 252,72,96
Mvaa 132,80,96
s_mov_b32 s78, 0
RD 8,20,10240
Mvaa 132,84,100
buffer_load_dwordx2 a[160:161], v2, s[52:55], s78 offen nt
Mvaa 248,92,100
RD 12,21,10240
Mvaa 248,88,96
Mvaa 164,64,104
RD 16,20,12288
Mvaa 164,68,108
buffer_load_dwordx4 v17, s[12:15], s29 offen offset:1024 lds
Maaa 208,76,108
RD 20,21,12288
Maaa 208,72,104
Mvaa 172,80,104
s_mov_b32 s78, 3584
RD 24,20,14336
Mvaa 172,84,108
buffer_load_dwordx2 a[162:163], v2, s[52:55], s78 offen nt
Maaa 212,92,108
RD 28,21,14336
Maaa 212,88,104
Mvaa 136,64,112
RT 32,22,16384
Mvaa 136,68,116
buffer_load_dwordx4 v18, s[12:15], s29 offen offset:2048 lds
Mvaa 244,76,116
RT 34,22,18432
Mvaa 244,72,112
Mvaa 140,80,112
s_mov_b32 s78, 7168
RT 36,22,17408
Mvaa 140,84,116
buffer_load_dwordx2 a[164:165], v2, s[52:55], s78 offen nt
Mvaa 240,92,116
RT 38,22,19456
Mvaa 240,88,112
Mvaa 64,64,120
RT 40,23,16384
Mvaa 64,68,124
buffer_load_dwordx4 v19, s[12:15], s29 offen offset:3072 lds
Maaa 216,76,124
RT 42,23,18432
Maaa 216,72,120
Mvaa 68,80,120
RT 44,23,17408
Mvaa 68,84,124
buffer_store_dwordx4 v[38:41], v5, s[4:7], s72 offen sc1
Maaa 220,92,124
s_waitcnt vmcnt(50)
RT 46,23,19456
Maaa 220,88,120
s_add_u32 s76, s30, 512
s_and_b32 s76, s76, 133119
s_waitcnt lgkmcnt(8)
Mvaa 144,64,0
s_add_u32 m0, s33, 0
RT 48,24,16384
v_accvgpr_read_b32 v29, a176
Mvaa 144,68,4
buffer_load_dwordx4 v12, s[8:11], s76 offen offset:0 lds
Maaa 224,76,4
RT 50,24,18432
v_lshlrev_b32 v30, 16, v29
Maaa 224,72,0
v_and_b32 v31, 0xffff0000, v29
v_accvgpr_read_b32 v29, a177
Mvaa 148,80,0
s_mov_b32 s78, 10752
RT 52,24,17408
v_lshlrev_b32 v32, 16, v29
Mvaa 148,84,4
buffer_load_dwordx2 a[166:167], v2, s[52:55], s78 offen nt
Maaa 228,92,4
RT 54,24,19456
v_and_b32 v33, 0xffff0000, v29
Maaa 228,88,0
v_accvgpr_read_b32 v29, a178
v_lshlrev_b32 v34, 16, v29
Mvaa 88,64,8
RT 56,25,16384
v_and_b32 v35, 0xffff0000, v29
Mvaa 88,68,12
buffer_load_dwordx4 v13, s[8:11], s76 offen offset:1024 lds
Maaa 232,76,12
RT 58,25,18432
v_accvgpr_read_b32 v29, a179
Maaa 232,72,8
v_lshlrev_b32 v36, 16, v29
v_and_b32 v37, 0xffff0000, v29
Mvaa 92,80,8
s_add_u32 s78, s73, 0
RT 60,25,17408
v_accvgpr_read_b32 v29, a180
Mvaa 92,84,12
buffer_load_dwordx2 a[168:169], v2, s[52:55], s78 offen nt
Maaa 236,92,12
RT 62,25,19456
v_lshlrev_b32 v38, 16, v29
Maaa 236,88,8
v_and_b32 v39, 0xffff0000, v29
v_accvgpr_read_b32 v29, a181
Mvaa 152,64,16
v_add_u32 v20, 65536, v20
v_add_u32 v21, 65536, v21
Mvaa 152,68,20
buffer_load_dwordx4 v14, s[8:11], s76 offen offset:2048 lds
Maaa 240,76,20
v_xor_b32 v22, 0x10000, v22
v_xor_b32 v23, 0x10000, v23
Maaa 240,72,16
v_lshlrev_b32 v40, 16, v29
v_and_b32 v41, 0xffff0000, v29
Mvaa 156,80,16
s_add_u32 s78, s73, 3584
v_xor_b32 v24, 0x10000, v24
v_xor_b32 v25, 0x10000, v25
Mvaa 156,84,20
buffer_load_dwordx2 a[170:171], v2, s[52:55], s78 offen nt
Maaa 244,92,20
v_accvgpr_read_b32 v29, a182
v_lshlrev_b32 v42, 16, v29
Maaa 244,88,16
v_and_b32 v43, 0xffff0000, v29
v_accvgpr_read_b32 v29, a183
Mvaa 112,64,24
v_lshlrev_b32 v44, 16, v29
v_and_b32 v45, 0xffff0000, v29
Mvaa 112,68,28
buffer_load_dwordx4 v15, s[8:11], s76 offen offset:3072 lds
Maaa 248,76,28
v_add_f32 v46, v30, v31
v_add_f32 v47, v32, v33
Maaa 248,72,24
v_add_f32 v46, v46, v34
v_add_f32 v47, v47, v35
Mvaa 116,80,24
v_add_f32 v46, v46, v36
v_add_f32 v47, v47, v37
Mvaa 116,84,28
v_add_f32 v46, v46, v38
v_add_f32 v47, v47, v39
Maaa 252,92,28
v_add_f32 v46, v46, v40
v_add_f32 v47, v47, v41
Maaa 252,88,24
v_add_f32 v46, v46, v42
v_add_f32 v47, v47, v43
s_bitcmp1_b32 s24, 1
s_cbranch_scc1 LH_K1
s_bitcmp1_b32 s24, 0
s_cbranch_scc1 LA_K1
s_call_b64 s[48:49], LP13
s_branch LR_K1
LA_K1:
s_call_b64 s[48:49], LP14
s_branch LR_K1
LH_K1:
s_bitcmp1_b32 s24, 0
s_cbranch_scc1 LB_K1
s_call_b64 s[48:49], LP15
s_branch LR_K1
LB_K1:
s_call_b64 s[48:49], LP15
LR_K1:
s_waitcnt vmcnt(31) lgkmcnt(0)
s_barrier
s_add_u32 s29, s37, 1573120
s_and_b32 s29, s29, 8388607
Mvaa 160,32,96
s_add_u32 m0, s34, 114688
RT 64,22,0
v_add_f32 v46, v46, v44
Mvaa 160,36,100
buffer_load_dwordx4 v16, s[12:15], s29 offen offset:0 lds
Mvaa 236,44,100
RT 66,22,2048
v_add_f32 v47, v47, v45
Mvaa 236,40,96
v_accvgpr_read_b32 v29, a184
v_lshlrev_b32 v7, 16, v29
Mvaa 168,48,96
s_add_u32 s78, s73, 7168
RT 68,22,1024
v_and_b32 v29, 0xffff0000, v29
Mvaa 168,52,100
buffer_load_dwordx2 a[172:173], v2, s[52:55], s78 offen nt
Mvaa 232,60,100
RT 70,22,3072
v_add_f32 v46, v46, v7
Mvaa 232,56,96
v_add_f32 v47, v47, v29
v_accvgpr_read_b32 v29, a185
Mvaa 48,32,104
RD 96,20,0
v_lshlrev_b32 v7, 16, v29
Mvaa 48,36,108
buffer_load_dwordx4 v17, s[12:15], s29 offen offset:1024 lds
Mvaa 228,44,108
RD 100,21,0
v_and_b32 v29, 0xffff0000, v29
Mvaa 228,40,104
v_add_f32 v46, v46, v7
v_add_f32 v47, v47, v29
Mvaa 52,48,104
RT 72,23,0
v_accvgpr_read_b32 v29, a186
Mvaa 52,52,108
v_lshlrev_b32 v7, 16, v29
v_and_b32 v29, 0xffff0000, v29
Mvaa 224,60,108
RT 74,23,2048
v_add_f32 v46, v46, v7
Mvaa 224,56,104
v_add_f32 v47, v47, v29
v_accvgpr_read_b32 v29, a187
Mvaa 56,32,112
RD 104,20,2048
v_lshlrev_b32 v7, 16, v29
Mvaa 56,36,116
buffer_load_dwordx4 v18, s[12:15], s29 offen offset:2048 lds
Mvaa 220,44,116
RD 108,21,2048
v_and_b32 v29, 0xffff0000, v29
Mvaa 220,40,112
v_add_f32 v46, v46, v7
v_add_f32 v47, v47, v29
Mvaa 60,48,112
RT 76,23,1024
v_accvgpr_read_b32 v29, a188
Mvaa 60,52,116
v_lshlrev_b32 v7, 16, v29
v_and_b32 v29, 0xffff0000, v29
Mvaa 216,60,116
RT 78,23,3072
v_add_f32 v46, v46, v7
Mvaa 216,56,112
v_add_f32 v47, v47, v29
v_accvgpr_read_b32 v29, a189
Mvaa 72,32,120
RD 112,20,4096
v_lshlrev_b32 v7, 16, v29
Mvaa 72,36,124
buffer_load_dwordx4 v19, s[12:15], s29 offen offset:3072 lds
Mvaa 212,44,124
RD 116,21,4096
v_and_b32 v29, 0xffff0000, v29
Mvaa 212,40,120
v_add_f32 v46, v46, v7
v_add_f32 v47, v47, v29
Mvaa 76,48,120
RT 80,24,0
v_accvgpr_read_b32 v29, a190
Mvaa 76,52,124
v_lshlrev_b32 v7, 16, v29
v_and_b32 v29, 0xffff0000, v29
Mvaa 208,60,124
RT 82,24,2048
v_add_f32 v46, v46, v7
Mvaa 208,56,120
s_add_u32 s76, s30, 131584
s_and_b32 s76, s76, 133119
v_add_f32 v47, v47, v29
v_accvgpr_read_b32 v29, a191
Mvaa 80,32,0
s_add_u32 m0, s33, 8192
RD 120,20,6144
v_lshlrev_b32 v7, 16, v29
Mvaa 80,36,4
buffer_load_dwordx4 v12, s[8:11], s76 offen offset:0 lds
Mvaa 204,44,4
RD 124,21,6144
v_and_b32 v29, 0xffff0000, v29
Mvaa 204,40,0
v_add_f32 v46, v46, v7
v_add_f32 v47, v47, v29
Mvaa 84,48,0
s_add_u32 s78, s73, 10752
RT 84,24,1024
v_add_f32 v46, v46, v47
Mvaa 84,52,4
buffer_load_dwordx2 a[174:175], v2, s[52:55], s78 offen nt
Mvaa 200,60,4
RT 86,24,3072
v_add_f32_dpp v46, v46, v46 row_ror:8 row_mask:0xf bank_mask:0xf
Mvaa 200,56,0
Mvaa 96,32,8
RT 88,25,0
v_add_f32_dpp v46, v46, v46 row_ror:4 row_mask:0xf bank_mask:0xf
Mvaa 96,36,12
buffer_load_dwordx4 v13, s[8:11], s76 offen offset:1024 lds
Mvaa 196,44,12
RT 90,25,2048
v_mov_b32 v7, v46
Mvaa 196,40,8
Mvaa 100,48,8
RT 92,25,1024
v_permlane16_swap_b32 v46, v7
Mvaa 100,52,12
v_add_f32 v46, v46, v7
v_mov_b32 v7, v46
Mvaa 192,60,12
RT 94,25,3072
Mvaa 192,56,8
v_permlane32_swap_b32 v46, v7
Mvaa 104,32,16
v_add_f32 v46, v46, v7
v_mul_f32 v46, 0x3b124925, v46
Mvaa 104,36,20
buffer_load_dwordx4 v14, s[8:11], s76 offen offset:2048 lds
Mvaa 188,44,20
v_sub_f32 v29, v30, v46
v_mul_f32 v47, v29, v29
Mvaa 188,40,16
v_sub_f32 v29, v31, v46
v_fma_f32 v47, v29, v29, v47
Mvaa 108,48,16
v_sub_f32 v29, v32, v46
v_fma_f32 v47, v29, v29, v47
Mvaa 108,52,20
v_sub_f32 v29, v33, v46
v_fma_f32 v47, v29, v29, v47
Mvaa 184,60,20
v_sub_f32 v29, v34, v46
v_fma_f32 v47, v29, v29, v47
Mvaa 184,56,16
v_sub_f32 v29, v35, v46
v_fma_f32 v47, v29, v29, v47
Mvaa 120,32,24
v_sub_f32 v29, v36, v46
v_fma_f32 v47, v29, v29, v47
Mvaa 120,36,28
buffer_load_dwordx4 v15, s[8:11], s76 offen offset:3072 lds
Mvaa 180,44,28
v_sub_f32 v29, v37, v46
v_fma_f32 v47, v29, v29, v47
Mvaa 180,40,24
v_sub_f32 v29, v38, v46
v_fma_f32 v47, v29, v29, v47
Mvaa 124,48,24
v_sub_f32 v29, v39, v46
v_fma_f32 v47, v29, v29, v47
Mvaa 124,52,28
v_sub_f32 v29, v40, v46
v_fma_f32 v47, v29, v29, v47
Mvaa 176,60,28
v_sub_f32 v29, v41, v46
v_fma_f32 v47, v29, v29, v47
Mvaa 176,56,24
v_sub_f32 v29, v42, v46
v_fma_f32 v47, v29, v29, v47
s_cmp_eq_u32 s60, 0
s_cbranch_scc0 L_tpbK3
s_bitcmp1_b32 s24, 1
s_cbranch_scc1 LH_aK2
s_bitcmp1_b32 s24, 0
s_cbranch_scc1 LA_aK2
s_call_b64 s[48:49], LP16
s_branch LR_aK2
LA_aK2:
s_call_b64 s[48:49], LP17
s_branch LR_aK2
LH_aK2:
s_bitcmp1_b32 s24, 0
s_cbranch_scc1 LB_aK2
s_call_b64 s[48:49], LP18
s_branch LR_aK2
LB_aK2:
s_call_b64 s[48:49], LP19
LR_aK2:
s_branch L_tpeK3
L_tpbK3:
s_bitcmp1_b32 s24, 1
s_cbranch_scc1 LH_bK3
s_bitcmp1_b32 s24, 0
s_cbranch_scc1 LA_bK3
s_call_b64 s[48:49], LP25
s_branch LR_bK3
LA_bK3:
s_call_b64 s[48:49], LP26
s_branch LR_bK3
LH_bK3:
s_bitcmp1_b32 s24, 0
s_cbranch_scc1 LB_bK3
s_call_b64 s[48:49], LP27
s_branch LR_bK3
LB_bK3:
s_call_b64 s[48:49], LP28
LR_bK3:
L_tpeK3:
s_waitcnt vmcnt(33) lgkmcnt(0)
s_barrier
s_add_u32 s29, s37, 2097152
s_and_b32 s29, s29, 8388607
Mvaa 128,64,96
s_add_u32 m0, s34, 32768
RD 0,20,8192
v_sub_f32 v29, v43, v46
Mvaa 128,68,100
buffer_load_dwordx4 v16, s[12:15], s29 offen offset:0 lds
Mvaa 252,76,100
RD 4,21,8192
v_fma_f32 v47, v29, v29, v47
Mvaa 252,72,96
v_sub_f32 v29, v44, v46
v_fma_f32 v47, v29, v29, v47
Mvaa 132,80,96
s_mov_b32 s78, 0
RD 8,20,10240
v_sub_f32 v29, v45, v46
Mvaa 132,84,100
buffer_load_dwordx2 a[128:129], v26, s[16:19], s78 offen nt
Mvaa 248,92,100
RD 12,21,10240
v_fma_f32 v47, v29, v29, v47
Mvaa 248,88,96
v_accvgpr_read_b32 v29, a184
v_lshlrev_b32 v7, 16, v29
Mvaa 164,64,104
RD 16,20,12288
v_and_b32 v29, 0xffff0000, v29
Mvaa 164,68,108
buffer_load_dwordx4 v17, s[12:15], s29 offen offset:1024 lds
Maaa 208,76,108
RD 20,21,12288
v_sub_f32 v7, v7, v46
Maaa 208,72,104
v_sub_f32 v29, v29, v46
v_fma_f32 v47, v7, v7, v47
Mvaa 172,80,104
RD 24,20,14336
v_fma_f32 v47, v29, v29, v47
Mvaa 172,84,108
v_accvgpr_read_b32 v29, a185
v_lshlrev_b32 v7, 16, v29
Maaa 212,92,108
RD 28,21,14336
v_and_b32 v29, 0xffff0000, v29
Maaa 212,88,104
v_sub_f32 v7, v7, v46
v_sub_f32 v29, v29, v46
Mvaa 136,64,112
RT 32,22,16384
v_fma_f32 v47, v7, v7, v47
Mvaa 136,68,116
buffer_load_dwordx4 v18, s[12:15], s29 offen offset:2048 lds
Mvaa 244,76,116
RT 34,22,18432
v_fma_f32 v47, v29, v29, v47
Mvaa 244,72,112
v_accvgpr_read_b32 v29, a186
v_lshlrev_b32 v7, 16, v29
Mvaa 140,80,112
s_mov_b32 s78, 8192
RT 36,22,17408
v_and_b32 v29, 0xffff0000, v29
Mvaa 140,84,116
buffer_load_dwordx2 a[130:131], v26, s[16:19], s78 offen nt
Mvaa 240,92,116
RT 38,22,19456
v_sub_f32 v7, v7, v46
Mvaa 240,88,112
s_branch LOP9
LP9:
s_setpc_b64 s[48:49]
LOP9:
v_sub_f32 v29, v29, v46
v_fma_f32 v47, v7, v7, v47
Mvaa 64,64,120
RT 40,23,16384
v_fma_f32 v47, v29, v29, v47
Mvaa 64,68,124
buffer_load_dwordx4 v19, s[12:15], s29 offen offset:3072 lds
Maaa 216,76,124
RT 42,23,18432
v_accvgpr_read_b32 v29, a187
Maaa 216,72,120
v_lshlrev_b32 v7, 16, v29
v_and_b32 v29, 0xffff0000, v29
Mvaa 68,80,120
RT 44,23,17408
v_sub_f32 v7, v7, v46
Mvaa 68,84,124
v_sub_f32 v29, v29, v46
v_fma_f32 v47, v7, v7, v47
Maaa 220,92,124
RT 46,23,19456
v_fma_f32 v47, v29, v29, v47
Maaa 220,88,120
s_add_u32 s76, s30, 640
s_and_b32 s76, s76, 133119
s_waitcnt lgkmcnt(8)
v_accvgpr_read_b32 v29, a188
Mvaa 144,64,0
s_add_u32 m0, s33, 65536
RT 48,24,16384
v_lshlrev_b32 v7, 16, v29
Mvaa 144,68,4
buffer_load_dwordx4 v12, s[8:11], s76 offen offset:0 lds
Maaa 224,76,4
RT 50,24,18432
v_and_b32 v29, 0xffff0000, v29
Maaa 224,72,0
v_sub_f32 v7, v7, v46
v_sub_f32 v29, v29, v46
Mvaa 148,80,0
s_mov_b32 s78, 16384
RT 52,24,17408
v_fma_f32 v47, v7, v7, v47
Mvaa 148,84,4
buffer_load_dwordx2 a[132:133], v26, s[16:19], s78 offen nt
Maaa 228,92,4
RT 54,24,19456
v_fma_f32 v47, v29, v29, v47
Maaa 228,88,0
v_accvgpr_read_b32 v29, a189
v_lshlrev_b32 v7, 16, v29
Mvaa 88,64,8
RT 56,25,16384
v_and_b32 v29, 0xffff0000, v29
Mvaa 88,68,12
buffer_load_dwordx4 v13, s[8:11], s76 offen offset:1024 lds
Maaa 232,76,12
RT 58,25,18432
v_sub_f32 v7, v7, v46
Maaa 232,72,8
v_sub_f32 v29, v29, v46
v_fma_f32 v47, v7, v7, v47
Mvaa 92,80,8
RT 60,25,17408
v_fma_f32 v47, v29, v29, v47
Mvaa 92,84,12
v_accvgpr_read_b32 v29, a190
v_lshlrev_b32 v7, 16, v29
Maaa 236,92,12
RT 62,25,19456
v_and_b32 v29, 0xffff0000, v29
Maaa 236,88,8
v_sub_f32 v7, v7, v46
v_sub_f32 v29, v29, v46
Mvaa 152,64,16
v_add_u32 v20, 65536, v20
v_add_u32 v21, 65536, v21
Mvaa 152,68,20
buffer_load_dwordx4 v14, s[8:11], s76 offen offset:2048 lds
Maaa 240,76,20
v_xor_b32 v22, 0x10000, v22
v_xor_b32 v23, 0x10000, v23
Maaa 240,72,16
v_fma_f32 v47, v7, v7, v47
v_fma_f32 v47, v29, v29, v47
Mvaa 156,80,16
s_mov_b32 s78, 24576
v_xor_b32 v24, 0x10000, v24
v_xor_b32 v25, 0x10000, v25
Mvaa 156,84,20
buffer_load_dwordx2 a[134:135], v26, s[16:19], s78 offen nt
Maaa 244,92,20
v_accvgpr_read_b32 v29, a191
v_lshlrev_b32 v7, 16, v29
Maaa 244,88,16
v_and_b32 v29, 0xffff0000, v29
v_sub_f32 v7, v7, v46
Mvaa 112,64,24
v_sub_f32 v29, v29, v46
v_fma_f32 v47, v7, v7, v47
Mvaa 112,68,28
buffer_load_dwordx4 v15, s[8:11], s76 offen offset:3072 lds
Maaa 248,76,28
v_fma_f32 v47, v29, v29, v47
v_cndmask_b32 v47, 0, v47, s[84:85]
Maaa 248,72,24
Mvaa 116,80,24
v_add_f32_dpp v47, v47, v47 row_ror:8 row_mask:0xf bank_mask:0xf
Mvaa 116,84,28
Maaa 252,92,28
v_add_f32_dpp v47, v47, v47 row_ror:4 row_mask:0xf bank_mask:0xf
v_mov_b32 v7, v47
Maaa 252,88,24
s_waitcnt vmcnt(30) lgkmcnt(0)
s_barrier
s_add_u32 s29, s37, 2097408
s_and_b32 s29, s29, 8388607
Mvaa 160,32,96
s_add_u32 m0, s34, 49152
RT 64,22,0
v_permlane16_swap_b32 v47, v7
Mvaa 160,36,100
buffer_load_dwordx4 v16, s[12:15], s29 offen offset:0 lds
Mvaa 236,44,100
RT 66,22,2048
v_add_f32 v47, v47, v7
Mvaa 236,40,96
v_mov_b32 v7, v47
Mvaa 168,48,96
s_mov_b32 s78, 32768
RT 68,22,1024
Mvaa 168,52,100
buffer_load_dwordx2 a[136:137], v26, s[16:19], s78 offen nt
Mvaa 232,60,100
RT 70,22,3072
v_permlane32_swap_b32 v47, v7
Mvaa 232,56,96
v_add_f32 v47, v47, v7
v_mul_f32 v47, 0x3b124925, v47
Mvaa 48,32,104
RD 96,20,0
v_cvt_pk_bf16_f32 v29, v46, v47
Mvaa 48,36,108
buffer_load_dwordx4 v17, s[12:15], s29 offen offset:1024 lds
Mvaa 228,44,108
RD 100,21,0
v_lshlrev_b32 v46, 16, v29
Mvaa 228,40,104
v_and_b32 v47, 0xffff0000, v29
v_add_f32 v47, 0x3727c5ac, v47
Mvaa 52,48,104
RT 72,23,0
v_cvt_pk_bf16_f32 v47, v47, v47
Mvaa 52,52,108
v_lshlrev_b32 v47, 16, v47
Mvaa 224,60,108
RT 74,23,2048
Mvaa 224,56,104
v_sqrt_f32 v47, v47
Mvaa 56,32,112
RD 104,20,2048
v_cvt_pk_bf16_f32 v47, v47, v47
Mvaa 56,36,116
buffer_load_dwordx4 v18, s[12:15], s29 offen offset:2048 lds
Mvaa 220,44,116
RD 108,21,2048
v_lshlrev_b32 v47, 16, v47
Mvaa 220,40,112
v_rcp_f32 v47, v47
Mvaa 60,48,112
s_mov_b32 s78, 40960
RT 76,23,1024
v_sub_f32 v30, v30, v46
Mvaa 60,52,116
buffer_load_dwordx2 a[138:139], v26, s[16:19], s78 offen nt
Mvaa 216,60,116
RT 78,23,3072
v_sub_f32 v31, v31, v46
Mvaa 216,56,112
v_sub_f32 v32, v32, v46
v_sub_f32 v33, v33, v46
Mvaa 72,32,120
RD 112,20,4096
v_sub_f32 v34, v34, v46
Mvaa 72,36,124
buffer_load_dwordx4 v19, s[12:15], s29 offen offset:3072 lds
Mvaa 212,44,124
RD 116,21,4096
v_sub_f32 v35, v35, v46
Mvaa 212,40,120
v_sub_f32 v36, v36, v46
v_sub_f32 v37, v37, v46
Mvaa 76,48,120
RT 80,24,0
v_sub_f32 v38, v38, v46
Mvaa 76,52,124
v_sub_f32 v39, v39, v46
v_sub_f32 v40, v40, v46
Mvaa 208,60,124
RT 82,24,2048
v_sub_f32 v41, v41, v46
Mvaa 208,56,120
s_add_u32 s76, s30, 131712
s_and_b32 s76, s76, 133119
v_sub_f32 v42, v42, v46
v_sub_f32 v43, v43, v46
Mvaa 80,32,0
s_add_u32 m0, s33, 73728
RD 120,20,6144
v_sub_f32 v44, v44, v46
Mvaa 80,36,4
buffer_load_dwordx4 v12, s[8:11], s76 offen offset:0 lds
Mvaa 204,44,4
RD 124,21,6144
v_sub_f32 v45, v45, v46
Mvaa 204,40,0
v_mul_f32 v47, 0x30800000, v47
v_cvt_pk_bf16_f32 v29, v30, v31
Mvaa 84,48,0
s_mov_b32 s78, 49152
RT 84,24,1024
v_lshlrev_b32 v30, 16, v29
Mvaa 84,52,4
buffer_load_dwordx2 a[140:141], v26, s[16:19], s78 offen nt
Mvaa 200,60,4
RT 86,24,3072
v_and_b32 v31, 0xffff0000, v29
Mvaa 200,56,0
v_mul_f32 v30, v30, v47
v_mul_f32 v31, v31, v47
Mvaa 96,32,8
RT 88,25,0
v_cvt_pk_bf16_f32 v30, v30, v31
Mvaa 96,36,12
buffer_load_dwordx4 v13, s[8:11], s76 offen offset:1024 lds
Mvaa 196,44,12
RT 90,25,2048
v_cvt_pk_bf16_f32 v29, v32, v33
Mvaa 196,40,8
v_lshlrev_b32 v32, 16, v29
v_and_b32 v33, 0xffff0000, v29
Mvaa 100,48,8
RT 92,25,1024
v_mul_f32 v32, v32, v47
Mvaa 100,52,12
v_mul_f32 v33, v33, v47
v_cvt_pk_bf16_f32 v31, v32, v33
Mvaa 192,60,12
RT 94,25,3072
v_cvt_pk_bf16_f32 v29, v34, v35
Mvaa 192,56,8
v_lshlrev_b32 v34, 16, v29
v_and_b32 v35, 0xffff0000, v29
Mvaa 104,32,16
v_mul_f32 v34, v34, v47
v_mul_f32 v35, v35, v47
Mvaa 104,36,20
buffer_load_dwordx4 v14, s[8:11], s76 offen offset:2048 lds
Mvaa 188,44,20
v_cvt_pk_bf16_f32 v32, v34, v35
v_cvt_pk_bf16_f32 v29, v36, v37
Mvaa 188,40,16
v_lshlrev_b32 v36, 16, v29
v_and_b32 v37, 0xffff0000, v29
Mvaa 108,48,16
s_mov_b32 s78, 57344
v_mul_f32 v36, v36, v47
v_mul_f32 v37, v37, v47
Mvaa 108,52,20
buffer_load_dwordx2 a[142:143], v26, s[16:19], s78 offen nt
Mvaa 184,60,20
v_cvt_pk_bf16_f32 v33, v36, v37
v_cvt_pk_bf16_f32 v29, v38, v39
Mvaa 184,56,16
v_lshlrev_b32 v38, 16, v29
v_and_b32 v39, 0xffff0000, v29
Mvaa 120,32,24
v_mul_f32 v38, v38, v47
v_mul_f32 v39, v39, v47
Mvaa 120,36,28
buffer_load_dwordx4 v15, s[8:11], s76 offen offset:3072 lds
Mvaa 180,44,28
v_cvt_pk_bf16_f32 v34, v38, v39
v_cvt_pk_bf16_f32 v29, v40, v41
Mvaa 180,40,24
v_lshlrev_b32 v40, 16, v29
v_and_b32 v41, 0xffff0000, v29
Mvaa 124,48,24
v_mul_f32 v40, v40, v47
v_mul_f32 v41, v41, v47
Mvaa 124,52,28
v_cvt_pk_bf16_f32 v35, v40, v41
v_cvt_pk_bf16_f32 v29, v42, v43
Mvaa 176,60,28
v_lshlrev_b32 v42, 16, v29
v_and_b32 v43, 0xffff0000, v29
Mvaa 176,56,24
s_waitcnt vmcnt(41)
v_mul_f32 v42, v42, v47
v_mul_f32 v43, v43, v47
s_waitcnt vmcnt(29) lgkmcnt(0)
s_barrier
s_add_u32 s29, s37, 2621440
s_and_b32 s29, s29, 8388607
Mvaa 128,64,96
s_add_u32 m0, s34, 98304
RD 0,20,8192
v_cvt_pk_bf16_f32 v36, v42, v43
Mvaa 128,68,100
buffer_load_dwordx4 v16, s[12:15], s29 offen offset:0 lds
Mvaa 252,76,100
RD 4,21,8192
v_cvt_pk_bf16_f32 v29, v44, v45
Mvaa 252,72,96
v_lshlrev_b32 v44, 16, v29
v_and_b32 v45, 0xffff0000, v29
Mvaa 132,80,96
RD 8,20,10240
v_mul_f32 v44, v44, v47
Mvaa 132,84,100
v_mul_f32 v45, v45, v47
v_cvt_pk_bf16_f32 v37, v44, v45
Mvaa 248,92,100
RD 12,21,10240
Mvaa 248,88,96
Mvaa 164,64,104
RD 16,20,12288
Mvaa 164,68,108
buffer_load_dwordx4 v17, s[12:15], s29 offen offset:1024 lds
Maaa 208,76,108
RD 20,21,12288
Maaa 208,72,104
Mvaa 172,80,104
RD 24,20,14336
Mvaa 172,84,108
Maaa 212,92,108
RD 28,21,14336
Maaa 212,88,104
Mvaa 136,64,112
RT 32,22,16384
Mvaa 136,68,116
buffer_load_dwordx4 v18, s[12:15], s29 offen offset:2048 lds
Mvaa 244,76,116
RT 34,22,18432
Mvaa 244,72,112
Mvaa 140,80,112
RT 36,22,17408
Mvaa 140,84,116
Mvaa 240,92,116
RT 38,22,19456
Mvaa 240,88,112
Mvaa 64,64,120
RT 40,23,16384
Mvaa 64,68,124
buffer_load_dwordx4 v19, s[12:15], s29 offen offset:3072 lds
Maaa 216,76,124
RT 42,23,18432
Maaa 216,72,120
Mvaa 68,80,120
RT 44,23,17408
Mvaa 68,84,124
Maaa 220,92,124
RT 46,23,19456
Maaa 220,88,120
s_add_u32 s76, s30, 768
s_and_b32 s76, s76, 133119
s_waitcnt lgkmcnt(8)
Mvaa 144,64,0
s_add_u32 m0, s33, 131072
RT 48,24,16384
Mvaa 144,68,4
buffer_load_dwordx4 v12, s[8:11], s76 offen offset:0 lds
Maaa 224,76,4
RT 50,24,18432
Maaa 224,72,0
Mvaa 148,80,0
RT 52,24,17408
Mvaa 148,84,4
Maaa 228,92,4
RT 54,24,19456
Maaa 228,88,0
Mvaa 88,64,8
RT 56,25,16384
Mvaa 88,68,12
buffer_load_dwordx4 v13, s[8:11], s76 offen offset:1024 lds
Maaa 232,76,12
RT 58,25,18432
Maaa 232,72,8
Mvaa 92,80,8
RT 60,25,17408
Mvaa 92,84,12
Maaa 236,92,12
RT 62,25,19456
Maaa 236,88,8
Mvaa 152,64,16
v_add_u32 v20, -131072, v20
v_add_u32 v21, -131072, v21
Mvaa 152,68,20
buffer_load_dwordx4 v14, s[8:11], s76 offen offset:2048 lds
Maaa 240,76,20
v_xor_b32 v22, 0x10000, v22
v_xor_b32 v23, 0x10000, v23
Maaa 240,72,16
Mvaa 156,80,16
v_xor_b32 v24, 0x10000, v24
v_xor_b32 v25, 0x10000, v25
Mvaa 156,84,20
Maaa 244,92,20
Maaa 244,88,16
Mvaa 112,64,24
Mvaa 112,68,28
buffer_load_dwordx4 v15, s[8:11], s76 offen offset:3072 lds
Maaa 248,76,28
Maaa 248,72,24
Mvaa 116,80,24
Mvaa 116,84,28
buffer_store_byte v9, v8, s[20:23], s38 offen sc1
Maaa 252,92,28
Maaa 252,88,24
s_waitcnt vmcnt(27) lgkmcnt(0)
s_barrier
s_add_u32 s29, s37, 2621696
s_and_b32 s29, s29, 8388607
Mvaa 160,32,96
s_add_u32 m0, s34, 114688
RT 64,22,0
Mvaa 160,36,100
buffer_load_dwordx4 v16, s[12:15], s29 offen offset:0 lds
Mvaa 236,44,100
RT 66,22,2048
Mvaa 236,40,96
Mvaa 168,48,96
RT 68,22,1024
Mvaa 168,52,100
Mvaa 232,60,100
RT 70,22,3072
Mvaa 232,56,96
Mvaa 48,32,104
RD 96,20,0
Mvaa 48,36,108
buffer_load_dwordx4 v17, s[12:15], s29 offen offset:1024 lds
Mvaa 228,44,108
RD 100,21,0
Mvaa 228,40,104
Mvaa 52,48,104
RT 72,23,0
Mvaa 52,52,108
Mvaa 224,60,108
RT 74,23,2048
Mvaa 224,56,104
Mvaa 56,32,112
RD 104,20,2048
Mvaa 56,36,116
buffer_load_dwordx4 v18, s[12:15], s29 offen offset:2048 lds
Mvaa 220,44,116
RD 108,21,2048
Mvaa 220,40,112
Mvaa 60,48,112
RT 76,23,1024
Mvaa 60,52,116
Mvaa 216,60,116
RT 78,23,3072
Mvaa 216,56,112
Mvaa 72,32,120
RD 112,20,4096
Mvaa 72,36,124
buffer_load_dwordx4 v19, s[12:15], s29 offen offset:3072 lds
Mvaa 212,44,124
RD 116,21,4096
Mvaa 212,40,120
Mvaa 76,48,120
RT 80,24,0
Mvaa 76,52,124
Mvaa 208,60,124
RT 82,24,2048
Mvaa 208,56,120
s_add_u32 s76, s30, 131840
s_and_b32 s76, s76, 133119
Mvaa 80,32,0
s_add_u32 m0, s33, 139264
RD 120,20,6144
Mvaa 80,36,4
buffer_load_dwordx4 v12, s[8:11], s76 offen offset:0 lds
Mvaa 204,44,4
RD 124,21,6144
Mvaa 204,40,0
Mvaa 84,48,0
RT 84,24,1024
Mvaa 84,52,4
Mvaa 200,60,4
RT 86,24,3072
Mvaa 200,56,0
Mvaa 96,32,8
RT 88,25,0
Mvaa 96,36,12
buffer_load_dwordx4 v13, s[8:11], s76 offen offset:1024 lds
Mvaa 196,44,12
RT 90,25,2048
Mvaa 196,40,8
Mvaa 100,48,8
RT 92,25,1024
Mvaa 100,52,12
Mvaa 192,60,12
RT 94,25,3072
Mvaa 192,56,8
Mvaa 104,32,16
Mvaa 104,36,20
buffer_load_dwordx4 v14, s[8:11], s76 offen offset:2048 lds
Mvaa 188,44,20
Mvaa 188,40,16
Mvaa 108,48,16
Mvaa 108,52,20
Mvaa 184,60,20
Mvaa 184,56,16
Mvaa 120,32,24
Mvaa 120,36,28
buffer_load_dwordx4 v15, s[8:11], s76 offen offset:3072 lds
Mvaa 180,44,28
Mvaa 180,40,24
Mvaa 124,48,24
Mvaa 124,52,28
Mvaa 176,60,28
Mvaa 176,56,24
s_waitcnt vmcnt(23) lgkmcnt(0)
s_barrier
s_add_u32 s29, s37, 3145728
s_and_b32 s29, s29, 8388607
Mvaa 128,64,96
s_add_u32 m0, s34, 32768
RD 0,20,8192
Mvaa 128,68,100
buffer_load_dwordx4 v16, s[12:15], s29 offen offset:0 lds
Mvaa 252,76,100
s_waitcnt vmcnt(19)
RD 4,21,8192
Mvaa 252,72,96
Mvaa 132,80,96
RD 8,20,10240
Mvaa 132,84,100
buffer_store_dwordx4 v[30:33], v28, s[4:7], s69 offen sc1
Mvaa 248,92,100
RD 12,21,10240
Mvaa 248,88,96
Mvaa 164,64,104
RD 16,20,12288
Mvaa 164,68,108
buffer_load_dwordx4 v17, s[12:15], s29 offen offset:1024 lds
Maaa 208,76,108
RD 20,21,12288
Maaa 208,72,104
Mvaa 172,80,104
s_branch LOP10
LP10:
s_setpc_b64 s[48:49]
LOP10:
RD 24,20,14336
Mvaa 172,84,108
buffer_store_dwordx4 v[34:37], v28, s[4:7], s69 offen offset:3584 sc1
Maaa 212,92,108
s_waitcnt vmcnt(48)
RD 28,21,14336
Maaa 212,88,104
Mvaa 136,64,112
RT 32,22,16384
v_accvgpr_read_b32 v30, a160
Mvaa 136,68,116
buffer_load_dwordx4 v18, s[12:15], s29 offen offset:2048 lds
Mvaa 244,76,116
RT 34,22,18432
v_accvgpr_read_b32 v31, a162
Mvaa 244,72,112
v_accvgpr_read_b32 v32, a164
v_accvgpr_read_b32 v33, a166
Mvaa 140,80,112
RT 36,22,17408
v_accvgpr_read_b32 v34, a168
Mvaa 140,84,116
v_accvgpr_read_b32 v35, a170
v_accvgpr_read_b32 v36, a172
Mvaa 240,92,116
RT 38,22,19456
v_accvgpr_read_b32 v37, a174
Mvaa 240,88,112
v_perm_b32 v38, v31, v30, s45
v_perm_b32 v39, v33, v32, s45
Mvaa 64,64,120
RT 40,23,16384
v_perm_b32 v40, v35, v34, s45
Mvaa 64,68,124
buffer_load_dwordx4 v19, s[12:15], s29 offen offset:3072 lds
Maaa 216,76,124
RT 42,23,18432
v_perm_b32 v41, v37, v36, s45
Maaa 216,72,120
Mvaa 68,80,120
RT 44,23,17408
Mvaa 68,84,124
buffer_store_dwordx4 v[38:41], v27, s[4:7], s68 offen sc1
Maaa 220,92,124
RT 46,23,19456
v_add_u32 v27, s74, v27
Maaa 220,88,120
s_add_u32 s76, s30, 896
s_and_b32 s76, s76, 133119
s_waitcnt lgkmcnt(8)
v_perm_b32 v42, v31, v30, s46
Mvaa 144,64,0
s_add_u32 m0, s33, 0
RT 48,24,16384
v_perm_b32 v43, v33, v32, s46
Mvaa 144,68,4
buffer_load_dwordx4 v12, s[8:11], s76 offen offset:0 lds
Maaa 224,76,4
RT 50,24,18432
v_perm_b32 v44, v35, v34, s46
Maaa 224,72,0
v_perm_b32 v45, v37, v36, s46
Mvaa 148,80,0
RT 52,24,17408
Mvaa 148,84,4
buffer_store_dwordx4 v[42:45], v27, s[4:7], s68 offen sc1
Maaa 228,92,4
RT 54,24,19456
v_add_u32 v27, s74, v27
Maaa 228,88,0
Mvaa 88,64,8
RT 56,25,16384
v_accvgpr_read_b32 v30, a161
Mvaa 88,68,12
buffer_load_dwordx4 v13, s[8:11], s76 offen offset:1024 lds
Maaa 232,76,12
RT 58,25,18432
v_accvgpr_read_b32 v31, a163
Maaa 232,72,8
v_accvgpr_read_b32 v32, a165
v_accvgpr_read_b32 v33, a167
Mvaa 92,80,8
RT 60,25,17408
v_accvgpr_read_b32 v34, a169
Mvaa 92,84,12
v_accvgpr_read_b32 v35, a171
v_accvgpr_read_b32 v36, a173
Maaa 236,92,12
RT 62,25,19456
v_accvgpr_read_b32 v37, a175
Maaa 236,88,8
v_perm_b32 v38, v31, v30, s45
v_perm_b32 v39, v33, v32, s45
Mvaa 152,64,16
v_add_u32 v20, 65536, v20
v_add_u32 v21, 65536, v21
Mvaa 152,68,20
buffer_load_dwordx4 v14, s[8:11], s76 offen offset:2048 lds
Maaa 240,76,20
v_xor_b32 v22, 0x10000, v22
v_xor_b32 v23, 0x10000, v23
Maaa 240,72,16
v_perm_b32 v40, v35, v34, s45
v_perm_b32 v41, v37, v36, s45
Mvaa 156,80,16
v_xor_b32 v24, 0x10000, v24
v_xor_b32 v25, 0x10000, v25
Mvaa 156,84,20
buffer_store_dwordx4 v[38:41], v27, s[4:7], s68 offen sc1
Maaa 244,92,20
v_add_u32 v27, s74, v27
v_perm_b32 v42, v31, v30, s46
Maaa 244,88,16
v_perm_b32 v43, v33, v32, s46
v_perm_b32 v44, v35, v34, s46
Mvaa 112,64,24
v_perm_b32 v45, v37, v36, s46
Mvaa 112,68,28
buffer_load_dwordx4 v15, s[8:11], s76 offen offset:3072 lds
Maaa 248,76,28
Maaa 248,72,24
Mvaa 116,80,24
Mvaa 116,84,28
buffer_store_dwordx4 v[42:45], v27, s[4:7], s68 offen sc1
Maaa 252,92,28
v_add_u32 v27, s74, v27
Maaa 252,88,24
s_waitcnt vmcnt(32)
s_waitcnt vmcnt(27) lgkmcnt(0)
s_barrier
s_add_u32 s29, s37, 3145984
s_and_b32 s29, s29, 8388607
Mvaa 160,32,96
s_add_u32 m0, s34, 49152
s_mov_b32 s73, 0x4cb8aa3b
RT 64,22,0
Mvaa 160,36,100
buffer_load_dwordx4 v16, s[12:15], s29 offen offset:0 lds
Mvaa 236,44,100
RT 66,22,2048
v_accvgpr_read_b32 v30, a128
Mvaa 236,40,96
v_accvgpr_read_b32 v31, a130
v_lshlrev_b32 v32, 16, v30
Mvaa 168,48,96
RT 68,22,1024
v_lshlrev_b32 v33, 16, v31
Mvaa 168,52,100
v_and_b32 v30, 0xffff0000, v30
v_and_b32 v31, 0xffff0000, v31
Mvaa 232,60,100
RT 70,22,3072
v_mul_f32 v30, s73, v30
Mvaa 232,56,96
v_mul_f32 v31, s73, v31
v_mul_f32 v32, s73, v32
Mvaa 48,32,104
RD 96,20,0
v_mul_f32 v33, s73, v33
Mvaa 48,36,108
buffer_load_dwordx4 v17, s[12:15], s29 offen offset:1024 lds
Mvaa 228,44,108
RD 100,21,0
v_cvt_pk_bf16_f32 v38, v32, v33
Mvaa 228,40,104
v_cvt_pk_bf16_f32 v42, v30, v31
v_accvgpr_read_b32 v34, a132
Mvaa 52,48,104
RT 72,23,0
v_accvgpr_read_b32 v35, a134
Mvaa 52,52,108
v_lshlrev_b32 v36, 16, v34
v_lshlrev_b32 v37, 16, v35
Mvaa 224,60,108
RT 74,23,2048
v_and_b32 v34, 0xffff0000, v34
Mvaa 224,56,104
v_and_b32 v35, 0xffff0000, v35
v_mul_f32 v34, s73, v34
Mvaa 56,32,112
RD 104,20,2048
v_mul_f32 v35, s73, v35
Mvaa 56,36,116
buffer_load_dwordx4 v18, s[12:15], s29 offen offset:2048 lds
Mvaa 220,44,116
RD 108,21,2048
v_mul_f32 v36, s73, v36
Mvaa 220,40,112
v_mul_f32 v37, s73, v37
v_cvt_pk_bf16_f32 v39, v36, v37
Mvaa 60,48,112
RT 76,23,1024
v_cvt_pk_bf16_f32 v43, v34, v35
Mvaa 60,52,116
v_accvgpr_read_b32 v30, a136
v_accvgpr_read_b32 v31, a138
Mvaa 216,60,116
RT 78,23,3072
v_lshlrev_b32 v32, 16, v30
Mvaa 216,56,112
v_lshlrev_b32 v33, 16, v31
v_and_b32 v30, 0xffff0000, v30
Mvaa 72,32,120
RD 112,20,4096
v_and_b32 v31, 0xffff0000, v31
Mvaa 72,36,124
buffer_load_dwordx4 v19, s[12:15], s29 offen offset:3072 lds
Mvaa 212,44,124
RD 116,21,4096
v_mul_f32 v30, s73, v30
Mvaa 212,40,120
v_mul_f32 v31, s73, v31
v_mul_f32 v32, s73, v32
Mvaa 76,48,120
RT 80,24,0
v_mul_f32 v33, s73, v33
Mvaa 76,52,124
v_cvt_pk_bf16_f32 v40, v32, v33
v_cvt_pk_bf16_f32 v44, v30, v31
Mvaa 208,60,124
RT 82,24,2048
v_accvgpr_read_b32 v34, a140
Mvaa 208,56,120
s_add_u32 s76, s30, 131968
s_and_b32 s76, s76, 133119
v_accvgpr_read_b32 v35, a142
v_lshlrev_b32 v36, 16, v34
Mvaa 80,32,0
s_add_u32 m0, s33, 8192
RD 120,20,6144
v_lshlrev_b32 v37, 16, v35
Mvaa 80,36,4
buffer_load_dwordx4 v12, s[8:11], s76 offen offset:0 lds
Mvaa 204,44,4
RD 124,21,6144
v_and_b32 v34, 0xffff0000, v34
Mvaa 204,40,0
v_and_b32 v35, 0xffff0000, v35
v_mul_f32 v34, s73, v34
Mvaa 84,48,0
RT 84,24,1024
v_mul_f32 v35, s73, v35
Mvaa 84,52,4
v_mul_f32 v36, s73, v36
v_mul_f32 v37, s73, v37
Mvaa 200,60,4
RT 86,24,3072
v_cvt_pk_bf16_f32 v41, v36, v37
Mvaa 200,56,0
v_cvt_pk_bf16_f32 v45, v34, v35
Mvaa 96,32,8
RT 88,25,0
Mvaa 96,36,12
buffer_load_dwordx4 v13, s[8:11], s76 offen offset:1024 lds
Mvaa 196,44,12
RT 90,25,2048
Mvaa 196,40,8
Mvaa 100,48,8
RT 92,25,1024
Mvaa 100,52,12
buffer_store_dwordx4 v[38:41], v5, s[4:7], s66 offen offset:0 sc1
Mvaa 192,60,12
RT 94,25,3072
Mvaa 192,56,8
Mvaa 104,32,16
Mvaa 104,36,20
buffer_load_dwordx4 v14, s[8:11], s76 offen offset:2048 lds
Mvaa 188,44,20
Mvaa 188,40,16
Mvaa 108,48,16
Mvaa 108,52,20
buffer_store_dwordx4 v[42:45], v5, s[4:7], s66 offen offset:2048 sc1
Mvaa 184,60,20
v_accvgpr_read_b32 v30, a129
v_accvgpr_read_b32 v31, a131
Mvaa 184,56,16
v_lshlrev_b32 v32, 16, v30
v_lshlrev_b32 v33, 16, v31
Mvaa 120,32,24
v_and_b32 v30, 0xffff0000, v30
v_and_b32 v31, 0xffff0000, v31
Mvaa 120,36,28
buffer_load_dwordx4 v15, s[8:11], s76 offen offset:3072 lds
Mvaa 180,44,28
v_mul_f32 v30, s73, v30
v_mul_f32 v31, s73, v31
Mvaa 180,40,24
v_mul_f32 v32, s73, v32
v_mul_f32 v33, s73, v33
Mvaa 124,48,24
v_cvt_pk_bf16_f32 v38, v32, v33
v_cvt_pk_bf16_f32 v42, v30, v31
Mvaa 124,52,28
v_accvgpr_read_b32 v34, a133
v_accvgpr_read_b32 v35, a135
Mvaa 176,60,28
v_lshlrev_b32 v36, 16, v34
v_lshlrev_b32 v37, 16, v35
Mvaa 176,56,24
v_and_b32 v34, 0xffff0000, v34
v_and_b32 v35, 0xffff0000, v35
s_waitcnt vmcnt(28) lgkmcnt(0)
s_barrier
s_add_u32 s29, s37, 3670016
s_and_b32 s29, s29, 8388607
Mvaa 128,64,96
s_add_u32 m0, s34, 98304
RD 0,20,8192
v_mul_f32 v34, s73, v34
Mvaa 128,68,100
buffer_load_dwordx4 v16, s[12:15], s29 offen offset:0 lds
Mvaa 252,76,100
RD 4,21,8192
v_mul_f32 v35, s73, v35
Mvaa 252,72,96
v_mul_f32 v36, s73, v36
v_mul_f32 v37, s73, v37
Mvaa 132,80,96
RD 8,20,10240
v_cvt_pk_bf16_f32 v39, v36, v37
Mvaa 132,84,100
v_cvt_pk_bf16_f32 v43, v34, v35
v_accvgpr_read_b32 v30, a137
Mvaa 248,92,100
RD 12,21,10240
v_accvgpr_read_b32 v31, a139
Mvaa 248,88,96
v_lshlrev_b32 v32, 16, v30
v_lshlrev_b32 v33, 16, v31
Mvaa 164,64,104
RD 16,20,12288
v_and_b32 v30, 0xffff0000, v30
Mvaa 164,68,108
buffer_load_dwordx4 v17, s[12:15], s29 offen offset:1024 lds
Maaa 208,76,108
RD 20,21,12288
v_and_b32 v31, 0xffff0000, v31
Maaa 208,72,104
v_mul_f32 v30, s73, v30
v_mul_f32 v31, s73, v31
Mvaa 172,80,104
RD 24,20,14336
v_mul_f32 v32, s73, v32
Mvaa 172,84,108
v_mul_f32 v33, s73, v33
v_cvt_pk_bf16_f32 v40, v32, v33
Maaa 212,92,108
RD 28,21,14336
v_cvt_pk_bf16_f32 v44, v30, v31
Maaa 212,88,104
v_accvgpr_read_b32 v34, a141
v_accvgpr_read_b32 v35, a143
Mvaa 136,64,112
RT 32,22,16384
v_lshlrev_b32 v36, 16, v34
Mvaa 136,68,116
buffer_load_dwordx4 v18, s[12:15], s29 offen offset:2048 lds
Mvaa 244,76,116
RT 34,22,18432
v_lshlrev_b32 v37, 16, v35
Mvaa 244,72,112
v_and_b32 v34, 0xffff0000, v34
v_and_b32 v35, 0xffff0000, v35
Mvaa 140,80,112
RT 36,22,17408
v_mul_f32 v34, s73, v34
Mvaa 140,84,116
v_mul_f32 v35, s73, v35
v_mul_f32 v36, s73, v36
Mvaa 240,92,116
RT 38,22,19456
v_mul_f32 v37, s73, v37
Mvaa 240,88,112
v_cvt_pk_bf16_f32 v41, v36, v37
v_cvt_pk_bf16_f32 v45, v34, v35
Mvaa 64,64,120
s_add_u32 s66, s66, 4096
RT 40,23,16384
Mvaa 64,68,124
buffer_load_dwordx4 v19, s[12:15], s29 offen offset:3072 lds
Maaa 216,76,124
RT 42,23,18432
Maaa 216,72,120
Mvaa 68,80,120
RT 44,23,17408
Mvaa 68,84,124
buffer_store_dwordx4 v[38:41], v5, s[4:7], s66 offen offset:0 sc1
Maaa 220,92,124
RT 46,23,19456
Maaa 220,88,120
s_add_u32 s76, s30, 1024
s_and_b32 s76, s76, 133119
s_waitcnt lgkmcnt(8)
Mvaa 144,64,0
s_add_u32 m0, s33, 65536
RT 48,24,16384
Mvaa 144,68,4
buffer_load_dwordx4 v12, s[8:11], s76 offen offset:0 lds
Maaa 224,76,4
RT 50,24,18432
Maaa 224,72,0
Mvaa 148,80,0
RT 52,24,17408
Mvaa 148,84,4
buffer_store_dwordx4 v[42:45], v5, s[4:7], s66 offen offset:2048 sc1
Maaa 228,92,4
RT 54,24,19456
Maaa 228,88,0
Mvaa 88,64,8
RT 56,25,16384
Mvaa 88,68,12
buffer_load_dwordx4 v13, s[8:11], s76 offen offset:1024 lds
Maaa 232,76,12
RT 58,25,18432
Maaa 232,72,8
Mvaa 92,80,8
RT 60,25,17408
Mvaa 92,84,12
Maaa 236,92,12
RT 62,25,19456
Maaa 236,88,8
Mvaa 152,64,16
v_add_u32 v20, 65536, v20
v_add_u32 v21, 65536, v21
Mvaa 152,68,20
buffer_load_dwordx4 v14, s[8:11], s76 offen offset:2048 lds
Maaa 240,76,20
v_xor_b32 v22, 0x10000, v22
v_xor_b32 v23, 0x10000, v23
Maaa 240,72,16
Mvaa 156,80,16
v_xor_b32 v24, 0x10000, v24
v_xor_b32 v25, 0x10000, v25
Mvaa 156,84,20
Maaa 244,92,20
Maaa 244,88,16
Mvaa 112,64,24
Mvaa 112,68,28
buffer_load_dwordx4 v15, s[8:11], s76 offen offset:3072 lds
Maaa 248,76,28
Maaa 248,72,24
Mvaa 116,80,24
Mvaa 116,84,28
buffer_load_dword v7, v10, s[20:23], s35 offen sc1
Maaa 252,92,28
Maaa 252,88,24
s_waitcnt vmcnt(29) lgkmcnt(0)
s_barrier
s_add_u32 s29, s37, 3670272
s_and_b32 s29, s29, 8388607
Mvaa 160,32,96
s_add_u32 m0, s34, 114688
RT 64,22,0
Mvaa 160,36,100
buffer_load_dwordx4 v16, s[12:15], s29 offen offset:0 lds
Mvaa 236,44,100
RT 66,22,2048
Mvaa 236,40,96
Mvaa 168,48,96
RT 68,22,1024
Mvaa 168,52,100
Mvaa 232,60,100
RT 70,22,3072
Mvaa 232,56,96
Mvaa 48,32,104
RD 96,20,0
Mvaa 48,36,108
buffer_load_dwordx4 v17, s[12:15], s29 offen offset:1024 lds
Mvaa 228,44,108
RD 100,21,0
Mvaa 228,40,104
Mvaa 52,48,104
RT 72,23,0
Mvaa 52,52,108
Mvaa 224,60,108
RT 74,23,2048
Mvaa 224,56,104
Mvaa 56,32,112
RD 104,20,2048
Mvaa 56,36,116
buffer_load_dwordx4 v18, s[12:15], s29 offen offset:2048 lds
Mvaa 220,44,116
RD 108,21,2048
Mvaa 220,40,112
Mvaa 60,48,112
RT 76,23,1024
Mvaa 60,52,116
Mvaa 216,60,116
RT 78,23,3072
Mvaa 216,56,112
Mvaa 72,32,120
RD 112,20,4096
Mvaa 72,36,124
buffer_load_dwordx4 v19, s[12:15], s29 offen offset:3072 lds
Mvaa 212,44,124
RD 116,21,4096
Mvaa 212,40,120
Mvaa 76,48,120
RT 80,24,0
Mvaa 76,52,124
Mvaa 208,60,124
RT 82,24,2048
Mvaa 208,56,120
s_add_u32 s76, s30, 132096
s_and_b32 s76, s76, 133119
Mvaa 80,32,0
s_add_u32 m0, s33, 73728
RD 120,20,6144
Mvaa 80,36,4
buffer_load_dwordx4 v12, s[8:11], s76 offen offset:0 lds
Mvaa 204,44,4
RD 124,21,6144
Mvaa 204,40,0
Mvaa 84,48,0
RT 84,24,1024
Mvaa 84,52,4
Mvaa 200,60,4
RT 86,24,3072
Mvaa 200,56,0
Mvaa 96,32,8
RT 88,25,0
Mvaa 96,36,12
buffer_load_dwordx4 v13, s[8:11], s76 offen offset:1024 lds
Mvaa 196,44,12
RT 90,25,2048
Mvaa 196,40,8
Mvaa 100,48,8
RT 92,25,1024
Mvaa 100,52,12
Mvaa 192,60,12
RT 94,25,3072
Mvaa 192,56,8
Mvaa 104,32,16
Mvaa 104,36,20
buffer_load_dwordx4 v14, s[8:11], s76 offen offset:2048 lds
Mvaa 188,44,20
Mvaa 188,40,16
Mvaa 108,48,16
Mvaa 108,52,20
Mvaa 184,60,20
Mvaa 184,56,16
Mvaa 120,32,24
s_branch LOP11
LP11:
s_setpc_b64 s[48:49]
LOP11:
Mvaa 120,36,28
buffer_load_dwordx4 v15, s[8:11], s76 offen offset:3072 lds
Mvaa 180,44,28
Mvaa 180,40,24
Mvaa 124,48,24
Mvaa 124,52,28
Mvaa 176,60,28
Mvaa 176,56,24
s_waitcnt vmcnt(25) lgkmcnt(0)
s_barrier
s_add_u32 s29, s37, 4194304
s_and_b32 s29, s29, 8388607
Mvaa 128,64,96
s_add_u32 m0, s34, 32768
RD 0,20,8192
Mvaa 128,68,100
buffer_load_dwordx4 v16, s[12:15], s29 offen offset:0 lds
Mvaa 252,76,100
RD 4,21,8192
Mvaa 252,72,96
Mvaa 132,80,96
RD 8,20,10240
Mvaa 132,84,100
Mvaa 248,92,100
RD 12,21,10240
Mvaa 248,88,96
Mvaa 164,64,104
RD 16,20,12288
Mvaa 164,68,108
buffer_load_dwordx4 v17, s[12:15], s29 offen offset:1024 lds
Maaa 208,76,108
RD 20,21,12288
Maaa 208,72,104
Mvaa 172,80,104
RD 24,20,14336
Mvaa 172,84,108
Maaa 212,92,108
RD 28,21,14336
Maaa 212,88,104
Mvaa 136,64,112
RT 32,22,16384
Mvaa 136,68,116
buffer_load_dwordx4 v18, s[12:15], s29 offen offset:2048 lds
Mvaa 244,76,116
RT 34,22,18432
Mvaa 244,72,112
Mvaa 140,80,112
RT 36,22,17408
Mvaa 140,84,116
Mvaa 240,92,116
RT 38,22,19456
Mvaa 240,88,112
Mvaa 64,64,120
RT 40,23,16384
Mvaa 64,68,124
buffer_load_dwordx4 v19, s[12:15], s29 offen offset:3072 lds
Maaa 216,76,124
RT 42,23,18432
Maaa 216,72,120
Mvaa 68,80,120
RT 44,23,17408
Mvaa 68,84,124
Maaa 220,92,124
RT 46,23,19456
Maaa 220,88,120
s_add_u32 s76, s30, 1152
s_and_b32 s76, s76, 133119
s_waitcnt lgkmcnt(8)
Mvaa 144,64,0
s_add_u32 m0, s33, 131072
RT 48,24,16384
Mvaa 144,68,4
buffer_load_dwordx4 v12, s[8:11], s76 offen offset:0 lds
Maaa 224,76,4
RT 50,24,18432
Maaa 224,72,0
Mvaa 148,80,0
RT 52,24,17408
Mvaa 148,84,4
Maaa 228,92,4
RT 54,24,19456
Maaa 228,88,0
Mvaa 88,64,8
RT 56,25,16384
Mvaa 88,68,12
buffer_load_dwordx4 v13, s[8:11], s76 offen offset:1024 lds
Maaa 232,76,12
RT 58,25,18432
Maaa 232,72,8
Mvaa 92,80,8
RT 60,25,17408
Mvaa 92,84,12
Maaa 236,92,12
RT 62,25,19456
Maaa 236,88,8
Mvaa 152,64,16
v_add_u32 v20, -131072, v20
v_add_u32 v21, -131072, v21
Mvaa 152,68,20
buffer_load_dwordx4 v14, s[8:11], s76 offen offset:2048 lds
Maaa 240,76,20
v_xor_b32 v22, 0x10000, v22
v_xor_b32 v23, 0x10000, v23
Maaa 240,72,16
Mvaa 156,80,16
v_xor_b32 v24, 0x10000, v24
v_xor_b32 v25, 0x10000, v25
Mvaa 156,84,20
Maaa 244,92,20
s_waitcnt vmcnt(15)
Maaa 244,88,16
s_cmp_eq_u32 s24, 0
s_cselect_b32 s77, 0x01010101, 0
Mvaa 112,64,24
v_cmp_ne_u32 vcc, s77, v7
Mvaa 112,68,28
buffer_load_dwordx4 v15, s[8:11], s76 offen offset:3072 lds
Maaa 248,76,28
Maaa 248,72,24
Mvaa 116,80,24
s_cbranch_vccnz L_zwaitK
L_zokK:
Mvaa 116,84,28
Maaa 252,92,28
Maaa 252,88,24
s_waitcnt vmcnt(23) lgkmcnt(0)
s_barrier
s_add_u32 s29, s37, 4194560
s_and_b32 s29, s29, 8388607
Mvaa 160,32,96
s_add_u32 m0, s34, 49152
RT 64,22,0
Mvaa 160,36,100
buffer_load_dwordx4 v16, s[12:15], s29 offen offset:0 lds
Mvaa 236,44,100
RT 66,22,2048
Mvaa 236,40,96
Mvaa 168,48,96
RT 68,22,1024
Mvaa 168,52,100
Mvaa 232,60,100
RT 70,22,3072
Mvaa 232,56,96
Mvaa 48,32,104
RD 96,20,0
Mvaa 48,36,108
buffer_load_dwordx4 v17, s[12:15], s29 offen offset:1024 lds
Mvaa 228,44,108
RD 100,21,0
Mvaa 228,40,104
Mvaa 52,48,104
RT 72,23,0
Mvaa 52,52,108
Mvaa 224,60,108
RT 74,23,2048
Mvaa 224,56,104
Mvaa 56,32,112
RD 104,20,2048
Mvaa 56,36,116
buffer_load_dwordx4 v18, s[12:15], s29 offen offset:2048 lds
Mvaa 220,44,116
RD 108,21,2048
Mvaa 220,40,112
Mvaa 60,48,112
RT 76,23,1024
Mvaa 60,52,116
Mvaa 216,60,116
RT 78,23,3072
Mvaa 216,56,112
Mvaa 72,32,120
RD 112,20,4096
Mvaa 72,36,124
buffer_load_dwordx4 v19, s[12:15], s29 offen offset:3072 lds
Mvaa 212,44,124
RD 116,21,4096
Mvaa 212,40,120
Mvaa 76,48,120
RT 80,24,0
Mvaa 76,52,124
Mvaa 208,60,124
RT 82,24,2048
Mvaa 208,56,120
s_add_u32 s76, s30, 132224
s_and_b32 s76, s76, 133119
Mvaa 80,32,0
s_add_u32 m0, s33, 139264
RD 120,20,6144
Mvaa 80,36,4
buffer_load_dwordx4 v12, s[8:11], s76 offen offset:0 lds
Mvaa 204,44,4
RD 124,21,6144
Mvaa 204,40,0
Mvaa 84,48,0
RT 84,24,1024
Mvaa 84,52,4
Mvaa 200,60,4
RT 86,24,3072
Mvaa 200,56,0
Mvaa 96,32,8
RT 88,25,0
Mvaa 96,36,12
buffer_load_dwordx4 v13, s[8:11], s76 offen offset:1024 lds
Mvaa 196,44,12
RT 90,25,2048
Mvaa 196,40,8
Mvaa 100,48,8
RT 92,25,1024
Mvaa 100,52,12
Mvaa 192,60,12
RT 94,25,3072
Mvaa 192,56,8
Mvaa 104,32,16
Mvaa 104,36,20
buffer_load_dwordx4 v14, s[8:11], s76 offen offset:2048 lds
Mvaa 188,44,20
Mvaa 188,40,16
Mvaa 108,48,16
Mvaa 108,52,20
Mvaa 184,60,20
Mvaa 184,56,16
Mvaa 120,32,24
Mvaa 120,36,28
buffer_load_dwordx4 v15, s[8:11], s76 offen offset:3072 lds
Mvaa 180,44,28
Mvaa 180,40,24
Mvaa 124,48,24
s_mov_b32 s78, 0
Mvaa 124,52,28
buffer_load_dwordx2 a[192:193], v6, s[56:59], s78 offen offset:0 nt
Mvaa 176,60,28
Mvaa 176,56,24
s_waitcnt vmcnt(21) lgkmcnt(0)
s_barrier
s_add_u32 s29, s37, 4718592
s_and_b32 s29, s29, 8388607
Mvaa 128,64,96
s_add_u32 m0, s34, 98304
RD 0,20,8192
Mvaa 128,68,100
buffer_load_dwordx4 v16, s[12:15], s29 offen offset:0 lds
Mvaa 252,76,100
RD 4,21,8192
Mvaa 252,72,96
Mvaa 132,80,96
s_mov_b32 s78, 0
RD 8,20,10240
Mvaa 132,84,100
buffer_load_dwordx2 a[194:195], v6, s[56:59], s78 offen offset:896 nt
Mvaa 248,92,100
RD 12,21,10240
Mvaa 248,88,96
Mvaa 164,64,104
RD 16,20,12288
Mvaa 164,68,108
buffer_load_dwordx4 v17, s[12:15], s29 offen offset:1024 lds
Maaa 208,76,108
s_load_dwordx2 s[16:17], s[0:1], 64
RD 20,21,12288
Maaa 208,72,104
Mvaa 172,80,104
RD 24,20,14336
Mvaa 172,84,108
Maaa 212,92,108
RD 28,21,14336
Maaa 212,88,104
Mvaa 136,64,112
RT 32,22,16384
Mvaa 136,68,116
buffer_load_dwordx4 v18, s[12:15], s29 offen offset:2048 lds
Mvaa 244,76,116
RT 34,22,18432
Mvaa 244,72,112
Mvaa 140,80,112
s_mov_b32 s78, 0
RT 36,22,17408
Mvaa 140,84,116
buffer_load_dwordx2 a[196:197], v6, s[56:59], s78 offen offset:1792 nt
Mvaa 240,92,116
RT 38,22,19456
Mvaa 240,88,112
Mvaa 64,64,120
RT 40,23,16384
Mvaa 64,68,124
buffer_load_dwordx4 v19, s[12:15], s29 offen offset:3072 lds
Maaa 216,76,124
RT 42,23,18432
Maaa 216,72,120
Mvaa 68,80,120
RT 44,23,17408
Mvaa 68,84,124
Maaa 220,92,124
RT 46,23,19456
Maaa 220,88,120
s_add_u32 s76, s30, 1280
s_and_b32 s76, s76, 133119
s_waitcnt lgkmcnt(8)
Mvaa 144,64,0
s_add_u32 m0, s33, 0
RT 48,24,16384
Mvaa 144,68,4
buffer_load_dwordx4 v12, s[8:11], s76 offen offset:0 lds
Maaa 224,76,4
RT 50,24,18432
Maaa 224,72,0
Mvaa 148,80,0
s_mov_b32 s78, 0
RT 52,24,17408
Mvaa 148,84,4
buffer_load_dwordx2 a[198:199], v6, s[56:59], s78 offen offset:2688 nt
Maaa 228,92,4
RT 54,24,19456
Maaa 228,88,0
Mvaa 88,64,8
RT 56,25,16384
Mvaa 88,68,12
buffer_load_dwordx4 v13, s[8:11], s76 offen offset:1024 lds
Maaa 232,76,12
RT 58,25,18432
Maaa 232,72,8
Mvaa 92,80,8
RT 60,25,17408
Mvaa 92,84,12
Maaa 236,92,12
RT 62,25,19456
Maaa 236,88,8
Mvaa 152,64,16
v_add_u32 v20, 65536, v20
v_add_u32 v21, 65536, v21
Mvaa 152,68,20
buffer_load_dwordx4 v14, s[8:11], s76 offen offset:2048 lds
Maaa 240,76,20
v_xor_b32 v22, 0x10000, v22
v_xor_b32 v23, 0x10000, v23
Maaa 240,72,16
Mvaa 156,80,16
s_mov_b32 s78, 14336
v_xor_b32 v24, 0x10000, v24
v_xor_b32 v25, 0x10000, v25
Mvaa 156,84,20
buffer_load_dwordx2 a[200:201], v6, s[56:59], s78 offen offset:0 nt
Maaa 244,92,20
Maaa 244,88,16
Mvaa 112,64,24
Mvaa 112,68,28
buffer_load_dwordx4 v15, s[8:11], s76 offen offset:3072 lds
Maaa 248,76,28
Maaa 248,72,24
s_mov_b32 s18, 3584
Mvaa 116,80,24
Mvaa 116,84,28
Maaa 252,92,28
Maaa 252,88,24
s_waitcnt vmcnt(41)
s_waitcnt vmcnt(25) lgkmcnt(0)
s_barrier
s_add_u32 s29, s37, 4718848
s_and_b32 s29, s29, 8388607
Mvaa 160,32,96
s_add_u32 m0, s34, 114688
RT 64,22,0
Mvaa 160,36,100
buffer_load_dwordx4 v16, s[12:15], s29 offen offset:0 lds
Mvaa 236,44,100
RT 66,22,2048
Mvaa 236,40,96
Mvaa 168,48,96
s_mov_b32 s78, 14336
RT 68,22,1024
Mvaa 168,52,100
buffer_load_dwordx2 a[202:203], v6, s[56:59], s78 offen offset:896 nt
Mvaa 232,60,100
RT 70,22,3072
Mvaa 232,56,96
Mvaa 48,32,104
RD 96,20,0
Mvaa 48,36,108
buffer_load_dwordx4 v17, s[12:15], s29 offen offset:1024 lds
Mvaa 228,44,108
RD 100,21,0
Mvaa 228,40,104
Mvaa 52,48,104
RT 72,23,0
Mvaa 52,52,108
Mvaa 224,60,108
RT 74,23,2048
Mvaa 224,56,104
Mvaa 56,32,112
RD 104,20,2048
Mvaa 56,36,116
buffer_load_dwordx4 v18, s[12:15], s29 offen offset:2048 lds
Mvaa 220,44,116
RD 108,21,2048
Mvaa 220,40,112
Mvaa 60,48,112
s_mov_b32 s78, 14336
RT 76,23,1024
Mvaa 60,52,116
buffer_load_dwordx2 a[204:205], v6, s[56:59], s78 offen offset:1792 nt
Mvaa 216,60,116
RT 78,23,3072
Mvaa 216,56,112
Mvaa 72,32,120
RD 112,20,4096
Mvaa 72,36,124
buffer_load_dwordx4 v19, s[12:15], s29 offen offset:3072 lds
Mvaa 212,44,124
RD 116,21,4096
Mvaa 212,40,120
Mvaa 76,48,120
RT 80,24,0
Mvaa 76,52,124
Mvaa 208,60,124
RT 82,24,2048
Mvaa 208,56,120
s_add_u32 s76, s30, 132352
s_and_b32 s76, s76, 133119
Mvaa 80,32,0
s_add_u32 m0, s33, 8192
RD 120,20,6144
Mvaa 80,36,4
buffer_load_dwordx4 v12, s[8:11], s76 offen offset:0 lds
Mvaa 204,44,4
RD 124,21,6144
Mvaa 204,40,0
Mvaa 84,48,0
s_mov_b32 s78, 14336
RT 84,24,1024
Mvaa 84,52,4
buffer_load_dwordx2 a[206:207], v6, s[56:59], s78 offen offset:2688 nt
Mvaa 200,60,4
RT 86,24,3072
Mvaa 200,56,0
Mvaa 96,32,8
RT 88,25,0
Mvaa 96,36,12
buffer_load_dwordx4 v13, s[8:11], s76 offen offset:1024 lds
Mvaa 196,44,12
RT 90,25,2048
Mvaa 196,40,8
Mvaa 100,48,8
RT 92,25,1024
Mvaa 100,52,12
Mvaa 192,60,12
RT 94,25,3072
Mvaa 192,56,8
Mvaa 104,32,16
Mvaa 104,36,20
buffer_load_dwordx4 v14, s[8:11], s76 offen offset:2048 lds
Mvaa 188,44,20
Mvaa 188,40,16
Mvaa 108,48,16
Mvaa 108,52,20
Mvaa 184,60,20
Mvaa 184,56,16
s_add_u32 s35, s35, 14684160
Mvaa 120,32,24
Mvaa 120,36,28
buffer_load_dwordx4 v15, s[8:11], s76 offen offset:3072 lds
Mvaa 180,44,28
s_lshl2_add_u32 s77, s2, s35
Mvaa 180,40,24
Mvaa 124,48,24
Mvaa 124,52,28
buffer_store_dword v9, v8, s[4:7], s77 offen sc1
Mvaa 176,60,28
Mvaa 176,56,24
s_waitcnt vmcnt(29) lgkmcnt(0)
s_barrier
s_add_u32 s29, s37, 5242880
s_and_b32 s29, s29, 8388607
Mvaa 128,64,96
s_add_u32 m0, s34, 32768
RD 0,20,8192
Mvaa 128,68,100
buffer_load_dwordx4 v16, s[12:15], s29 offen offset:0 lds
Mvaa 252,76,100
RD 4,21,8192
Mvaa 252,72,96
Mvaa 132,80,96
RD 8,20,10240
Mvaa 132,84,100
Mvaa 248,92,100
RD 12,21,10240
Mvaa 248,88,96
Mvaa 164,64,104
RD 16,20,12288
Mvaa 164,68,108
buffer_load_dwordx4 v17, s[12:15], s29 offen offset:1024 lds
Maaa 208,76,108
RD 20,21,12288
Maaa 208,72,104
Mvaa 172,80,104
RD 24,20,14336
Mvaa 172,84,108
Maaa 212,92,108
RD 28,21,14336
Maaa 212,88,104
Mvaa 136,64,112
RT 32,22,16384
Mvaa 136,68,116
buffer_load_dwordx4 v18, s[12:15], s29 offen offset:2048 lds
Mvaa 244,76,116
RT 34,22,18432
Mvaa 244,72,112
Mvaa 140,80,112
RT 36,22,17408
Mvaa 140,84,116
Mvaa 240,92,116
RT 38,22,19456
Mvaa 240,88,112
Mvaa 64,64,120
RT 40,23,16384
Mvaa 64,68,124
buffer_load_dwordx4 v19, s[12:15], s29 offen offset:3072 lds
Maaa 216,76,124
RT 42,23,18432
Maaa 216,72,120
Mvaa 68,80,120
RT 44,23,17408
Mvaa 68,84,124
Maaa 220,92,124
RT 46,23,19456
Maaa 220,88,120
s_add_u32 s76, s30, 1408
s_branch LOP12
LP12:
s_setpc_b64 s[48:49]
LOP12:
s_and_b32 s76, s76, 133119
s_waitcnt lgkmcnt(8)
Mvaa 144,64,0
s_add_u32 m0, s33, 65536
RT 48,24,16384
Mvaa 144,68,4
buffer_load_dwordx4 v12, s[8:11], s76 offen offset:0 lds
Maaa 224,76,4
RT 50,24,18432
Maaa 224,72,0
Mvaa 148,80,0
RT 52,24,17408
Mvaa 148,84,4
Maaa 228,92,4
RT 54,24,19456
Maaa 228,88,0
Mvaa 88,64,8
RT 56,25,16384
Mvaa 88,68,12
buffer_load_dwordx4 v13, s[8:11], s76 offen offset:1024 lds
Maaa 232,76,12
RT 58,25,18432
Maaa 232,72,8
Mvaa 92,80,8
RT 60,25,17408
Mvaa 92,84,12
Maaa 236,92,12
RT 62,25,19456
Maaa 236,88,8
Mvaa 152,64,16
v_add_u32 v20, 65536, v20
v_add_u32 v21, 65536, v21
Mvaa 152,68,20
buffer_load_dwordx4 v14, s[8:11], s76 offen offset:2048 lds
Maaa 240,76,20
v_xor_b32 v22, 0x10000, v22
v_xor_b32 v23, 0x10000, v23
Maaa 240,72,16
Mvaa 156,80,16
v_xor_b32 v24, 0x10000, v24
v_xor_b32 v25, 0x10000, v25
Mvaa 156,84,20
Maaa 244,92,20
Maaa 244,88,16
Mvaa 112,64,24
Mvaa 112,68,28
buffer_load_dwordx4 v15, s[8:11], s76 offen offset:3072 lds
Maaa 248,76,28
Maaa 248,72,24
Mvaa 116,80,24
Mvaa 116,84,28
Maaa 252,92,28
Maaa 252,88,24
s_waitcnt vmcnt(26) lgkmcnt(0)
s_barrier
s_add_u32 s29, s37, 5243136
s_and_b32 s29, s29, 8388607
Mvaa 160,32,96
s_add_u32 m0, s34, 49152
RT 64,22,0
Mvaa 160,36,100
buffer_load_dwordx4 v16, s[12:15], s29 offen offset:0 lds
Mvaa 236,44,100
RT 66,22,2048
Mvaa 236,40,96
Mvaa 168,48,96
RT 68,22,1024
Mvaa 168,52,100
Mvaa 232,60,100
RT 70,22,3072
Mvaa 232,56,96
Mvaa 48,32,104
RD 96,20,0
Mvaa 48,36,108
buffer_load_dwordx4 v17, s[12:15], s29 offen offset:1024 lds
Mvaa 228,44,108
RD 100,21,0
Mvaa 228,40,104
Mvaa 52,48,104
RT 72,23,0
Mvaa 52,52,108
Mvaa 224,60,108
RT 74,23,2048
Mvaa 224,56,104
Mvaa 56,32,112
RD 104,20,2048
Mvaa 56,36,116
buffer_load_dwordx4 v18, s[12:15], s29 offen offset:2048 lds
Mvaa 220,44,116
RD 108,21,2048
Mvaa 220,40,112
Mvaa 60,48,112
RT 76,23,1024
Mvaa 60,52,116
Mvaa 216,60,116
RT 78,23,3072
Mvaa 216,56,112
Mvaa 72,32,120
RD 112,20,4096
Mvaa 72,36,124
buffer_load_dwordx4 v19, s[12:15], s29 offen offset:3072 lds
Mvaa 212,44,124
RD 116,21,4096
Mvaa 212,40,120
Mvaa 76,48,120
RT 80,24,0
Mvaa 76,52,124
Mvaa 208,60,124
RT 82,24,2048
Mvaa 208,56,120
s_add_u32 s76, s30, 132480
s_and_b32 s76, s76, 133119
Mvaa 80,32,0
s_add_u32 m0, s33, 73728
RD 120,20,6144
Mvaa 80,36,4
buffer_load_dwordx4 v12, s[8:11], s76 offen offset:0 lds
Mvaa 204,44,4
RD 124,21,6144
Mvaa 204,40,0
Mvaa 84,48,0
RT 84,24,1024
Mvaa 84,52,4
Mvaa 200,60,4
RT 86,24,3072
Mvaa 200,56,0
Mvaa 96,32,8
RT 88,25,0
Mvaa 96,36,12
buffer_load_dwordx4 v13, s[8:11], s76 offen offset:1024 lds
Mvaa 196,44,12
RT 90,25,2048
Mvaa 196,40,8
Mvaa 100,48,8
RT 92,25,1024
Mvaa 100,52,12
Mvaa 192,60,12
RT 94,25,3072
Mvaa 192,56,8
Mvaa 104,32,16
Mvaa 104,36,20
buffer_load_dwordx4 v14, s[8:11], s76 offen offset:2048 lds
Mvaa 188,44,20
s_waitcnt vmcnt(19)
Mvaa 188,40,16
Mvaa 108,48,16
v_accvgpr_read_b32 v30, a192
v_accvgpr_read_b32 v31, a194
Mvaa 108,52,20
v_accvgpr_read_b32 v32, a196
v_accvgpr_read_b32 v33, a198
Mvaa 184,60,20
v_accvgpr_read_b32 v34, a200
v_accvgpr_read_b32 v35, a202
Mvaa 184,56,16
v_accvgpr_read_b32 v36, a204
v_accvgpr_read_b32 v37, a206
Mvaa 120,32,24
v_perm_b32 v38, v31, v30, s45
v_perm_b32 v39, v33, v32, s45
Mvaa 120,36,28
buffer_load_dwordx4 v15, s[8:11], s76 offen offset:3072 lds
Mvaa 180,44,28
v_perm_b32 v40, v35, v34, s45
v_perm_b32 v41, v37, v36, s45
Mvaa 180,40,24
Mvaa 124,48,24
Mvaa 124,52,28
buffer_store_dwordx4 v[38:41], v5, s[4:7], s67 offen offset:0 sc1
Mvaa 176,60,28
v_perm_b32 v42, v31, v30, s46
v_perm_b32 v43, v33, v32, s46
Mvaa 176,56,24
v_perm_b32 v44, v35, v34, s46
v_perm_b32 v45, v37, v36, s46
s_waitcnt vmcnt(23) lgkmcnt(0)
s_barrier
s_add_u32 s29, s37, 5767168
s_and_b32 s29, s29, 8388607
Mvaa 128,64,96
s_add_u32 m0, s34, 98304
RD 0,20,8192
Mvaa 128,68,100
buffer_load_dwordx4 v16, s[12:15], s29 offen offset:0 lds
Mvaa 252,76,100
RD 4,21,8192
Mvaa 252,72,96
Mvaa 132,80,96
RD 8,20,10240
Mvaa 132,84,100
buffer_store_dwordx4 v[42:45], v5, s[4:7], s67 offen offset:1024 sc1
Mvaa 248,92,100
RD 12,21,10240
Mvaa 248,88,96
v_accvgpr_read_b32 v30, a193
v_accvgpr_read_b32 v31, a195
Mvaa 164,64,104
RD 16,20,12288
v_accvgpr_read_b32 v32, a197
Mvaa 164,68,108
buffer_load_dwordx4 v17, s[12:15], s29 offen offset:1024 lds
Maaa 208,76,108
RD 20,21,12288
v_accvgpr_read_b32 v33, a199
Maaa 208,72,104
v_accvgpr_read_b32 v34, a201
v_accvgpr_read_b32 v35, a203
Mvaa 172,80,104
RD 24,20,14336
v_accvgpr_read_b32 v36, a205
Mvaa 172,84,108
v_accvgpr_read_b32 v37, a207
v_perm_b32 v38, v31, v30, s45
Maaa 212,92,108
RD 28,21,14336
v_perm_b32 v39, v33, v32, s45
Maaa 212,88,104
v_perm_b32 v40, v35, v34, s45
v_perm_b32 v41, v37, v36, s45
Mvaa 136,64,112
RT 32,22,16384
Mvaa 136,68,116
buffer_load_dwordx4 v18, s[12:15], s29 offen offset:2048 lds
Mvaa 244,76,116
RT 34,22,18432
Mvaa 244,72,112
Mvaa 140,80,112
RT 36,22,17408
Mvaa 140,84,116
buffer_store_dwordx4 v[38:41], v5, s[4:7], s67 offen offset:2048 sc1
Mvaa 240,92,116
RT 38,22,19456
v_perm_b32 v42, v31, v30, s46
Mvaa 240,88,112
v_perm_b32 v43, v33, v32, s46
v_perm_b32 v44, v35, v34, s46
Mvaa 64,64,120
RT 40,23,16384
v_perm_b32 v45, v37, v36, s46
Mvaa 64,68,124
buffer_load_dwordx4 v19, s[12:15], s29 offen offset:3072 lds
Maaa 216,76,124
RT 42,23,18432
Maaa 216,72,120
Mvaa 68,80,120
RT 44,23,17408
Mvaa 68,84,124
buffer_store_dwordx4 v[42:45], v5, s[4:7], s67 offen offset:3072 sc1
Maaa 220,92,124
RT 46,23,19456
v_add_u32 v2, s3, v5
Maaa 220,88,120
s_add_u32 s76, s30, 1536
s_and_b32 s76, s76, 133119
s_waitcnt lgkmcnt(8)
v_mov_b32 v6, v5
Mvaa 144,64,0
s_add_u32 m0, s33, 131072
RT 48,24,16384
v_lshrrev_b32 v30, 4, v1
Mvaa 144,68,4
buffer_load_dwordx4 v12, s[8:11], s76 offen offset:0 lds
Maaa 224,76,4
RT 50,24,18432
v_lshlrev_b32 v30, 2, v30
Maaa 224,72,0
v_and_b32 v31, 15, v1
v_sub_u32 v30, v31, v30
Mvaa 148,80,0
RT 52,24,17408
v_cmp_gt_i32 s[52:53], 0, v30
Mvaa 148,84,4
v_cmp_gt_i32 s[54:55], 1, v30
v_cmp_gt_i32 s[56:57], 2, v30
Maaa 228,92,4
RT 54,24,19456
v_cmp_gt_i32 s[58:59], 3, v30
Maaa 228,88,0
Mvaa 88,64,8
RT 56,25,16384
Mvaa 88,68,12
buffer_load_dwordx4 v13, s[8:11], s76 offen offset:1024 lds
Maaa 232,76,12
RT 58,25,18432
Maaa 232,72,8
Mvaa 92,80,8
RT 60,25,17408
Mvaa 92,84,12
Maaa 236,92,12
RT 62,25,19456
Maaa 236,88,8
Mvaa 152,64,16
v_add_u32 v20, -131072, v20
v_add_u32 v21, -131072, v21
Mvaa 152,68,20
buffer_load_dwordx4 v14, s[8:11], s76 offen offset:2048 lds
Maaa 240,76,20
v_xor_b32 v22, 0x10000, v22
v_xor_b32 v23, 0x10000, v23
Maaa 240,72,16
Mvaa 156,80,16
v_xor_b32 v24, 0x10000, v24
v_xor_b32 v25, 0x10000, v25
Mvaa 156,84,20
Maaa 244,92,20
Maaa 244,88,16
Mvaa 112,64,24
Mvaa 112,68,28
buffer_load_dwordx4 v15, s[8:11], s76 offen offset:3072 lds
Maaa 248,76,28
Maaa 248,72,24
Mvaa 116,80,24
Mvaa 116,84,28
Maaa 252,92,28
Maaa 252,88,24
s_waitcnt vmcnt(24) lgkmcnt(0)
s_barrier
s_add_u32 s29, s37, 5767424
s_and_b32 s29, s29, 8388607
Mvaa 160,32,96
s_add_u32 m0, s34, 114688
s_mul_i32 s79, s25, 7
RT 64,22,0
Mvaa 160,36,100
buffer_load_dwordx4 v16, s[12:15], s29 offen offset:0 lds
Mvaa 236,44,100
s_and_b32 s82, s26, 7
RT 66,22,2048
Mvaa 236,40,96
s_add_u32 s79, s79, s82
Mvaa 168,48,96
s_lshr_b32 s79, s79, 4
RT 68,22,1024
Mvaa 168,52,100
s_lshl_b32 s79, s79, 9
Mvaa 232,60,100
RT 70,22,3072
v_lshlrev_b32 v32, 3, v1
Mvaa 232,56,96
Mvaa 48,32,104
RD 96,20,0
Mvaa 48,36,108
buffer_load_dwordx4 v17, s[12:15], s29 offen offset:1024 lds
Mvaa 228,44,108
RD 100,21,0
Mvaa 228,40,104
Mvaa 52,48,104
RT 72,23,0
Mvaa 52,52,108
buffer_load_dwordx2 v[30:31], v32, s[16:19], s79 offen
Mvaa 224,60,108
RT 74,23,2048
Mvaa 224,56,104
Mvaa 56,32,112
RD 104,20,2048
Mvaa 56,36,116
buffer_load_dwordx4 v18, s[12:15], s29 offen offset:2048 lds
Mvaa 220,44,116
RD 108,21,2048
Mvaa 220,40,112
Mvaa 60,48,112
RT 76,23,1024
Mvaa 60,52,116
Mvaa 216,60,116
RT 78,23,3072
Mvaa 216,56,112
Mvaa 72,32,120
RD 112,20,4096
Mvaa 72,36,124
buffer_load_dwordx4 v19, s[12:15], s29 offen offset:3072 lds
Mvaa 212,44,124
RD 116,21,4096
Mvaa 212,40,120
Mvaa 76,48,120
RT 80,24,0
Mvaa 76,52,124
Mvaa 208,60,124
RT 82,24,2048
Mvaa 208,56,120
s_add_u32 s76, s30, 132608
s_and_b32 s76, s76, 133119
Mvaa 80,32,0
s_add_u32 m0, s33, 139264
RD 120,20,6144
Mvaa 80,36,4
buffer_load_dwordx4 v12, s[8:11], s76 offen offset:0 lds
Mvaa 204,44,4
RD 124,21,6144
Mvaa 204,40,0
Mvaa 84,48,0
RT 84,24,1024
Mvaa 84,52,4
Mvaa 200,60,4
RT 86,24,3072
Mvaa 200,56,0
Mvaa 96,32,8
RT 88,25,0
Mvaa 96,36,12
buffer_load_dwordx4 v13, s[8:11], s76 offen offset:1024 lds
Mvaa 196,44,12
RT 90,25,2048
Mvaa 196,40,8
Mvaa 100,48,8
RT 92,25,1024
Mvaa 100,52,12
Mvaa 192,60,12
RT 94,25,3072
Mvaa 192,56,8
Mvaa 104,32,16
Mvaa 104,36,20
buffer_load_dwordx4 v14, s[8:11], s76 offen offset:2048 lds
Mvaa 188,44,20
Mvaa 188,40,16
Mvaa 108,48,16
Mvaa 108,52,20
Mvaa 184,60,20
Mvaa 184,56,16
Mvaa 120,32,24
Mvaa 120,36,28
buffer_load_dwordx4 v15, s[8:11], s76 offen offset:3072 lds
Mvaa 180,44,28
Mvaa 180,40,24
Mvaa 124,48,24
Mvaa 124,52,28
Mvaa 176,60,28
Mvaa 176,56,24
s_waitcnt vmcnt(25) lgkmcnt(0)
s_barrier
s_add_u32 s29, s37, 6291456
s_and_b32 s29, s29, 8388607
Mvaa 128,64,96
s_add_u32 m0, s34, 32768
RD 0,20,8192
Mvaa 128,68,100
buffer_load_dwordx4 v16, s[12:15], s29 offen offset:0 lds
Mvaa 252,76,100
RD 4,21,8192
Mvaa 252,72,96
Mvaa 132,80,96
RD 8,20,10240
Mvaa 132,84,100
Mvaa 248,92,100
RD 12,21,10240
Mvaa 248,88,96
Mvaa 164,64,104
RD 16,20,12288
Mvaa 164,68,108
buffer_load_dwordx4 v17, s[12:15], s29 offen offset:1024 lds
Maaa 208,76,108
RD 20,21,12288
Maaa 208,72,104
Mvaa 172,80,104
RD 24,20,14336
Mvaa 172,84,108
Maaa 212,92,108
RD 28,21,14336
Maaa 212,88,104
Mvaa 136,64,112
RT 32,22,16384
Mvaa 136,68,116
buffer_load_dwordx4 v18, s[12:15], s29 offen offset:2048 lds
Mvaa 244,76,116
RT 34,22,18432
Mvaa 244,72,112
Mvaa 140,80,112
RT 36,22,17408
Mvaa 140,84,116
Mvaa 240,92,116
RT 38,22,19456
Mvaa 240,88,112
Mvaa 64,64,120
RT 40,23,16384
Mvaa 64,68,124
buffer_load_dwordx4 v19, s[12:15], s29 offen offset:3072 lds
Maaa 216,76,124
RT 42,23,18432
Maaa 216,72,120
Mvaa 68,80,120
RT 44,23,17408
Mvaa 68,84,124
Maaa 220,92,124
RT 46,23,19456
Maaa 220,88,120
s_add_u32 s76, s30, 1664
s_and_b32 s76, s76, 133119
s_waitcnt lgkmcnt(8)
Mvaa 144,64,0
s_add_u32 m0, s33, 0
RT 48,24,16384
Mvaa 144,68,4
buffer_load_dwordx4 v12, s[8:11], s76 offen offset:0 lds
Maaa 224,76,4
RT 50,24,18432
Maaa 224,72,0
Mvaa 148,80,0
RT 52,24,17408
Mvaa 148,84,4
Maaa 228,92,4
RT 54,24,19456
Maaa 228,88,0
Mvaa 88,64,8
RT 56,25,16384
Mvaa 88,68,12
buffer_load_dwordx4 v13, s[8:11], s76 offen offset:1024 lds
Maaa 232,76,12
RT 58,25,18432
Maaa 232,72,8
Mvaa 92,80,8
RT 60,25,17408
Mvaa 92,84,12
Maaa 236,92,12
RT 62,25,19456
Maaa 236,88,8
Mvaa 152,64,16
v_add_u32 v20, 65536, v20
v_add_u32 v21, 65536, v21
Mvaa 152,68,20
buffer_load_dwordx4 v14, s[8:11], s76 offen offset:2048 lds
Maaa 240,76,20
v_xor_b32 v22, 0x10000, v22
v_xor_b32 v23, 0x10000, v23
Maaa 240,72,16
Mvaa 156,80,16
s_branch LOP13
LP13:
s_setpc_b64 s[48:49]
LOP13:
v_xor_b32 v24, 0x10000, v24
v_xor_b32 v25, 0x10000, v25
Mvaa 156,84,20
Maaa 244,92,20
Maaa 244,88,16
Mvaa 112,64,24
Mvaa 112,68,28
buffer_load_dwordx4 v15, s[8:11], s76 offen offset:3072 lds
Maaa 248,76,28
Maaa 248,72,24
Mvaa 116,80,24
Mvaa 116,84,28
buffer_load_dwordx4 v[38:41], v5, s[4:7], s35 offen sc1
Maaa 252,92,28
Maaa 252,88,24
s_waitcnt vmcnt(23) lgkmcnt(0)
s_barrier
s_add_u32 s29, s37, 6291712
s_and_b32 s29, s29, 8388607
Mvaa 160,32,96
s_add_u32 m0, s34, 49152
RT 64,22,0
Mvaa 160,36,100
buffer_load_dwordx4 v16, s[12:15], s29 offen offset:0 lds
Mvaa 236,44,100
RT 66,22,2048
Mvaa 236,40,96
Mvaa 168,48,96
RT 68,22,1024
Mvaa 168,52,100
Mvaa 232,60,100
RT 70,22,3072
Mvaa 232,56,96
Mvaa 48,32,104
s_waitcnt vmcnt(16)
RD 96,20,0
Mvaa 48,36,108
buffer_load_dwordx4 v17, s[12:15], s29 offen offset:1024 lds
Mvaa 228,44,108
s_lshl2_add_u32 s79, s2, s24
RD 100,21,0
Mvaa 228,40,104
s_lshl_b32 s79, s79, 9
Mvaa 52,48,104
s_add_u32 s79, s79, 15728640
RT 72,23,0
Mvaa 52,52,108
v_lshlrev_b32 v33, 16, v30
Mvaa 224,60,108
RT 74,23,2048
v_and_b32 v34, 0xffff0000, v30
Mvaa 224,56,104
v_mul_f32 v33, 0x30800000, v33
Mvaa 56,32,112
RD 104,20,2048
v_mul_f32 v34, 0x30800000, v34
Mvaa 56,36,116
buffer_load_dwordx4 v18, s[12:15], s29 offen offset:2048 lds
Mvaa 220,44,116
RD 108,21,2048
v_cvt_pk_bf16_f32 v30, v33, v34
Mvaa 220,40,112
v_lshlrev_b32 v33, 16, v31
Mvaa 60,48,112
RT 76,23,1024
v_and_b32 v34, 0xffff0000, v31
Mvaa 60,52,116
v_mul_f32 v33, 0x30800000, v33
Mvaa 216,60,116
RT 78,23,3072
v_mul_f32 v34, 0x30800000, v34
Mvaa 216,56,112
v_cvt_pk_bf16_f32 v31, v33, v34
Mvaa 72,32,120
RD 112,20,4096
Mvaa 72,36,124
buffer_load_dwordx4 v19, s[12:15], s29 offen offset:3072 lds
Mvaa 212,44,124
RD 116,21,4096
Mvaa 212,40,120
Mvaa 76,48,120
RT 80,24,0
Mvaa 76,52,124
buffer_store_dwordx2 v[30:31], v32, s[4:7], s79 offen sc1
Mvaa 208,60,124
RT 82,24,2048
Mvaa 208,56,120
s_add_u32 s76, s30, 132736
s_and_b32 s76, s76, 133119
Mvaa 80,32,0
s_add_u32 m0, s33, 8192
RD 120,20,6144
Mvaa 80,36,4
buffer_load_dwordx4 v12, s[8:11], s76 offen offset:0 lds
Mvaa 204,44,4
RD 124,21,6144
Mvaa 204,40,0
Mvaa 84,48,0
RT 84,24,1024
Mvaa 84,52,4
Mvaa 200,60,4
RT 86,24,3072
Mvaa 200,56,0
Mvaa 96,32,8
RT 88,25,0
Mvaa 96,36,12
buffer_load_dwordx4 v13, s[8:11], s76 offen offset:1024 lds
Mvaa 196,44,12
RT 90,25,2048
Mvaa 196,40,8
Mvaa 100,48,8
RT 92,25,1024
Mvaa 100,52,12
Mvaa 192,60,12
RT 94,25,3072
Mvaa 192,56,8
Mvaa 104,32,16
Mvaa 104,36,20
buffer_load_dwordx4 v14, s[8:11], s76 offen offset:2048 lds
Mvaa 188,44,20
Mvaa 188,40,16
Mvaa 108,48,16
Mvaa 108,52,20
Mvaa 184,60,20
Mvaa 184,56,16
Mvaa 120,32,24
Mvaa 120,36,28
buffer_load_dwordx4 v15, s[8:11], s76 offen offset:3072 lds
Mvaa 180,44,28
Mvaa 180,40,24
Mvaa 124,48,24
Mvaa 124,52,28
Mvaa 176,60,28
Mvaa 176,56,24
s_waitcnt vmcnt(22) lgkmcnt(0)
s_barrier
s_add_u32 s29, s37, 6815744
s_and_b32 s29, s29, 8388607
Mvaa 128,64,96
s_add_u32 m0, s34, 98304
RD 0,20,8192
Mvaa 128,68,100
buffer_load_dwordx4 v16, s[12:15], s29 offen offset:0 lds
Mvaa 252,76,100
RD 4,21,8192
Mvaa 252,72,96
Mvaa 132,80,96
RD 8,20,10240
Mvaa 132,84,100
Mvaa 248,92,100
RD 12,21,10240
Mvaa 248,88,96
Mvaa 164,64,104
RD 16,20,12288
Mvaa 164,68,108
buffer_load_dwordx4 v17, s[12:15], s29 offen offset:1024 lds
Maaa 208,76,108
RD 20,21,12288
Maaa 208,72,104
Mvaa 172,80,104
RD 24,20,14336
Mvaa 172,84,108
Maaa 212,92,108
RD 28,21,14336
Maaa 212,88,104
Mvaa 136,64,112
RT 32,22,16384
Mvaa 136,68,116
buffer_load_dwordx4 v18, s[12:15], s29 offen offset:2048 lds
Mvaa 244,76,116
RT 34,22,18432
Mvaa 244,72,112
Mvaa 140,80,112
RT 36,22,17408
Mvaa 140,84,116
Mvaa 240,92,116
RT 38,22,19456
Mvaa 240,88,112
Mvaa 64,64,120
RT 40,23,16384
Mvaa 64,68,124
buffer_load_dwordx4 v19, s[12:15], s29 offen offset:3072 lds
Maaa 216,76,124
RT 42,23,18432
Maaa 216,72,120
Mvaa 68,80,120
RT 44,23,17408
Mvaa 68,84,124
Maaa 220,92,124
RT 46,23,19456
Maaa 220,88,120
s_add_u32 s76, s30, 1792
s_and_b32 s76, s76, 133119
s_waitcnt lgkmcnt(8)
Mvaa 144,64,0
s_add_u32 m0, s33, 65536
RT 48,24,16384
Mvaa 144,68,4
buffer_load_dwordx4 v12, s[8:11], s76 offen offset:0 lds
Maaa 224,76,4
RT 50,24,18432
Maaa 224,72,0
Mvaa 148,80,0
RT 52,24,17408
Mvaa 148,84,4
Maaa 228,92,4
RT 54,24,19456
Maaa 228,88,0
Mvaa 88,64,8
RT 56,25,16384
Mvaa 88,68,12
buffer_load_dwordx4 v13, s[8:11], s76 offen offset:1024 lds
Maaa 232,76,12
RT 58,25,18432
Maaa 232,72,8
Mvaa 92,80,8
RT 60,25,17408
Mvaa 92,84,12
Maaa 236,92,12
RT 62,25,19456
Maaa 236,88,8
Mvaa 152,64,16
v_add_u32 v20, 65536, v20
v_add_u32 v21, 65536, v21
Mvaa 152,68,20
buffer_load_dwordx4 v14, s[8:11], s76 offen offset:2048 lds
Maaa 240,76,20
s_waitcnt vmcnt(16)
v_xor_b32 v22, 0x10000, v22
v_xor_b32 v23, 0x10000, v23
Maaa 240,72,16
s_cmp_eq_u32 s24, 0
s_cselect_b32 s77, 1, 0
Mvaa 156,80,16
v_xor_b32 v24, 0x10000, v24
v_xor_b32 v25, 0x10000, v25
Mvaa 156,84,20
Maaa 244,92,20
v_and_b32 v38, v38, v39
v_and_b32 v40, v40, v41
Maaa 244,88,16
v_and_b32 v38, v38, v40
v_cmp_ne_u32 vcc, s77, v38
Mvaa 112,64,24
v_lshrrev_b32 v46, 4, v1
v_lshlrev_b32 v46, 5, v46
Mvaa 112,68,28
buffer_load_dwordx4 v15, s[8:11], s76 offen offset:3072 lds
Maaa 248,76,28
Maaa 248,72,24
Mvaa 116,80,24
s_cbranch_vccnz L_prepwaitK
L_prepokK:
Mvaa 116,84,28
Maaa 252,92,28
Maaa 252,88,24
s_waitcnt vmcnt(22) lgkmcnt(0)
s_barrier
s_add_u32 s29, s37, 6816000
s_and_b32 s29, s29, 8388607
Mvaa 160,32,96
s_add_u32 m0, s34, 114688
s_mov_b32 s84, 0x11111111
RT 64,22,0
Mvaa 160,36,100
buffer_load_dwordx4 v16, s[12:15], s29 offen offset:0 lds
Mvaa 236,44,100
s_mov_b32 s85, 0x32765432
RT 66,22,2048
Mvaa 236,40,96
s_lshl_b32 s44, s25, 3
Mvaa 168,48,96
s_add_u32 s78, s39, 0
s_and_b32 s43, s26, 7
RT 68,22,1024
Mvaa 168,52,100
buffer_load_dwordx4 a[128:131], v5, s[4:7], s78 offen sc1
Mvaa 232,60,100
s_add_u32 s44, s44, s43
RT 70,22,3072
Mvaa 232,56,96
s_lshl_b32 s44, s44, 2
Mvaa 48,32,104
s_add_u32 s44, s44, s24
RD 96,20,0
Mvaa 48,36,108
buffer_load_dwordx4 v17, s[12:15], s29 offen offset:1024 lds
Mvaa 228,44,108
s_mul_i32 s66, s44, 17408
RD 100,21,0
Mvaa 228,40,104
s_add_u32 s66, s66, 54525952
Mvaa 52,48,104
s_mul_i32 s67, s44, 19456
RT 72,23,0
Mvaa 52,52,108
s_add_u32 s67, s67, 63963136
Mvaa 224,60,108
s_lshl_b32 s72, s44, 5
RT 74,23,2048
Mvaa 224,56,104
s_add_u32 s72, s72, 14696448
Mvaa 56,32,112
s_mul_i32 s42, s24, 28672
RD 104,20,2048
Mvaa 56,36,116
buffer_load_dwordx4 v18, s[12:15], s29 offen offset:2048 lds
Mvaa 220,44,116
s_add_u32 s42, s42, 75497472
RD 108,21,2048
Mvaa 220,40,112
s_mul_i32 s44, s25, 7
Mvaa 60,48,112
s_add_u32 s78, s39, 57344
s_add_u32 s44, s44, s43
RT 76,23,1024
Mvaa 60,52,116
buffer_load_dwordx4 a[132:135], v5, s[4:7], s78 offen sc1
Mvaa 216,60,116
s_lshr_b32 s43, s44, 4
RT 78,23,3072
Mvaa 216,56,112
s_and_b32 s73, s44, 15
Mvaa 72,32,120
s_lshl2_add_u32 s79, s2, s24
RD 112,20,4096
Mvaa 72,36,124
buffer_load_dwordx4 v19, s[12:15], s29 offen offset:3072 lds
Mvaa 212,44,124
s_lshl_b32 s79, s79, 9
RD 116,21,4096
Mvaa 212,40,120
s_add_u32 s79, s79, 15728640
Mvaa 76,48,120
s_mul_i32 s68, s73, 2661376
RT 80,24,0
Mvaa 76,52,124
s_add_u32 s68, s68, s42
Mvaa 208,60,124
s_mul_i32 s44, s43, 115712
RT 82,24,2048
Mvaa 208,56,120
s_add_u32 s76, s30, 132864
s_and_b32 s76, s76, 133119
s_add_u32 s68, s68, s44
Mvaa 80,32,0
s_add_u32 m0, s33, 73728
s_add_u32 s68, s68, 1851392
RD 120,20,6144
Mvaa 80,36,4
buffer_load_dwordx4 v12, s[8:11], s76 offen offset:0 lds
Mvaa 204,44,4
s_lshl_b32 s73, s73, 9
RD 124,21,6144
Mvaa 204,40,0
s_lshl_b32 s44, s43, 2
Mvaa 84,48,0
s_add_u32 s73, s73, s44
RT 84,24,1024
Mvaa 84,52,4
s_lshl_b32 s44, s24, 7
Mvaa 200,60,4
s_add_u32 s44, s44, 14688256
RT 86,24,3072
Mvaa 200,56,0
s_add_u32 s73, s73, s44
Mvaa 96,32,8
s_add_u32 s73, s73, 64
RT 88,25,0
Mvaa 96,36,12
buffer_load_dwordx4 v13, s[8:11], s76 offen offset:1024 lds
Mvaa 196,44,12
s_lshr_b32 s43, s26, 3
RT 90,25,2048
Mvaa 196,40,8
s_mul_i32 s43, s43, 7
Mvaa 100,48,8
s_xor_b32 s43, s43, 7
RT 92,25,1024
Mvaa 100,52,12
s_xor_b32 s43, s43, s26
Mvaa 192,60,12
s_mul_i32 s69, s43, 2661376
RT 94,25,3072
Mvaa 192,56,8
s_add_u32 s69, s69, s42
Mvaa 104,32,16
s_mul_i32 s42, s25, 115712
Mvaa 104,36,20
buffer_load_dwordx4 v14, s[8:11], s76 offen offset:2048 lds
Mvaa 188,44,20
s_add_u32 s69, s69, s42
Mvaa 188,40,16
s_lshl_b32 s74, s43, 9
Mvaa 108,48,16
s_add_u32 s78, s39, 1024
s_add_u32 s74, s74, s44
Mvaa 108,52,20
buffer_load_dwordx4 a[136:139], v5, s[4:7], s78 offen sc1
Mvaa 184,60,20
s_lshl_b32 s42, s25, 2
Mvaa 184,56,16
s_add_u32 s74, s74, s42
Mvaa 120,32,24
s_lshr_b32 s43, s61, 1
Mvaa 120,36,28
buffer_load_dwordx4 v15, s[8:11], s76 offen offset:3072 lds
Mvaa 180,44,28
s_sub_u32 s43, s43, 1
Mvaa 180,40,24
s_lshl_b32 s44, s26, 2
Mvaa 124,48,24
s_add_u32 s78, s39, 58368
s_lshr_b64 s[80:81], s[84:85], s44
Mvaa 124,52,28
buffer_load_dwordx4 a[140:143], v5, s[4:7], s78 offen sc1
Mvaa 176,60,28
s_and_b32 s44, s80, 15
Mvaa 176,56,24
s_cmp_eq_u32 s60, 1
s_cselect_b32 s66, 2130706432, s66
s_waitcnt vmcnt(25) lgkmcnt(0)
s_barrier
s_add_u32 s29, s37, 7340032
s_and_b32 s29, s29, 8388607
Mvaa 128,64,96
s_add_u32 m0, s34, 32768
s_cmp_eq_u32 s60, 0
s_cselect_b32 s73, s73, 2130706432
RD 0,20,8192
Mvaa 128,68,100
buffer_load_dwordx4 v16, s[12:15], s29 offen offset:0 lds
Mvaa 252,76,100
s_cmp_eq_u32 s24, 0
s_cselect_b32 s77, 0, 0x40000000
s_cselect_b32 s38, 1, 0
s_or_b32 s72, s72, s77
RD 4,21,8192
Mvaa 252,72,96
Mvaa 132,80,96
RD 8,20,10240
Mvaa 132,84,100
Mvaa 248,92,100
RD 12,21,10240
Mvaa 248,88,96
Mvaa 164,64,104
RD 16,20,12288
Mvaa 164,68,108
buffer_load_dwordx4 v17, s[12:15], s29 offen offset:1024 lds
Maaa 208,76,108
RD 20,21,12288
Maaa 208,72,104
Mvaa 172,80,104
RD 24,20,14336
Mvaa 172,84,108
Maaa 212,92,108
RD 28,21,14336
Maaa 212,88,104
Mvaa 136,64,112
RT 32,22,16384
Mvaa 136,68,116
buffer_load_dwordx4 v18, s[12:15], s29 offen offset:2048 lds
Mvaa 244,76,116
RT 34,22,18432
Mvaa 244,72,112
Mvaa 140,80,112
s_add_u32 s78, s39, 2048
RT 36,22,17408
Mvaa 140,84,116
buffer_load_dwordx4 a[144:147], v5, s[4:7], s78 offen sc1
Mvaa 240,92,116
RT 38,22,19456
Mvaa 240,88,112
Mvaa 64,64,120
RT 40,23,16384
Mvaa 64,68,124
buffer_load_dwordx4 v19, s[12:15], s29 offen offset:3072 lds
Maaa 216,76,124
RT 42,23,18432
Maaa 216,72,120
Mvaa 68,80,120
RT 44,23,17408
Mvaa 68,84,124
Maaa 220,92,124
RT 46,23,19456
Maaa 220,88,120
s_add_u32 s76, s30, 1920
s_and_b32 s76, s76, 133119
s_waitcnt lgkmcnt(8)
Mvaa 144,64,0
s_add_u32 m0, s33, 131072
RT 48,24,16384
Mvaa 144,68,4
buffer_load_dwordx4 v12, s[8:11], s76 offen offset:0 lds
Maaa 224,76,4
RT 50,24,18432
Maaa 224,72,0
Mvaa 148,80,0
RT 52,24,17408
Mvaa 148,84,4
Maaa 228,92,4
RT 54,24,19456
Maaa 228,88,0
Mvaa 88,64,8
RT 56,25,16384
Mvaa 88,68,12
buffer_load_dwordx4 v13, s[8:11], s76 offen offset:1024 lds
Maaa 232,76,12
RT 58,25,18432
Maaa 232,72,8
Mvaa 92,80,8
s_add_u32 s78, s39, 59392
RT 60,25,17408
Mvaa 92,84,12
buffer_load_dwordx4 a[148:151], v5, s[4:7], s78 offen sc1
Maaa 236,92,12
RT 62,25,19456
Maaa 236,88,8
Mvaa 152,64,16
v_add_u32 v20, -131072, v20
v_add_u32 v21, -131072, v21
Mvaa 152,68,20
buffer_load_dwordx4 v14, s[8:11], s76 offen offset:2048 lds
Maaa 240,76,20
v_xor_b32 v22, 0x10000, v22
v_xor_b32 v23, 0x10000, v23
Maaa 240,72,16
Mvaa 156,80,16
v_xor_b32 v24, 0x10000, v24
v_xor_b32 v25, 0x10000, v25
Mvaa 156,84,20
Maaa 244,92,20
Maaa 244,88,16
Mvaa 112,64,24
Mvaa 112,68,28
buffer_load_dwordx4 v15, s[8:11], s76 offen offset:3072 lds
Maaa 248,76,28
Maaa 248,72,24
Mvaa 116,80,24
s_add_u32 s78, s39, 3072
Mvaa 116,84,28
buffer_load_dwordx4 a[152:155], v5, s[4:7], s78 offen sc1
Maaa 252,92,28
Maaa 252,88,24
s_waitcnt vmcnt(27) lgkmcnt(0)
s_barrier
s_add_u32 s29, s37, 7340288
s_branch LOP14
LP14:
s_setpc_b64 s[48:49]
LOP14:
s_and_b32 s29, s29, 8388607
Mvaa 160,32,96
s_add_u32 m0, s34, 49152
RT 64,22,0
Mvaa 160,36,100
buffer_load_dwordx4 v16, s[12:15], s29 offen offset:0 lds
Mvaa 236,44,100
RT 66,22,2048
Mvaa 236,40,96
Mvaa 168,48,96
RT 68,22,1024
Mvaa 168,52,100
Mvaa 232,60,100
RT 70,22,3072
Mvaa 232,56,96
Mvaa 48,32,104
RD 96,20,0
Mvaa 48,36,108
buffer_load_dwordx4 v17, s[12:15], s29 offen offset:1024 lds
Mvaa 228,44,108
RD 100,21,0
Mvaa 228,40,104
Mvaa 52,48,104
RT 72,23,0
Mvaa 52,52,108
Mvaa 224,60,108
RT 74,23,2048
Mvaa 224,56,104
Mvaa 56,32,112
RD 104,20,2048
Mvaa 56,36,116
buffer_load_dwordx4 v18, s[12:15], s29 offen offset:2048 lds
Mvaa 220,44,116
RD 108,21,2048
Mvaa 220,40,112
Mvaa 60,48,112
s_add_u32 s78, s39, 60416
RT 76,23,1024
Mvaa 60,52,116
buffer_load_dwordx4 a[156:159], v5, s[4:7], s78 offen sc1
Mvaa 216,60,116
RT 78,23,3072
Mvaa 216,56,112
Mvaa 72,32,120
RD 112,20,4096
Mvaa 72,36,124
buffer_load_dwordx4 v19, s[12:15], s29 offen offset:3072 lds
Mvaa 212,44,124
RD 116,21,4096
Mvaa 212,40,120
Mvaa 76,48,120
RT 80,24,0
Mvaa 76,52,124
Mvaa 208,60,124
RT 82,24,2048
Mvaa 208,56,120
s_add_u32 s76, s30, 132992
s_and_b32 s76, s76, 133119
Mvaa 80,32,0
s_add_u32 m0, s33, 139264
RD 120,20,6144
Mvaa 80,36,4
buffer_load_dwordx4 v12, s[8:11], s76 offen offset:0 lds
Mvaa 204,44,4
RD 124,21,6144
Mvaa 204,40,0
Mvaa 84,48,0
RT 84,24,1024
Mvaa 84,52,4
Mvaa 200,60,4
RT 86,24,3072
Mvaa 200,56,0
Mvaa 96,32,8
RT 88,25,0
Mvaa 96,36,12
buffer_load_dwordx4 v13, s[8:11], s76 offen offset:1024 lds
Mvaa 196,44,12
RT 90,25,2048
Mvaa 196,40,8
Mvaa 100,48,8
s_add_u32 s78, s39, 4096
RT 92,25,1024
Mvaa 100,52,12
buffer_load_dwordx4 a[160:163], v5, s[4:7], s78 offen sc1
Mvaa 192,60,12
RT 94,25,3072
Mvaa 192,56,8
Mvaa 104,32,16
Mvaa 104,36,20
buffer_load_dwordx4 v14, s[8:11], s76 offen offset:2048 lds
Mvaa 188,44,20
Mvaa 188,40,16
Mvaa 108,48,16
Mvaa 108,52,20
Mvaa 184,60,20
Mvaa 184,56,16
Mvaa 120,32,24
Mvaa 120,36,28
buffer_load_dwordx4 v15, s[8:11], s76 offen offset:3072 lds
Mvaa 180,44,28
Mvaa 180,40,24
Mvaa 124,48,24
s_add_u32 s78, s39, 61440
Mvaa 124,52,28
buffer_load_dwordx4 a[164:167], v5, s[4:7], s78 offen sc1
Mvaa 176,60,28
Mvaa 176,56,24
s_waitcnt vmcnt(28) lgkmcnt(0)
s_barrier
s_add_u32 s29, s37, 7864320
s_and_b32 s29, s29, 8388607
Mvaa 128,64,96
s_add_u32 m0, s34, 98304
RD 0,20,8192
Mvaa 128,68,100
buffer_load_dwordx4 v16, s[12:15], s29 offen offset:0 lds
Mvaa 252,76,100
RD 4,21,8192
Mvaa 252,72,96
Mvaa 132,80,96
RD 8,20,10240
Mvaa 132,84,100
buffer_load_dwordx4 v17, s[12:15], s29 offen offset:1024 lds
Mvaa 248,92,100
RD 12,21,10240
Mvaa 248,88,96
Mvaa 164,64,104
RD 16,20,12288
Mvaa 164,68,108
buffer_load_dwordx4 v18, s[12:15], s29 offen offset:2048 lds
Maaa 208,76,108
RD 20,21,12288
Maaa 208,72,104
Mvaa 172,80,104
RD 24,20,14336
Mvaa 172,84,108
buffer_load_dwordx4 v19, s[12:15], s29 offen offset:3072 lds
Maaa 212,92,108
RD 28,21,14336
Maaa 212,88,104
Mvaa 136,64,112
s_add_u32 s78, s39, 5120
RT 32,22,16384
Mvaa 136,68,116
buffer_load_dwordx4 a[168:171], v5, s[4:7], s78 offen sc1
Mvaa 244,76,116
RT 34,22,18432
Mvaa 244,72,112
Mvaa 140,80,112
RT 36,22,17408
Mvaa 140,84,116
Mvaa 240,92,116
RT 38,22,19456
Mvaa 240,88,112
Mvaa 64,64,120
RT 40,23,16384
Mvaa 64,68,124
Maaa 216,76,124
RT 42,23,18432
Maaa 216,72,120
Mvaa 68,80,120
RT 44,23,17408
Mvaa 68,84,124
Maaa 220,92,124
RT 46,23,19456
Maaa 220,88,120
s_waitcnt lgkmcnt(8)
Mvaa 144,64,0
s_add_u32 s78, s39, 62464
RT 48,24,16384
Mvaa 144,68,4
buffer_load_dwordx4 a[172:175], v5, s[4:7], s78 offen sc1
Maaa 224,76,4
RT 50,24,18432
Maaa 224,72,0
Mvaa 148,80,0
RT 52,24,17408
Mvaa 148,84,4
Maaa 228,92,4
RT 54,24,19456
Maaa 228,88,0
Mvaa 88,64,8
RT 56,25,16384
Mvaa 88,68,12
Maaa 232,76,12
RT 58,25,18432
Maaa 232,72,8
Mvaa 92,80,8
RT 60,25,17408
Mvaa 92,84,12
Maaa 236,92,12
RT 62,25,19456
Maaa 236,88,8
Mvaa 152,64,16
s_add_u32 s78, s39, 6144
v_add_u32 v20, 65536, v20
v_add_u32 v21, 65536, v21
Mvaa 152,68,20
buffer_load_dwordx4 a[176:179], v5, s[4:7], s78 offen sc1
Maaa 240,76,20
v_xor_b32 v22, 0x10000, v22
v_xor_b32 v23, 0x10000, v23
Maaa 240,72,16
Mvaa 156,80,16
v_xor_b32 v24, 0x10000, v24
v_xor_b32 v25, 0x10000, v25
Mvaa 156,84,20
Maaa 244,92,20
Maaa 244,88,16
Mvaa 112,64,24
Mvaa 112,68,28
Maaa 248,76,28
Maaa 248,72,24
Mvaa 116,80,24
Mvaa 116,84,28
Maaa 252,92,28
Maaa 252,88,24
s_waitcnt vmcnt(24) lgkmcnt(0)
s_barrier
s_add_u32 s29, s37, 7864576
s_and_b32 s29, s29, 8388607
Mvaa 160,32,96
s_add_u32 m0, s34, 114688
RT 64,22,0
Mvaa 160,36,100
buffer_load_dwordx4 v16, s[12:15], s29 offen offset:0 lds
Mvaa 236,44,100
RT 66,22,2048
Mvaa 236,40,96
Mvaa 168,48,96
RT 68,22,1024
Mvaa 168,52,100
buffer_load_dwordx4 v17, s[12:15], s29 offen offset:1024 lds
Mvaa 232,60,100
RT 70,22,3072
Mvaa 232,56,96
Mvaa 48,32,104
RD 96,20,0
Mvaa 48,36,108
buffer_load_dwordx4 v18, s[12:15], s29 offen offset:2048 lds
Mvaa 228,44,108
RD 100,21,0
Mvaa 228,40,104
Mvaa 52,48,104
RT 72,23,0
Mvaa 52,52,108
buffer_load_dwordx4 v19, s[12:15], s29 offen offset:3072 lds
Mvaa 224,60,108
RT 74,23,2048
Mvaa 224,56,104
s_add_u32 s76, s63, 0
Mvaa 56,32,112
s_add_u32 m0, s34, 0
RD 104,20,2048
Mvaa 56,36,116
buffer_load_dwordx4 v2, s[4:7], s76 offen offset:0 sc1 lds
Mvaa 220,44,116
RD 108,21,2048
Mvaa 220,40,112
Mvaa 60,48,112
RT 76,23,1024
Mvaa 60,52,116
buffer_load_dwordx4 v2, s[4:7], s76 offen offset:1024 sc1 lds
Mvaa 216,60,116
RT 78,23,3072
Mvaa 216,56,112
Mvaa 72,32,120
RD 112,20,4096
Mvaa 72,36,124
buffer_load_dwordx4 v2, s[4:7], s76 offen offset:2048 sc1 lds
Mvaa 212,44,124
RD 116,21,4096
Mvaa 212,40,120
Mvaa 76,48,120
RT 80,24,0
Mvaa 76,52,124
buffer_load_dwordx4 v2, s[4:7], s76 offen offset:3072 sc1 lds
Mvaa 208,60,124
RT 82,24,2048
Mvaa 208,56,120
s_add_u32 s29, s63, 16384
Mvaa 80,32,0
s_add_u32 m0, s34, 16384
RD 120,20,6144
Mvaa 80,36,4
buffer_load_dwordx4 v2, s[4:7], s29 offen offset:0 sc1 lds
Mvaa 204,44,4
RD 124,21,6144
Mvaa 204,40,0
Mvaa 84,48,0
RT 84,24,1024
Mvaa 84,52,4
buffer_load_dwordx4 v2, s[4:7], s29 offen offset:1024 sc1 lds
Mvaa 200,60,4
RT 86,24,3072
Mvaa 200,56,0
Mvaa 96,32,8
RT 88,25,0
Mvaa 96,36,12
buffer_load_dwordx4 v2, s[4:7], s29 offen offset:2048 sc1 lds
Mvaa 196,44,12
RT 90,25,2048
Mvaa 196,40,8
Mvaa 100,48,8
RT 92,25,1024
Mvaa 100,52,12
buffer_load_dwordx4 v2, s[4:7], s29 offen offset:3072 sc1 lds
Mvaa 192,60,12
RT 94,25,3072
Mvaa 192,56,8
Mvaa 104,32,16
s_add_u32 s78, s39, 63488
Mvaa 104,36,20
buffer_load_dwordx4 a[180:183], v5, s[4:7], s78 offen sc1
Mvaa 188,44,20
Mvaa 188,40,16
Mvaa 108,48,16
s_add_u32 s78, s39, 7168
Mvaa 108,52,20
buffer_load_dwordx4 a[184:187], v5, s[4:7], s78 offen sc1
Mvaa 184,60,20
Mvaa 184,56,16
Mvaa 120,32,24
s_add_u32 s78, s39, 64512
Mvaa 120,36,28
buffer_load_dwordx4 a[188:191], v5, s[4:7], s78 offen sc1
Mvaa 180,44,28
Mvaa 180,40,24
Mvaa 124,48,24
Mvaa 124,52,28
Mvaa 176,60,28
Mvaa 176,56,24
s_waitcnt vmcnt(63)
s_waitcnt vmcnt(28) lgkmcnt(0)
s_barrier
s_add_u32 s29, s63, 32768
Mvaa 128,64,96
s_add_u32 m0, s34, 32768
RD 0,20,8192
Mvaa 128,68,100
buffer_load_dwordx4 v2, s[4:7], s29 offen offset:0 sc1 lds
Mvaa 252,76,100
RD 4,21,8192
Mvaa 252,72,96
Mvaa 132,80,96
RD 8,20,10240
Mvaa 132,84,100
buffer_load_dwordx4 v2, s[4:7], s29 offen offset:1024 sc1 lds
Mvaa 248,92,100
RD 12,21,10240
Mvaa 248,88,96
Mvaa 164,64,104
RD 16,20,12288
Mvaa 164,68,108
buffer_load_dwordx4 v2, s[4:7], s29 offen offset:2048 sc1 lds
Maaa 208,76,108
RD 20,21,12288
Maaa 208,72,104
Mvaa 172,80,104
RD 24,20,14336
Mvaa 172,84,108
buffer_load_dwordx4 v2, s[4:7], s29 offen offset:3072 sc1 lds
Maaa 212,92,108
RD 28,21,14336
Maaa 212,88,104
Mvaa 136,64,112
s_add_u32 s78, s39, 8192
RT 32,22,16384
Mvaa 136,68,116
buffer_load_dwordx4 a[192:195], v5, s[4:7], s78 offen sc1
Mvaa 244,76,116
RT 34,22,18432
Mvaa 244,72,112
Mvaa 140,80,112
RT 36,22,17408
Mvaa 140,84,116
Mvaa 240,92,116
RT 38,22,19456
Mvaa 240,88,112
Mvaa 64,64,120
RT 40,23,16384
Mvaa 64,68,124
Maaa 216,76,124
RT 42,23,18432
Maaa 216,72,120
Mvaa 68,80,120
s_add_u32 s78, s39, 65536
RT 44,23,17408
Mvaa 68,84,124
buffer_load_dwordx4 a[196:199], v5, s[4:7], s78 offen sc1
Maaa 220,92,124
RT 46,23,19456
Maaa 220,88,120
s_waitcnt lgkmcnt(8)
Mvaa 144,64,0
RT 48,24,16384
Mvaa 144,68,4
Maaa 224,76,4
RT 50,24,18432
Maaa 224,72,0
Mvaa 148,80,0
RT 52,24,17408
Mvaa 148,84,4
Maaa 228,92,4
RT 54,24,19456
Maaa 228,88,0
Mvaa 88,64,8
s_add_u32 s78, s39, 9216
RT 56,25,16384
Mvaa 88,68,12
buffer_load_dwordx4 a[200:203], v5, s[4:7], s78 offen sc1
Maaa 232,76,12
RT 58,25,18432
Maaa 232,72,8
Mvaa 92,80,8
RT 60,25,17408
Mvaa 92,84,12
Maaa 236,92,12
RT 62,25,19456
Maaa 236,88,8
Mvaa 152,64,16
v_add_u32 v20, 65536, v20
v_add_u32 v21, 65536, v21
Mvaa 152,68,20
Maaa 240,76,20
v_xor_b32 v22, 0x10000, v22
v_xor_b32 v23, 0x10000, v23
Maaa 240,72,16
Mvaa 156,80,16
v_xor_b32 v24, 0x10000, v24
v_xor_b32 v25, 0x10000, v25
Mvaa 156,84,20
Maaa 244,92,20
Maaa 244,88,16
Mvaa 112,64,24
Mvaa 112,68,28
Maaa 248,76,28
Maaa 248,72,24
Mvaa 116,80,24
s_add_u32 s78, s39, 66560
Mvaa 116,84,28
buffer_load_dwordx4 a[204:207], v5, s[4:7], s78 offen sc1
Maaa 252,92,28
Maaa 252,88,24
s_waitcnt vmcnt(26) lgkmcnt(0)
s_barrier
s_add_u32 s29, s63, 49152
Mvaa 160,32,96
s_add_u32 m0, s34, 49152
RT 64,22,0
Mvaa 160,36,100
buffer_load_dwordx4 v2, s[4:7], s29 offen offset:0 sc1 lds
Mvaa 236,44,100
RT 66,22,2048
Mvaa 236,40,96
Mvaa 168,48,96
RT 68,22,1024
Mvaa 168,52,100
buffer_load_dwordx4 v2, s[4:7], s29 offen offset:1024 sc1 lds
Mvaa 232,60,100
RT 70,22,3072
Mvaa 232,56,96
Mvaa 48,32,104
RD 96,20,0
Mvaa 48,36,108
buffer_load_dwordx4 v2, s[4:7], s29 offen offset:2048 sc1 lds
Mvaa 228,44,108
RD 100,21,0
Mvaa 228,40,104
Mvaa 52,48,104
RT 72,23,0
Mvaa 52,52,108
buffer_load_dwordx4 v2, s[4:7], s29 offen offset:3072 sc1 lds
Mvaa 224,60,108
RT 74,23,2048
Mvaa 224,56,104
s_add_u32 s76, s63, 65536
Mvaa 56,32,112
s_add_u32 m0, s34, 65536
RD 104,20,2048
Mvaa 56,36,116
buffer_load_dwordx4 v2, s[4:7], s76 offen offset:0 sc1 lds
Mvaa 220,44,116
RD 108,21,2048
Mvaa 220,40,112
Mvaa 60,48,112
RT 76,23,1024
Mvaa 60,52,116
buffer_load_dwordx4 v2, s[4:7], s76 offen offset:1024 sc1 lds
Mvaa 216,60,116
RT 78,23,3072
Mvaa 216,56,112
Mvaa 72,32,120
RD 112,20,4096
Mvaa 72,36,124
buffer_load_dwordx4 v2, s[4:7], s76 offen offset:2048 sc1 lds
Mvaa 212,44,124
RD 116,21,4096
Mvaa 212,40,120
Mvaa 76,48,120
RT 80,24,0
Mvaa 76,52,124
buffer_load_dwordx4 v2, s[4:7], s76 offen offset:3072 sc1 lds
Mvaa 208,60,124
RT 82,24,2048
Mvaa 208,56,120
s_add_u32 s29, s63, 81920
Mvaa 80,32,0
s_add_u32 m0, s34, 81920
RD 120,20,6144
Mvaa 80,36,4
buffer_load_dwordx4 v2, s[4:7], s29 offen offset:0 sc1 lds
Mvaa 204,44,4
RD 124,21,6144
Mvaa 204,40,0
Mvaa 84,48,0
RT 84,24,1024
s_branch LOP15
LP15:
s_setpc_b64 s[48:49]
LOP15:
Mvaa 84,52,4
buffer_load_dwordx4 v2, s[4:7], s29 offen offset:1024 sc1 lds
Mvaa 200,60,4
RT 86,24,3072
Mvaa 200,56,0
Mvaa 96,32,8
RT 88,25,0
Mvaa 96,36,12
buffer_load_dwordx4 v2, s[4:7], s29 offen offset:2048 sc1 lds
Mvaa 196,44,12
RT 90,25,2048
Mvaa 196,40,8
Mvaa 100,48,8
RT 92,25,1024
Mvaa 100,52,12
buffer_load_dwordx4 v2, s[4:7], s29 offen offset:3072 sc1 lds
Mvaa 192,60,12
RT 94,25,3072
Mvaa 192,56,8
Mvaa 104,32,16
Mvaa 104,36,20
buffer_load_dwordx4 v[12:15], v46, s[4:7], s79 offen offset:0 sc1
Mvaa 188,44,20
Mvaa 188,40,16
Mvaa 108,48,16
Mvaa 108,52,20
buffer_load_dwordx4 v[16:19], v46, s[4:7], s79 offen offset:16 sc1
Mvaa 184,60,20
Mvaa 184,56,16
Mvaa 120,32,24
Mvaa 120,36,28
buffer_load_dwordx4 v[28:31], v46, s[4:7], s79 offen offset:128 sc1
Mvaa 180,44,28
Mvaa 180,40,24
Mvaa 124,48,24
Mvaa 124,52,28
buffer_load_dwordx4 v[32:35], v46, s[4:7], s79 offen offset:144 sc1
Mvaa 176,60,28
Mvaa 176,56,24
s_waitcnt vmcnt(35) lgkmcnt(0)
s_barrier
s_add_u32 s29, s63, 98304
Mvaa 128,64,96
s_add_u32 m0, s34, 98304
RD 0,20,8192
Mvaa 128,68,100
buffer_load_dwordx4 v2, s[4:7], s29 offen offset:0 sc1 lds
Mvaa 252,76,100
RD 4,21,8192
Mvaa 252,72,96
Mvaa 132,80,96
RD 8,20,10240
v_cvt_pk_bf16_f32 v128, v128, v129
Mvaa 132,84,100
buffer_load_dwordx4 v2, s[4:7], s29 offen offset:1024 sc1 lds
Mvaa 248,92,100
RD 12,21,10240
v_cvt_pk_bf16_f32 v129, v130, v131
Mvaa 248,88,96
v_cvt_pk_bf16_f32 v130, v252, v253
v_cvt_pk_bf16_f32 v131, v254, v255
Mvaa 164,64,104
RD 16,20,12288
v_cvt_pk_bf16_f32 v132, v132, v133
Mvaa 164,68,108
buffer_load_dwordx4 v2, s[4:7], s29 offen offset:2048 sc1 lds
Maaa 208,76,108
RD 20,21,12288
v_cvt_pk_bf16_f32 v133, v134, v135
Maaa 208,72,104
v_cvt_pk_bf16_f32 v134, v248, v249
v_cvt_pk_bf16_f32 v135, v250, v251
Mvaa 172,80,104
RD 24,20,14336
v_cvt_pk_bf16_f32 v164, v164, v165
Mvaa 172,84,108
buffer_load_dwordx4 v2, s[4:7], s29 offen offset:3072 sc1 lds
Maaa 212,92,108
RD 28,21,14336
v_cvt_pk_bf16_f32 v165, v166, v167
Maaa 212,88,104
v_accvgpr_read_b32 v166, a208
v_accvgpr_read_b32 v167, a209
Mvaa 136,64,112
RT 32,22,16384
v_accvgpr_read_b32 v47, a211
Mvaa 136,68,116
buffer_load_dwordx4 v[36:39], v46, s[4:7], s79 offen offset:256 sc1
Mvaa 244,76,116
RT 34,22,18432
v_cvt_pk_bf16_f32 v166, v166, v167
Mvaa 244,72,112
v_accvgpr_read_b32 v167, a210
v_cvt_pk_bf16_f32 v167, v167, v47
Mvaa 140,80,112
RT 36,22,17408
v_cvt_pk_bf16_f32 v172, v172, v173
Mvaa 140,84,116
buffer_load_dwordx4 v[40:43], v46, s[4:7], s79 offen offset:272 sc1
Mvaa 240,92,116
RT 38,22,19456
v_cvt_pk_bf16_f32 v173, v174, v175
Mvaa 240,88,112
v_accvgpr_read_b32 v174, a212
v_accvgpr_read_b32 v175, a213
Mvaa 64,64,120
s_add_u32 s78, s64, 0
RT 40,23,16384
v_accvgpr_read_b32 v47, a215
Mvaa 64,68,124
buffer_store_dwordx4 v[128:131], v5, s[4:7], s78 offen sc1
Maaa 216,76,124
RT 42,23,18432
v_cvt_pk_bf16_f32 v174, v174, v175
Maaa 216,72,120
v_accvgpr_read_b32 v175, a214
v_cvt_pk_bf16_f32 v175, v175, v47
Mvaa 68,80,120
RT 44,23,17408
v_cvt_pk_bf16_f32 v136, v136, v137
Mvaa 68,84,124
v_cvt_pk_bf16_f32 v137, v138, v139
v_cvt_pk_bf16_f32 v138, v244, v245
Maaa 220,92,124
RT 46,23,19456
v_cvt_pk_bf16_f32 v139, v246, v247
Maaa 220,88,120
s_waitcnt lgkmcnt(8)
v_cvt_pk_bf16_f32 v140, v140, v141
v_cvt_pk_bf16_f32 v141, v142, v143
Mvaa 144,64,0
s_add_u32 s78, s64, 1024
RT 48,24,16384
v_cvt_pk_bf16_f32 v142, v240, v241
Mvaa 144,68,4
buffer_store_dwordx4 v[132:135], v5, s[4:7], s78 offen sc1
Maaa 224,76,4
RT 50,24,18432
v_cvt_pk_bf16_f32 v143, v242, v243
Maaa 224,72,0
v_cvt_pk_bf16_f32 v64, v64, v65
v_cvt_pk_bf16_f32 v65, v66, v67
Mvaa 148,80,0
RT 52,24,17408
v_accvgpr_read_b32 v66, a216
Mvaa 148,84,4
v_accvgpr_read_b32 v67, a217
v_accvgpr_read_b32 v47, a219
Maaa 228,92,4
RT 54,24,19456
v_cvt_pk_bf16_f32 v66, v66, v67
Maaa 228,88,0
v_accvgpr_read_b32 v67, a218
v_cvt_pk_bf16_f32 v67, v67, v47
Mvaa 88,64,8
s_add_u32 s78, s64, 17408
RT 56,25,16384
v_cvt_pk_bf16_f32 v68, v68, v69
Mvaa 88,68,12
buffer_store_dwordx4 v[136:139], v5, s[4:7], s78 offen sc1
Maaa 232,76,12
RT 58,25,18432
v_cvt_pk_bf16_f32 v69, v70, v71
Maaa 232,72,8
v_accvgpr_read_b32 v70, a220
v_accvgpr_read_b32 v71, a221
Mvaa 92,80,8
RT 60,25,17408
v_accvgpr_read_b32 v47, a223
Mvaa 92,84,12
v_cvt_pk_bf16_f32 v70, v70, v71
v_accvgpr_read_b32 v71, a222
Maaa 236,92,12
RT 62,25,19456
v_cvt_pk_bf16_f32 v71, v71, v47
Maaa 236,88,8
v_cvt_pk_bf16_f32 v144, v144, v145
v_cvt_pk_bf16_f32 v145, v146, v147
Mvaa 152,64,16
s_add_u32 s78, s64, 18432
v_accvgpr_read_b32 v146, a224
v_accvgpr_read_b32 v147, a225
Mvaa 152,68,20
buffer_store_dwordx4 v[140:143], v5, s[4:7], s78 offen sc1
Maaa 240,76,20
v_accvgpr_read_b32 v47, a227
v_cvt_pk_bf16_f32 v146, v146, v147
Maaa 240,72,16
v_accvgpr_read_b32 v147, a226
v_cvt_pk_bf16_f32 v147, v147, v47
Mvaa 156,80,16
v_cvt_pk_bf16_f32 v148, v148, v149
v_cvt_pk_bf16_f32 v149, v150, v151
Mvaa 156,84,20
v_accvgpr_read_b32 v150, a228
v_accvgpr_read_b32 v151, a229
Maaa 244,92,20
v_accvgpr_read_b32 v47, a231
v_cvt_pk_bf16_f32 v150, v150, v151
Maaa 244,88,16
v_accvgpr_read_b32 v151, a230
v_cvt_pk_bf16_f32 v151, v151, v47
Mvaa 112,64,24
s_add_u32 s78, s64, 34816
v_cvt_pk_bf16_f32 v88, v88, v89
v_cvt_pk_bf16_f32 v89, v90, v91
Mvaa 112,68,28
buffer_store_dwordx4 v[144:147], v5, s[4:7], s78 offen sc1
Maaa 248,76,28
v_accvgpr_read_b32 v90, a232
v_accvgpr_read_b32 v91, a233
Maaa 248,72,24
v_accvgpr_read_b32 v47, a235
v_cvt_pk_bf16_f32 v90, v90, v91
Mvaa 116,80,24
s_add_u32 s78, s64, 35840
v_accvgpr_read_b32 v91, a234
v_cvt_pk_bf16_f32 v91, v91, v47
Mvaa 116,84,28
buffer_store_dwordx4 v[148:151], v5, s[4:7], s78 offen sc1
Maaa 252,92,28
v_cvt_pk_bf16_f32 v92, v92, v93
v_cvt_pk_bf16_f32 v93, v94, v95
Maaa 252,88,24
v_accvgpr_read_b32 v94, a236
v_accvgpr_read_b32 v95, a237
s_waitcnt vmcnt(39) lgkmcnt(0)
s_barrier
s_add_u32 s29, s63, 114688
Mvaa 160,32,96
s_add_u32 m0, s34, 114688
RD 64,6,0
v_accvgpr_read_b32 v47, a239
Mvaa 160,36,100
buffer_load_dwordx4 v2, s[4:7], s29 offen offset:0 sc1 lds
Mvaa 236,44,100
RD 68,6,1024
v_cvt_pk_bf16_f32 v94, v94, v95
Mvaa 236,40,96
v_accvgpr_read_b32 v95, a238
v_cvt_pk_bf16_f32 v95, v95, v47
Mvaa 168,48,96
RD 72,6,2048
v_cvt_pk_bf16_f32 v152, v152, v153
Mvaa 168,52,100
buffer_load_dwordx4 v2, s[4:7], s29 offen offset:1024 sc1 lds
Mvaa 232,60,100
RD 76,6,3072
v_cvt_pk_bf16_f32 v153, v154, v155
Mvaa 232,56,96
v_accvgpr_read_b32 v154, a240
v_accvgpr_read_b32 v155, a241
Mvaa 48,32,104
RD 80,6,4096
v_accvgpr_read_b32 v47, a243
Mvaa 48,36,108
buffer_load_dwordx4 v2, s[4:7], s29 offen offset:2048 sc1 lds
Mvaa 228,44,108
RD 84,6,5120
v_cvt_pk_bf16_f32 v154, v154, v155
Mvaa 228,40,104
v_accvgpr_read_b32 v155, a242
v_cvt_pk_bf16_f32 v155, v155, v47
Mvaa 52,48,104
RD 88,6,6144
v_cvt_pk_bf16_f32 v156, v156, v157
Mvaa 52,52,108
buffer_load_dwordx4 v2, s[4:7], s29 offen offset:3072 sc1 lds
Mvaa 224,60,108
RD 92,6,7168
v_cvt_pk_bf16_f32 v157, v158, v159
Mvaa 224,56,104
v_accvgpr_read_b32 v158, a244
v_accvgpr_read_b32 v159, a245
Mvaa 56,32,112
RD 96,6,8192
v_accvgpr_read_b32 v47, a247
Mvaa 56,36,116
buffer_load_dwordx4 v[20:23], v46, s[4:7], s79 offen offset:384 sc1
Mvaa 220,44,116
RD 100,6,9216
v_cvt_pk_bf16_f32 v158, v158, v159
Mvaa 220,40,112
v_accvgpr_read_b32 v159, a246
v_cvt_pk_bf16_f32 v159, v159, v47
Mvaa 60,48,112
RD 104,6,10240
v_cvt_pk_bf16_f32 v112, v112, v113
Mvaa 60,52,116
buffer_load_dwordx4 v[24:27], v46, s[4:7], s79 offen offset:400 sc1
Mvaa 216,60,116
RD 108,6,11264
v_cvt_pk_bf16_f32 v113, v114, v115
Mvaa 216,56,112
v_accvgpr_read_b32 v114, a248
v_accvgpr_read_b32 v115, a249
Mvaa 72,32,120
s_add_u32 s78, s64, 52224
v_accvgpr_read_b32 v47, a251
v_cvt_pk_bf16_f32 v114, v114, v115
Mvaa 72,36,124
buffer_store_dwordx4 v[152:155], v5, s[4:7], s78 offen sc1
Mvaa 212,44,124
v_accvgpr_read_b32 v115, a250
v_cvt_pk_bf16_f32 v115, v115, v47
Mvaa 212,40,120
v_cvt_pk_bf16_f32 v116, v116, v117
v_cvt_pk_bf16_f32 v117, v118, v119
Mvaa 76,48,120
v_accvgpr_read_b32 v118, a252
v_accvgpr_read_b32 v119, a253
Mvaa 76,52,124
v_accvgpr_read_b32 v47, a255
v_cvt_pk_bf16_f32 v118, v118, v119
Mvaa 208,60,124
s_mov_b32 s29, 4
v_accvgpr_read_b32 v119, a254
v_cvt_pk_bf16_f32 v119, v119, v47
Mvaa 208,56,120
s_add_u32 s30, s3, 131072
v_cvt_pk_bf16_f32 v160, v160, v161
v_cvt_pk_bf16_f32 v161, v162, v163
Mvaa 80,32,0
s_add_u32 s78, s64, 53248
s_add_u32 s32, s63, 131072
v_cvt_pk_bf16_f32 v162, v236, v237
Mvaa 80,36,4
buffer_store_dwordx4 v[156:159], v5, s[4:7], s78 offen sc1
Mvaa 204,44,4
s_mov_b32 s36, -131072
v_cvt_pk_bf16_f32 v163, v238, v239
v_cvt_pk_bf16_f32 v168, v168, v169
Mvaa 204,40,0
s_mov_b32 s33, -131072
v_cvt_pk_bf16_f32 v169, v170, v171
v_cvt_pk_bf16_f32 v170, v232, v233
Mvaa 84,48,0
s_mov_b32 s34, 32768
v_cvt_pk_bf16_f32 v171, v234, v235
v_cvt_pk_bf16_f32 v48, v48, v49
Mvaa 84,52,4
s_mov_b32 m0, s30
v_cvt_pk_bf16_f32 v49, v50, v51
v_cvt_pk_bf16_f32 v50, v228, v229
Mvaa 200,60,4
v_cvt_pk_bf16_f32 v51, v230, v231
v_cvt_pk_bf16_f32 v52, v52, v53
Mvaa 200,56,0
v_cvt_pk_bf16_f32 v53, v54, v55
v_cvt_pk_bf16_f32 v54, v224, v225
Mvaa 96,32,8
s_add_u32 s78, s64, 2048
v_cvt_pk_bf16_f32 v55, v226, v227
v_cvt_pk_bf16_f32 v56, v56, v57
Mvaa 96,36,12
buffer_store_dwordx4 v[160:163], v5, s[4:7], s78 offen sc1
Mvaa 196,44,12
v_cvt_pk_bf16_f32 v57, v58, v59
v_cvt_pk_bf16_f32 v58, v220, v221
Mvaa 196,40,8
v_cvt_pk_bf16_f32 v59, v222, v223
v_cvt_pk_bf16_f32 v60, v60, v61
Mvaa 100,48,8
v_cvt_pk_bf16_f32 v61, v62, v63
v_cvt_pk_bf16_f32 v62, v216, v217
Mvaa 100,52,12
v_cvt_pk_bf16_f32 v63, v218, v219
v_cvt_pk_bf16_f32 v72, v72, v73
Mvaa 192,60,12
v_cvt_pk_bf16_f32 v73, v74, v75
v_cvt_pk_bf16_f32 v74, v212, v213
Mvaa 192,56,8
v_cvt_pk_bf16_f32 v75, v214, v215
v_cvt_pk_bf16_f32 v76, v76, v77
Mvaa 104,32,16
s_add_u32 s78, s65, 0
v_cvt_pk_bf16_f32 v77, v78, v79
v_cvt_pk_bf16_f32 v78, v208, v209
Mvaa 104,36,20
buffer_store_dwordx4 v[164:167], v5, s[4:7], s78 offen sc1
Mvaa 188,44,20
v_cvt_pk_bf16_f32 v79, v210, v211
v_cvt_pk_bf16_f32 v80, v80, v81
Mvaa 188,40,16
v_cvt_pk_bf16_f32 v81, v82, v83
v_cvt_pk_bf16_f32 v82, v204, v205
Mvaa 108,48,16
v_cvt_pk_bf16_f32 v83, v206, v207
v_cvt_pk_bf16_f32 v84, v84, v85
Mvaa 108,52,20
v_cvt_pk_bf16_f32 v85, v86, v87
v_cvt_pk_bf16_f32 v86, v200, v201
Mvaa 184,60,20
v_cvt_pk_bf16_f32 v87, v202, v203
v_cvt_pk_bf16_f32 v96, v96, v97
Mvaa 184,56,16
v_cvt_pk_bf16_f32 v97, v98, v99
v_cvt_pk_bf16_f32 v98, v196, v197
Mvaa 120,32,24
s_add_u32 s78, s64, 3072
v_cvt_pk_bf16_f32 v99, v198, v199
v_cvt_pk_bf16_f32 v100, v100, v101
Mvaa 120,36,28
buffer_store_dwordx4 v[168:171], v5, s[4:7], s78 offen sc1
Mvaa 180,44,28
v_cvt_pk_bf16_f32 v101, v102, v103
v_cvt_pk_bf16_f32 v102, v192, v193
Mvaa 180,40,24
v_cvt_pk_bf16_f32 v103, v194, v195
v_cvt_pk_bf16_f32 v104, v104, v105
Mvaa 124,48,24
s_add_u32 s78, s65, 1024
v_cvt_pk_bf16_f32 v105, v106, v107
v_cvt_pk_bf16_f32 v106, v188, v189
Mvaa 124,52,28
buffer_store_dwordx4 v[172:175], v5, s[4:7], s78 offen sc1
Mvaa 176,60,28
v_cvt_pk_bf16_f32 v107, v190, v191
v_cvt_pk_bf16_f32 v108, v108, v109
Mvaa 176,56,24
v_cvt_pk_bf16_f32 v109, v110, v111
v_cvt_pk_bf16_f32 v110, v184, v185
s_nop 7
v_cvt_pk_bf16_f32 v111, v186, v187
v_cvt_pk_bf16_f32 v120, v120, v121
v_cvt_pk_bf16_f32 v121, v122, v123
v_cvt_pk_bf16_f32 v122, v180, v181
v_cvt_pk_bf16_f32 v123, v182, v183
v_cvt_pk_bf16_f32 v124, v124, v125
v_cvt_pk_bf16_f32 v125, v126, v127
v_cvt_pk_bf16_f32 v126, v176, v177
v_cvt_pk_bf16_f32 v127, v178, v179
s_waitcnt vmcnt(18) lgkmcnt(8)
s_cmp_eq_u32 s60, 0
s_cbranch_scc0 L_P1B
s_branch LOP16
LP16:
s_setpc_b64 s[48:49]
LOP16:
L_P1A:
v_lshlrev_b32 v132, 16, v12
v_lshlrev_b32 v133, 16, v14
v_lshlrev_b32 v134, 16, v16
v_lshlrev_b32 v135, 16, v18
v_and_b32 v140, 0xffff0000, v12
v_and_b32 v141, 0xffff0000, v14
v_and_b32 v142, 0xffff0000, v16
v_and_b32 v143, 0xffff0000, v18
Nvaa 128,64,128,132
s_add_u32 s78, s65, 2048
RD 112,6,12288
v_lshlrev_b32 v148, 16, v13
Mvaa 128,68,136
buffer_store_dwordx4 v[48:51], v5, s[4:7], s78 offen sc1
Mvaa 132,68,140
RD 116,6,13312
v_lshlrev_b32 v149, 16, v15
Mvaa 132,64,132
v_lshlrev_b32 v150, 16, v17
v_lshlrev_b32 v151, 16, v19
Nvaa 136,72,128,140
RD 120,6,14336
v_and_b32 v156, 0xffff0000, v13
Mvaa 136,76,136
buffer_load_dwordx4 v2, s[4:7], s32 offen offset:0 sc1 lds
Mvaa 140,76,140
s_waitcnt lgkmcnt(7)
RD 124,6,15360
v_and_b32 v157, 0xffff0000, v15
Mvaa 140,72,132
v_and_b32 v158, 0xffff0000, v17
v_and_b32 v159, 0xffff0000, v19
Nvaa 144,80,128,148
RD 64,6,16384
v_lshlrev_b32 v164, 16, v28
Mvaa 144,84,136
v_lshlrev_b32 v165, 16, v30
v_lshlrev_b32 v166, 16, v32
Mvaa 148,84,140
RD 68,6,17408
v_lshlrev_b32 v167, 16, v34
Mvaa 148,80,132
v_and_b32 v172, 0xffff0000, v28
v_and_b32 v173, 0xffff0000, v30
Nvaa 152,88,128,156
RD 72,6,18432
v_and_b32 v174, 0xffff0000, v32
Mvaa 152,92,136
buffer_load_dwordx4 v2, s[4:7], s32 offen offset:1024 sc1 lds
Mvaa 156,92,140
s_waitcnt lgkmcnt(7)
RD 76,6,19456
v_and_b32 v175, 0xffff0000, v34
Mvaa 156,88,132
v_lshlrev_b32 v180, 16, v29
v_lshlrev_b32 v181, 16, v31
Nvaa 160,96,128,164
s_add_u32 s78, s65, 3072
RD 80,6,20480
v_lshlrev_b32 v182, 16, v33
Mvaa 160,100,136
buffer_store_dwordx4 v[52:55], v5, s[4:7], s78 offen sc1
Mvaa 164,100,140
RD 84,6,21504
v_lshlrev_b32 v183, 16, v35
Mvaa 164,96,132
v_and_b32 v188, 0xffff0000, v29
v_and_b32 v189, 0xffff0000, v31
Nvaa 168,104,128,172
RD 88,6,22528
v_and_b32 v190, 0xffff0000, v33
Mvaa 168,108,136
buffer_load_dwordx4 v2, s[4:7], s32 offen offset:2048 sc1 lds
Mvaa 172,108,140
s_waitcnt lgkmcnt(7)
RD 92,6,23552
v_and_b32 v191, 0xffff0000, v35
Mvaa 172,104,132
v_lshlrev_b32 v196, 16, v36
v_lshlrev_b32 v197, 16, v38
Nvaa 176,112,128,180
s_add_u32 s78, s64, 19456
RD 96,6,24576
v_lshlrev_b32 v198, 16, v40
Mvaa 176,116,136
buffer_store_dwordx4 v[56:59], v5, s[4:7], s78 offen sc1
Mvaa 180,116,140
RD 100,6,25600
v_lshlrev_b32 v199, 16, v42
Mvaa 180,112,132
v_and_b32 v204, 0xffff0000, v36
v_and_b32 v205, 0xffff0000, v38
Nvaa 184,120,128,188
s_branch LOP17
LP17:
s_setpc_b64 s[48:49]
LOP17:
RD 104,6,26624
v_and_b32 v206, 0xffff0000, v40
Mvaa 184,124,136
buffer_load_dwordx4 v2, s[4:7], s32 offen offset:3072 sc1 lds
Mvaa 188,124,140
s_waitcnt lgkmcnt(7)
RD 108,6,27648
v_and_b32 v207, 0xffff0000, v42
Mvaa 188,120,132
s_add_u32 m0, s30, 16384
v_readlane_b32 s31, v4, s29
Nvaa 192,64,128,196
RD 112,6,28672
v_lshlrev_b32 v212, 16, v37
Mvaa 192,68,136
v_lshlrev_b32 v213, 16, v39
v_lshlrev_b32 v214, 16, v41
Mvaa 196,68,140
s_add_u32 s30, s30, s36
RD 116,6,29696
v_lshlrev_b32 v215, 16, v43
Mvaa 196,64,132
v_and_b32 v220, 0xffff0000, v37
v_and_b32 v221, 0xffff0000, v39
Nvaa 200,72,128,204
s_cmp_ge_u32 s30, 131072
RD 120,6,30720
v_and_b32 v222, 0xffff0000, v41
Mvaa 200,76,136
buffer_load_dwordx4 v2, s[4:7], s31 offen offset:0 sc1 lds
Mvaa 204,76,140
s_waitcnt vmcnt(44) lgkmcnt(7)
s_cselect_b32 s36, s33, s34
RD 124,6,31744
Mvaa 204,72,132
s_barrier
v_add_u32 v6, s36, v6
v_and_b32 v223, 0xffff0000, v43
Nvaa 208,80,128,212
s_add_u32 s78, s64, 20480
s_waitcnt vmcnt(14)
RD 64,6,0
Mvaa 208,84,136
buffer_store_dwordx4 v[60:63], v5, s[4:7], s78 offen sc1
Mvaa 212,84,140
RD 68,6,1024
v_lshlrev_b32 v228, 16, v20
Mvaa 212,80,132
v_lshlrev_b32 v229, 16, v22
v_lshlrev_b32 v230, 16, v24
Nvaa 216,88,128,220
s_add_u32 s29, s29, 1
RD 72,6,2048
v_lshlrev_b32 v231, 16, v26
Mvaa 216,92,136
buffer_load_dwordx4 v2, s[4:7], s31 offen offset:1024 sc1 lds
Mvaa 220,92,140
s_waitcnt lgkmcnt(7)
RD 76,6,3072
v_and_b32 v236, 0xffff0000, v20
Mvaa 220,88,132
v_and_b32 v237, 0xffff0000, v22
v_and_b32 v238, 0xffff0000, v24
Nvaa 224,96,128,228
s_add_u32 s78, s65, 17408
RD 80,6,4096
v_and_b32 v239, 0xffff0000, v26
Mvaa 224,100,136
buffer_store_dwordx4 v[64:67], v5, s[4:7], s78 offen sc1
Mvaa 228,100,140
RD 84,6,5120
v_lshlrev_b32 v244, 16, v21
Mvaa 228,96,132
v_lshlrev_b32 v245, 16, v23
v_lshlrev_b32 v246, 16, v25
Nvaa 232,104,128,236
RD 88,6,6144
v_lshlrev_b32 v247, 16, v27
Mvaa 232,108,136
buffer_load_dwordx4 v2, s[4:7], s31 offen offset:2048 sc1 lds
Mvaa 236,108,140
s_waitcnt lgkmcnt(7)
RD 92,6,7168
v_and_b32 v252, 0xffff0000, v21
Mvaa 236,104,132
v_readlane_b32 s32, v3, s29
Nvaa 240,112,128,244
RD 96,6,8192
v_and_b32 v253, 0xffff0000, v23
Mvaa 240,116,136
v_and_b32 v254, 0xffff0000, v25
v_and_b32 v255, 0xffff0000, v27
Mvaa 244,116,140
RD 100,6,9216
Mvaa 244,112,132
Nvaa 248,120,128,252
RD 104,6,10240
Mvaa 248,124,136
buffer_load_dwordx4 v2, s[4:7], s31 offen offset:3072 sc1 lds
Mvaa 252,124,140
s_waitcnt lgkmcnt(7)
RD 108,6,11264
Mvaa 252,120,132
s_mov_b32 m0, s30
s_bitcmp1_b32 s24, 1
s_cbranch_scc1 LH_A8
s_bitcmp1_b32 s24, 0
s_cbranch_scc1 LA_A8
s_call_b64 s[48:49], LP20
s_branch LR_A8
LA_A8:
s_call_b64 s[48:49], LP21
s_branch LR_A8
LH_A8:
s_bitcmp1_b32 s24, 0
s_cbranch_scc1 LB_A8
s_call_b64 s[48:49], LP22
s_branch LR_A8
LB_A8:
s_call_b64 s[48:49], LP23
LR_A8:
Mvaa 128,64,144
s_add_u32 s78, s65, 18432
RD 112,6,12288
Mvaa 128,68,152
buffer_store_dwordx4 v[68:71], v5, s[4:7], s78 offen sc1
Mvaa 132,68,156
RD 116,6,13312
Mvaa 132,64,148
Mvaa 136,72,144
RD 120,6,14336
Mvaa 136,76,152
buffer_load_dwordx4 v2, s[4:7], s32 offen offset:0 sc1 lds
Mvaa 140,76,156
s_waitcnt lgkmcnt(7)
RD 124,6,15360
Mvaa 140,72,148
Mvaa 144,80,144
s_add_u32 s78, s65, 19456
RD 64,6,16384
Mvaa 144,84,152
buffer_store_dwordx4 v[72:75], v5, s[4:7], s78 offen sc1
Mvaa 148,84,156
RD 68,6,17408
Mvaa 148,80,148
Mvaa 152,88,144
RD 72,6,18432
Mvaa 152,92,152
buffer_load_dwordx4 v2, s[4:7], s32 offen offset:1024 sc1 lds
Mvaa 156,92,156
s_waitcnt lgkmcnt(7)
RD 76,6,19456
Mvaa 156,88,148
Mvaa 160,96,144
RD 80,6,20480
Mvaa 160,100,152
Mvaa 164,100,156
RD 84,6,21504
Mvaa 164,96,148
Mvaa 168,104,144
RD 88,6,22528
Mvaa 168,108,152
buffer_load_dwordx4 v2, s[4:7], s32 offen offset:2048 sc1 lds
Mvaa 172,108,156
s_waitcnt lgkmcnt(7)
RD 92,6,23552
Mvaa 172,104,148
Mvaa 176,112,144
s_add_u32 s78, s65, 20480
RD 96,6,24576
Mvaa 176,116,152
buffer_store_dwordx4 v[76:79], v5, s[4:7], s78 offen sc1
Mvaa 180,116,156
RD 100,6,25600
Mvaa 180,112,148
Mvaa 184,120,144
RD 104,6,26624
Mvaa 184,124,152
buffer_load_dwordx4 v2, s[4:7], s32 offen offset:3072 sc1 lds
Mvaa 188,124,156
s_waitcnt lgkmcnt(7)
RD 108,6,27648
Mvaa 188,120,148
s_add_u32 m0, s30, 16384
v_readlane_b32 s31, v4, s29
Mvaa 192,64,144
s_add_u32 s78, s64, 36864
RD 112,6,28672
Mvaa 192,68,152
buffer_store_dwordx4 v[80:83], v5, s[4:7], s78 offen sc1
Mvaa 196,68,156
s_add_u32 s30, s30, s36
RD 116,6,29696
Mvaa 196,64,148
Mvaa 200,72,144
s_cmp_ge_u32 s30, 131072
RD 120,6,30720
Mvaa 200,76,152
buffer_load_dwordx4 v2, s[4:7], s31 offen offset:0 sc1 lds
Mvaa 204,76,156
s_waitcnt vmcnt(50) lgkmcnt(7)
s_cselect_b32 s36, s33, s34
RD 124,6,31744
Mvaa 204,72,148
s_barrier
v_add_u32 v6, s36, v6
Mvaa 208,80,144
RD 64,6,0
Mvaa 208,84,152
Mvaa 212,84,156
RD 68,6,1024
Mvaa 212,80,148
Mvaa 216,88,144
s_add_u32 s29, s29, 1
RD 72,6,2048
Mvaa 216,92,152
buffer_load_dwordx4 v2, s[4:7], s31 offen offset:1024 sc1 lds
Mvaa 220,92,156
s_waitcnt lgkmcnt(7)
RD 76,6,3072
Mvaa 220,88,148
Mvaa 224,96,144
s_add_u32 s78, s64, 37888
RD 80,6,4096
Mvaa 224,100,152
buffer_store_dwordx4 v[84:87], v5, s[4:7], s78 offen sc1
Mvaa 228,100,156
RD 84,6,5120
Mvaa 228,96,148
Mvaa 232,104,144
RD 88,6,6144
Mvaa 232,108,152
buffer_load_dwordx4 v2, s[4:7], s31 offen offset:2048 sc1 lds
Mvaa 236,108,156
s_waitcnt lgkmcnt(7)
RD 92,6,7168
Mvaa 236,104,148
v_readlane_b32 s32, v3, s29
Mvaa 240,112,144
s_add_u32 s78, s65, 34816
RD 96,6,8192
Mvaa 240,116,152
buffer_store_dwordx4 v[88:91], v5, s[4:7], s78 offen sc1
Mvaa 244,116,156
RD 100,6,9216
Mvaa 244,112,148
Mvaa 248,120,144
RD 104,6,10240
Mvaa 248,124,152
buffer_load_dwordx4 v2, s[4:7], s31 offen offset:3072 sc1 lds
Mvaa 252,124,156
s_waitcnt lgkmcnt(7)
RD 108,6,11264
Mvaa 252,120,148
s_mov_b32 m0, s30
s_bitcmp1_b32 s24, 1
s_cbranch_scc1 LH_A9
s_bitcmp1_b32 s24, 0
s_cbranch_scc1 LA_A9
s_call_b64 s[48:49], LP24
s_branch LR_A9
LA_A9:
s_call_b64 s[48:49], LP30
s_branch LR_A9
LH_A9:
s_bitcmp1_b32 s24, 0
s_cbranch_scc1 LB_A9
s_call_b64 s[48:49], LP31
s_branch LR_A9
LB_A9:
s_call_b64 s[48:49], LP33
LR_A9:
Mvaa 128,64,160
RD 112,6,12288
Mvaa 128,68,168
Mvaa 132,68,172
RD 116,6,13312
Mvaa 132,64,164
Mvaa 136,72,160
RD 120,6,14336
Mvaa 136,76,168
buffer_load_dwordx4 v2, s[4:7], s32 offen offset:0 sc1 lds
Mvaa 140,76,172
s_waitcnt lgkmcnt(7)
RD 124,6,15360
Mvaa 140,72,164
Mvaa 144,80,160
s_add_u32 s78, s65, 35840
RD 64,6,16384
Mvaa 144,84,168
buffer_store_dwordx4 v[92:95], v5, s[4:7], s78 offen sc1
Mvaa 148,84,172
RD 68,6,17408
Mvaa 148,80,164
Mvaa 152,88,160
RD 72,6,18432
Mvaa 152,92,168
buffer_load_dwordx4 v2, s[4:7], s32 offen offset:1024 sc1 lds
Mvaa 156,92,172
s_waitcnt lgkmcnt(7)
RD 76,6,19456
Mvaa 156,88,164
Mvaa 160,96,160
s_add_u32 s78, s65, 36864
RD 80,6,20480
Mvaa 160,100,168
buffer_store_dwordx4 v[96:99], v5, s[4:7], s78 offen sc1
Mvaa 164,100,172
RD 84,6,21504
Mvaa 164,96,164
Mvaa 168,104,160
RD 88,6,22528
Mvaa 168,108,168
buffer_load_dwordx4 v2, s[4:7], s32 offen offset:2048 sc1 lds
Mvaa 172,108,172
s_waitcnt lgkmcnt(7)
RD 92,6,23552
Mvaa 172,104,164
Mvaa 176,112,160
RD 96,6,24576
Mvaa 176,116,168
Mvaa 180,116,172
RD 100,6,25600
Mvaa 180,112,164
Mvaa 184,120,160
RD 104,6,26624
Mvaa 184,124,168
buffer_load_dwordx4 v2, s[4:7], s32 offen offset:3072 sc1 lds
Mvaa 188,124,172
s_waitcnt lgkmcnt(7)
RD 108,6,27648
Mvaa 188,120,164
s_add_u32 m0, s30, 16384
v_readlane_b32 s31, v4, s29
Mvaa 192,64,160
s_add_u32 s78, s65, 37888
RD 112,6,28672
Mvaa 192,68,168
buffer_store_dwordx4 v[100:103], v5, s[4:7], s78 offen sc1
Mvaa 196,68,172
s_add_u32 s30, s30, s36
RD 116,6,29696
Mvaa 196,64,164
Mvaa 200,72,160
s_cmp_ge_u32 s30, 131072
RD 120,6,30720
Mvaa 200,76,168
buffer_load_dwordx4 v2, s[4:7], s31 offen offset:0 sc1 lds
Mvaa 204,76,172
s_waitcnt vmcnt(43) lgkmcnt(7)
s_cselect_b32 s36, s33, s34
RD 124,6,31744
Mvaa 204,72,164
s_barrier
v_add_u32 v6, s36, v6
Mvaa 208,80,160
s_add_u32 s78, s64, 54272
RD 64,6,0
Mvaa 208,84,168
buffer_store_dwordx4 v[104:107], v5, s[4:7], s78 offen sc1
Mvaa 212,84,172
RD 68,6,1024
Mvaa 212,80,164
Mvaa 216,88,160
s_add_u32 s29, s29, 1
RD 72,6,2048
Mvaa 216,92,168
buffer_load_dwordx4 v2, s[4:7], s31 offen offset:1024 sc1 lds
Mvaa 220,92,172
s_waitcnt lgkmcnt(7)
RD 76,6,3072
Mvaa 220,88,164
Mvaa 224,96,160
RD 80,6,4096
Mvaa 224,100,168
Mvaa 228,100,172
RD 84,6,5120
Mvaa 228,96,164
Mvaa 232,104,160
RD 88,6,6144
Mvaa 232,108,168
buffer_load_dwordx4 v2, s[4:7], s31 offen offset:2048 sc1 lds
Mvaa 236,108,172
s_waitcnt lgkmcnt(7)
RD 92,6,7168
Mvaa 236,104,164
v_readlane_b32 s32, v3, s29
Mvaa 240,112,160
s_add_u32 s78, s64, 55296
RD 96,6,8192
Mvaa 240,116,168
buffer_store_dwordx4 v[108:111], v5, s[4:7], s78 offen sc1
Mvaa 244,116,172
RD 100,6,9216
Mvaa 244,112,164
Mvaa 248,120,160
RD 104,6,10240
Mvaa 248,124,168
buffer_load_dwordx4 v2, s[4:7], s31 offen offset:3072 sc1 lds
Mvaa 252,124,172
s_waitcnt lgkmcnt(7)
RD 108,6,11264
Mvaa 252,120,164
s_mov_b32 m0, s30
s_bitcmp1_b32 s24, 1
s_cbranch_scc1 LH_A10
s_bitcmp1_b32 s24, 0
s_cbranch_scc1 LA_A10
s_call_b64 s[48:49], LP34
s_branch LR_A10
LA_A10:
s_call_b64 s[48:49], LP40
s_branch LR_A10
LH_A10:
s_bitcmp1_b32 s24, 0
s_cbranch_scc1 LB_A10
s_call_b64 s[48:49], LP41
s_branch LR_A10
LB_A10:
s_call_b64 s[48:49], LP42
LR_A10:
Mvaa 128,64,176
s_add_u32 s78, s65, 52224
RD 112,6,12288
Mvaa 128,68,184
buffer_store_dwordx4 v[112:115], v5, s[4:7], s78 offen sc1
Mvaa 132,68,188
RD 116,6,13312
Mvaa 132,64,180
Mvaa 136,72,176
RD 120,6,14336
Mvaa 136,76,184
buffer_load_dwordx4 v2, s[4:7], s32 offen offset:0 sc1 lds
Mvaa 140,76,188
s_waitcnt lgkmcnt(7)
RD 124,6,15360
Mvaa 140,72,180
Mvaa 144,80,176
s_add_u32 s78, s39, 10240
RD 64,6,16384
Mvaa 144,84,184
buffer_load_dwordx4 a[208:211], v5, s[4:7], s78 offen sc1
Mvaa 148,84,188
RD 68,6,17408
Mvaa 148,80,180
Mvaa 152,88,176
RD 72,6,18432
Mvaa 152,92,184
buffer_load_dwordx4 v2, s[4:7], s32 offen offset:1024 sc1 lds
Mvaa 156,92,188
s_waitcnt lgkmcnt(7)
RD 76,6,19456
Mvaa 156,88,180
Mvaa 160,96,176
s_add_u32 s78, s65, 53248
RD 80,6,20480
Mvaa 160,100,184
buffer_store_dwordx4 v[116:119], v5, s[4:7], s78 offen sc1
Mvaa 164,100,188
RD 84,6,21504
Mvaa 164,96,180
Mvaa 168,104,176
RD 88,6,22528
Mvaa 168,108,184
buffer_load_dwordx4 v2, s[4:7], s32 offen offset:2048 sc1 lds
Mvaa 172,108,188
s_waitcnt lgkmcnt(7)
RD 92,6,23552
Mvaa 172,104,180
Mvaa 176,112,176
s_add_u32 s78, s65, 54272
RD 96,6,24576
Mvaa 176,116,184
buffer_store_dwordx4 v[120:123], v5, s[4:7], s78 offen sc1
Mvaa 180,116,188
RD 100,6,25600
Mvaa 180,112,180
Mvaa 184,120,176
RD 104,6,26624
Mvaa 184,124,184
buffer_load_dwordx4 v2, s[4:7], s32 offen offset:3072 sc1 lds
Mvaa 188,124,188
s_waitcnt lgkmcnt(7)
RD 108,6,27648
Mvaa 188,120,180
s_add_u32 m0, s30, 16384
v_readlane_b32 s31, v4, s29
Mvaa 192,64,176
s_add_u32 s78, s39, 67584
RD 112,6,28672
Mvaa 192,68,184
buffer_load_dwordx4 a[212:215], v5, s[4:7], s78 offen sc1
Mvaa 196,68,188
s_add_u32 s30, s30, s36
RD 116,6,29696
Mvaa 196,64,180
Mvaa 200,72,176
s_cmp_ge_u32 s30, 131072
RD 120,6,30720
Mvaa 200,76,184
buffer_load_dwordx4 v2, s[4:7], s31 offen offset:0 sc1 lds
Mvaa 204,76,188
s_waitcnt vmcnt(37) lgkmcnt(7)
s_cselect_b32 s36, s33, s34
RD 124,6,31744
Mvaa 204,72,180
s_barrier
v_add_u32 v6, s36, v6
Mvaa 208,80,176
s_add_u32 s78, s65, 55296
RD 64,6,0
Mvaa 208,84,184
buffer_store_dwordx4 v[124:127], v5, s[4:7], s78 offen sc1
Mvaa 212,84,188
RD 68,6,1024
Mvaa 212,80,180
Mvaa 216,88,176
s_add_u32 s29, s29, 1
RD 72,6,2048
Mvaa 216,92,184
buffer_load_dwordx4 v2, s[4:7], s31 offen offset:1024 sc1 lds
Mvaa 220,92,188
s_waitcnt lgkmcnt(7)
RD 76,6,3072
Mvaa 220,88,180
Mvaa 224,96,176
s_add_u32 s78, s39, 11264
RD 80,6,4096
Mvaa 224,100,184
buffer_load_dwordx4 a[216:219], v5, s[4:7], s78 offen sc1
Mvaa 228,100,188
RD 84,6,5120
Mvaa 228,96,180
Mvaa 232,104,176
RD 88,6,6144
Mvaa 232,108,184
buffer_load_dwordx4 v2, s[4:7], s31 offen offset:2048 sc1 lds
Mvaa 236,108,188
s_waitcnt lgkmcnt(7)
RD 92,6,7168
Mvaa 236,104,180
v_readlane_b32 s32, v3, s29
Mvaa 240,112,176
s_add_u32 s78, s39, 68608
RD 96,6,8192
Mvaa 240,116,184
buffer_load_dwordx4 a[220:223], v5, s[4:7], s78 offen sc1
Mvaa 244,116,188
RD 100,6,9216
Mvaa 244,112,180
Mvaa 248,120,176
RD 104,6,10240
Mvaa 248,124,184
buffer_load_dwordx4 v2, s[4:7], s31 offen offset:3072 sc1 lds
Mvaa 252,124,188
s_waitcnt lgkmcnt(7)
RD 108,6,11264
Mvaa 252,120,180
s_mov_b32 m0, s30
Mvaa 128,64,192
s_add_u32 s78, s39, 12288
RD 112,6,12288
Mvaa 128,68,200
buffer_load_dwordx4 a[224:227], v5, s[4:7], s78 offen sc1
Mvaa 132,68,204
RD 116,6,13312
Mvaa 132,64,196
Mvaa 136,72,192
RD 120,6,14336
Mvaa 136,76,200
buffer_load_dwordx4 v2, s[4:7], s32 offen offset:0 sc1 lds
Mvaa 140,76,204
s_waitcnt lgkmcnt(7)
RD 124,6,15360
Mvaa 140,72,196
Mvaa 144,80,192
s_branch LOP18
LP18:
s_setpc_b64 s[48:49]
LOP18:
s_add_u32 s78, s39, 69632
RD 64,6,16384
Mvaa 144,84,200
buffer_load_dwordx4 a[228:231], v5, s[4:7], s78 offen sc1
Mvaa 148,84,204
RD 68,6,17408
Mvaa 148,80,196
Mvaa 152,88,192
RD 72,6,18432
Mvaa 152,92,200
buffer_load_dwordx4 v2, s[4:7], s32 offen offset:1024 sc1 lds
Mvaa 156,92,204
s_waitcnt lgkmcnt(7)
RD 76,6,19456
Mvaa 156,88,196
Mvaa 160,96,192
s_add_u32 s78, s39, 13312
RD 80,6,20480
Mvaa 160,100,200
buffer_load_dwordx4 a[232:235], v5, s[4:7], s78 offen sc1
Mvaa 164,100,204
RD 84,6,21504
Mvaa 164,96,196
Mvaa 168,104,192
RD 88,6,22528
Mvaa 168,108,200
buffer_load_dwordx4 v2, s[4:7], s32 offen offset:2048 sc1 lds
Mvaa 172,108,204
s_waitcnt lgkmcnt(7)
RD 92,6,23552
Mvaa 172,104,196
Mvaa 176,112,192
s_add_u32 s78, s39, 70656
RD 96,6,24576
Mvaa 176,116,200
buffer_load_dwordx4 a[236:239], v5, s[4:7], s78 offen sc1
Mvaa 180,116,204
RD 100,6,25600
Mvaa 180,112,196
Mvaa 184,120,192
RD 104,6,26624
Mvaa 184,124,200
buffer_load_dwordx4 v2, s[4:7], s32 offen offset:3072 sc1 lds
Mvaa 188,124,204
s_waitcnt lgkmcnt(7)
RD 108,6,27648
Mvaa 188,120,196
s_add_u32 m0, s30, 16384
v_readlane_b32 s31, v4, s29
Mvaa 192,64,192
RD 112,6,28672
Mvaa 192,68,200
Mvaa 196,68,204
s_add_u32 s30, s30, s36
RD 116,6,29696
Mvaa 196,64,196
Mvaa 200,72,192
s_cmp_ge_u32 s30, 131072
RD 120,6,30720
Mvaa 200,76,200
buffer_load_dwordx4 v2, s[4:7], s31 offen offset:0 sc1 lds
Mvaa 204,76,204
s_waitcnt vmcnt(38) lgkmcnt(7)
s_cselect_b32 s36, s33, s34
RD 124,6,31744
Mvaa 204,72,196
s_barrier
v_add_u32 v6, s36, v6
Mvaa 208,80,192
RD 64,6,0
Mvaa 208,84,200
Mvaa 212,84,204
RD 68,6,1024
Mvaa 212,80,196
Mvaa 216,88,192
s_add_u32 s29, s29, 1
RD 72,6,2048
Mvaa 216,92,200
buffer_load_dwordx4 v2, s[4:7], s31 offen offset:1024 sc1 lds
Mvaa 220,92,204
s_waitcnt lgkmcnt(7)
RD 76,6,3072
Mvaa 220,88,196
Mvaa 224,96,192
s_waitcnt vmcnt(15)
s_barrier
RD 80,6,4096
Mvaa 224,100,200
buffer_store_dword v9, v8, s[4:7], s70 offen sc1
Mvaa 228,100,204
RD 84,6,5120
Mvaa 228,96,196
Mvaa 232,104,192
RD 88,6,6144
Mvaa 232,108,200
buffer_load_dwordx4 v2, s[4:7], s31 offen offset:2048 sc1 lds
Mvaa 236,108,204
s_waitcnt lgkmcnt(7)
RD 92,6,7168
Mvaa 236,104,196
v_readlane_b32 s32, v3, s29
Mvaa 240,112,192
RD 96,6,8192
Mvaa 240,116,200
Mvaa 244,116,204
RD 100,6,9216
Mvaa 244,112,196
Mvaa 248,120,192
RD 104,6,10240
Mvaa 248,124,200
buffer_load_dwordx4 v2, s[4:7], s31 offen offset:3072 sc1 lds
Mvaa 252,124,204
s_waitcnt lgkmcnt(7)
s_waitcnt vmcnt(14)
RD 108,6,11264
Mvaa 252,120,196
s_mov_b32 m0, s30
Mvaa 128,64,208
RD 112,6,12288
Mvaa 128,68,216
Mvaa 132,68,220
RD 116,6,13312
Mvaa 132,64,212
Mvaa 136,72,208
RD 120,6,14336
Mvaa 136,76,216
buffer_load_dwordx4 v2, s[4:7], s32 offen offset:0 sc1 lds
Mvaa 140,76,220
s_waitcnt lgkmcnt(7)
RD 124,6,15360
Mvaa 140,72,212
Mvaa 144,80,208
RD 64,6,16384
Mvaa 144,84,216
Mvaa 148,84,220
RD 68,6,17408
Mvaa 148,80,212
Mvaa 152,88,208
RD 72,6,18432
Mvaa 152,92,216
buffer_load_dwordx4 v2, s[4:7], s32 offen offset:1024 sc1 lds
Mvaa 156,92,220
s_waitcnt lgkmcnt(7)
RD 76,6,19456
Mvaa 156,88,212
Mvaa 160,96,208
RD 80,6,20480
Mvaa 160,100,216
Mvaa 164,100,220
RD 84,6,21504
Mvaa 164,96,212
Mvaa 168,104,208
RD 88,6,22528
Mvaa 168,108,216
buffer_load_dwordx4 v2, s[4:7], s32 offen offset:2048 sc1 lds
Mvaa 172,108,220
s_waitcnt lgkmcnt(7)
RD 92,6,23552
Mvaa 172,104,212
Mvaa 176,112,208
RD 96,6,24576
Mvaa 176,116,216
Mvaa 180,116,220
RD 100,6,25600
Mvaa 180,112,212
Mvaa 184,120,208
RD 104,6,26624
Mvaa 184,124,216
buffer_load_dwordx4 v2, s[4:7], s32 offen offset:3072 sc1 lds
Mvaa 188,124,220
s_waitcnt lgkmcnt(7)
s_waitcnt vmcnt(10)
RD 108,6,27648
Mvaa 188,120,212
s_add_u32 m0, s30, 16384
v_readlane_b32 s31, v4, s29
Mvaa 128,64,224
RD 112,6,28672
Mvaa 128,68,232
Mvaa 132,68,236
s_add_u32 s30, s30, s36
RD 116,6,29696
Mvaa 132,64,228
Mvaa 136,72,224
s_cmp_ge_u32 s30, 131072
RD 120,6,30720
Mvaa 136,76,232
buffer_load_dwordx4 v2, s[4:7], s31 offen offset:0 sc1 lds
Mvaa 140,76,236
s_waitcnt vmcnt(34) lgkmcnt(7)
s_cselect_b32 s36, s33, s34
RD 124,6,31744
Mvaa 140,72,228
s_barrier
v_add_u32 v6, s36, v6
Mvaa 144,80,224
RD 64,6,0
Mvaa 144,84,232
Mvaa 148,84,236
RD 68,6,1024
v_mul_f32 v128, |v128|, v128 clamp
Mvaa 148,80,228
v_mul_f32 v129, |v129|, v129 clamp
v_mul_f32 v130, |v130|, v130 clamp
Mvaa 152,88,224
s_add_u32 s29, s29, 1
RD 72,6,2048
v_mul_f32 v131, |v131|, v131 clamp
Mvaa 152,92,232
buffer_load_dwordx4 v2, s[4:7], s31 offen offset:1024 sc1 lds
Mvaa 156,92,236
s_waitcnt lgkmcnt(7)
RD 76,6,3072
v_mul_f32 v136, |v136|, v136 clamp
Mvaa 156,88,228
v_mul_f32 v137, |v137|, v137 clamp
v_mul_f32 v138, |v138|, v138 clamp
Mvaa 160,96,224
RD 80,6,4096
v_mul_f32 v139, |v139|, v139 clamp
Mvaa 160,100,232
v_cvt_pk_bf16_f32 v128, v128, v129
v_cvt_pk_bf16_f32 v129, v130, v131
Mvaa 164,100,236
RD 84,6,5120
v_cvt_pk_bf16_f32 v130, v136, v137
Mvaa 164,96,228
v_cvt_pk_bf16_f32 v131, v138, v139
v_mul_f32 v132, |v132|, v132 clamp
Mvaa 168,104,224
RD 88,6,6144
v_mul_f32 v133, |v133|, v133 clamp
Mvaa 168,108,232
buffer_load_dwordx4 v2, s[4:7], s31 offen offset:2048 sc1 lds
Mvaa 172,108,236
s_waitcnt lgkmcnt(7)
RD 92,6,7168
v_mul_f32 v134, |v134|, v134 clamp
Mvaa 172,104,228
v_readlane_b32 s32, v3, s29
Mvaa 176,112,224
RD 96,6,8192
v_mul_f32 v135, |v135|, v135 clamp
Mvaa 176,116,232
v_mul_f32 v140, |v140|, v140 clamp
v_mul_f32 v141, |v141|, v141 clamp
Mvaa 180,116,236
RD 100,6,9216
v_mul_f32 v142, |v142|, v142 clamp
Mvaa 180,112,228
v_mul_f32 v143, |v143|, v143 clamp
v_cvt_pk_bf16_f32 v132, v132, v133
Mvaa 184,120,224
RD 104,6,10240
v_cvt_pk_bf16_f32 v133, v134, v135
Mvaa 184,124,232
buffer_load_dwordx4 v2, s[4:7], s31 offen offset:3072 sc1 lds
Mvaa 188,124,236
s_waitcnt lgkmcnt(7)
RD 108,6,11264
v_cvt_pk_bf16_f32 v134, v140, v141
Mvaa 188,120,228
s_mov_b32 m0, s30
v_cvt_pk_bf16_f32 v135, v142, v143
v_mul_f32 v144, |v144|, v144 clamp
Mvaa 192,64,208
RD 112,6,12288
v_mul_f32 v145, |v145|, v145 clamp
Mvaa 192,68,216
v_mul_f32 v146, |v146|, v146 clamp
v_mul_f32 v147, |v147|, v147 clamp
Mvaa 196,68,220
RD 116,6,13312
v_mul_f32 v152, |v152|, v152 clamp
Mvaa 196,64,212
v_mul_f32 v153, |v153|, v153 clamp
v_mul_f32 v154, |v154|, v154 clamp
Mvaa 200,72,208
RD 120,6,14336
v_mul_f32 v155, |v155|, v155 clamp
Mvaa 200,76,216
buffer_load_dwordx4 v2, s[4:7], s32 offen offset:0 sc1 lds
Mvaa 204,76,220
s_waitcnt lgkmcnt(7)
RD 124,6,15360
v_cvt_pk_bf16_f32 v144, v144, v145
Mvaa 204,72,212
v_cvt_pk_bf16_f32 v145, v146, v147
v_cvt_pk_bf16_f32 v146, v152, v153
Mvaa 208,80,208
RD 64,6,16384
v_cvt_pk_bf16_f32 v147, v154, v155
Mvaa 208,84,216
v_mul_f32 v148, |v148|, v148 clamp
v_mul_f32 v149, |v149|, v149 clamp
Mvaa 212,84,220
RD 68,6,17408
v_mul_f32 v150, |v150|, v150 clamp
Mvaa 212,80,212
v_mul_f32 v151, |v151|, v151 clamp
v_mul_f32 v156, |v156|, v156 clamp
Mvaa 216,88,208
RD 72,6,18432
v_mul_f32 v157, |v157|, v157 clamp
Mvaa 216,92,216
buffer_load_dwordx4 v2, s[4:7], s32 offen offset:1024 sc1 lds
Mvaa 220,92,220
s_waitcnt lgkmcnt(7)
RD 76,6,19456
v_mul_f32 v158, |v158|, v158 clamp
Mvaa 220,88,212
v_mul_f32 v159, |v159|, v159 clamp
v_cvt_pk_bf16_f32 v148, v148, v149
Mvaa 224,96,208
RD 80,6,20480
v_cvt_pk_bf16_f32 v149, v150, v151
Mvaa 224,100,216
v_cvt_pk_bf16_f32 v150, v156, v157
v_cvt_pk_bf16_f32 v151, v158, v159
Mvaa 228,100,220
RD 84,6,21504
v_mul_f32 v160, |v160|, v160 clamp
Mvaa 228,96,212
v_mul_f32 v161, |v161|, v161 clamp
v_mul_f32 v162, |v162|, v162 clamp
Mvaa 232,104,208
RD 88,6,22528
v_mul_f32 v163, |v163|, v163 clamp
Mvaa 232,108,216
buffer_load_dwordx4 v2, s[4:7], s32 offen offset:2048 sc1 lds
Mvaa 236,108,220
s_waitcnt lgkmcnt(7)
RD 92,6,23552
v_mul_f32 v168, |v168|, v168 clamp
Mvaa 236,104,212
v_mul_f32 v169, |v169|, v169 clamp
v_mul_f32 v170, |v170|, v170 clamp
Mvaa 240,112,208
RD 96,6,24576
v_mul_f32 v171, |v171|, v171 clamp
Mvaa 240,116,216
v_cvt_pk_bf16_f32 v160, v160, v161
v_cvt_pk_bf16_f32 v161, v162, v163
Mvaa 244,116,220
RD 100,6,25600
v_cvt_pk_bf16_f32 v162, v168, v169
Mvaa 244,112,212
v_cvt_pk_bf16_f32 v163, v170, v171
v_mul_f32 v164, |v164|, v164 clamp
Mvaa 248,120,208
RD 104,6,26624
v_mul_f32 v165, |v165|, v165 clamp
Mvaa 248,124,216
buffer_load_dwordx4 v2, s[4:7], s32 offen offset:3072 sc1 lds
Mvaa 252,124,220
s_waitcnt lgkmcnt(7)
RD 108,6,27648
v_mul_f32 v166, |v166|, v166 clamp
Mvaa 252,120,212
s_add_u32 m0, s30, 16384
v_readlane_b32 s31, v4, s29
Mvaa 192,64,224
RD 112,6,28672
v_mul_f32 v167, |v167|, v167 clamp
Mvaa 192,68,232
v_mul_f32 v172, |v172|, v172 clamp
v_mul_f32 v173, |v173|, v173 clamp
Mvaa 196,68,236
s_add_u32 s30, s30, s36
RD 116,6,29696
v_mul_f32 v174, |v174|, v174 clamp
Mvaa 196,64,228
v_mul_f32 v175, |v175|, v175 clamp
v_cvt_pk_bf16_f32 v164, v164, v165
Mvaa 200,72,224
s_cmp_ge_u32 s30, 131072
RD 120,6,30720
v_cvt_pk_bf16_f32 v165, v166, v167
Mvaa 200,76,232
buffer_load_dwordx4 v2, s[4:7], s31 offen offset:0 sc1 lds
Mvaa 204,76,236
s_waitcnt vmcnt(26) lgkmcnt(7)
s_cselect_b32 s36, s33, s34
RD 124,6,31744
Mvaa 204,72,228
s_barrier
v_add_u32 v6, s36, v6
v_cvt_pk_bf16_f32 v166, v172, v173
Mvaa 208,80,224
RD 64,6,0
v_cvt_pk_bf16_f32 v167, v174, v175
Mvaa 208,84,232
v_mul_f32 v176, |v176|, v176 clamp
v_mul_f32 v177, |v177|, v177 clamp
Mvaa 212,84,236
RD 68,6,1024
v_mul_f32 v178, |v178|, v178 clamp
Mvaa 212,80,228
v_mul_f32 v179, |v179|, v179 clamp
v_mul_f32 v184, |v184|, v184 clamp
Mvaa 216,88,224
s_add_u32 s29, s29, 1
RD 72,6,2048
v_mul_f32 v185, |v185|, v185 clamp
Mvaa 216,92,232
buffer_load_dwordx4 v2, s[4:7], s31 offen offset:1024 sc1 lds
Mvaa 220,92,236
s_waitcnt lgkmcnt(7)
RD 76,6,3072
v_mul_f32 v186, |v186|, v186 clamp
Mvaa 220,88,228
v_mul_f32 v187, |v187|, v187 clamp
v_cvt_pk_bf16_f32 v176, v176, v177
Mvaa 224,96,224
RD 80,6,4096
v_cvt_pk_bf16_f32 v177, v178, v179
Mvaa 224,100,232
v_cvt_pk_bf16_f32 v178, v184, v185
v_cvt_pk_bf16_f32 v179, v186, v187
Mvaa 228,100,236
RD 84,6,5120
v_mul_f32 v180, |v180|, v180 clamp
Mvaa 228,96,228
v_mul_f32 v181, |v181|, v181 clamp
v_mul_f32 v182, |v182|, v182 clamp
Mvaa 232,104,224
RD 88,6,6144
v_mul_f32 v183, |v183|, v183 clamp
Mvaa 232,108,232
buffer_load_dwordx4 v2, s[4:7], s31 offen offset:2048 sc1 lds
Mvaa 236,108,236
s_waitcnt lgkmcnt(7)
RD 92,6,7168
v_mul_f32 v188, |v188|, v188 clamp
Mvaa 236,104,228
v_readlane_b32 s32, v3, s29
Mvaa 240,112,224
RD 96,6,8192
v_mul_f32 v189, |v189|, v189 clamp
Mvaa 240,116,232
v_mul_f32 v190, |v190|, v190 clamp
v_mul_f32 v191, |v191|, v191 clamp
Mvaa 244,116,236
RD 100,6,9216
v_cvt_pk_bf16_f32 v180, v180, v181
Mvaa 244,112,228
v_cvt_pk_bf16_f32 v181, v182, v183
v_cvt_pk_bf16_f32 v182, v188, v189
Mvaa 248,120,224
RD 104,6,10240
v_cvt_pk_bf16_f32 v183, v190, v191
Mvaa 248,124,232
buffer_load_dwordx4 v2, s[4:7], s31 offen offset:3072 sc1 lds
Mvaa 252,124,236
s_waitcnt lgkmcnt(7)
RD 108,6,11264
v_mul_f32 v192, |v192|, v192 clamp
Mvaa 252,120,228
s_mov_b32 m0, s30
v_mul_f32 v193, |v193|, v193 clamp
v_mul_f32 v194, |v194|, v194 clamp
s_nop 3
v_mul_f32 v195, |v195|, v195 clamp
v_mul_f32 v200, |v200|, v200 clamp
v_mul_f32 v201, |v201|, v201 clamp
v_mul_f32 v202, |v202|, v202 clamp
v_mul_f32 v203, |v203|, v203 clamp
v_cvt_pk_bf16_f32 v192, v192, v193
v_cvt_pk_bf16_f32 v193, v194, v195
v_cvt_pk_bf16_f32 v194, v200, v201
v_cvt_pk_bf16_f32 v195, v202, v203
v_mul_f32 v196, |v196|, v196 clamp
v_mul_f32 v197, |v197|, v197 clamp
v_mul_f32 v198, |v198|, v198 clamp
v_mul_f32 v199, |v199|, v199 clamp
v_mul_f32 v204, |v204|, v204 clamp
v_mul_f32 v205, |v205|, v205 clamp
v_mul_f32 v206, |v206|, v206 clamp
v_mul_f32 v207, |v207|, v207 clamp
v_cvt_pk_bf16_f32 v196, v196, v197
v_cvt_pk_bf16_f32 v197, v198, v199
v_cvt_pk_bf16_f32 v198, v204, v205
v_cvt_pk_bf16_f32 v199, v206, v207
v_mul_f32 v208, |v208|, v208 clamp
v_mul_f32 v209, |v209|, v209 clamp
v_mul_f32 v210, |v210|, v210 clamp
v_mul_f32 v211, |v211|, v211 clamp
v_mul_f32 v216, |v216|, v216 clamp
v_mul_f32 v217, |v217|, v217 clamp
v_mul_f32 v218, |v218|, v218 clamp
v_mul_f32 v219, |v219|, v219 clamp
v_cvt_pk_bf16_f32 v208, v208, v209
s_nop 1
Zvav 136,64,128
RD 112,6,12288
v_cvt_pk_bf16_f32 v209, v210, v211
Zvav 140,64,132
v_cvt_pk_bf16_f32 v210, v216, v217
v_cvt_pk_bf16_f32 v211, v218, v219
Zvav 152,68,128
RD 116,6,13312
v_mul_f32 v212, |v212|, v212 clamp
Zvav 156,68,132
v_mul_f32 v213, |v213|, v213 clamp
v_mul_f32 v214, |v214|, v214 clamp
Zvav 168,72,128
RD 120,6,14336
v_mul_f32 v215, |v215|, v215 clamp
Zvav 172,72,132
buffer_load_dwordx4 v2, s[4:7], s32 offen offset:0 sc1 lds
Zvav 184,76,128
s_waitcnt lgkmcnt(7)
RD 124,6,15360
v_mul_f32 v220, |v220|, v220 clamp
Zvav 188,76,132
v_mul_f32 v221, |v221|, v221 clamp
v_mul_f32 v222, |v222|, v222 clamp
Mvav 136,80,144
RD 64,6,16384
v_mul_f32 v223, |v223|, v223 clamp
Mvav 140,80,148
v_cvt_pk_bf16_f32 v212, v212, v213
v_cvt_pk_bf16_f32 v213, v214, v215
Mvav 152,84,144
RD 68,6,17408
v_cvt_pk_bf16_f32 v214, v220, v221
Mvav 156,84,148
v_cvt_pk_bf16_f32 v215, v222, v223
v_mul_f32 v224, |v224|, v224 clamp
Mvav 168,88,144
RD 72,6,18432
v_mul_f32 v225, |v225|, v225 clamp
Mvav 172,88,148
buffer_load_dwordx4 v2, s[4:7], s32 offen offset:1024 sc1 lds
Mvav 184,92,144
s_branch LOP19
LP19:
s_setpc_b64 s[48:49]
LOP19:
s_waitcnt lgkmcnt(7)
RD 76,6,19456
v_mul_f32 v226, |v226|, v226 clamp
Mvav 188,92,148
v_mul_f32 v227, |v227|, v227 clamp
v_mul_f32 v232, |v232|, v232 clamp
Mvav 136,96,160
RD 80,6,20480
v_mul_f32 v233, |v233|, v233 clamp
Mvav 140,96,164
v_mul_f32 v234, |v234|, v234 clamp
v_mul_f32 v235, |v235|, v235 clamp
Mvav 152,100,160
RD 84,6,21504
v_cvt_pk_bf16_f32 v224, v224, v225
Mvav 156,100,164
v_cvt_pk_bf16_f32 v225, v226, v227
v_cvt_pk_bf16_f32 v226, v232, v233
Mvav 168,104,160
RD 88,6,22528
v_cvt_pk_bf16_f32 v227, v234, v235
Mvav 172,104,164
buffer_load_dwordx4 v2, s[4:7], s32 offen offset:2048 sc1 lds
Mvav 184,108,160
s_waitcnt lgkmcnt(7)
RD 92,6,23552
v_mul_f32 v228, |v228|, v228 clamp
Mvav 188,108,164
v_mul_f32 v229, |v229|, v229 clamp
v_mul_f32 v230, |v230|, v230 clamp
Mvav 136,112,176
RD 96,6,24576
v_mul_f32 v231, |v231|, v231 clamp
Mvav 140,112,180
v_mul_f32 v236, |v236|, v236 clamp
v_mul_f32 v237, |v237|, v237 clamp
Mvav 152,116,176
RD 100,6,25600
v_mul_f32 v238, |v238|, v238 clamp
Mvav 156,116,180
v_mul_f32 v239, |v239|, v239 clamp
v_cvt_pk_bf16_f32 v228, v228, v229
Mvav 168,120,176
RD 104,6,26624
v_cvt_pk_bf16_f32 v229, v230, v231
Mvav 172,120,180
buffer_load_dwordx4 v2, s[4:7], s32 offen offset:3072 sc1 lds
Mvav 184,124,176
s_waitcnt lgkmcnt(7)
RD 108,6,27648
v_cvt_pk_bf16_f32 v230, v236, v237
Mvav 188,124,180
s_add_u32 m0, s30, 16384
v_readlane_b32 s31, v4, s29
Mvav 136,64,192
RD 112,6,28672
v_cvt_pk_bf16_f32 v231, v238, v239
Mvav 140,64,196
v_mul_f32 v240, |v240|, v240 clamp
v_mul_f32 v241, |v241|, v241 clamp
Mvav 152,68,192
s_add_u32 s30, s30, s36
RD 116,6,29696
v_mul_f32 v242, |v242|, v242 clamp
Mvav 156,68,196
v_mul_f32 v243, |v243|, v243 clamp
v_mul_f32 v248, |v248|, v248 clamp
Mvav 168,72,192
s_cmp_ge_u32 s30, 131072
RD 120,6,30720
v_mul_f32 v249, |v249|, v249 clamp
Mvav 172,72,196
buffer_load_dwordx4 v2, s[4:7], s31 offen offset:0 sc1 lds
Mvav 184,76,192
s_waitcnt vmcnt(21) lgkmcnt(7)
s_cselect_b32 s36, s33, s34
RD 124,6,31744
Mvav 188,76,196
s_barrier
v_add_u32 v6, s36, v6
v_mul_f32 v250, |v250|, v250 clamp
Mvav 136,80,208
RD 64,6,0
v_mul_f32 v251, |v251|, v251 clamp
Mvav 140,80,212
v_cvt_pk_bf16_f32 v240, v240, v241
v_cvt_pk_bf16_f32 v241, v242, v243
Mvav 152,84,208
RD 68,6,1024
v_cvt_pk_bf16_f32 v242, v248, v249
Mvav 156,84,212
v_cvt_pk_bf16_f32 v243, v250, v251
v_mul_f32 v244, |v244|, v244 clamp
Mvav 168,88,208
s_add_u32 s29, s29, 1
RD 72,6,2048
v_mul_f32 v245, |v245|, v245 clamp
Mvav 172,88,212
buffer_load_dwordx4 v2, s[4:7], s31 offen offset:1024 sc1 lds
Mvav 184,92,208
s_waitcnt lgkmcnt(7)
RD 76,6,3072
v_mul_f32 v246, |v246|, v246 clamp
Mvav 188,92,212
v_mul_f32 v247, |v247|, v247 clamp
v_mul_f32 v252, |v252|, v252 clamp
Mvav 136,96,224
RD 80,6,4096
v_mul_f32 v253, |v253|, v253 clamp
Mvav 140,96,228
v_mul_f32 v254, |v254|, v254 clamp
v_mul_f32 v255, |v255|, v255 clamp
Mvav 152,100,224
RD 84,6,5120
v_cvt_pk_bf16_f32 v244, v244, v245
Mvav 156,100,228
v_cvt_pk_bf16_f32 v245, v246, v247
v_cvt_pk_bf16_f32 v246, v252, v253
Mvav 168,104,224
RD 88,6,6144
v_cvt_pk_bf16_f32 v247, v254, v255
Mvav 172,104,228
buffer_load_dwordx4 v2, s[4:7], s31 offen offset:2048 sc1 lds
Mvav 184,108,224
s_waitcnt lgkmcnt(7)
RD 92,6,7168
Mvav 188,108,228
v_readlane_b32 s32, v3, s29
Mvav 136,112,240
RD 96,6,8192
Mvav 140,112,244
Mvav 152,116,240
RD 100,6,9216
Mvav 156,116,244
Mvav 168,120,240
RD 104,6,10240
Mvav 172,120,244
buffer_load_dwordx4 v2, s[4:7], s31 offen offset:3072 sc1 lds
Mvav 184,124,240
s_waitcnt lgkmcnt(7)
RD 108,6,11264
Mvav 188,124,244
s_mov_b32 m0, s30
Zvav 64,64,128
RD 112,6,12288
Zvav 68,64,132
Zvav 72,68,128
s_lshl2_add_u32 s77, s27, 4
s_cmp_eq_u32 s61, s77
s_cselect_b32 s60, 4, 0
s_cselect_b32 s67, 2130706432, s67
RD 116,6,13312
v_cvt_pk_bf16_f32 v28, v136, v152
Zvav 76,68,132
v_cvt_pk_bf16_f32 v29, v168, v184
v_cvt_pk_bf16_f32 v30, v137, v153
Zvav 80,72,128
RD 120,6,14336
v_cvt_pk_bf16_f32 v31, v169, v185
Zvav 84,72,132
buffer_load_dwordx4 v2, s[4:7], s32 offen offset:0 sc1 lds
Zvav 88,76,128
s_waitcnt lgkmcnt(7)
RD 124,6,15360
v_cvt_pk_bf16_f32 v32, v138, v154
Zvav 92,76,132
v_cvt_pk_bf16_f32 v33, v170, v186
v_cvt_pk_bf16_f32 v34, v139, v155
Mvav 64,80,144
RD 64,6,16384
v_cvt_pk_bf16_f32 v35, v171, v187
Mvav 68,80,148
v_cvt_pk_bf16_f32 v36, v140, v156
v_cvt_pk_bf16_f32 v37, v172, v188
Mvav 72,84,144
RD 68,6,17408
v_cvt_pk_bf16_f32 v38, v141, v157
Mvav 76,84,148
v_cvt_pk_bf16_f32 v39, v173, v189
v_cvt_pk_bf16_f32 v40, v142, v158
Mvav 80,88,144
RD 72,6,18432
v_cvt_pk_bf16_f32 v41, v174, v190
Mvav 84,88,148
buffer_load_dwordx4 v2, s[4:7], s32 offen offset:1024 sc1 lds
Mvav 88,92,144
s_waitcnt lgkmcnt(7)
RD 76,6,19456
v_cvt_pk_bf16_f32 v42, v143, v159
Mvav 92,92,148
v_cvt_pk_bf16_f32 v43, v175, v191
v_accvgpr_write_b32 a128, v28
Mvav 64,96,160
RD 80,6,20480
v_accvgpr_write_b32 a129, v29
Mvav 68,96,164
v_accvgpr_write_b32 a130, v30
v_accvgpr_write_b32 a131, v31
Mvav 72,100,160
RD 84,6,21504
v_accvgpr_write_b32 a132, v32
Mvav 76,100,164
v_accvgpr_write_b32 a133, v33
v_accvgpr_write_b32 a134, v34
Mvav 80,104,160
RD 88,6,22528
v_accvgpr_write_b32 a135, v35
Mvav 84,104,164
buffer_load_dwordx4 v2, s[4:7], s32 offen offset:2048 sc1 lds
Mvav 88,108,160
s_waitcnt lgkmcnt(7)
RD 92,6,23552
v_accvgpr_write_b32 a136, v36
Mvav 92,108,164
v_accvgpr_write_b32 a137, v37
v_accvgpr_write_b32 a138, v38
Mvav 64,112,176
RD 96,6,24576
v_accvgpr_write_b32 a139, v39
Mvav 68,112,180
v_accvgpr_write_b32 a140, v40
v_accvgpr_write_b32 a141, v41
Mvav 72,116,176
RD 100,6,25600
v_accvgpr_write_b32 a142, v42
Mvav 76,116,180
v_accvgpr_write_b32 a143, v43
v_min_u32 v63, 6, v1
Mvav 80,120,176
RD 104,6,26624
v_lshl_add_u32 v63, v63, 2, 64
Mvav 84,120,180
buffer_load_dwordx4 v2, s[4:7], s32 offen offset:3072 sc1 lds
Mvav 88,124,176
s_waitcnt lgkmcnt(7)
RD 108,6,27648
v_lshrrev_b32 v61, 4, v1
Mvav 92,124,180
s_add_u32 m0, s30, 16384
v_readlane_b32 s31, v4, s29
Mvav 64,64,192
RD 112,6,28672
v_mul_u32_u24 v61, 115456, v61
Mvav 68,64,196
v_add_u32 v61, v61, v5
Mvav 72,68,192
s_add_u32 s30, s30, s36
RD 116,6,29696
v_cmp_gt_u32 s[80:81], 48, v1
Mvav 76,68,196
s_lshr_b32 s65, s2, 2
Mvav 80,72,192
s_cmp_ge_u32 s30, 131072
RD 120,6,30720
Mvav 84,72,196
buffer_load_dwordx4 v2, s[4:7], s31 offen offset:0 sc1 lds
Mvav 88,76,192
s_waitcnt vmcnt(21) lgkmcnt(7)
s_cselect_b32 s36, s33, s34
RD 124,6,31744
Mvav 92,76,196
s_barrier
v_add_u32 v6, s36, v6
v_cndmask_b32 v62, v8, v61, s[80:81]
Mvav 64,80,208
s_lshl_b32 s65, s65, 7
RD 64,6,0
Mvav 68,80,212
s_add_u32 s65, s65, 14688256
Mvav 72,84,208
s_lshr_b32 s80, s2, 4
RD 68,6,1024
Mvav 76,84,212
s_mul_i32 s64, s80, 2661376
Mvav 80,88,208
s_add_u32 s29, s29, 1
s_bfe_u32 s80, s2, 0x20002
RD 72,6,2048
Mvav 84,88,212
buffer_load_dwordx4 v2, s[4:7], s31 offen offset:1024 sc1 lds
Mvav 88,92,208
s_waitcnt lgkmcnt(7)
s_mul_i32 s81, s80, 28672
RD 76,6,3072
Mvav 92,92,212
s_add_u32 s64, s64, s81
Mvav 64,96,224
s_and_b32 s80, s80, 2
RD 80,6,4096
Mvav 68,96,228
s_xor_b32 s80, s80, s2
Mvav 72,100,224
s_and_b32 s80, s80, 3
RD 84,6,5120
Mvav 76,100,228
s_lshl2_add_u32 s80, s24, s80
Mvav 80,104,224
s_lshl_b32 s81, s80, 11
RD 88,6,6144
Mvav 84,104,228
buffer_load_dwordx4 v2, s[4:7], s31 offen offset:2048 sc1 lds
Mvav 88,108,224
s_waitcnt lgkmcnt(7)
s_add_u32 s64, s64, s81
RD 92,6,7168
Mvav 92,108,228
s_add_u32 s64, s64, 77348864
v_readlane_b32 s32, v3, s29
Mvav 64,112,240
s_cmp_lt_u32 s80, 14
s_cselect_b32 s64, s64, 2130706432
RD 96,6,8192
Mvav 68,112,244
s_cmp_lt_u32 s60, 2
s_cselect_b32 s42, 2, s24
Mvav 72,116,240
s_cmp_lt_u32 s42, 2
s_cselect_b32 s42, 2, 64
RD 100,6,9216
Mvav 76,116,244
s_sub_u32 s41, s42, 1
Mvav 80,120,240
RD 104,6,10240
Mvav 84,120,244
buffer_load_dwordx4 v2, s[4:7], s31 offen offset:3072 sc1 lds
Mvav 88,124,240
s_waitcnt lgkmcnt(7)
RD 108,6,11264
Mvav 92,124,244
s_mov_b32 m0, s30
Zvav 136,64,128
RD 112,6,12288
Zvav 140,64,132
Zvav 152,68,128
RD 116,6,13312
v_cvt_pk_bf16_f32 v28, v64, v72
Zvav 156,68,132
buffer_load_dword v7, v10, s[4:7], s71 offen sc1
Zvav 168,72,128
RD 120,6,14336
v_cvt_pk_bf16_f32 v29, v80, v88
Zvav 172,72,132
buffer_load_dwordx4 v2, s[4:7], s32 offen offset:0 sc1 lds
Zvav 184,76,128
s_waitcnt lgkmcnt(7)
RD 124,6,15360
v_cvt_pk_bf16_f32 v30, v65, v73
Zvav 188,76,132
v_cvt_pk_bf16_f32 v31, v81, v89
v_cvt_pk_bf16_f32 v32, v66, v74
Mvav 136,80,144
RD 64,6,16384
v_cvt_pk_bf16_f32 v33, v82, v90
Mvav 140,80,148
v_cvt_pk_bf16_f32 v34, v67, v75
v_cvt_pk_bf16_f32 v35, v83, v91
Mvav 152,84,144
RD 68,6,17408
v_cvt_pk_bf16_f32 v36, v68, v76
Mvav 156,84,148
v_cvt_pk_bf16_f32 v37, v84, v92
v_cvt_pk_bf16_f32 v38, v69, v77
Mvav 168,88,144
RD 72,6,18432
v_cvt_pk_bf16_f32 v39, v85, v93
Mvav 172,88,148
buffer_load_dwordx4 v2, s[4:7], s32 offen offset:1024 sc1 lds
Mvav 184,92,144
s_waitcnt lgkmcnt(7)
RD 76,6,19456
v_cvt_pk_bf16_f32 v40, v70, v78
Mvav 188,92,148
v_cvt_pk_bf16_f32 v41, v86, v94
v_cvt_pk_bf16_f32 v42, v71, v79
Mvav 136,96,160
RD 80,6,20480
v_cvt_pk_bf16_f32 v43, v87, v95
Mvav 140,96,164
v_accvgpr_write_b32 a144, v28
v_accvgpr_write_b32 a145, v29
Mvav 152,100,160
RD 84,6,21504
v_accvgpr_write_b32 a146, v30
Mvav 156,100,164
v_accvgpr_write_b32 a147, v31
v_accvgpr_write_b32 a148, v32
Mvav 168,104,160
RD 88,6,22528
v_accvgpr_write_b32 a149, v33
Mvav 172,104,164
buffer_load_dwordx4 v2, s[4:7], s32 offen offset:2048 sc1 lds
Mvav 184,108,160
s_waitcnt lgkmcnt(7)
RD 92,6,23552
v_accvgpr_write_b32 a150, v34
Mvav 188,108,164
v_accvgpr_write_b32 a151, v35
v_accvgpr_write_b32 a152, v36
Mvav 136,112,176
RD 96,6,24576
v_accvgpr_write_b32 a153, v37
Mvav 140,112,180
v_accvgpr_write_b32 a154, v38
v_accvgpr_write_b32 a155, v39
Mvav 152,116,176
RD 100,6,25600
v_accvgpr_write_b32 a156, v40
Mvav 156,116,180
v_accvgpr_write_b32 a157, v41
v_accvgpr_write_b32 a158, v42
Mvav 168,120,176
RD 104,6,26624
v_accvgpr_write_b32 a159, v43
Mvav 172,120,180
buffer_load_dwordx4 v2, s[4:7], s32 offen offset:3072 sc1 lds
Mvav 184,124,176
s_waitcnt lgkmcnt(7)
RD 108,6,27648
Mvav 188,124,180
s_add_u32 m0, s30, 16384
v_readlane_b32 s31, v4, s29
Mvav 136,64,192
RD 112,6,28672
Mvav 140,64,196
Mvav 152,68,192
s_add_u32 s30, s30, s36
RD 116,6,29696
Mvav 156,68,196
Mvav 168,72,192
s_cmp_ge_u32 s30, 131072
RD 120,6,30720
Mvav 172,72,196
buffer_load_dwordx4 v2, s[4:7], s31 offen offset:0 sc1 lds
Mvav 184,76,192
s_waitcnt vmcnt(22) lgkmcnt(7)
s_cselect_b32 s36, s33, s34
RD 124,6,31744
Mvav 188,76,196
s_barrier
v_add_u32 v6, s36, v6
Mvav 136,80,208
RD 64,6,0
Mvav 140,80,212
Mvav 152,84,208
RD 68,6,1024
Mvav 156,84,212
Mvav 168,88,208
s_add_u32 s29, s29, 1
RD 72,6,2048
Mvav 172,88,212
buffer_load_dwordx4 v2, s[4:7], s31 offen offset:1024 sc1 lds
Mvav 184,92,208
s_waitcnt lgkmcnt(7)
RD 76,6,3072
Mvav 188,92,212
Mvav 136,96,224
RD 80,6,4096
Mvav 140,96,228
Mvav 152,100,224
RD 84,6,5120
Mvav 156,100,228
Mvav 168,104,224
RD 88,6,6144
Mvav 172,104,228
buffer_load_dwordx4 v2, s[4:7], s31 offen offset:2048 sc1 lds
Mvav 184,108,224
s_waitcnt lgkmcnt(7)
RD 92,6,7168
Mvav 188,108,228
v_readlane_b32 s32, v3, s29
Mvav 136,112,240
RD 96,6,8192
Mvav 140,112,244
Mvav 152,116,240
s_waitcnt vmcnt(7)
RD 100,6,9216
v_cmp_ne_u32 s[80:81], s38, v7
Mvav 156,116,244
Mvav 168,120,240
s_cmp_lg_u64 s[80:81], 0
s_cbranch_scc1 L_pw_kva
L_po_kva:
s_barrier
RD 104,6,10240
Mvav 172,120,244
buffer_load_dwordx4 v2, s[4:7], s31 offen offset:3072 sc1 lds
Mvav 184,124,240
s_waitcnt lgkmcnt(7)
RD 108,6,11264
Mvav 188,124,244
s_mov_b32 m0, s30
Zvav 64,64,128
RD 112,6,12288
Zvav 68,64,132
Zvav 72,68,128
RD 116,6,13312
v_min_u32 v10, 11, v1
Zvav 76,68,132
v_cvt_pk_bf16_f32 v28, v136, v152
v_cvt_pk_bf16_f32 v29, v168, v184
Zvav 80,72,128
RD 120,6,14336
v_lshlrev_b32 v10, 2, v10
Zvav 84,72,132
buffer_load_dwordx4 v2, s[4:7], s32 offen offset:0 sc1 lds
Zvav 88,76,128
s_waitcnt lgkmcnt(7)
RD 124,6,15360
v_cvt_pk_bf16_f32 v30, v137, v153
Zvav 92,76,132
v_cvt_pk_bf16_f32 v31, v169, v185
v_cvt_pk_bf16_f32 v32, v138, v154
Mvav 64,80,144
RD 64,6,16384
v_add_u32 v10, 128, v10
Mvav 68,80,148
v_cvt_pk_bf16_f32 v33, v170, v186
v_cvt_pk_bf16_f32 v34, v139, v155
Mvav 72,84,144
RD 68,6,17408
v_cvt_pk_bf16_f32 v35, v171, v187
Mvav 76,84,148
buffer_load_dword v7, v8, s[4:7], s72 offen sc1
Mvav 80,88,144
RD 72,6,18432
v_cvt_pk_bf16_f32 v36, v140, v156
Mvav 84,88,148
buffer_load_dwordx4 v2, s[4:7], s32 offen offset:1024 sc1 lds
Mvav 88,92,144
s_waitcnt lgkmcnt(7)
RD 76,6,19456
v_cvt_pk_bf16_f32 v37, v172, v188
Mvav 92,92,148
v_cvt_pk_bf16_f32 v38, v141, v157
v_cvt_pk_bf16_f32 v39, v173, v189
Mvav 64,96,160
RD 80,6,20480
v_cvt_pk_bf16_f32 v40, v142, v158
Mvav 68,96,164
v_cvt_pk_bf16_f32 v41, v174, v190
v_cvt_pk_bf16_f32 v42, v143, v159
Mvav 72,100,160
RD 84,6,21504
v_cvt_pk_bf16_f32 v43, v175, v191
Mvav 76,100,164
v_accvgpr_write_b32 a160, v28
v_accvgpr_write_b32 a161, v29
Mvav 80,104,160
s_branch LOP20
LP20:
s_setpc_b64 s[48:49]
LOP20:
RD 88,6,22528
v_accvgpr_write_b32 a162, v30
Mvav 84,104,164
buffer_load_dwordx4 v2, s[4:7], s32 offen offset:2048 sc1 lds
Mvav 88,108,160
s_waitcnt lgkmcnt(7)
RD 92,6,23552
v_accvgpr_write_b32 a163, v31
Mvav 92,108,164
v_accvgpr_write_b32 a164, v32
v_accvgpr_write_b32 a165, v33
Mvav 64,112,176
RD 96,6,24576
v_accvgpr_write_b32 a166, v34
Mvav 68,112,180
v_accvgpr_write_b32 a167, v35
v_accvgpr_write_b32 a168, v36
Mvav 72,116,176
RD 100,6,25600
v_accvgpr_write_b32 a169, v37
Mvav 76,116,180
v_accvgpr_write_b32 a170, v38
v_accvgpr_write_b32 a171, v39
Mvav 80,120,176
RD 104,6,26624
v_accvgpr_write_b32 a172, v40
Mvav 84,120,180
buffer_load_dwordx4 v2, s[4:7], s32 offen offset:3072 sc1 lds
Mvav 88,124,176
s_waitcnt lgkmcnt(7)
RD 108,6,27648
v_accvgpr_write_b32 a173, v41
Mvav 92,124,180
s_add_u32 m0, s30, 16384
v_readlane_b32 s31, v4, s29
Mvav 64,64,192
RD 112,6,28672
v_accvgpr_write_b32 a174, v42
Mvav 68,64,196
v_accvgpr_write_b32 a175, v43
Mvav 72,68,192
s_add_u32 s30, s30, s36
RD 116,6,29696
Mvav 76,68,196
Mvav 80,72,192
s_cmp_ge_u32 s30, 131072
RD 120,6,30720
Mvav 84,72,196
buffer_load_dwordx4 v2, s[4:7], s31 offen offset:0 sc1 lds
Mvav 88,76,192
s_waitcnt vmcnt(23) lgkmcnt(7)
s_cselect_b32 s36, s33, s34
RD 124,6,31744
Mvav 92,76,196
s_barrier
v_add_u32 v6, s36, v6
Mvav 64,80,208
RD 64,6,0
Mvav 68,80,212
Mvav 72,84,208
RD 68,6,1024
Mvav 76,84,212
Mvav 80,88,208
s_add_u32 s29, s29, 1
RD 72,6,2048
Mvav 84,88,212
buffer_load_dwordx4 v2, s[4:7], s31 offen offset:1024 sc1 lds
Mvav 88,92,208
s_waitcnt lgkmcnt(7)
RD 76,6,3072
Mvav 92,92,212
Mvav 64,96,224
RD 80,6,4096
Mvav 68,96,228
Mvav 72,100,224
RD 84,6,5120
Mvav 76,100,228
Mvav 80,104,224
RD 88,6,6144
Mvav 84,104,228
buffer_load_dwordx4 v2, s[4:7], s31 offen offset:2048 sc1 lds
Mvav 88,108,224
s_waitcnt lgkmcnt(7)
RD 92,6,7168
Mvav 92,108,228
v_readlane_b32 s32, v3, s29
Mvav 64,112,240
RD 96,6,8192
Mvav 68,112,244
Mvav 72,116,240
RD 100,6,9216
Mvav 76,116,244
Mvav 80,120,240
RD 104,6,10240
Mvav 84,120,244
buffer_load_dwordx4 v2, s[4:7], s31 offen offset:3072 sc1 lds
Mvav 88,124,240
s_waitcnt lgkmcnt(7)
RD 108,6,11264
Mvav 92,124,244
s_mov_b32 m0, s30
s_cmp_eq_u32 s60, 4
s_cbranch_scc0 L_td
s_bitcmp1_b32 s24, 1
s_cbranch_scc1 LH_D11
s_bitcmp1_b32 s24, 0
s_cbranch_scc1 LA_D11
s_call_b64 s[48:49], LP35
s_branch LR_D11
LA_D11:
s_call_b64 s[48:49], LP36
s_branch LR_D11
LH_D11:
s_bitcmp1_b32 s24, 0
s_cbranch_scc1 LB_D11
s_call_b64 s[48:49], LP36
s_branch LR_D11
LB_D11:
s_call_b64 s[48:49], LP36
LR_D11:
L_td:
Zvav 136,64,128
RD 112,6,12288
Zvav 140,64,132
Zvav 152,68,128
s_waitcnt vmcnt(7)
RD 116,6,13312
v_cmp_eq_u32 s[80:81], s38, v7
Zvav 156,68,132
v_cvt_pk_bf16_f32 v28, v64, v72
v_cvt_pk_bf16_f32 v29, v80, v88
Zvav 168,72,128
s_cmp_eq_u64 s[80:81], 0
s_cbranch_scc1 L_pw_qa
L_po_qa:
s_barrier
RD 120,6,14336
Zvav 172,72,132
buffer_load_dwordx4 v2, s[4:7], s32 offen offset:0 sc1 lds
Zvav 184,76,128
s_waitcnt lgkmcnt(7)
RD 124,6,15360
v_cvt_pk_bf16_f32 v30, v65, v73
Zvav 188,76,132
v_cvt_pk_bf16_f32 v31, v81, v89
v_cvt_pk_bf16_f32 v32, v66, v74
Mvav 136,80,144
s_add_u32 s78, s66, 0
RD 64,6,16384
v_cvt_pk_bf16_f32 v33, v82, v90
Mvav 140,80,148
buffer_load_dwordx4 a[0:3], v5, s[4:7], s78 offen sc1
Mvav 152,84,144
RD 68,6,17408
v_cvt_pk_bf16_f32 v34, v67, v75
Mvav 156,84,148
v_cvt_pk_bf16_f32 v35, v83, v91
v_cvt_pk_bf16_f32 v36, v68, v76
Mvav 168,88,144
RD 72,6,18432
v_cvt_pk_bf16_f32 v37, v84, v92
Mvav 172,88,148
buffer_load_dwordx4 v2, s[4:7], s32 offen offset:1024 sc1 lds
Mvav 184,92,144
s_waitcnt lgkmcnt(7)
RD 76,6,19456
v_cvt_pk_bf16_f32 v38, v69, v77
Mvav 188,92,148
v_cvt_pk_bf16_f32 v39, v85, v93
v_cvt_pk_bf16_f32 v40, v70, v78
Mvav 136,96,160
s_add_u32 s78, s66, 1024
RD 80,6,20480
v_cvt_pk_bf16_f32 v41, v86, v94
Mvav 140,96,164
buffer_load_dwordx4 a[4:7], v5, s[4:7], s78 offen sc1
Mvav 152,100,160
RD 84,6,21504
v_cvt_pk_bf16_f32 v42, v71, v79
Mvav 156,100,164
v_cvt_pk_bf16_f32 v43, v87, v95
v_accvgpr_write_b32 a176, v28
Mvav 168,104,160
RD 88,6,22528
v_accvgpr_write_b32 a177, v29
Mvav 172,104,164
buffer_load_dwordx4 v2, s[4:7], s32 offen offset:2048 sc1 lds
Mvav 184,108,160
s_waitcnt lgkmcnt(7)
RD 92,6,23552
v_accvgpr_write_b32 a178, v30
Mvav 188,108,164
v_accvgpr_write_b32 a179, v31
v_accvgpr_write_b32 a180, v32
Mvav 136,112,176
s_add_u32 s78, s66, 2048
RD 96,6,24576
v_accvgpr_write_b32 a181, v33
Mvav 140,112,180
buffer_load_dwordx4 a[8:11], v5, s[4:7], s78 offen sc1
Mvav 152,116,176
RD 100,6,25600
v_accvgpr_write_b32 a182, v34
Mvav 156,116,180
v_accvgpr_write_b32 a183, v35
v_accvgpr_write_b32 a184, v36
Mvav 168,120,176
RD 104,6,26624
v_accvgpr_write_b32 a185, v37
Mvav 172,120,180
buffer_load_dwordx4 v2, s[4:7], s32 offen offset:3072 sc1 lds
Mvav 184,124,176
s_waitcnt lgkmcnt(7)
RD 108,6,27648
v_accvgpr_write_b32 a186, v38
Mvav 188,124,180
s_add_u32 m0, s30, 16384
v_readlane_b32 s31, v4, s29
Mvav 136,64,192
s_add_u32 s78, s66, 3072
RD 112,6,28672
v_accvgpr_write_b32 a187, v39
Mvav 140,64,196
buffer_load_dwordx4 a[12:15], v5, s[4:7], s78 offen sc1
Mvav 152,68,192
s_add_u32 s30, s30, s36
RD 116,6,29696
v_accvgpr_write_b32 a188, v40
Mvav 156,68,196
v_accvgpr_write_b32 a189, v41
v_accvgpr_write_b32 a190, v42
Mvav 168,72,192
s_cmp_ge_u32 s30, 131072
RD 120,6,30720
v_accvgpr_write_b32 a191, v43
Mvav 172,72,196
buffer_load_dwordx4 v2, s[4:7], s31 offen offset:0 sc1 lds
Mvav 184,76,192
s_waitcnt vmcnt(27) lgkmcnt(7)
s_cselect_b32 s36, s33, s34
RD 124,6,31744
Mvav 188,76,196
s_barrier
v_add_u32 v6, s36, v6
Mvav 136,80,208
RD 64,6,0
Mvav 140,80,212
Mvav 152,84,208
s_add_u32 s78, s66, 4096
RD 68,6,1024
Mvav 156,84,212
buffer_load_dwordx4 a[16:19], v5, s[4:7], s78 offen sc1
Mvav 168,88,208
s_add_u32 s29, s29, 1
RD 72,6,2048
Mvav 172,88,212
buffer_load_dwordx4 v2, s[4:7], s31 offen offset:1024 sc1 lds
Mvav 184,92,208
s_waitcnt lgkmcnt(7)
RD 76,6,3072
Mvav 188,92,212
Mvav 136,96,224
RD 80,6,4096
Mvav 140,96,228
Mvav 152,100,224
s_add_u32 s78, s66, 5120
RD 84,6,5120
Mvav 156,100,228
buffer_load_dwordx4 a[20:23], v5, s[4:7], s78 offen sc1
Mvav 168,104,224
RD 88,6,6144
Mvav 172,104,228
buffer_load_dwordx4 v2, s[4:7], s31 offen offset:2048 sc1 lds
Mvav 184,108,224
s_waitcnt lgkmcnt(7)
RD 92,6,7168
Mvav 188,108,228
v_readlane_b32 s32, v3, s29
Mvav 136,112,240
RD 96,6,8192
Mvav 140,112,244
Mvav 152,116,240
s_add_u32 s78, s66, 6144
RD 100,6,9216
Mvav 156,116,244
buffer_load_dwordx4 a[24:27], v5, s[4:7], s78 offen sc1
Mvav 168,120,240
RD 104,6,10240
Mvav 172,120,244
buffer_load_dwordx4 v2, s[4:7], s31 offen offset:3072 sc1 lds
Mvav 184,124,240
s_waitcnt lgkmcnt(7)
RD 108,6,11264
Mvav 188,124,244
s_mov_b32 m0, s30
Zvav 64,64,128
s_add_u32 s78, s66, 7168
RD 112,6,12288
Zvav 68,64,132
buffer_load_dwordx4 a[28:31], v5, s[4:7], s78 offen sc1
Zvav 72,68,128
RD 116,6,13312
v_cvt_pk_bf16_f32 v28, v136, v152
Zvav 76,68,132
v_cvt_pk_bf16_f32 v29, v168, v184
v_cvt_pk_bf16_f32 v30, v137, v153
Zvav 80,72,128
RD 120,6,14336
v_cvt_pk_bf16_f32 v31, v169, v185
Zvav 84,72,132
buffer_load_dwordx4 v2, s[4:7], s32 offen offset:0 sc1 lds
Zvav 88,76,128
s_waitcnt lgkmcnt(7)
RD 124,6,15360
v_cvt_pk_bf16_f32 v32, v138, v154
Zvav 92,76,132
v_cvt_pk_bf16_f32 v33, v170, v186
v_cvt_pk_bf16_f32 v34, v139, v155
Mvav 64,80,144
s_add_u32 s78, s66, 8192
RD 64,6,16384
v_cvt_pk_bf16_f32 v35, v171, v187
Mvav 68,80,148
buffer_load_dwordx4 a[32:35], v5, s[4:7], s78 offen sc1
Mvav 72,84,144
RD 68,6,17408
v_cvt_pk_bf16_f32 v36, v140, v156
Mvav 76,84,148
v_cvt_pk_bf16_f32 v37, v172, v188
v_cvt_pk_bf16_f32 v38, v141, v157
Mvav 80,88,144
RD 72,6,18432
v_cvt_pk_bf16_f32 v39, v173, v189
Mvav 84,88,148
buffer_load_dwordx4 v2, s[4:7], s32 offen offset:1024 sc1 lds
Mvav 88,92,144
s_waitcnt lgkmcnt(7)
RD 76,6,19456
v_cvt_pk_bf16_f32 v40, v142, v158
Mvav 92,92,148
v_cvt_pk_bf16_f32 v41, v174, v190
v_cvt_pk_bf16_f32 v42, v143, v159
Mvav 64,96,160
s_add_u32 s78, s66, 9216
RD 80,6,20480
v_cvt_pk_bf16_f32 v43, v175, v191
Mvav 68,96,164
buffer_load_dwordx4 a[36:39], v5, s[4:7], s78 offen sc1
Mvav 72,100,160
RD 84,6,21504
v_accvgpr_write_b32 a192, v28
Mvav 76,100,164
v_accvgpr_write_b32 a193, v29
v_accvgpr_write_b32 a194, v30
Mvav 80,104,160
RD 88,6,22528
v_accvgpr_write_b32 a195, v31
Mvav 84,104,164
buffer_load_dwordx4 v2, s[4:7], s32 offen offset:2048 sc1 lds
Mvav 88,108,160
s_waitcnt lgkmcnt(7)
RD 92,6,23552
v_accvgpr_write_b32 a196, v32
Mvav 92,108,164
v_accvgpr_write_b32 a197, v33
v_accvgpr_write_b32 a198, v34
Mvav 64,112,176
s_add_u32 s78, s66, 10240
RD 96,6,24576
v_accvgpr_write_b32 a199, v35
Mvav 68,112,180
buffer_load_dwordx4 a[40:43], v5, s[4:7], s78 offen sc1
Mvav 72,116,176
RD 100,6,25600
v_accvgpr_write_b32 a200, v36
Mvav 76,116,180
v_accvgpr_write_b32 a201, v37
v_accvgpr_write_b32 a202, v38
Mvav 80,120,176
RD 104,6,26624
v_accvgpr_write_b32 a203, v39
Mvav 84,120,180
buffer_load_dwordx4 v2, s[4:7], s32 offen offset:3072 sc1 lds
Mvav 88,124,176
s_waitcnt lgkmcnt(7)
RD 108,6,27648
v_accvgpr_write_b32 a204, v40
Mvav 92,124,180
s_add_u32 m0, s30, 16384
v_readlane_b32 s31, v4, s29
Mvav 64,64,192
s_add_u32 s78, s66, 11264
RD 112,6,28672
v_accvgpr_write_b32 a205, v41
Mvav 68,64,196
buffer_load_dwordx4 a[44:47], v5, s[4:7], s78 offen sc1
Mvav 72,68,192
s_add_u32 s30, s30, s36
RD 116,6,29696
v_accvgpr_write_b32 a206, v42
Mvav 76,68,196
v_accvgpr_write_b32 a207, v43
Mvav 80,72,192
s_cmp_ge_u32 s30, 131072
RD 120,6,30720
Mvav 84,72,196
buffer_load_dwordx4 v2, s[4:7], s31 offen offset:0 sc1 lds
Mvav 88,76,192
s_waitcnt vmcnt(34) lgkmcnt(7)
s_cselect_b32 s36, s33, s34
RD 124,6,31744
Mvav 92,76,196
s_barrier
v_add_u32 v6, s36, v6
Mvav 64,80,208
RD 64,6,0
Mvav 68,80,212
Mvav 72,84,208
s_add_u32 s78, s66, 12288
RD 68,6,1024
Mvav 76,84,212
buffer_load_dwordx4 a[48:51], v5, s[4:7], s78 offen sc1
Mvav 80,88,208
s_add_u32 s29, s29, 1
RD 72,6,2048
Mvav 84,88,212
buffer_load_dwordx4 v2, s[4:7], s31 offen offset:1024 sc1 lds
Mvav 88,92,208
s_waitcnt lgkmcnt(7)
RD 76,6,3072
Mvav 92,92,212
Mvav 64,96,224
RD 80,6,4096
Mvav 68,96,228
Mvav 72,100,224
s_add_u32 s78, s66, 13312
RD 84,6,5120
Mvav 76,100,228
buffer_load_dwordx4 a[52:55], v5, s[4:7], s78 offen sc1
Mvav 80,104,224
RD 88,6,6144
Mvav 84,104,228
buffer_load_dwordx4 v2, s[4:7], s31 offen offset:2048 sc1 lds
Mvav 88,108,224
s_waitcnt lgkmcnt(7)
RD 92,6,7168
Mvav 92,108,228
v_readlane_b32 s32, v3, s29
Mvav 64,112,240
RD 96,6,8192
Mvav 68,112,244
Mvav 72,116,240
RD 100,6,9216
Mvav 76,116,244
Mvav 80,120,240
RD 104,6,10240
Mvav 84,120,244
buffer_load_dwordx4 v2, s[4:7], s31 offen offset:3072 sc1 lds
Mvav 88,124,240
s_waitcnt lgkmcnt(7)
s_and_b32 s72, s72, 0x3fffffff
s_add_u32 s72, s72, 16
RD 108,6,11264
Mvav 92,124,244
s_mov_b32 m0, s30
Zvav 136,64,128
s_add_u32 s78, s66, 14336
RD 112,6,12288
v_mov_b64 v[112:113], 0
Zvav 140,64,132
buffer_load_dwordx4 a[56:59], v5, s[4:7], s78 offen sc1
Zvav 152,68,128
RD 116,6,13312
v_cvt_pk_bf16_f32 v28, v64, v72
Zvav 156,68,132
v_cvt_pk_bf16_f32 v29, v80, v88
v_cvt_pk_bf16_f32 v30, v65, v73
Zvav 168,72,128
RD 120,6,14336
v_cvt_pk_bf16_f32 v31, v81, v89
Zvav 172,72,132
buffer_load_dwordx4 v2, s[4:7], s32 offen offset:0 sc1 lds
Zvav 184,76,128
s_waitcnt lgkmcnt(7)
RD 124,6,15360
v_cvt_pk_bf16_f32 v32, v66, v74
Zvav 188,76,132
v_cvt_pk_bf16_f32 v33, v82, v90
v_cvt_pk_bf16_f32 v34, v67, v75
Mvav 136,80,144
RD 64,6,16384
v_cvt_pk_bf16_f32 v35, v83, v91
Mvav 140,80,148
v_cvt_pk_bf16_f32 v36, v68, v76
v_cvt_pk_bf16_f32 v37, v84, v92
Mvav 152,84,144
s_add_u32 s78, s66, 15360
RD 68,6,17408
v_cvt_pk_bf16_f32 v38, v69, v77
Mvav 156,84,148
buffer_load_dwordx4 a[60:63], v5, s[4:7], s78 offen sc1
Mvav 168,88,144
RD 72,6,18432
v_cvt_pk_bf16_f32 v39, v85, v93
Mvav 172,88,148
buffer_load_dwordx4 v2, s[4:7], s32 offen offset:1024 sc1 lds
Mvav 184,92,144
s_waitcnt lgkmcnt(7)
RD 76,6,19456
v_cvt_pk_bf16_f32 v40, v70, v78
Mvav 188,92,148
v_cvt_pk_bf16_f32 v41, v86, v94
v_cvt_pk_bf16_f32 v42, v71, v79
Mvav 136,96,160
RD 80,6,20480
v_cvt_pk_bf16_f32 v43, v87, v95
Mvav 140,96,164
v_accvgpr_write_b32 a208, v28
v_accvgpr_write_b32 a209, v29
Mvav 152,100,160
RD 84,6,21504
v_accvgpr_write_b32 a210, v30
Mvav 156,100,164
v_accvgpr_write_b32 a211, v31
v_accvgpr_write_b32 a212, v32
Mvav 168,104,160
RD 88,6,22528
v_accvgpr_write_b32 a213, v33
Mvav 172,104,164
buffer_load_dwordx4 v2, s[4:7], s32 offen offset:2048 sc1 lds
Mvav 184,108,160
s_waitcnt lgkmcnt(7)
RD 92,6,23552
v_accvgpr_write_b32 a214, v34
Mvav 188,108,164
v_accvgpr_write_b32 a215, v35
v_accvgpr_write_b32 a216, v36
Mvav 136,112,176
RD 96,6,24576
v_accvgpr_write_b32 a217, v37
Mvav 140,112,180
v_accvgpr_write_b32 a218, v38
v_accvgpr_write_b32 a219, v39
Mvav 152,116,176
RD 100,6,25600
v_accvgpr_write_b32 a220, v40
Mvav 156,116,180
v_accvgpr_write_b32 a221, v41
v_accvgpr_write_b32 a222, v42
s_branch LOP21
LP21:
s_setpc_b64 s[48:49]
LOP21:
Mvav 168,120,176
RD 104,6,26624
v_accvgpr_write_b32 a223, v43
Mvav 172,120,180
buffer_load_dwordx4 v2, s[4:7], s32 offen offset:3072 sc1 lds
Mvav 184,124,176
s_waitcnt lgkmcnt(7)
RD 108,6,27648
v_mov_b64 v[114:115], 0
Mvav 188,124,180
s_add_u32 m0, s30, 16384
v_readlane_b32 s31, v4, s29
Mvav 136,64,192
RD 112,6,28672
v_mov_b64 v[116:117], 0
Mvav 140,64,196
v_mov_b64 v[118:119], 0
v_mov_b64 v[120:121], 0
Mvav 152,68,192
s_add_u32 s30, s30, s36
RD 116,6,29696
v_mov_b32 v126, 0xf149f2ca
Mvav 156,68,196
v_mov_b32 v127, v126
Mvav 168,72,192
s_cmp_ge_u32 s30, 131072
s_mov_b32 s46, 1
RD 120,6,30720
Mvav 172,72,196
buffer_load_dwordx4 v2, s[4:7], s31 offen offset:0 sc1 lds
Mvav 184,76,192
s_waitcnt vmcnt(37) lgkmcnt(7)
s_cselect_b32 s36, s33, s34
RD 124,6,31744
Mvav 188,76,196
s_barrier
s_mov_b32 s45, 0xff61b1e6
v_add_u32 v6, s36, v6
Mvav 136,80,208
RD 64,6,0
Mvav 140,80,212
Mvav 152,84,208
RD 68,6,1024
Mvav 156,84,212
Mvav 168,88,208
s_add_u32 s29, s29, 1
RD 72,6,2048
Mvav 172,88,212
buffer_load_dwordx4 v2, s[4:7], s31 offen offset:1024 sc1 lds
Mvav 184,92,208
s_waitcnt lgkmcnt(7)
RD 76,6,3072
Mvav 188,92,212
Mvav 136,96,224
RD 80,6,4096
Mvav 140,96,228
Mvav 152,100,224
RD 84,6,5120
Mvav 156,100,228
Mvav 168,104,224
RD 88,6,6144
Mvav 172,104,228
buffer_load_dwordx4 v2, s[4:7], s31 offen offset:2048 sc1 lds
Mvav 184,108,224
s_waitcnt lgkmcnt(7)
RD 92,6,7168
Mvav 188,108,228
v_readlane_b32 s32, v3, s29
Mvav 136,112,240
RD 96,6,8192
Mvav 140,112,244
Mvav 152,116,240
RD 100,6,9216
Mvav 156,116,244
Mvav 168,120,240
RD 104,6,10240
Mvav 172,120,244
buffer_load_dwordx4 v2, s[4:7], s31 offen offset:3072 sc1 lds
Mvav 184,124,240
s_waitcnt lgkmcnt(7)
RD 108,6,11264
Mvav 188,124,244
s_mov_b32 m0, s30
s_waitcnt vmcnt(7)
Zvaa 64,64,0
RD 112,6,12288
Mvaa 64,68,4
buffer_load_dword v7, v10, s[4:7], s71 offen sc1
Mvaa 64,72,16
RD 116,6,13312
v_cvt_pk_bf16_f32 v28, v136, v152
Mvaa 64,76,20
v_cvt_pk_bf16_f32 v29, v168, v184
v_cvt_pk_bf16_f32 v30, v137, v153
Zvaa 68,64,32
RD 120,6,14336
v_cvt_pk_bf16_f32 v31, v169, v185
Mvaa 68,68,36
buffer_load_dwordx4 v2, s[4:7], s32 offen offset:0 sc1 lds
Mvaa 68,72,48
s_waitcnt lgkmcnt(7)
RD 124,6,15360
v_cvt_pk_bf16_f32 v32, v138, v154
Mvaa 68,76,52
v_cvt_pk_bf16_f32 v33, v170, v186
v_cvt_pk_bf16_f32 v34, v139, v155
Mvaa 68,80,40
s_add_u32 s78, s68, 24576
RD 64,6,16384
v_cvt_pk_bf16_f32 v35, v171, v187
Mvaa 68,84,44
buffer_store_dwordx4 v[28:31], v5, s[4:7], s78 offen sc1
Mvaa 68,88,56
RD 68,6,17408
v_cvt_pk_bf16_f32 v36, v140, v156
Mvaa 68,92,60
v_cvt_pk_bf16_f32 v37, v172, v188
v_cvt_pk_bf16_f32 v38, v141, v157
Mvaa 64,80,8
RD 72,6,18432
v_cvt_pk_bf16_f32 v39, v173, v189
Mvaa 64,84,12
buffer_load_dwordx4 v2, s[4:7], s32 offen offset:1024 sc1 lds
Mvaa 64,88,24
s_waitcnt lgkmcnt(7)
RD 76,6,19456
v_cvt_pk_bf16_f32 v40, v142, v158
Mvaa 64,92,28
v_cvt_pk_bf16_f32 v41, v174, v190
v_cvt_pk_bf16_f32 v42, v143, v159
Zvaa 72,96,0
s_add_u32 s78, s68, 25600
RD 80,6,20480
v_cvt_pk_bf16_f32 v43, v175, v191
Mvaa 72,100,4
buffer_store_dwordx4 v[32:35], v5, s[4:7], s78 offen sc1
Mvaa 72,104,16
RD 84,6,21504
Mvaa 72,108,20
v_exp_f32 v12, v68
Zvaa 76,96,32
RD 88,6,22528
v_exp_f32 v13, v69
Mvaa 76,100,36
buffer_load_dwordx4 v2, s[4:7], s32 offen offset:2048 sc1 lds
Mvaa 76,104,48
s_waitcnt lgkmcnt(7)
RD 92,6,23552
v_cvt_pk_bf16_f32 v100, v12, v13
Mvaa 76,108,52
v_exp_f32 v14, v70
Mvaa 76,112,40
s_add_u32 s78, s68, 26624
RD 96,6,24576
v_exp_f32 v15, v71
Mvaa 76,116,44
buffer_store_dwordx4 v[36:39], v5, s[4:7], s78 offen sc1
Mvaa 76,120,56
RD 100,6,25600
v_cvt_pk_bf16_f32 v101, v14, v15
Mvaa 76,124,60
v_exp_f32 v16, v64
Mvaa 72,112,8
RD 104,6,26624
v_exp_f32 v17, v65
Mvaa 72,116,12
buffer_load_dwordx4 v2, s[4:7], s32 offen offset:3072 sc1 lds
Mvaa 72,120,24
s_waitcnt lgkmcnt(7)
RD 108,6,27648
v_cvt_pk_bf16_f32 v96, v16, v17
Mvaa 72,124,28
s_add_u32 m0, s30, 16384
v_readlane_b32 s31, v4, s29
Zvaa 80,64,0
s_add_u32 s78, s68, 27648
RD 112,6,28672
v_exp_f32 v18, v66
Mvaa 80,68,4
buffer_store_dwordx4 v[40:43], v5, s[4:7], s78 offen sc1
Mvaa 80,72,16
s_add_u32 s30, s30, s36
RD 116,6,29696
v_exp_f32 v19, v67
Mvaa 80,76,20
v_cvt_pk_bf16_f32 v97, v18, v19
v_exp_f32 v20, v76
Zvaa 84,64,32
s_cmp_ge_u32 s30, 131072
RD 120,6,30720
v_exp_f32 v21, v77
Mvaa 84,68,36
buffer_load_dwordx4 v2, s[4:7], s31 offen offset:0 sc1 lds
Mvaa 84,72,48
s_waitcnt vmcnt(35) lgkmcnt(7)
s_cselect_b32 s36, s33, s34
RD 124,6,31744
Mvaa 84,76,52
s_barrier
v_add_u32 v6, s36, v6
v_cvt_pk_bf16_f32 v102, v20, v21
Mvaa 84,80,40
RD 64,6,0
v_exp_f32 v22, v78
Mvaa 84,84,44
v_exp_f32 v23, v79
Mvaa 84,88,56
RD 68,6,1024
v_cvt_pk_bf16_f32 v103, v22, v23
Mvaa 84,92,60
v_add_f32 v124, v12, v13
v_exp_f32 v12, v72
Mvaa 80,80,8
s_add_u32 s29, s29, 1
RD 72,6,2048
v_exp_f32 v13, v73
Mvaa 80,84,12
buffer_load_dwordx4 v2, s[4:7], s31 offen offset:1024 sc1 lds
Mvaa 80,88,24
s_waitcnt lgkmcnt(7)
RD 76,6,3072
v_cvt_pk_bf16_f32 v98, v12, v13
Mvaa 80,92,28
v_add_f32 v125, v14, v15
v_exp_f32 v14, v74
Zvaa 88,96,0
RD 80,6,4096
v_exp_f32 v15, v75
Mvaa 88,100,4
v_cvt_pk_bf16_f32 v99, v14, v15
v_add_f32 v122, v16, v17
v_add_f32 v123, v18, v19
Mvaa 88,104,16
RD 84,6,5120
v_add_f32 v124, v124, v20
v_add_f32 v124, v124, v21
Mvaa 88,108,20
v_add_f32 v125, v125, v22
v_add_f32 v125, v125, v23
Zvaa 92,96,32
RD 88,6,6144
v_add_f32 v122, v122, v12
Mvaa 92,100,36
buffer_load_dwordx4 v2, s[4:7], s31 offen offset:2048 sc1 lds
Mvaa 92,104,48
s_waitcnt lgkmcnt(7)
RD 92,6,7168
v_add_f32 v122, v122, v13
v_add_f32 v123, v123, v14
Mvaa 92,108,52
v_readlane_b32 s32, v3, s29
Mvaa 92,112,40
RD 96,6,8192
v_add_f32 v123, v123, v15
Mvaa 92,116,44
v_add_f32 v122, v122, v123
v_add_f32 v124, v124, v125
Mvaa 92,120,56
s_waitcnt vmcnt(11)
RD 100,6,9216
v_cmp_ne_u32 s[80:81], s38, v7
v_subrev_u32 v26, 0x2b800000, v122
Mvaa 92,124,60
v_subrev_u32 v27, 0x2b800000, v124
v_max_u32 v26, v26, v27
Mvaa 88,112,8
s_cmp_lg_u64 s[80:81], 0
s_cbranch_scc1 L_pw_kv2a
L_po_kv2a:
s_barrier
RD 104,6,10240
Mvaa 88,116,12
buffer_load_dwordx4 v2, s[4:7], s31 offen offset:3072 sc1 lds
Mvaa 88,120,24
s_waitcnt lgkmcnt(7)
RD 108,6,11264
v_cmp_lt_u32 vcc, 0x28000000, v26
Mvaa 88,124,28
s_mov_b32 m0, s30
s_cbranch_vccnz L_fchk_fa1
L_fok_fa1:
s_mov_b32 s46, 0
s_mov_b32 s45, 0
Zvav 128,64,96
RD 112,6,12288
v_add_f32 v120, v120, v122
Zvav 132,64,100
v_exp_f32 v12, v80
Zvav 136,68,96
RD 116,6,13312
v_add_f32 v121, v121, v124
Zvav 140,68,100
v_exp_f32 v13, v81
Zvav 144,72,96
RD 120,6,14336
v_cvt_pk_bf16_f32 v104, v12, v13
Zvav 148,72,100
buffer_load_dwordx4 v2, s[4:7], s32 offen offset:0 sc1 lds
Zvav 152,76,96
s_waitcnt lgkmcnt(7)
RD 124,6,15360
v_add_f32 v122, v12, v13
Zvav 156,76,100
v_exp_f32 v14, v82
Zvav 160,80,96
s_add_u32 s78, s68, 0
RD 64,6,16384
Zvav 164,80,100
buffer_store_dwordx4 a[128:131], v5, s[4:7], s78 offen sc1
Zvav 168,84,96
RD 68,6,17408
Zvav 172,84,100
v_exp_f32 v15, v83
Zvav 176,88,96
RD 72,6,18432
v_cvt_pk_bf16_f32 v105, v14, v15
Zvav 180,88,100
buffer_load_dwordx4 v2, s[4:7], s32 offen offset:1024 sc1 lds
Zvav 184,92,96
s_waitcnt lgkmcnt(7)
RD 76,6,19456
v_add_f32 v123, v14, v15
Zvav 188,92,100
v_exp_f32 v16, v84
Zvav 192,96,96
RD 80,6,20480
Zvav 196,96,100
v_exp_f32 v17, v85
Zvav 200,100,96
RD 84,6,21504
v_cvt_pk_bf16_f32 v108, v16, v17
Zvav 204,100,100
v_exp_f32 v18, v86
Zvav 208,104,96
RD 88,6,22528
v_add_f32 v124, v16, v17
Zvav 212,104,100
buffer_load_dwordx4 v2, s[4:7], s32 offen offset:2048 sc1 lds
Zvav 216,108,96
s_waitcnt lgkmcnt(7)
RD 92,6,23552
Zvav 220,108,100
v_exp_f32 v19, v87
Zvav 224,112,96
s_add_u32 s78, s68, 1024
RD 96,6,24576
v_cvt_pk_bf16_f32 v109, v18, v19
Zvav 228,112,100
buffer_store_dwordx4 a[132:135], v5, s[4:7], s78 offen sc1
Zvav 232,116,96
RD 100,6,25600
v_add_f32 v125, v18, v19
Zvav 236,116,100
v_exp_f32 v20, v88
Zvav 240,120,96
RD 104,6,26624
v_add_f32 v122, v122, v20
Zvav 244,120,100
buffer_load_dwordx4 v2, s[4:7], s32 offen offset:3072 sc1 lds
Zvav 248,124,96
s_waitcnt lgkmcnt(7)
RD 108,6,27648
Zvav 252,124,100
s_add_u32 m0, s30, 16384
v_readlane_b32 s31, v4, s29
Nvaa 64,64,0,112
RD 112,6,28672
Mvaa 64,68,4
v_exp_f32 v21, v89
Mvaa 64,72,16
s_add_u32 s30, s30, s36
RD 116,6,29696
v_cvt_pk_bf16_f32 v106, v20, v21
Mvaa 64,76,20
v_exp_f32 v22, v90
Nvaa 68,64,32,116
s_cmp_ge_u32 s30, 131072
RD 120,6,30720
v_add_f32 v122, v122, v21
Mvaa 68,68,36
buffer_load_dwordx4 v2, s[4:7], s31 offen offset:0 sc1 lds
Mvaa 68,72,48
s_waitcnt vmcnt(30) lgkmcnt(7)
s_cselect_b32 s36, s33, s34
RD 124,6,31744
Mvaa 68,76,52
s_barrier
v_add_u32 v6, s36, v6
v_add_f32 v123, v123, v22
Mvaa 68,80,40
RD 64,6,0
Mvaa 68,84,44
v_exp_f32 v23, v91
Mvaa 68,88,56
RD 68,6,1024
v_cvt_pk_bf16_f32 v107, v22, v23
Mvaa 68,92,60
v_exp_f32 v12, v92
Mvaa 64,80,8
s_add_u32 s29, s29, 1
RD 72,6,2048
v_add_f32 v123, v123, v23
Mvaa 64,84,12
buffer_load_dwordx4 v2, s[4:7], s31 offen offset:1024 sc1 lds
Mvaa 64,88,24
s_waitcnt lgkmcnt(7)
RD 76,6,3072
v_add_f32 v124, v124, v12
Mvaa 64,92,28
v_exp_f32 v13, v93
Nvaa 72,96,0,112
s_add_u32 s78, s68, 2048
RD 80,6,4096
v_cvt_pk_bf16_f32 v110, v12, v13
Mvaa 72,100,4
buffer_store_dwordx4 a[136:139], v5, s[4:7], s78 offen sc1
Mvaa 72,104,16
RD 84,6,5120
v_add_f32 v124, v124, v13
Mvaa 72,108,20
v_exp_f32 v14, v94
Nvaa 76,96,32,116
RD 88,6,6144
v_add_f32 v125, v125, v14
Mvaa 76,100,36
buffer_load_dwordx4 v2, s[4:7], s31 offen offset:2048 sc1 lds
Mvaa 76,104,48
s_waitcnt lgkmcnt(7)
RD 92,6,7168
v_add_f32 v122, v122, v123
Mvaa 76,108,52
v_readlane_b32 s32, v3, s29
Mvaa 76,112,40
RD 96,6,8192
Mvaa 76,116,44
v_exp_f32 v15, v95
Mvaa 76,120,56
RD 100,6,9216
v_cvt_pk_bf16_f32 v111, v14, v15
Mvaa 76,124,60
v_add_f32 v125, v125, v15
v_add_f32 v124, v124, v125
Mvaa 72,112,8
RD 104,6,10240
v_max_f32 v26, v122, v124
Mvaa 72,116,12
buffer_load_dwordx4 v2, s[4:7], s31 offen offset:3072 sc1 lds
Mvaa 72,120,24
s_waitcnt lgkmcnt(7)
RD 108,6,11264
v_cmp_nge_f32 vcc, 0x53800000, v26
Mvaa 72,124,28
s_mov_b32 m0, s30
s_cbranch_vccnz L_dorare_pa0
L_norare_pa0:
Mvav 128,64,104
RD 112,6,12288
v_add_f32 v120, v120, v122
Mvav 132,64,108
v_exp_f32 v12, v64
Mvav 136,68,104
RD 116,6,13312
v_add_f32 v121, v121, v124
Mvav 140,68,108
v_exp_f32 v13, v65
Mvav 144,72,104
RD 120,6,14336
v_cvt_pk_bf16_f32 v96, v12, v13
Mvav 148,72,108
buffer_load_dwordx4 v2, s[4:7], s32 offen offset:0 sc1 lds
Mvav 152,76,104
s_waitcnt lgkmcnt(7)
RD 124,6,15360
v_add_f32 v122, v12, v13
Mvav 156,76,108
v_exp_f32 v14, v66
Mvav 160,80,104
s_add_u32 s78, s68, 3072
RD 64,6,16384
Mvav 164,80,108
buffer_store_dwordx4 a[140:143], v5, s[4:7], s78 offen sc1
Mvav 168,84,104
RD 68,6,17408
Mvav 172,84,108
v_exp_f32 v15, v67
Mvav 176,88,104
RD 72,6,18432
v_cvt_pk_bf16_f32 v97, v14, v15
Mvav 180,88,108
buffer_load_dwordx4 v2, s[4:7], s32 offen offset:1024 sc1 lds
Mvav 184,92,104
s_waitcnt lgkmcnt(7)
RD 76,6,19456
v_add_f32 v123, v14, v15
Mvav 188,92,108
v_exp_f32 v16, v68
Mvav 192,96,104
RD 80,6,20480
Mvav 196,96,108
v_exp_f32 v17, v69
Mvav 200,100,104
RD 84,6,21504
v_cvt_pk_bf16_f32 v100, v16, v17
Mvav 204,100,108
v_exp_f32 v18, v70
Mvav 208,104,104
RD 88,6,22528
v_add_f32 v124, v16, v17
Mvav 212,104,108
buffer_load_dwordx4 v2, s[4:7], s32 offen offset:2048 sc1 lds
Mvav 216,108,104
s_waitcnt lgkmcnt(7)
RD 92,6,23552
Mvav 220,108,108
v_exp_f32 v19, v71
Mvav 224,112,104
s_add_u32 s78, s68, 4096
RD 96,6,24576
v_cvt_pk_bf16_f32 v101, v18, v19
Mvav 228,112,108
buffer_store_dwordx4 a[144:147], v5, s[4:7], s78 offen sc1
Mvav 232,116,104
RD 100,6,25600
v_add_f32 v125, v18, v19
Mvav 236,116,108
v_exp_f32 v20, v72
Mvav 240,120,104
RD 104,6,26624
v_add_f32 v122, v122, v20
Mvav 244,120,108
buffer_load_dwordx4 v2, s[4:7], s32 offen offset:3072 sc1 lds
Mvav 248,124,104
s_waitcnt lgkmcnt(7)
RD 108,6,27648
Mvav 252,124,108
s_add_u32 m0, s30, 16384
v_readlane_b32 s31, v4, s29
Nvaa 80,64,0,112
RD 112,6,28672
Mvaa 80,68,4
v_exp_f32 v21, v73
Mvaa 80,72,16
s_add_u32 s30, s30, s36
RD 116,6,29696
v_cvt_pk_bf16_f32 v98, v20, v21
Mvaa 80,76,20
v_exp_f32 v22, v74
Nvaa 84,64,32,116
s_cmp_ge_u32 s30, 131072
RD 120,6,30720
v_add_f32 v122, v122, v21
Mvaa 84,68,36
buffer_load_dwordx4 v2, s[4:7], s31 offen offset:0 sc1 lds
Mvaa 84,72,48
s_waitcnt vmcnt(31) lgkmcnt(7)
s_cselect_b32 s36, s33, s34
RD 124,6,31744
Mvaa 84,76,52
s_barrier
v_add_u32 v6, s36, v6
v_add_f32 v123, v123, v22
Mvaa 84,80,40
RD 64,6,0
Mvaa 84,84,44
v_exp_f32 v23, v75
Mvaa 84,88,56
RD 68,6,1024
v_cvt_pk_bf16_f32 v99, v22, v23
Mvaa 84,92,60
v_exp_f32 v12, v76
Mvaa 80,80,8
s_add_u32 s29, s29, 1
RD 72,6,2048
v_add_f32 v123, v123, v23
Mvaa 80,84,12
buffer_load_dwordx4 v2, s[4:7], s31 offen offset:1024 sc1 lds
Mvaa 80,88,24
s_waitcnt lgkmcnt(7)
RD 76,6,3072
v_add_f32 v124, v124, v12
Mvaa 80,92,28
v_exp_f32 v13, v77
Nvaa 88,96,0,112
s_add_u32 s78, s68, 5120
RD 80,6,4096
v_cvt_pk_bf16_f32 v102, v12, v13
Mvaa 88,100,4
buffer_store_dwordx4 a[148:151], v5, s[4:7], s78 offen sc1
Mvaa 88,104,16
RD 84,6,5120
v_add_f32 v124, v124, v13
Mvaa 88,108,20
s_branch LOP22
LP22:
s_setpc_b64 s[48:49]
LOP22:
v_exp_f32 v14, v78
Nvaa 92,96,32,116
RD 88,6,6144
v_add_f32 v125, v125, v14
Mvaa 92,100,36
buffer_load_dwordx4 v2, s[4:7], s31 offen offset:2048 sc1 lds
Mvaa 92,104,48
s_waitcnt lgkmcnt(7)
RD 92,6,7168
v_add_f32 v122, v122, v123
Mvaa 92,108,52
v_readlane_b32 s32, v3, s29
Mvaa 92,112,40
RD 96,6,8192
Mvaa 92,116,44
v_exp_f32 v15, v79
Mvaa 92,120,56
RD 100,6,9216
v_cvt_pk_bf16_f32 v103, v14, v15
Mvaa 92,124,60
v_add_f32 v125, v125, v15
v_add_f32 v124, v124, v125
Mvaa 88,112,8
RD 104,6,10240
v_max_f32 v26, v122, v124
Mvaa 88,116,12
buffer_load_dwordx4 v2, s[4:7], s31 offen offset:3072 sc1 lds
Mvaa 88,120,24
s_waitcnt lgkmcnt(7)
RD 108,6,11264
v_cmp_nge_f32 vcc, 0x53800000, v26
Mvaa 88,124,28
s_mov_b32 m0, s30
s_cbranch_vccnz L_dorare_pa1
L_norare_pa1:
Mvav 128,64,96
RD 112,6,12288
v_add_f32 v120, v120, v122
Mvav 132,64,100
v_exp_f32 v12, v80
Mvav 136,68,96
RD 116,6,13312
v_add_f32 v121, v121, v124
Mvav 140,68,100
v_exp_f32 v13, v81
Mvav 144,72,96
RD 120,6,14336
v_cvt_pk_bf16_f32 v104, v12, v13
Mvav 148,72,100
buffer_load_dwordx4 v2, s[4:7], s32 offen offset:0 sc1 lds
Mvav 152,76,96
s_waitcnt lgkmcnt(7)
RD 124,6,15360
v_add_f32 v122, v12, v13
Mvav 156,76,100
v_exp_f32 v14, v82
Mvav 160,80,96
s_add_u32 s78, s68, 6144
RD 64,6,16384
Mvav 164,80,100
buffer_store_dwordx4 a[152:155], v5, s[4:7], s78 offen sc1
Mvav 168,84,96
RD 68,6,17408
Mvav 172,84,100
v_exp_f32 v15, v83
Mvav 176,88,96
RD 72,6,18432
v_cvt_pk_bf16_f32 v105, v14, v15
Mvav 180,88,100
buffer_load_dwordx4 v2, s[4:7], s32 offen offset:1024 sc1 lds
Mvav 184,92,96
s_waitcnt lgkmcnt(7)
RD 76,6,19456
v_add_f32 v123, v14, v15
Mvav 188,92,100
v_exp_f32 v16, v84
Mvav 192,96,96
RD 80,6,20480
Mvav 196,96,100
v_exp_f32 v17, v85
Mvav 200,100,96
RD 84,6,21504
v_cvt_pk_bf16_f32 v108, v16, v17
Mvav 204,100,100
v_exp_f32 v18, v86
Mvav 208,104,96
RD 88,6,22528
v_add_f32 v124, v16, v17
Mvav 212,104,100
buffer_load_dwordx4 v2, s[4:7], s32 offen offset:2048 sc1 lds
Mvav 216,108,96
s_waitcnt lgkmcnt(7)
RD 92,6,23552
Mvav 220,108,100
v_exp_f32 v19, v87
Mvav 224,112,96
s_add_u32 s78, s68, 7168
RD 96,6,24576
v_cvt_pk_bf16_f32 v109, v18, v19
Mvav 228,112,100
buffer_store_dwordx4 a[156:159], v5, s[4:7], s78 offen sc1
Mvav 232,116,96
RD 100,6,25600
v_add_f32 v125, v18, v19
Mvav 236,116,100
v_exp_f32 v20, v88
Mvav 240,120,96
RD 104,6,26624
v_add_f32 v122, v122, v20
Mvav 244,120,100
buffer_load_dwordx4 v2, s[4:7], s32 offen offset:3072 sc1 lds
Mvav 248,124,96
s_waitcnt lgkmcnt(7)
RD 108,6,27648
Mvav 252,124,100
s_add_u32 m0, s30, 16384
v_readlane_b32 s31, v4, s29
Nvaa 64,64,0,112
RD 112,6,28672
Mvaa 64,68,4
v_exp_f32 v21, v89
Mvaa 64,72,16
s_add_u32 s30, s30, s36
RD 116,6,29696
v_cvt_pk_bf16_f32 v106, v20, v21
Mvaa 64,76,20
v_exp_f32 v22, v90
Nvaa 68,64,32,116
s_cmp_ge_u32 s30, 131072
RD 120,6,30720
v_add_f32 v122, v122, v21
Mvaa 68,68,36
buffer_load_dwordx4 v2, s[4:7], s31 offen offset:0 sc1 lds
Mvaa 68,72,48
s_waitcnt vmcnt(29) lgkmcnt(7)
s_cselect_b32 s36, s33, s34
RD 124,6,31744
Mvaa 68,76,52
s_barrier
v_add_u32 v6, s36, v6
v_add_f32 v123, v123, v22
Mvaa 68,80,40
RD 64,6,0
Mvaa 68,84,44
v_exp_f32 v23, v91
Mvaa 68,88,56
RD 68,6,1024
v_cvt_pk_bf16_f32 v107, v22, v23
Mvaa 68,92,60
v_exp_f32 v12, v92
Mvaa 64,80,8
s_add_u32 s29, s29, 1
RD 72,6,2048
v_add_f32 v123, v123, v23
Mvaa 64,84,12
buffer_load_dwordx4 v2, s[4:7], s31 offen offset:1024 sc1 lds
Mvaa 64,88,24
s_waitcnt lgkmcnt(7)
RD 76,6,3072
v_add_f32 v124, v124, v12
Mvaa 64,92,28
v_exp_f32 v13, v93
Nvaa 72,96,0,112
s_add_u32 s78, s68, 8192
RD 80,6,4096
v_cvt_pk_bf16_f32 v110, v12, v13
Mvaa 72,100,4
buffer_store_dwordx4 a[160:163], v5, s[4:7], s78 offen sc1
Mvaa 72,104,16
RD 84,6,5120
v_add_f32 v124, v124, v13
Mvaa 72,108,20
v_exp_f32 v14, v94
Nvaa 76,96,32,116
RD 88,6,6144
v_add_f32 v125, v125, v14
Mvaa 76,100,36
buffer_load_dwordx4 v2, s[4:7], s31 offen offset:2048 sc1 lds
Mvaa 76,104,48
s_waitcnt lgkmcnt(7)
RD 92,6,7168
v_add_f32 v122, v122, v123
Mvaa 76,108,52
v_readlane_b32 s32, v3, s29
Mvaa 76,112,40
RD 96,6,8192
Mvaa 76,116,44
v_exp_f32 v15, v95
Mvaa 76,120,56
RD 100,6,9216
v_cvt_pk_bf16_f32 v111, v14, v15
Mvaa 76,124,60
v_add_f32 v125, v125, v15
v_add_f32 v124, v124, v125
Mvaa 72,112,8
RD 104,6,10240
v_max_f32 v26, v122, v124
Mvaa 72,116,12
buffer_load_dwordx4 v2, s[4:7], s31 offen offset:3072 sc1 lds
Mvaa 72,120,24
s_waitcnt lgkmcnt(7)
RD 108,6,11264
v_cmp_nge_f32 vcc, 0x53800000, v26
Mvaa 72,124,28
s_mov_b32 m0, s30
s_cbranch_vccnz L_dorare_pa2
L_norare_pa2:
Mvav 128,64,104
RD 112,6,12288
v_add_f32 v120, v120, v122
Mvav 132,64,108
v_exp_f32 v12, v64
Mvav 136,68,104
RD 116,6,13312
v_add_f32 v121, v121, v124
Mvav 140,68,108
v_exp_f32 v13, v65
Mvav 144,72,104
RD 120,6,14336
v_cvt_pk_bf16_f32 v96, v12, v13
Mvav 148,72,108
buffer_load_dwordx4 v2, s[4:7], s32 offen offset:0 sc1 lds
Mvav 152,76,104
s_waitcnt lgkmcnt(7)
RD 124,6,15360
v_add_f32 v122, v12, v13
Mvav 156,76,108
v_exp_f32 v14, v66
Mvav 160,80,104
s_add_u32 s78, s68, 9216
RD 64,6,16384
Mvav 164,80,108
buffer_store_dwordx4 a[164:167], v5, s[4:7], s78 offen sc1
Mvav 168,84,104
RD 68,6,17408
Mvav 172,84,108
v_exp_f32 v15, v67
Mvav 176,88,104
RD 72,6,18432
v_cvt_pk_bf16_f32 v97, v14, v15
Mvav 180,88,108
buffer_load_dwordx4 v2, s[4:7], s32 offen offset:1024 sc1 lds
Mvav 184,92,104
s_waitcnt lgkmcnt(7)
RD 76,6,19456
v_add_f32 v123, v14, v15
Mvav 188,92,108
v_exp_f32 v16, v68
Mvav 192,96,104
RD 80,6,20480
Mvav 196,96,108
v_exp_f32 v17, v69
Mvav 200,100,104
RD 84,6,21504
v_cvt_pk_bf16_f32 v100, v16, v17
Mvav 204,100,108
v_exp_f32 v18, v70
Mvav 208,104,104
RD 88,6,22528
v_add_f32 v124, v16, v17
Mvav 212,104,108
buffer_load_dwordx4 v2, s[4:7], s32 offen offset:2048 sc1 lds
Mvav 216,108,104
s_waitcnt lgkmcnt(7)
RD 92,6,23552
Mvav 220,108,108
v_exp_f32 v19, v71
Mvav 224,112,104
s_add_u32 s78, s68, 10240
RD 96,6,24576
v_cvt_pk_bf16_f32 v101, v18, v19
Mvav 228,112,108
buffer_store_dwordx4 a[168:171], v5, s[4:7], s78 offen sc1
Mvav 232,116,104
RD 100,6,25600
v_add_f32 v125, v18, v19
Mvav 236,116,108
v_exp_f32 v20, v72
Mvav 240,120,104
RD 104,6,26624
v_add_f32 v122, v122, v20
Mvav 244,120,108
buffer_load_dwordx4 v2, s[4:7], s32 offen offset:3072 sc1 lds
Mvav 248,124,104
s_waitcnt lgkmcnt(7)
RD 108,6,27648
Mvav 252,124,108
s_add_u32 m0, s30, 16384
v_readlane_b32 s31, v4, s29
Nvaa 80,64,0,112
RD 112,6,28672
Mvaa 80,68,4
v_exp_f32 v21, v73
Mvaa 80,72,16
s_add_u32 s30, s30, s36
RD 116,6,29696
v_cvt_pk_bf16_f32 v98, v20, v21
Mvaa 80,76,20
v_exp_f32 v22, v74
Nvaa 84,64,32,116
s_cmp_ge_u32 s30, 131072
RD 120,6,30720
v_add_f32 v122, v122, v21
Mvaa 84,68,36
buffer_load_dwordx4 v2, s[4:7], s31 offen offset:0 sc1 lds
Mvaa 84,72,48
s_waitcnt vmcnt(29) lgkmcnt(7)
s_cselect_b32 s36, s33, s34
RD 124,6,31744
Mvaa 84,76,52
s_barrier
v_add_u32 v6, s36, v6
v_add_f32 v123, v123, v22
Mvaa 84,80,40
RD 64,6,0
Mvaa 84,84,44
v_exp_f32 v23, v75
Mvaa 84,88,56
RD 68,6,1024
v_cvt_pk_bf16_f32 v99, v22, v23
Mvaa 84,92,60
v_exp_f32 v12, v76
Mvaa 80,80,8
s_add_u32 s29, s29, 1
RD 72,6,2048
v_add_f32 v123, v123, v23
Mvaa 80,84,12
buffer_load_dwordx4 v2, s[4:7], s31 offen offset:1024 sc1 lds
Mvaa 80,88,24
s_waitcnt lgkmcnt(7)
RD 76,6,3072
v_add_f32 v124, v124, v12
Mvaa 80,92,28
v_exp_f32 v13, v77
Nvaa 88,96,0,112
s_add_u32 s78, s68, 11264
RD 80,6,4096
v_cvt_pk_bf16_f32 v102, v12, v13
Mvaa 88,100,4
buffer_store_dwordx4 a[172:175], v5, s[4:7], s78 offen sc1
Mvaa 88,104,16
RD 84,6,5120
v_add_f32 v124, v124, v13
Mvaa 88,108,20
v_exp_f32 v14, v78
Nvaa 92,96,32,116
RD 88,6,6144
v_add_f32 v125, v125, v14
Mvaa 92,100,36
buffer_load_dwordx4 v2, s[4:7], s31 offen offset:2048 sc1 lds
Mvaa 92,104,48
s_waitcnt lgkmcnt(7)
RD 92,6,7168
v_add_f32 v122, v122, v123
Mvaa 92,108,52
v_readlane_b32 s32, v3, s29
Mvaa 92,112,40
RD 96,6,8192
Mvaa 92,116,44
v_exp_f32 v15, v79
Mvaa 92,120,56
RD 100,6,9216
v_cvt_pk_bf16_f32 v103, v14, v15
Mvaa 92,124,60
v_add_f32 v125, v125, v15
v_add_f32 v124, v124, v125
Mvaa 88,112,8
RD 104,6,10240
v_max_f32 v26, v122, v124
Mvaa 88,116,12
buffer_load_dwordx4 v2, s[4:7], s31 offen offset:3072 sc1 lds
Mvaa 88,120,24
s_waitcnt lgkmcnt(7)
RD 108,6,11264
v_cmp_nge_f32 vcc, 0x53800000, v26
Mvaa 88,124,28
s_mov_b32 m0, s30
s_cbranch_vccnz L_dorare_pa3
L_norare_pa3:
Mvav 128,64,96
RD 112,6,12288
v_add_f32 v120, v120, v122
Mvav 132,64,100
v_exp_f32 v12, v80
Mvav 136,68,96
RD 116,6,13312
v_add_f32 v121, v121, v124
Mvav 140,68,100
v_exp_f32 v13, v81
Mvav 144,72,96
RD 120,6,14336
v_cvt_pk_bf16_f32 v104, v12, v13
Mvav 148,72,100
buffer_load_dwordx4 v2, s[4:7], s32 offen offset:0 sc1 lds
Mvav 152,76,96
s_waitcnt lgkmcnt(7)
RD 124,6,15360
v_add_f32 v122, v12, v13
Mvav 156,76,100
v_exp_f32 v14, v82
Mvav 160,80,96
s_add_u32 s78, s68, 12288
RD 64,6,16384
Mvav 164,80,100
buffer_store_dwordx4 a[176:179], v5, s[4:7], s78 offen sc1
Mvav 168,84,96
RD 68,6,17408
Mvav 172,84,100
v_exp_f32 v15, v83
Mvav 176,88,96
RD 72,6,18432
v_cvt_pk_bf16_f32 v105, v14, v15
Mvav 180,88,100
buffer_load_dwordx4 v2, s[4:7], s32 offen offset:1024 sc1 lds
Mvav 184,92,96
s_waitcnt lgkmcnt(7)
RD 76,6,19456
v_add_f32 v123, v14, v15
Mvav 188,92,100
v_exp_f32 v16, v84
Mvav 192,96,96
RD 80,6,20480
Mvav 196,96,100
v_exp_f32 v17, v85
Mvav 200,100,96
RD 84,6,21504
v_cvt_pk_bf16_f32 v108, v16, v17
Mvav 204,100,100
v_exp_f32 v18, v86
Mvav 208,104,96
RD 88,6,22528
v_add_f32 v124, v16, v17
Mvav 212,104,100
buffer_load_dwordx4 v2, s[4:7], s32 offen offset:2048 sc1 lds
Mvav 216,108,96
s_waitcnt lgkmcnt(7)
RD 92,6,23552
Mvav 220,108,100
v_exp_f32 v19, v87
Mvav 224,112,96
s_add_u32 s78, s68, 13312
RD 96,6,24576
v_cvt_pk_bf16_f32 v109, v18, v19
Mvav 228,112,100
buffer_store_dwordx4 a[180:183], v5, s[4:7], s78 offen sc1
Mvav 232,116,96
RD 100,6,25600
v_add_f32 v125, v18, v19
Mvav 236,116,100
v_exp_f32 v20, v88
Mvav 240,120,96
RD 104,6,26624
v_add_f32 v122, v122, v20
Mvav 244,120,100
buffer_load_dwordx4 v2, s[4:7], s32 offen offset:3072 sc1 lds
Mvav 248,124,96
s_waitcnt lgkmcnt(7)
RD 108,6,27648
Mvav 252,124,100
s_add_u32 m0, s30, 16384
v_readlane_b32 s31, v4, s29
Nvaa 64,64,0,112
RD 112,6,28672
Mvaa 64,68,4
v_exp_f32 v21, v89
Mvaa 64,72,16
s_add_u32 s30, s30, s36
RD 116,6,29696
v_cvt_pk_bf16_f32 v106, v20, v21
Mvaa 64,76,20
v_exp_f32 v22, v90
Nvaa 68,64,32,116
s_cmp_ge_u32 s30, 131072
RD 120,6,30720
v_add_f32 v122, v122, v21
Mvaa 68,68,36
buffer_load_dwordx4 v2, s[4:7], s31 offen offset:0 sc1 lds
Mvaa 68,72,48
s_waitcnt vmcnt(29) lgkmcnt(7)
s_cselect_b32 s36, s33, s34
RD 124,6,31744
Mvaa 68,76,52
s_barrier
v_add_u32 v6, s36, v6
v_add_f32 v123, v123, v22
Mvaa 68,80,40
RD 64,6,0
Mvaa 68,84,44
v_exp_f32 v23, v91
Mvaa 68,88,56
RD 68,6,1024
v_cvt_pk_bf16_f32 v107, v22, v23
Mvaa 68,92,60
v_exp_f32 v12, v92
Mvaa 64,80,8
s_add_u32 s29, s29, 1
RD 72,6,2048
v_add_f32 v123, v123, v23
Mvaa 64,84,12
buffer_load_dwordx4 v2, s[4:7], s31 offen offset:1024 sc1 lds
Mvaa 64,88,24
s_waitcnt lgkmcnt(7)
RD 76,6,3072
v_add_f32 v124, v124, v12
Mvaa 64,92,28
v_exp_f32 v13, v93
Nvaa 72,96,0,112
s_add_u32 s78, s68, 14336
RD 80,6,4096
v_cvt_pk_bf16_f32 v110, v12, v13
Mvaa 72,100,4
buffer_store_dwordx4 a[184:187], v5, s[4:7], s78 offen sc1
Mvaa 72,104,16
RD 84,6,5120
v_add_f32 v124, v124, v13
Mvaa 72,108,20
v_exp_f32 v14, v94
Nvaa 76,96,32,116
RD 88,6,6144
v_add_f32 v125, v125, v14
Mvaa 76,100,36
buffer_load_dwordx4 v2, s[4:7], s31 offen offset:2048 sc1 lds
Mvaa 76,104,48
s_waitcnt lgkmcnt(7)
RD 92,6,7168
v_add_f32 v122, v122, v123
Mvaa 76,108,52
v_readlane_b32 s32, v3, s29
Mvaa 76,112,40
RD 96,6,8192
Mvaa 76,116,44
v_exp_f32 v15, v95
Mvaa 76,120,56
RD 100,6,9216
v_cvt_pk_bf16_f32 v111, v14, v15
Mvaa 76,124,60
v_add_f32 v125, v125, v15
v_add_f32 v124, v124, v125
Mvaa 72,112,8
RD 104,6,10240
v_max_f32 v26, v122, v124
Mvaa 72,116,12
buffer_load_dwordx4 v2, s[4:7], s31 offen offset:3072 sc1 lds
Mvaa 72,120,24
s_waitcnt lgkmcnt(7)
RD 108,6,11264
v_cmp_nge_f32 vcc, 0x53800000, v26
Mvaa 72,124,28
s_mov_b32 m0, s30
s_cbranch_vccnz L_dorare_pa4
L_norare_pa4:
Mvav 128,64,104
RD 112,6,12288
v_add_f32 v120, v120, v122
Mvav 132,64,108
v_exp_f32 v12, v64
Mvav 136,68,104
RD 116,6,13312
v_add_f32 v121, v121, v124
Mvav 140,68,108
v_exp_f32 v13, v65
Mvav 144,72,104
RD 120,6,14336
v_cvt_pk_bf16_f32 v96, v12, v13
Mvav 148,72,108
buffer_load_dwordx4 v2, s[4:7], s32 offen offset:0 sc1 lds
Mvav 152,76,104
s_waitcnt lgkmcnt(7)
RD 124,6,15360
v_add_f32 v122, v12, v13
Mvav 156,76,108
v_exp_f32 v14, v66
Mvav 160,80,104
s_add_u32 s78, s68, 15360
RD 64,6,16384
Mvav 164,80,108
buffer_store_dwordx4 a[188:191], v5, s[4:7], s78 offen sc1
Mvav 168,84,104
RD 68,6,17408
Mvav 172,84,108
v_exp_f32 v15, v67
Mvav 176,88,104
RD 72,6,18432
v_cvt_pk_bf16_f32 v97, v14, v15
Mvav 180,88,108
buffer_load_dwordx4 v2, s[4:7], s32 offen offset:1024 sc1 lds
Mvav 184,92,104
s_waitcnt lgkmcnt(7)
RD 76,6,19456
v_add_f32 v123, v14, v15
Mvav 188,92,108
v_exp_f32 v16, v68
Mvav 192,96,104
RD 80,6,20480
Mvav 196,96,108
v_exp_f32 v17, v69
Mvav 200,100,104
RD 84,6,21504
v_cvt_pk_bf16_f32 v100, v16, v17
s_branch LOP23
LP23:
s_setpc_b64 s[48:49]
LOP23:
Mvav 204,100,108
v_exp_f32 v18, v70
Mvav 208,104,104
RD 88,6,22528
v_add_f32 v124, v16, v17
Mvav 212,104,108
buffer_load_dwordx4 v2, s[4:7], s32 offen offset:2048 sc1 lds
Mvav 216,108,104
s_waitcnt lgkmcnt(7)
RD 92,6,23552
Mvav 220,108,108
v_exp_f32 v19, v71
Mvav 224,112,104
s_add_u32 s78, s68, 16384
RD 96,6,24576
v_cvt_pk_bf16_f32 v101, v18, v19
Mvav 228,112,108
buffer_store_dwordx4 a[192:195], v5, s[4:7], s78 offen sc1
Mvav 232,116,104
RD 100,6,25600
v_add_f32 v125, v18, v19
Mvav 236,116,108
v_exp_f32 v20, v72
Mvav 240,120,104
RD 104,6,26624
v_add_f32 v122, v122, v20
Mvav 244,120,108
buffer_load_dwordx4 v2, s[4:7], s32 offen offset:3072 sc1 lds
Mvav 248,124,104
s_waitcnt lgkmcnt(7)
RD 108,6,27648
Mvav 252,124,108
s_add_u32 m0, s30, 16384
v_readlane_b32 s31, v4, s29
Nvaa 80,64,0,112
RD 112,6,28672
Mvaa 80,68,4
v_exp_f32 v21, v73
Mvaa 80,72,16
s_add_u32 s30, s30, s36
RD 116,6,29696
v_cvt_pk_bf16_f32 v98, v20, v21
Mvaa 80,76,20
v_exp_f32 v22, v74
Nvaa 84,64,32,116
s_cmp_ge_u32 s30, 131072
RD 120,6,30720
v_add_f32 v122, v122, v21
Mvaa 84,68,36
buffer_load_dwordx4 v2, s[4:7], s31 offen offset:0 sc1 lds
Mvaa 84,72,48
s_waitcnt vmcnt(29) lgkmcnt(7)
s_cselect_b32 s36, s33, s34
RD 124,6,31744
Mvaa 84,76,52
s_barrier
v_add_u32 v6, s36, v6
v_add_f32 v123, v123, v22
Mvaa 84,80,40
RD 64,6,0
Mvaa 84,84,44
v_exp_f32 v23, v75
Mvaa 84,88,56
RD 68,6,1024
v_cvt_pk_bf16_f32 v99, v22, v23
Mvaa 84,92,60
v_exp_f32 v12, v76
Mvaa 80,80,8
s_add_u32 s29, s29, 1
RD 72,6,2048
v_add_f32 v123, v123, v23
Mvaa 80,84,12
buffer_load_dwordx4 v2, s[4:7], s31 offen offset:1024 sc1 lds
Mvaa 80,88,24
s_waitcnt lgkmcnt(7)
RD 76,6,3072
v_add_f32 v124, v124, v12
Mvaa 80,92,28
v_exp_f32 v13, v77
Nvaa 88,96,0,112
s_add_u32 s78, s68, 17408
RD 80,6,4096
v_cvt_pk_bf16_f32 v102, v12, v13
Mvaa 88,100,4
buffer_store_dwordx4 a[196:199], v5, s[4:7], s78 offen sc1
Mvaa 88,104,16
RD 84,6,5120
v_add_f32 v124, v124, v13
Mvaa 88,108,20
v_exp_f32 v14, v78
Nvaa 92,96,32,116
RD 88,6,6144
v_add_f32 v125, v125, v14
Mvaa 92,100,36
buffer_load_dwordx4 v2, s[4:7], s31 offen offset:2048 sc1 lds
Mvaa 92,104,48
s_waitcnt lgkmcnt(7)
RD 92,6,7168
v_add_f32 v122, v122, v123
Mvaa 92,108,52
v_readlane_b32 s32, v3, s29
Mvaa 92,112,40
RD 96,6,8192
Mvaa 92,116,44
v_exp_f32 v15, v79
Mvaa 92,120,56
RD 100,6,9216
v_cvt_pk_bf16_f32 v103, v14, v15
Mvaa 92,124,60
v_add_f32 v125, v125, v15
v_add_f32 v124, v124, v125
Mvaa 88,112,8
RD 104,6,10240
v_max_f32 v26, v122, v124
Mvaa 88,116,12
buffer_load_dwordx4 v2, s[4:7], s31 offen offset:3072 sc1 lds
Mvaa 88,120,24
s_waitcnt lgkmcnt(7)
RD 108,6,11264
v_cmp_nge_f32 vcc, 0x53800000, v26
Mvaa 88,124,28
s_mov_b32 m0, s30
s_cbranch_vccnz L_dorare_pa5
L_norare_pa5:
Mvav 128,64,96
RD 112,6,12288
v_add_f32 v120, v120, v122
Mvav 132,64,100
v_exp_f32 v12, v80
Mvav 136,68,96
RD 116,6,13312
v_add_f32 v121, v121, v124
Mvav 140,68,100
v_exp_f32 v13, v81
Mvav 144,72,96
RD 120,6,14336
v_cvt_pk_bf16_f32 v104, v12, v13
Mvav 148,72,100
buffer_load_dwordx4 v2, s[4:7], s32 offen offset:0 sc1 lds
Mvav 152,76,96
s_waitcnt lgkmcnt(7)
RD 124,6,15360
v_add_f32 v122, v12, v13
Mvav 156,76,100
v_exp_f32 v14, v82
Mvav 160,80,96
s_add_u32 s78, s68, 18432
RD 64,6,16384
Mvav 164,80,100
buffer_store_dwordx4 a[200:203], v5, s[4:7], s78 offen sc1
Mvav 168,84,96
RD 68,6,17408
Mvav 172,84,100
v_exp_f32 v15, v83
Mvav 176,88,96
RD 72,6,18432
v_cvt_pk_bf16_f32 v105, v14, v15
Mvav 180,88,100
buffer_load_dwordx4 v2, s[4:7], s32 offen offset:1024 sc1 lds
Mvav 184,92,96
s_waitcnt lgkmcnt(7)
RD 76,6,19456
v_add_f32 v123, v14, v15
Mvav 188,92,100
v_exp_f32 v16, v84
Mvav 192,96,96
RD 80,6,20480
Mvav 196,96,100
v_exp_f32 v17, v85
Mvav 200,100,96
RD 84,6,21504
v_cvt_pk_bf16_f32 v108, v16, v17
Mvav 204,100,100
v_exp_f32 v18, v86
Mvav 208,104,96
RD 88,6,22528
v_add_f32 v124, v16, v17
Mvav 212,104,100
buffer_load_dwordx4 v2, s[4:7], s32 offen offset:2048 sc1 lds
Mvav 216,108,96
s_waitcnt lgkmcnt(7)
RD 92,6,23552
Mvav 220,108,100
v_exp_f32 v19, v87
Mvav 224,112,96
s_add_u32 s78, s68, 19456
RD 96,6,24576
v_cvt_pk_bf16_f32 v109, v18, v19
Mvav 228,112,100
buffer_store_dwordx4 a[204:207], v5, s[4:7], s78 offen sc1
Mvav 232,116,96
RD 100,6,25600
v_add_f32 v125, v18, v19
Mvav 236,116,100
v_exp_f32 v20, v88
Mvav 240,120,96
RD 104,6,26624
v_add_f32 v122, v122, v20
Mvav 244,120,100
buffer_load_dwordx4 v2, s[4:7], s32 offen offset:3072 sc1 lds
Mvav 248,124,96
s_waitcnt lgkmcnt(7)
RD 108,6,27648
Mvav 252,124,100
s_add_u32 m0, s30, 16384
v_readlane_b32 s31, v4, s29
Nvaa 64,64,0,112
RD 112,6,28672
Mvaa 64,68,4
v_exp_f32 v21, v89
Mvaa 64,72,16
s_add_u32 s30, s30, s36
RD 116,6,29696
v_cvt_pk_bf16_f32 v106, v20, v21
Mvaa 64,76,20
v_exp_f32 v22, v90
Nvaa 68,64,32,116
s_cmp_ge_u32 s30, 131072
RD 120,6,30720
v_add_f32 v122, v122, v21
Mvaa 68,68,36
buffer_load_dwordx4 v2, s[4:7], s31 offen offset:0 sc1 lds
Mvaa 68,72,48
s_waitcnt vmcnt(29) lgkmcnt(7)
s_cselect_b32 s36, s33, s34
RD 124,6,31744
Mvaa 68,76,52
s_barrier
v_add_u32 v6, s36, v6
v_add_f32 v123, v123, v22
Mvaa 68,80,40
RD 64,6,0
Mvaa 68,84,44
v_exp_f32 v23, v91
Mvaa 68,88,56
RD 68,6,1024
v_cvt_pk_bf16_f32 v107, v22, v23
Mvaa 68,92,60
v_exp_f32 v12, v92
Mvaa 64,80,8
s_add_u32 s29, s29, 1
RD 72,6,2048
v_add_f32 v123, v123, v23
Mvaa 64,84,12
buffer_load_dwordx4 v2, s[4:7], s31 offen offset:1024 sc1 lds
Mvaa 64,88,24
s_waitcnt lgkmcnt(7)
RD 76,6,3072
v_add_f32 v124, v124, v12
Mvaa 64,92,28
v_exp_f32 v13, v93
Nvaa 72,96,0,112
s_add_u32 s78, s68, 20480
RD 80,6,4096
v_cvt_pk_bf16_f32 v110, v12, v13
Mvaa 72,100,4
buffer_store_dwordx4 a[208:211], v5, s[4:7], s78 offen sc1
Mvaa 72,104,16
RD 84,6,5120
v_add_f32 v124, v124, v13
Mvaa 72,108,20
v_exp_f32 v14, v94
Nvaa 76,96,32,116
RD 88,6,6144
v_add_f32 v125, v125, v14
Mvaa 76,100,36
buffer_load_dwordx4 v2, s[4:7], s31 offen offset:2048 sc1 lds
Mvaa 76,104,48
s_waitcnt lgkmcnt(7)
RD 92,6,7168
v_add_f32 v122, v122, v123
Mvaa 76,108,52
v_readlane_b32 s32, v3, s29
Mvaa 76,112,40
RD 96,6,8192
Mvaa 76,116,44
v_exp_f32 v15, v95
Mvaa 76,120,56
RD 100,6,9216
v_cvt_pk_bf16_f32 v111, v14, v15
Mvaa 76,124,60
v_add_f32 v125, v125, v15
v_add_f32 v124, v124, v125
Mvaa 72,112,8
RD 104,6,10240
v_max_f32 v26, v122, v124
Mvaa 72,116,12
buffer_load_dwordx4 v2, s[4:7], s31 offen offset:3072 sc1 lds
Mvaa 72,120,24
s_waitcnt lgkmcnt(7)
RD 108,6,11264
v_cmp_nge_f32 vcc, 0x53800000, v26
Mvaa 72,124,28
s_mov_b32 m0, s30
s_cbranch_vccnz L_dorare_pa6
L_norare_pa6:
Mvav 128,64,104
RD 112,6,12288
v_add_f32 v120, v120, v122
Mvav 132,64,108
v_exp_f32 v12, v64
Mvav 136,68,104
RD 116,6,13312
v_add_f32 v121, v121, v124
Mvav 140,68,108
v_exp_f32 v13, v65
Mvav 144,72,104
RD 120,6,14336
v_cvt_pk_bf16_f32 v96, v12, v13
Mvav 148,72,108
buffer_load_dwordx4 v2, s[4:7], s32 offen offset:0 sc1 lds
Mvav 152,76,104
s_waitcnt lgkmcnt(7)
RD 124,6,15360
v_add_f32 v122, v12, v13
Mvav 156,76,108
v_exp_f32 v14, v66
Mvav 160,80,104
s_add_u32 s78, s68, 21504
RD 64,6,16384
Mvav 164,80,108
buffer_store_dwordx4 a[212:215], v5, s[4:7], s78 offen sc1
Mvav 168,84,104
RD 68,6,17408
Mvav 172,84,108
v_exp_f32 v15, v67
Mvav 176,88,104
RD 72,6,18432
v_cvt_pk_bf16_f32 v97, v14, v15
Mvav 180,88,108
buffer_load_dwordx4 v2, s[4:7], s32 offen offset:1024 sc1 lds
Mvav 184,92,104
s_waitcnt lgkmcnt(7)
RD 76,6,19456
v_add_f32 v123, v14, v15
Mvav 188,92,108
v_exp_f32 v16, v68
Mvav 192,96,104
RD 80,6,20480
Mvav 196,96,108
v_exp_f32 v17, v69
Mvav 200,100,104
RD 84,6,21504
v_cvt_pk_bf16_f32 v100, v16, v17
Mvav 204,100,108
v_exp_f32 v18, v70
Mvav 208,104,104
RD 88,6,22528
v_add_f32 v124, v16, v17
Mvav 212,104,108
buffer_load_dwordx4 v2, s[4:7], s32 offen offset:2048 sc1 lds
Mvav 216,108,104
s_waitcnt lgkmcnt(7)
RD 92,6,23552
Mvav 220,108,108
v_exp_f32 v19, v71
Mvav 224,112,104
s_add_u32 s78, s68, 22528
RD 96,6,24576
v_cvt_pk_bf16_f32 v101, v18, v19
Mvav 228,112,108
buffer_store_dwordx4 a[216:219], v5, s[4:7], s78 offen sc1
Mvav 232,116,104
RD 100,6,25600
v_add_f32 v125, v18, v19
Mvav 236,116,108
v_exp_f32 v20, v72
Mvav 240,120,104
RD 104,6,26624
v_add_f32 v122, v122, v20
Mvav 244,120,108
buffer_load_dwordx4 v2, s[4:7], s32 offen offset:3072 sc1 lds
Mvav 248,124,104
s_waitcnt lgkmcnt(7)
RD 108,6,27648
Mvav 252,124,108
s_add_u32 m0, s30, 16384
v_readlane_b32 s31, v4, s29
Nvaa 80,64,0,112
RD 112,6,28672
Mvaa 80,68,4
v_exp_f32 v21, v73
Mvaa 80,72,16
s_add_u32 s30, s30, s36
RD 116,6,29696
v_cvt_pk_bf16_f32 v98, v20, v21
Mvaa 80,76,20
v_exp_f32 v22, v74
Nvaa 84,64,32,116
s_cmp_ge_u32 s30, 131072
RD 120,6,30720
v_add_f32 v122, v122, v21
Mvaa 84,68,36
buffer_load_dwordx4 v2, s[4:7], s31 offen offset:0 sc1 lds
Mvaa 84,72,48
s_waitcnt vmcnt(29) lgkmcnt(7)
s_cselect_b32 s36, s33, s34
RD 124,6,31744
Mvaa 84,76,52
s_barrier
v_add_u32 v6, s36, v6
v_add_f32 v123, v123, v22
Mvaa 84,80,40
RD 64,6,0
Mvaa 84,84,44
v_exp_f32 v23, v75
Mvaa 84,88,56
RD 68,6,1024
v_cvt_pk_bf16_f32 v99, v22, v23
Mvaa 84,92,60
v_exp_f32 v12, v76
Mvaa 80,80,8
s_add_u32 s29, s29, 1
RD 72,6,2048
v_add_f32 v123, v123, v23
Mvaa 80,84,12
buffer_load_dwordx4 v2, s[4:7], s31 offen offset:1024 sc1 lds
Mvaa 80,88,24
s_waitcnt lgkmcnt(7)
RD 76,6,3072
v_add_f32 v124, v124, v12
Mvaa 80,92,28
v_exp_f32 v13, v77
Nvaa 88,96,0,112
s_add_u32 s78, s68, 23552
RD 80,6,4096
v_cvt_pk_bf16_f32 v102, v12, v13
Mvaa 88,100,4
buffer_store_dwordx4 a[220:223], v5, s[4:7], s78 offen sc1
Mvaa 88,104,16
RD 84,6,5120
v_add_f32 v124, v124, v13
Mvaa 88,108,20
v_exp_f32 v14, v78
Nvaa 92,96,32,116
RD 88,6,6144
v_add_f32 v125, v125, v14
Mvaa 92,100,36
buffer_load_dwordx4 v2, s[4:7], s31 offen offset:2048 sc1 lds
Mvaa 92,104,48
s_waitcnt lgkmcnt(7)
RD 92,6,7168
v_add_f32 v122, v122, v123
Mvaa 92,108,52
v_readlane_b32 s32, v3, s29
Mvaa 92,112,40
RD 96,6,8192
Mvaa 92,116,44
v_exp_f32 v15, v79
Mvaa 92,120,56
RD 100,6,9216
v_cvt_pk_bf16_f32 v103, v14, v15
Mvaa 92,124,60
v_add_f32 v125, v125, v15
v_add_f32 v124, v124, v125
Mvaa 88,112,8
RD 104,6,10240
v_max_f32 v26, v122, v124
Mvaa 88,116,12
buffer_load_dwordx4 v2, s[4:7], s31 offen offset:3072 sc1 lds
Mvaa 88,120,24
s_waitcnt lgkmcnt(7)
RD 108,6,11264
v_cmp_nge_f32 vcc, 0x53800000, v26
Mvaa 88,124,28
s_mov_b32 m0, s30
s_cbranch_vccnz L_dorare_pa7
L_norare_pa7:
Mvav 128,64,96
RD 112,6,12288
v_add_f32 v120, v120, v122
Mvav 132,64,100
v_exp_f32 v12, v80
Mvav 136,68,96
RD 116,6,13312
v_add_f32 v121, v121, v124
Mvav 140,68,100
v_exp_f32 v13, v81
Mvav 144,72,96
RD 120,6,14336
v_cvt_pk_bf16_f32 v104, v12, v13
Mvav 148,72,100
buffer_load_dwordx4 v2, s[4:7], s32 offen offset:0 sc1 lds
Mvav 152,76,96
s_waitcnt lgkmcnt(7)
RD 124,6,15360
v_add_f32 v122, v12, v13
Mvav 156,76,100
v_exp_f32 v14, v82
Mvav 160,80,96
RD 64,6,16384
Mvav 164,80,100
v_exp_f32 v15, v83
Mvav 168,84,96
RD 68,6,17408
v_cvt_pk_bf16_f32 v105, v14, v15
Mvav 172,84,100
v_exp_f32 v16, v84
Mvav 176,88,96
RD 72,6,18432
v_add_f32 v123, v14, v15
Mvav 180,88,100
buffer_load_dwordx4 v2, s[4:7], s32 offen offset:1024 sc1 lds
Mvav 184,92,96
s_waitcnt lgkmcnt(7)
RD 76,6,19456
Mvav 188,92,100
v_exp_f32 v17, v85
Mvav 192,96,96
RD 80,6,20480
v_cvt_pk_bf16_f32 v108, v16, v17
Mvav 196,96,100
v_exp_f32 v18, v86
Mvav 200,100,96
RD 84,6,21504
v_add_f32 v124, v16, v17
Mvav 204,100,100
v_exp_f32 v19, v87
Mvav 208,104,96
RD 88,6,22528
v_cvt_pk_bf16_f32 v109, v18, v19
Mvav 212,104,100
buffer_load_dwordx4 v2, s[4:7], s32 offen offset:2048 sc1 lds
Mvav 216,108,96
s_waitcnt lgkmcnt(7)
RD 92,6,23552
v_add_f32 v125, v18, v19
Mvav 220,108,100
v_exp_f32 v20, v88
Mvav 224,112,96
RD 96,6,24576
v_add_f32 v122, v122, v20
Mvav 228,112,100
v_exp_f32 v21, v89
Mvav 232,116,96
RD 100,6,25600
v_cvt_pk_bf16_f32 v106, v20, v21
Mvav 236,116,100
v_exp_f32 v22, v90
Mvav 240,120,96
RD 104,6,26624
v_add_f32 v122, v122, v21
Mvav 244,120,100
buffer_load_dwordx4 v2, s[4:7], s32 offen offset:3072 sc1 lds
Mvav 248,124,96
s_waitcnt lgkmcnt(7)
RD 108,6,27648
v_add_f32 v123, v123, v22
Mvav 252,124,100
s_add_u32 m0, s30, 16384
v_readlane_b32 s31, v4, s29
Nvaa 64,64,0,112
RD 112,6,28672
Mvaa 64,68,4
v_exp_f32 v23, v91
Mvaa 64,72,16
s_add_u32 s30, s30, s36
RD 116,6,29696
v_cvt_pk_bf16_f32 v107, v22, v23
Mvaa 64,76,20
v_exp_f32 v12, v92
Nvaa 68,64,32,116
s_cmp_ge_u32 s30, 131072
RD 120,6,30720
v_add_f32 v123, v123, v23
Mvaa 68,68,36
buffer_load_dwordx4 v2, s[4:7], s31 offen offset:0 sc1 lds
Mvaa 68,72,48
s_waitcnt vmcnt(27) lgkmcnt(7)
s_cselect_b32 s36, s33, s34
RD 124,6,31744
Mvaa 68,76,52
s_barrier
v_add_u32 v6, s36, v6
v_add_f32 v124, v124, v12
Mvaa 68,80,40
RD 64,6,0
v_add_f32 v122, v122, v123
Mvaa 68,84,44
v_exp_f32 v13, v93
Mvaa 68,88,56
RD 68,6,1024
v_cvt_pk_bf16_f32 v110, v12, v13
Mvaa 68,92,60
v_exp_f32 v14, v94
Mvaa 64,80,8
s_add_u32 s29, s29, 1
RD 72,6,2048
v_add_f32 v124, v124, v13
Mvaa 64,84,12
buffer_load_dwordx4 v2, s[4:7], s31 offen offset:1024 sc1 lds
Mvaa 64,88,24
s_waitcnt lgkmcnt(7)
RD 76,6,3072
v_add_f32 v125, v125, v14
Mvaa 64,92,28
v_exp_f32 v15, v95
Nvaa 72,96,0,112
RD 80,6,4096
v_cvt_pk_bf16_f32 v111, v14, v15
s_branch LOP24
LP24:
s_setpc_b64 s[48:49]
LOP24:
Mvaa 72,100,4
v_add_f32 v125, v125, v15
v_add_f32 v124, v124, v125
Mvaa 72,104,16
RD 84,6,5120
v_max_f32 v26, v122, v124
Mvaa 72,108,20
v_cmp_nge_f32 vcc, 0x53800000, v26
Nvaa 76,96,32,116
RD 88,6,6144
Mvaa 76,100,36
buffer_load_dwordx4 v2, s[4:7], s31 offen offset:2048 sc1 lds
Mvaa 76,104,48
s_waitcnt lgkmcnt(7)
RD 92,6,7168
Mvaa 76,108,52
v_readlane_b32 s32, v3, s29
Mvaa 76,112,40
RD 96,6,8192
Mvaa 76,116,44
Mvaa 76,120,56
RD 100,6,9216
Mvaa 76,124,60
Mvaa 72,112,8
RD 104,6,10240
Mvaa 72,116,12
buffer_load_dwordx4 v2, s[4:7], s31 offen offset:3072 sc1 lds
Mvaa 72,120,24
s_waitcnt lgkmcnt(7)
RD 108,6,11264
Mvaa 72,124,28
s_mov_b32 m0, s30
s_cbranch_vccnz L_dorare_pa8
L_norare_pa8:
Mvav 128,64,104
RD 112,6,12288
v_add_f32 v120, v120, v122
Mvav 132,64,108
v_exp_f32 v12, v64
Mvav 136,68,104
RD 116,6,13312
v_add_f32 v121, v121, v124
Mvav 140,68,108
v_exp_f32 v13, v65
Mvav 144,72,104
s_sub_u32 s43, s43, 5
RD 120,6,14336
v_cvt_pk_bf16_f32 v96, v12, v13
Mvav 148,72,108
buffer_load_dwordx4 v2, s[4:7], s32 offen offset:0 sc1 lds
Mvav 152,76,104
s_waitcnt lgkmcnt(7)
RD 124,6,15360
v_add_f32 v122, v12, v13
Mvav 156,76,108
v_exp_f32 v14, v66
Mvav 160,80,104
RD 64,6,16384
Mvav 164,80,108
v_exp_f32 v15, v67
Mvav 168,84,104
RD 68,6,17408
v_cvt_pk_bf16_f32 v97, v14, v15
Mvav 172,84,108
v_exp_f32 v16, v68
Mvav 176,88,104
RD 72,6,18432
v_add_f32 v123, v14, v15
Mvav 180,88,108
buffer_load_dwordx4 v2, s[4:7], s32 offen offset:1024 sc1 lds
Mvav 184,92,104
s_waitcnt lgkmcnt(7)
RD 76,6,19456
Mvav 188,92,108
v_exp_f32 v17, v69
Mvav 192,96,104
RD 80,6,20480
v_cvt_pk_bf16_f32 v100, v16, v17
Mvav 196,96,108
v_exp_f32 v18, v70
Mvav 200,100,104
RD 84,6,21504
v_add_f32 v124, v16, v17
Mvav 204,100,108
v_exp_f32 v19, v71
Mvav 208,104,104
RD 88,6,22528
v_cvt_pk_bf16_f32 v101, v18, v19
Mvav 212,104,108
buffer_load_dwordx4 v2, s[4:7], s32 offen offset:2048 sc1 lds
Mvav 216,108,104
s_waitcnt lgkmcnt(7)
RD 92,6,23552
v_add_f32 v125, v18, v19
Mvav 220,108,108
v_exp_f32 v20, v72
Mvav 224,112,104
RD 96,6,24576
v_add_f32 v122, v122, v20
Mvav 228,112,108
v_exp_f32 v21, v73
Mvav 232,116,104
RD 100,6,25600
v_cvt_pk_bf16_f32 v98, v20, v21
Mvav 236,116,108
v_exp_f32 v22, v74
Mvav 240,120,104
RD 104,6,26624
v_add_f32 v122, v122, v21
Mvav 244,120,108
buffer_load_dwordx4 v2, s[4:7], s32 offen offset:3072 sc1 lds
Mvav 248,124,104
s_waitcnt lgkmcnt(7)
RD 108,6,27648
v_add_f32 v123, v123, v22
Mvav 252,124,108
s_add_u32 m0, s30, 16384
v_readlane_b32 s31, v4, s29
Nvaa 80,64,0,112
RD 112,6,28672
Mvaa 80,68,4
v_exp_f32 v23, v75
Mvaa 80,72,16
s_add_u32 s30, s30, s36
RD 116,6,29696
v_cvt_pk_bf16_f32 v99, v22, v23
Mvaa 80,76,20
v_exp_f32 v12, v76
Nvaa 84,64,32,116
s_cmp_ge_u32 s30, 131072
RD 120,6,30720
v_add_f32 v123, v123, v23
Mvaa 84,68,36
buffer_load_dwordx4 v2, s[4:7], s31 offen offset:0 sc1 lds
Mvaa 84,72,48
s_waitcnt vmcnt(24) lgkmcnt(7)
s_cselect_b32 s36, s33, s34
RD 124,6,31744
Mvaa 84,76,52
s_barrier
v_add_u32 v6, s36, v6
v_add_f32 v124, v124, v12
Mvaa 84,80,40
RD 64,6,0
v_add_f32 v122, v122, v123
Mvaa 84,84,44
v_exp_f32 v13, v77
Mvaa 84,88,56
RD 68,6,1024
v_cvt_pk_bf16_f32 v102, v12, v13
Mvaa 84,92,60
v_exp_f32 v14, v78
Mvaa 80,80,8
s_add_u32 s29, s29, 1
RD 72,6,2048
v_add_f32 v124, v124, v13
Mvaa 80,84,12
buffer_load_dwordx4 v2, s[4:7], s31 offen offset:1024 sc1 lds
Mvaa 80,88,24
s_waitcnt lgkmcnt(7)
RD 76,6,3072
v_add_f32 v125, v125, v14
Mvaa 80,92,28
v_exp_f32 v15, v79
Nvaa 88,96,0,112
RD 80,6,4096
v_cvt_pk_bf16_f32 v103, v14, v15
Mvaa 88,100,4
v_add_f32 v125, v125, v15
v_add_f32 v124, v124, v125
Mvaa 88,104,16
RD 84,6,5120
v_max_f32 v26, v122, v124
Mvaa 88,108,20
v_cmp_nge_f32 vcc, 0x53800000, v26
Nvaa 92,96,32,116
RD 88,6,6144
Mvaa 92,100,36
buffer_load_dwordx4 v2, s[4:7], s31 offen offset:2048 sc1 lds
Mvaa 92,104,48
s_waitcnt lgkmcnt(7)
RD 92,6,7168
Mvaa 92,108,52
v_readlane_b32 s32, v3, s29
Mvaa 92,112,40
s_waitcnt vmcnt(17)
RD 96,6,8192
Mvaa 92,116,44
buffer_store_dword v9, v8, s[4:7], s73 offen sc1
Mvaa 92,120,56
RD 100,6,9216
Mvaa 92,124,60
Mvaa 88,112,8
RD 104,6,10240
Mvaa 88,116,12
buffer_load_dwordx4 v2, s[4:7], s31 offen offset:3072 sc1 lds
Mvaa 88,120,24
s_waitcnt lgkmcnt(7)
RD 108,6,11264
Mvaa 88,124,28
s_mov_b32 m0, s30
s_cbranch_vccnz L_dorare_pa9
L_norare_pa9:
s_branch L_steady0
LP25:
s_setpc_b64 s[48:49]
L_P1B:
Zvaa 128,64,128
RD 112,6,12288
Mvaa 128,68,136
Zvaa 132,68,140
RD 116,6,13312
Mvaa 132,64,132
Zvaa 136,72,128
RD 120,6,14336
Mvaa 136,76,136
buffer_load_dwordx4 v2, s[4:7], s32 offen offset:0 sc1 lds
Zvaa 140,76,140
s_waitcnt lgkmcnt(7)
RD 124,6,15360
Mvaa 140,72,132
Zvaa 144,80,128
RD 64,6,16384
Mvaa 144,84,136
Zvaa 148,84,140
RD 68,6,17408
Mvaa 148,80,132
Zvaa 152,88,128
RD 72,6,18432
Mvaa 152,92,136
buffer_load_dwordx4 v2, s[4:7], s32 offen offset:1024 sc1 lds
Zvaa 156,92,140
s_waitcnt lgkmcnt(7)
RD 76,6,19456
Mvaa 156,88,132
Zvaa 160,96,128
RD 80,6,20480
Mvaa 160,100,136
Zvaa 164,100,140
RD 84,6,21504
Mvaa 164,96,132
Zvaa 168,104,128
RD 88,6,22528
Mvaa 168,108,136
buffer_load_dwordx4 v2, s[4:7], s32 offen offset:2048 sc1 lds
Zvaa 172,108,140
s_waitcnt lgkmcnt(7)
RD 92,6,23552
Mvaa 172,104,132
Zvaa 176,112,128
RD 96,6,24576
Mvaa 176,116,136
Zvaa 180,116,140
RD 100,6,25600
Mvaa 180,112,132
Zvaa 184,120,128
RD 104,6,26624
Mvaa 184,124,136
buffer_load_dwordx4 v2, s[4:7], s32 offen offset:3072 sc1 lds
Zvaa 188,124,140
s_waitcnt lgkmcnt(7)
RD 108,6,27648
Mvaa 188,120,132
s_add_u32 m0, s30, 16384
v_readlane_b32 s31, v4, s29
Zvaa 192,64,128
RD 112,6,28672
Mvaa 192,68,136
Zvaa 196,68,140
s_add_u32 s30, s30, s36
RD 116,6,29696
Mvaa 196,64,132
Zvaa 200,72,128
s_cmp_ge_u32 s30, 131072
RD 120,6,30720
Mvaa 200,76,136
buffer_load_dwordx4 v2, s[4:7], s31 offen offset:0 sc1 lds
Zvaa 204,76,140
s_waitcnt vmcnt(41) lgkmcnt(7)
s_cselect_b32 s36, s33, s34
RD 124,6,31744
Mvaa 204,72,132
s_barrier
v_add_u32 v6, s36, v6
Zvaa 208,80,128
RD 64,6,0
Mvaa 208,84,136
Zvaa 212,84,140
RD 68,6,1024
Mvaa 212,80,132
Zvaa 216,88,128
s_add_u32 s29, s29, 1
RD 72,6,2048
Mvaa 216,92,136
buffer_load_dwordx4 v2, s[4:7], s31 offen offset:1024 sc1 lds
Zvaa 220,92,140
s_waitcnt lgkmcnt(7)
RD 76,6,3072
Mvaa 220,88,132
Zvaa 224,96,128
RD 80,6,4096
Mvaa 224,100,136
Zvaa 228,100,140
RD 84,6,5120
Mvaa 228,96,132
Zvaa 232,104,128
RD 88,6,6144
Mvaa 232,108,136
buffer_load_dwordx4 v2, s[4:7], s31 offen offset:2048 sc1 lds
Zvaa 236,108,140
s_waitcnt lgkmcnt(7)
RD 92,6,7168
Mvaa 236,104,132
v_readlane_b32 s32, v3, s29
Zvaa 240,112,128
RD 96,6,8192
Mvaa 240,116,136
Zvaa 244,116,140
RD 100,6,9216
Mvaa 244,112,132
Zvaa 248,120,128
RD 104,6,10240
Mvaa 248,124,136
buffer_load_dwordx4 v2, s[4:7], s31 offen offset:3072 sc1 lds
Zvaa 252,124,140
s_waitcnt lgkmcnt(7)
RD 108,6,11264
Mvaa 252,120,132
s_mov_b32 m0, s30
Mvaa 128,64,144
RD 112,6,12288
Mvaa 128,68,152
Mvaa 132,68,156
s_cmp_gt_u32 s41, 34
s_cselect_b32 s77, 34, 2
RD 116,6,13312
Mvaa 132,64,148
Mvaa 136,72,144
RD 120,6,14336
v_and_b32 v12, 4, v1
Mvaa 136,76,152
buffer_load_dwordx4 v2, s[4:7], s32 offen offset:0 sc1 lds
Mvaa 140,76,156
s_waitcnt lgkmcnt(7)
RD 124,6,15360
Mvaa 140,72,148
Mvaa 144,80,144
RD 64,6,16384
v_mul_u32_u24 v12, s77, v12
Mvaa 144,84,152
Mvaa 148,84,156
RD 68,6,17408
v_or_b32 v10, v10, v12
Mvaa 148,80,148
Mvaa 152,88,144
RD 72,6,18432
Mvaa 152,92,152
buffer_load_dwordx4 v2, s[4:7], s32 offen offset:1024 sc1 lds
Mvaa 156,92,156
s_waitcnt lgkmcnt(7)
RD 76,6,19456
Mvaa 156,88,148
Mvaa 160,96,144
RD 80,6,20480
Mvaa 160,100,152
Mvaa 164,100,156
RD 84,6,21504
Mvaa 164,96,148
Mvaa 168,104,144
RD 88,6,22528
Mvaa 168,108,152
buffer_load_dwordx4 v2, s[4:7], s32 offen offset:2048 sc1 lds
Mvaa 172,108,156
s_waitcnt lgkmcnt(7)
RD 92,6,23552
Mvaa 172,104,148
Mvaa 176,112,144
RD 96,6,24576
Mvaa 176,116,152
Mvaa 180,116,156
RD 100,6,25600
Mvaa 180,112,148
Mvaa 184,120,144
RD 104,6,26624
Mvaa 184,124,152
buffer_load_dwordx4 v2, s[4:7], s32 offen offset:3072 sc1 lds
Mvaa 188,124,156
s_waitcnt lgkmcnt(7)
RD 108,6,27648
Mvaa 188,120,148
s_add_u32 m0, s30, 16384
v_readlane_b32 s31, v4, s29
Mvaa 192,64,144
RD 112,6,28672
Mvaa 192,68,152
Mvaa 196,68,156
s_add_u32 s30, s30, s36
RD 116,6,29696
Mvaa 196,64,148
Mvaa 200,72,144
s_cmp_ge_u32 s30, 131072
RD 120,6,30720
Mvaa 200,76,152
buffer_load_dwordx4 v2, s[4:7], s31 offen offset:0 sc1 lds
Mvaa 204,76,156
s_waitcnt vmcnt(41) lgkmcnt(7)
s_cselect_b32 s36, s33, s34
RD 124,6,31744
Mvaa 204,72,148
s_barrier
v_add_u32 v6, s36, v6
Mvaa 208,80,144
RD 64,6,0
Mvaa 208,84,152
Mvaa 212,84,156
RD 68,6,1024
Mvaa 212,80,148
Mvaa 216,88,144
s_add_u32 s29, s29, 1
RD 72,6,2048
Mvaa 216,92,152
buffer_load_dwordx4 v2, s[4:7], s31 offen offset:1024 sc1 lds
Mvaa 220,92,156
s_waitcnt lgkmcnt(7)
RD 76,6,3072
Mvaa 220,88,148
Mvaa 224,96,144
RD 80,6,4096
Mvaa 224,100,152
Mvaa 228,100,156
RD 84,6,5120
Mvaa 228,96,148
Mvaa 232,104,144
RD 88,6,6144
Mvaa 232,108,152
buffer_load_dwordx4 v2, s[4:7], s31 offen offset:2048 sc1 lds
Mvaa 236,108,156
s_waitcnt lgkmcnt(7)
RD 92,6,7168
Mvaa 236,104,148
v_readlane_b32 s32, v3, s29
Mvaa 240,112,144
RD 96,6,8192
Mvaa 240,116,152
Mvaa 244,116,156
RD 100,6,9216
Mvaa 244,112,148
Mvaa 248,120,144
RD 104,6,10240
Mvaa 248,124,152
buffer_load_dwordx4 v2, s[4:7], s31 offen offset:3072 sc1 lds
Mvaa 252,124,156
s_waitcnt lgkmcnt(7)
RD 108,6,11264
Mvaa 252,120,148
s_mov_b32 m0, s30
Mvaa 128,64,160
RD 112,6,12288
Mvaa 128,68,168
Mvaa 132,68,172
RD 116,6,13312
Mvaa 132,64,164
Mvaa 136,72,160
RD 120,6,14336
Mvaa 136,76,168
buffer_load_dwordx4 v2, s[4:7], s32 offen offset:0 sc1 lds
Mvaa 140,76,172
s_waitcnt lgkmcnt(7)
RD 124,6,15360
Mvaa 140,72,164
Mvaa 144,80,160
RD 64,6,16384
Mvaa 144,84,168
Mvaa 148,84,172
RD 68,6,17408
Mvaa 148,80,164
Mvaa 152,88,160
RD 72,6,18432
Mvaa 152,92,168
buffer_load_dwordx4 v2, s[4:7], s32 offen offset:1024 sc1 lds
Mvaa 156,92,172
s_waitcnt lgkmcnt(7)
RD 76,6,19456
Mvaa 156,88,164
Mvaa 160,96,160
RD 80,6,20480
Mvaa 160,100,168
Mvaa 164,100,172
RD 84,6,21504
Mvaa 164,96,164
Mvaa 168,104,160
RD 88,6,22528
Mvaa 168,108,168
buffer_load_dwordx4 v2, s[4:7], s32 offen offset:2048 sc1 lds
Mvaa 172,108,172
s_waitcnt lgkmcnt(7)
RD 92,6,23552
Mvaa 172,104,164
Mvaa 176,112,160
RD 96,6,24576
Mvaa 176,116,168
Mvaa 180,116,172
RD 100,6,25600
Mvaa 180,112,164
Mvaa 184,120,160
RD 104,6,26624
Mvaa 184,124,168
buffer_load_dwordx4 v2, s[4:7], s32 offen offset:3072 sc1 lds
Mvaa 188,124,172
s_waitcnt lgkmcnt(7)
RD 108,6,27648
Mvaa 188,120,164
s_add_u32 m0, s30, 16384
v_readlane_b32 s31, v4, s29
Mvaa 192,64,160
RD 112,6,28672
Mvaa 192,68,168
Mvaa 196,68,172
s_add_u32 s30, s30, s36
RD 116,6,29696
Mvaa 196,64,164
Mvaa 200,72,160
s_cmp_ge_u32 s30, 131072
RD 120,6,30720
Mvaa 200,76,168
buffer_load_dwordx4 v2, s[4:7], s31 offen offset:0 sc1 lds
Mvaa 204,76,172
s_waitcnt vmcnt(29) lgkmcnt(7)
s_cselect_b32 s36, s33, s34
RD 124,6,31744
Mvaa 204,72,164
s_barrier
v_add_u32 v6, s36, v6
Mvaa 208,80,160
RD 64,6,0
Mvaa 208,84,168
Mvaa 212,84,172
RD 68,6,1024
Mvaa 212,80,164
Mvaa 216,88,160
s_add_u32 s29, s29, 1
RD 72,6,2048
Mvaa 216,92,168
buffer_load_dwordx4 v2, s[4:7], s31 offen offset:1024 sc1 lds
Mvaa 220,92,172
s_waitcnt lgkmcnt(7)
RD 76,6,3072
Mvaa 220,88,164
Mvaa 224,96,160
RD 80,6,4096
Mvaa 224,100,168
Mvaa 228,100,172
RD 84,6,5120
Mvaa 228,96,164
Mvaa 232,104,160
RD 88,6,6144
Mvaa 232,108,168
buffer_load_dwordx4 v2, s[4:7], s31 offen offset:2048 sc1 lds
Mvaa 236,108,172
s_waitcnt lgkmcnt(7)
RD 92,6,7168
Mvaa 236,104,164
v_readlane_b32 s32, v3, s29
Mvaa 240,112,160
RD 96,6,8192
Mvaa 240,116,168
Mvaa 244,116,172
s_branch LOP26
LP26:
s_setpc_b64 s[48:49]
LOP26:
RD 100,6,9216
Mvaa 244,112,164
Mvaa 248,120,160
RD 104,6,10240
Mvaa 248,124,168
buffer_load_dwordx4 v2, s[4:7], s31 offen offset:3072 sc1 lds
Mvaa 252,124,172
s_waitcnt lgkmcnt(7)
RD 108,6,11264
Mvaa 252,120,164
s_mov_b32 m0, s30
Mvaa 128,64,176
s_add_u32 s78, s39, 10240
RD 112,6,12288
Mvaa 128,68,184
buffer_load_dwordx4 a[208:211], v5, s[4:7], s78 offen sc1
Mvaa 132,68,188
RD 116,6,13312
Mvaa 132,64,180
Mvaa 136,72,176
s_add_u32 s78, s39, 67584
RD 120,6,14336
Mvaa 136,76,184
buffer_load_dwordx4 a[212:215], v5, s[4:7], s78 offen sc1
Mvaa 140,76,188
s_waitcnt lgkmcnt(7)
RD 124,6,15360
Mvaa 140,72,180
Mvaa 144,80,176
s_add_u32 s78, s39, 11264
RD 64,6,16384
Mvaa 144,84,184
buffer_load_dwordx4 a[216:219], v5, s[4:7], s78 offen sc1
Mvaa 148,84,188
RD 68,6,17408
Mvaa 148,80,180
Mvaa 152,88,176
s_add_u32 s78, s39, 68608
RD 72,6,18432
Mvaa 152,92,184
buffer_load_dwordx4 a[220:223], v5, s[4:7], s78 offen sc1
Mvaa 156,92,188
s_waitcnt lgkmcnt(7)
RD 76,6,19456
Mvaa 156,88,180
Mvaa 160,96,176
RD 80,6,20480
Mvaa 160,100,184
Mvaa 164,100,188
RD 84,6,21504
Mvaa 164,96,180
Mvaa 168,104,176
s_add_u32 s78, s40, 4096
RD 88,6,22528
Mvaa 168,108,184
buffer_load_dwordx4 a[128:131], v5, s[4:7], s78 offen sc1
Mvaa 172,108,188
s_waitcnt lgkmcnt(7)
RD 92,6,23552
Mvaa 172,104,180
Mvaa 176,112,176
s_add_u32 s78, s40, 61440
RD 96,6,24576
Mvaa 176,116,184
buffer_load_dwordx4 a[132:135], v5, s[4:7], s78 offen sc1
Mvaa 180,116,188
RD 100,6,25600
Mvaa 180,112,180
Mvaa 184,120,176
s_add_u32 s78, s39, 12288
RD 104,6,26624
Mvaa 184,124,184
buffer_load_dwordx4 a[224:227], v5, s[4:7], s78 offen sc1
Mvaa 188,124,188
s_waitcnt lgkmcnt(7)
RD 108,6,27648
Mvaa 188,120,180
s_add_u32 m0, s30, 16384
Mvaa 192,64,176
s_add_u32 s78, s39, 69632
RD 112,6,28672
Mvaa 192,68,184
buffer_load_dwordx4 a[228:231], v5, s[4:7], s78 offen sc1
Mvaa 196,68,188
s_add_u32 s30, s30, s36
RD 116,6,29696
Mvaa 196,64,180
Mvaa 200,72,176
s_cmp_ge_u32 s30, 131072
RD 120,6,30720
Mvaa 200,76,184
Mvaa 204,76,188
s_waitcnt vmcnt(24) lgkmcnt(7)
s_cselect_b32 s36, s33, s34
RD 124,6,31744
Mvaa 204,72,180
s_barrier
v_add_u32 v6, s36, v6
Mvaa 208,80,176
RD 64,6,0
Mvaa 208,84,184
Mvaa 212,84,188
RD 68,6,1024
Mvaa 212,80,180
Mvaa 216,88,176
s_add_u32 s29, s29, 1
s_add_u32 s78, s39, 13312
RD 72,6,2048
Mvaa 216,92,184
buffer_load_dwordx4 a[232:235], v5, s[4:7], s78 offen sc1
Mvaa 220,92,188
s_waitcnt lgkmcnt(7)
RD 76,6,3072
Mvaa 220,88,180
Mvaa 224,96,176
s_add_u32 s78, s39, 70656
RD 80,6,4096
Mvaa 224,100,184
buffer_load_dwordx4 a[236:239], v5, s[4:7], s78 offen sc1
Mvaa 228,100,188
RD 84,6,5120
Mvaa 228,96,180
Mvaa 232,104,176
s_add_u32 s78, s40, 5120
RD 88,6,6144
Mvaa 232,108,184
buffer_load_dwordx4 a[136:139], v5, s[4:7], s78 offen sc1
Mvaa 236,108,188
s_waitcnt lgkmcnt(7)
RD 92,6,7168
Mvaa 236,104,180
Mvaa 240,112,176
s_add_u32 s78, s40, 62464
RD 96,6,8192
Mvaa 240,116,184
buffer_load_dwordx4 a[140:143], v5, s[4:7], s78 offen sc1
Mvaa 244,116,188
RD 100,6,9216
Mvaa 244,112,180
Mvaa 248,120,176
RD 104,6,10240
Mvaa 248,124,184
Mvaa 252,124,188
s_waitcnt lgkmcnt(7)
RD 108,6,11264
Mvaa 252,120,180
s_mov_b32 m0, s30
Mvaa 128,64,192
s_add_u32 s78, s40, 6144
RD 112,6,12288
Mvaa 128,68,200
buffer_load_dwordx4 a[144:147], v5, s[4:7], s78 offen sc1
Mvaa 132,68,204
RD 116,6,13312
Mvaa 132,64,196
Mvaa 136,72,192
s_add_u32 s78, s65, 2048
RD 120,6,14336
Mvaa 136,76,200
buffer_store_dwordx4 v[48:51], v5, s[4:7], s78 offen sc1
Mvaa 140,76,204
s_waitcnt lgkmcnt(7)
RD 124,6,15360
Mvaa 140,72,196
Mvaa 144,80,192
s_add_u32 s78, s40, 63488
RD 64,6,16384
Mvaa 144,84,200
buffer_load_dwordx4 a[148:151], v5, s[4:7], s78 offen sc1
Mvaa 148,84,204
RD 68,6,17408
Mvaa 148,80,196
Mvaa 152,88,192
s_add_u32 s78, s40, 7168
RD 72,6,18432
Mvaa 152,92,200
buffer_load_dwordx4 a[152:155], v5, s[4:7], s78 offen sc1
Mvaa 156,92,204
s_waitcnt lgkmcnt(7)
RD 76,6,19456
Mvaa 156,88,196
Mvaa 160,96,192
RD 80,6,20480
Mvaa 160,100,200
Mvaa 164,100,204
RD 84,6,21504
Mvaa 164,96,196
Mvaa 168,104,192
s_add_u32 s78, s65, 3072
RD 88,6,22528
Mvaa 168,108,200
buffer_store_dwordx4 v[52:55], v5, s[4:7], s78 offen sc1
Mvaa 172,108,204
s_waitcnt lgkmcnt(7)
RD 92,6,23552
Mvaa 172,104,196
Mvaa 176,112,192
s_add_u32 s78, s40, 64512
RD 96,6,24576
Mvaa 176,116,200
buffer_load_dwordx4 a[156:159], v5, s[4:7], s78 offen sc1
Mvaa 180,116,204
RD 100,6,25600
Mvaa 180,112,196
Mvaa 184,120,192
s_add_u32 s78, s64, 19456
RD 104,6,26624
Mvaa 184,124,200
buffer_store_dwordx4 v[56:59], v5, s[4:7], s78 offen sc1
Mvaa 188,124,204
s_waitcnt lgkmcnt(7)
RD 108,6,27648
Mvaa 188,120,196
s_add_u32 m0, s30, 16384
Mvaa 192,64,192
s_add_u32 s78, s40, 8192
RD 112,6,28672
Mvaa 192,68,200
buffer_load_dwordx4 a[160:163], v5, s[4:7], s78 offen sc1
Mvaa 196,68,204
s_add_u32 s30, s30, s36
RD 116,6,29696
Mvaa 196,64,196
Mvaa 200,72,192
s_cmp_ge_u32 s30, 131072
RD 120,6,30720
Mvaa 200,76,200
Mvaa 204,76,204
s_waitcnt vmcnt(28) lgkmcnt(7)
s_cselect_b32 s36, s33, s34
RD 124,6,31744
Mvaa 204,72,196
s_barrier
v_add_u32 v6, s36, v6
Mvaa 208,80,192
RD 64,6,0
Mvaa 208,84,200
Mvaa 212,84,204
RD 68,6,1024
Mvaa 212,80,196
Mvaa 216,88,192
s_add_u32 s29, s29, 1
s_add_u32 s78, s64, 20480
RD 72,6,2048
Mvaa 216,92,200
buffer_store_dwordx4 v[60:63], v5, s[4:7], s78 offen sc1
Mvaa 220,92,204
s_waitcnt lgkmcnt(7)
RD 76,6,3072
Mvaa 220,88,196
Mvaa 224,96,192
s_add_u32 s78, s40, 65536
RD 80,6,4096
Mvaa 224,100,200
buffer_load_dwordx4 a[164:167], v5, s[4:7], s78 offen sc1
Mvaa 228,100,204
RD 84,6,5120
Mvaa 228,96,196
Mvaa 232,104,192
s_add_u32 s78, s40, 9216
RD 88,6,6144
Mvaa 232,108,200
buffer_load_dwordx4 a[168:171], v5, s[4:7], s78 offen sc1
Mvaa 236,108,204
s_waitcnt lgkmcnt(7)
RD 92,6,7168
Mvaa 236,104,196
Mvaa 240,112,192
s_add_u32 s78, s65, 17408
RD 96,6,8192
Mvaa 240,116,200
buffer_store_dwordx4 v[64:67], v5, s[4:7], s78 offen sc1
Mvaa 244,116,204
RD 100,6,9216
Mvaa 244,112,196
Mvaa 248,120,192
RD 104,6,10240
Mvaa 248,124,200
Mvaa 252,124,204
s_waitcnt lgkmcnt(7)
s_waitcnt vmcnt(20)
RD 108,6,11264
Mvaa 252,120,196
s_mov_b32 m0, s30
Mvaa 128,64,208
s_add_u32 s78, s40, 66560
RD 112,6,12288
Mvaa 128,68,216
buffer_load_dwordx4 a[172:175], v5, s[4:7], s78 offen sc1
Mvaa 132,68,220
RD 116,6,13312
Mvaa 132,64,212
Mvaa 136,72,208
s_add_u32 s78, s65, 18432
RD 120,6,14336
Mvaa 136,76,216
buffer_store_dwordx4 v[68:71], v5, s[4:7], s78 offen sc1
Mvaa 140,76,220
s_waitcnt lgkmcnt(7)
RD 124,6,15360
Mvaa 140,72,212
Mvaa 144,80,208
s_add_u32 s78, s40, 10240
RD 64,6,16384
Mvaa 144,84,216
buffer_load_dwordx4 a[176:179], v5, s[4:7], s78 offen sc1
Mvaa 148,84,220
RD 68,6,17408
Mvaa 148,80,212
Mvaa 152,88,208
s_add_u32 s78, s40, 67584
RD 72,6,18432
Mvaa 152,92,216
buffer_load_dwordx4 a[180:183], v5, s[4:7], s78 offen sc1
Mvaa 156,92,220
s_waitcnt lgkmcnt(7)
RD 76,6,19456
Mvaa 156,88,212
Mvaa 160,96,208
RD 80,6,20480
Mvaa 160,100,216
Mvaa 164,100,220
RD 84,6,21504
Mvaa 164,96,212
Mvaa 168,104,208
s_add_u32 s78, s65, 19456
RD 88,6,22528
Mvaa 168,108,216
buffer_store_dwordx4 v[72:75], v5, s[4:7], s78 offen sc1
Mvaa 172,108,220
s_waitcnt lgkmcnt(7)
RD 92,6,23552
Mvaa 172,104,212
Mvaa 176,112,208
s_add_u32 s78, s40, 11264
RD 96,6,24576
Mvaa 176,116,216
buffer_load_dwordx4 a[184:187], v5, s[4:7], s78 offen sc1
Mvaa 180,116,220
RD 100,6,25600
Mvaa 180,112,212
Mvaa 184,120,208
s_add_u32 s78, s65, 20480
RD 104,6,26624
Mvaa 184,124,216
buffer_store_dwordx4 v[76:79], v5, s[4:7], s78 offen sc1
Mvaa 188,124,220
s_waitcnt lgkmcnt(7)
s_waitcnt vmcnt(21)
RD 108,6,27648
Mvaa 188,120,212
s_add_u32 m0, s30, 16384
Mvaa 128,64,224
s_add_u32 s78, s40, 68608
RD 112,6,28672
Mvaa 128,68,232
buffer_load_dwordx4 a[188:191], v5, s[4:7], s78 offen sc1
Mvaa 132,68,236
s_add_u32 s30, s30, s36
RD 116,6,29696
Mvaa 132,64,228
Mvaa 136,72,224
s_cmp_ge_u32 s30, 131072
RD 120,6,30720
Mvaa 136,76,232
Mvaa 140,76,236
s_waitcnt vmcnt(32) lgkmcnt(7)
s_cselect_b32 s36, s33, s34
RD 124,6,31744
Mvaa 140,72,228
s_barrier
v_add_u32 v6, s36, v6
Mvaa 144,80,224
RD 64,6,0
Mvaa 144,84,232
Mvaa 148,84,236
RD 68,6,1024
Mvaa 148,80,228
Mvaa 152,88,224
s_add_u32 s29, s29, 1
s_add_u32 s78, s64, 36864
RD 72,6,2048
Mvaa 152,92,232
buffer_store_dwordx4 v[80:83], v5, s[4:7], s78 offen sc1
Mvaa 156,92,236
s_waitcnt lgkmcnt(7)
RD 76,6,3072
Mvaa 156,88,228
Mvaa 160,96,224
s_add_u32 s78, s40, 12288
RD 80,6,4096
Mvaa 160,100,232
buffer_load_dwordx4 a[192:195], v5, s[4:7], s78 offen sc1
Mvaa 164,100,236
RD 84,6,5120
v_cvt_pk_bf16_f32 v28, v128, v136
Mvaa 164,96,228
v_cvt_pk_bf16_f32 v29, v144, v152
v_cvt_pk_bf16_f32 v30, v129, v137
Mvaa 168,104,224
s_add_u32 s78, s40, 69632
RD 88,6,6144
v_cvt_pk_bf16_f32 v31, v145, v153
Mvaa 168,108,232
buffer_load_dwordx4 a[196:199], v5, s[4:7], s78 offen sc1
Mvaa 172,108,236
s_waitcnt lgkmcnt(7)
RD 92,6,7168
v_accvgpr_write_b32 a0, v28
Mvaa 172,104,228
v_accvgpr_write_b32 a1, v29
v_accvgpr_write_b32 a2, v30
Mvaa 176,112,224
s_add_u32 s78, s64, 37888
RD 96,6,8192
v_accvgpr_write_b32 a3, v31
Mvaa 176,116,232
buffer_store_dwordx4 v[84:87], v5, s[4:7], s78 offen sc1
Mvaa 180,116,236
RD 100,6,9216
v_cvt_pk_bf16_f32 v32, v132, v140
Mvaa 180,112,228
v_cvt_pk_bf16_f32 v33, v148, v156
v_cvt_pk_bf16_f32 v34, v133, v141
Mvaa 184,120,224
RD 104,6,10240
v_cvt_pk_bf16_f32 v35, v149, v157
Mvaa 184,124,232
v_accvgpr_write_b32 a32, v32
v_accvgpr_write_b32 a33, v33
Mvaa 188,124,236
s_waitcnt lgkmcnt(7)
RD 108,6,11264
v_accvgpr_write_b32 a34, v34
Mvaa 188,120,228
s_mov_b32 m0, s30
v_accvgpr_write_b32 a35, v35
v_cvt_pk_bf16_f32 v36, v130, v138
s_cmp_eq_u32 s60, 1
s_cbranch_scc0 L_tc
s_bitcmp1_b32 s24, 1
s_cbranch_scc1 LH_C12
s_bitcmp1_b32 s24, 0
s_cbranch_scc1 LA_C12
s_call_b64 s[48:49], LP33
s_branch LR_C12
LA_C12:
s_call_b64 s[48:49], LP34
s_branch LR_C12
LH_C12:
s_bitcmp1_b32 s24, 0
s_cbranch_scc1 LB_C12
s_call_b64 s[48:49], LP30
s_branch LR_C12
LB_C12:
s_call_b64 s[48:49], LP31
LR_C12:
L_tc:
Mvaa 192,64,208
s_add_u32 s78, s66, 0
RD 112,6,12288
v_cvt_pk_bf16_f32 v37, v146, v154
Mvaa 192,68,216
buffer_store_dwordx4 a[0:3], v5, s[4:7], s78 offen sc1
Mvaa 196,68,220
RD 116,6,13312
v_cvt_pk_bf16_f32 v38, v131, v139
Mvaa 196,64,212
v_cvt_pk_bf16_f32 v39, v147, v155
v_accvgpr_write_b32 a4, v36
Mvaa 200,72,208
s_add_u32 s78, s66, 8192
RD 120,6,14336
v_accvgpr_write_b32 a5, v37
Mvaa 200,76,216
buffer_store_dwordx4 a[32:35], v5, s[4:7], s78 offen sc1
Mvaa 204,76,220
s_waitcnt lgkmcnt(7)
RD 124,6,15360
v_accvgpr_write_b32 a6, v38
Mvaa 204,72,212
v_accvgpr_write_b32 a7, v39
v_cvt_pk_bf16_f32 v40, v134, v142
Mvaa 208,80,208
s_add_u32 s78, s40, 13312
RD 64,6,16384
v_cvt_pk_bf16_f32 v41, v150, v158
Mvaa 208,84,216
buffer_load_dwordx4 a[200:203], v5, s[4:7], s78 offen sc1
Mvaa 212,84,220
RD 68,6,17408
v_cvt_pk_bf16_f32 v42, v135, v143
Mvaa 212,80,212
v_cvt_pk_bf16_f32 v43, v151, v159
v_accvgpr_write_b32 a36, v40
Mvaa 216,88,208
s_add_u32 s78, s66, 1024
RD 72,6,18432
v_accvgpr_write_b32 a37, v41
Mvaa 216,92,216
buffer_store_dwordx4 a[4:7], v5, s[4:7], s78 offen sc1
Mvaa 220,92,220
s_waitcnt lgkmcnt(7)
RD 76,6,19456
v_accvgpr_write_b32 a38, v42
Mvaa 220,88,212
v_accvgpr_write_b32 a39, v43
v_cvt_pk_bf16_f32 v28, v160, v168
Mvaa 224,96,208
RD 80,6,20480
v_cvt_pk_bf16_f32 v29, v176, v184
Mvaa 224,100,216
v_cvt_pk_bf16_f32 v30, v161, v169
v_cvt_pk_bf16_f32 v31, v177, v185
Mvaa 228,100,220
RD 84,6,21504
v_accvgpr_write_b32 a8, v28
Mvaa 228,96,212
v_accvgpr_write_b32 a9, v29
v_accvgpr_write_b32 a10, v30
Mvaa 232,104,208
s_add_u32 s78, s66, 9216
RD 88,6,22528
v_accvgpr_write_b32 a11, v31
Mvaa 232,108,216
buffer_store_dwordx4 a[36:39], v5, s[4:7], s78 offen sc1
Mvaa 236,108,220
s_waitcnt lgkmcnt(7)
RD 92,6,23552
v_cvt_pk_bf16_f32 v32, v164, v172
Mvaa 236,104,212
v_cvt_pk_bf16_f32 v33, v180, v188
v_cvt_pk_bf16_f32 v34, v165, v173
Mvaa 240,112,208
s_add_u32 s78, s40, 70656
RD 96,6,24576
v_cvt_pk_bf16_f32 v35, v181, v189
Mvaa 240,116,216
buffer_load_dwordx4 a[204:207], v5, s[4:7], s78 offen sc1
Mvaa 244,116,220
RD 100,6,25600
v_accvgpr_write_b32 a40, v32
Mvaa 244,112,212
v_accvgpr_write_b32 a41, v33
v_accvgpr_write_b32 a42, v34
Mvaa 248,120,208
s_add_u32 s78, s66, 2048
RD 104,6,26624
v_accvgpr_write_b32 a43, v35
s_branch LOP27
LP27:
s_setpc_b64 s[48:49]
LOP27:
Mvaa 248,124,216
buffer_store_dwordx4 a[8:11], v5, s[4:7], s78 offen sc1
Mvaa 252,124,220
s_waitcnt lgkmcnt(7)
RD 108,6,27648
v_cvt_pk_bf16_f32 v36, v162, v170
Mvaa 252,120,212
s_add_u32 m0, s30, 16384
v_cvt_pk_bf16_f32 v37, v178, v186
v_cvt_pk_bf16_f32 v38, v163, v171
Mvaa 192,64,224
RD 112,6,28672
v_cvt_pk_bf16_f32 v39, v179, v187
Mvaa 192,68,232
v_accvgpr_write_b32 a12, v36
v_accvgpr_write_b32 a13, v37
Mvaa 196,68,236
s_add_u32 s30, s30, s36
RD 116,6,29696
v_accvgpr_write_b32 a14, v38
Mvaa 196,64,228
v_accvgpr_write_b32 a15, v39
v_cvt_pk_bf16_f32 v40, v166, v174
Mvaa 200,72,224
s_cmp_ge_u32 s30, 131072
RD 120,6,30720
v_cvt_pk_bf16_f32 v41, v182, v190
Mvaa 200,76,232
v_cvt_pk_bf16_f32 v42, v167, v175
v_cvt_pk_bf16_f32 v43, v183, v191
Mvaa 204,76,236
s_waitcnt lgkmcnt(7)
s_cselect_b32 s36, s33, s34
RD 124,6,31744
Mvaa 204,72,228
s_barrier
v_add_u32 v6, s36, v6
v_accvgpr_write_b32 a44, v40
Mvaa 208,80,224
RD 64,6,0
v_accvgpr_write_b32 a45, v41
Mvaa 208,84,232
v_accvgpr_write_b32 a46, v42
v_accvgpr_write_b32 a47, v43
Mvaa 212,84,236
RD 68,6,1024
Mvaa 212,80,228
Mvaa 216,88,224
s_add_u32 s29, s29, 1
s_add_u32 s78, s66, 10240
RD 72,6,2048
Mvaa 216,92,232
buffer_store_dwordx4 a[40:43], v5, s[4:7], s78 offen sc1
Mvaa 220,92,236
s_waitcnt lgkmcnt(7)
RD 76,6,3072
Mvaa 220,88,228
Mvaa 224,96,224
s_add_u32 s78, s66, 3072
RD 80,6,4096
Mvaa 224,100,232
buffer_store_dwordx4 a[12:15], v5, s[4:7], s78 offen sc1
Mvaa 228,100,236
RD 84,6,5120
v_cvt_pk_bf16_f32 v28, v192, v200
Mvaa 228,96,228
v_cvt_pk_bf16_f32 v29, v208, v216
v_cvt_pk_bf16_f32 v30, v193, v201
Mvaa 232,104,224
s_add_u32 s78, s66, 11264
RD 88,6,6144
v_cvt_pk_bf16_f32 v31, v209, v217
Mvaa 232,108,232
buffer_store_dwordx4 a[44:47], v5, s[4:7], s78 offen sc1
Mvaa 236,108,236
s_waitcnt lgkmcnt(7)
RD 92,6,7168
v_accvgpr_write_b32 a16, v28
Mvaa 236,104,228
v_accvgpr_write_b32 a17, v29
v_accvgpr_write_b32 a18, v30
Mvaa 240,112,224
s_add_u32 s78, s40, 0
RD 96,6,8192
v_accvgpr_write_b32 a19, v31
Mvaa 240,116,232
buffer_load_dwordx4 a[208:211], v5, s[4:7], s78 offen sc1
Mvaa 244,116,236
RD 100,6,9216
v_cvt_pk_bf16_f32 v32, v196, v204
Mvaa 244,112,228
v_cvt_pk_bf16_f32 v33, v212, v220
v_cvt_pk_bf16_f32 v34, v197, v205
Mvaa 248,120,224
s_add_u32 s78, s40, 57344
RD 104,6,10240
v_cvt_pk_bf16_f32 v35, v213, v221
Mvaa 248,124,232
buffer_load_dwordx4 a[212:215], v5, s[4:7], s78 offen sc1
Mvaa 252,124,236
s_waitcnt lgkmcnt(7)
s_waitcnt vmcnt(36)
RD 108,6,11264
Mvaa 252,120,228
s_mov_b32 m0, s30
v_accvgpr_write_b32 a48, v32
v_accvgpr_write_b32 a49, v33
s_cmp_eq_u32 s60, 1
s_cbranch_scc0 L_e15s
buffer_load_dword v7, v10, s[4:7], s71 offen sc1
s_bitcmp1_b32 s24, 1
s_cbranch_scc1 LH_C13
s_bitcmp1_b32 s24, 0
s_cbranch_scc1 LA_C13
s_call_b64 s[48:49], LP29
s_branch LR_C13
LA_C13:
s_call_b64 s[48:49], LP40
s_branch LR_C13
LH_C13:
s_bitcmp1_b32 s24, 0
s_cbranch_scc1 LB_C13
s_call_b64 s[48:49], LP41
s_branch LR_C13
LB_C13:
s_call_b64 s[48:49], LP42
LR_C13:
s_cbranch_execnz L_e15
L_e15s:
s_bitcmp1_b32 s24, 1
s_cbranch_scc1 LH_B14
s_bitcmp1_b32 s24, 0
s_cbranch_scc1 LA_B14
s_call_b64 s[48:49], LP29
s_branch LR_B14
LA_B14:
s_call_b64 s[48:49], LP30
s_branch LR_B14
LH_B14:
s_bitcmp1_b32 s24, 0
s_cbranch_scc1 LB_B14
s_call_b64 s[48:49], LP31
s_branch LR_B14
LB_B14:
s_call_b64 s[48:49], LP32
LR_B14:
s_nop 3
v_accvgpr_write_b32 a50, v34
v_accvgpr_write_b32 a51, v35
s_nop 1
Zvaa 128,64,128
s_add_u32 s78, s66, 4096
RD 112,6,12288
v_cvt_pk_bf16_f32 v36, v194, v202
Mvaa 128,68,136
buffer_store_dwordx4 a[16:19], v5, s[4:7], s78 offen sc1
Zvaa 132,68,140
RD 116,6,13312
v_cvt_pk_bf16_f32 v37, v210, v218
Mvaa 132,64,132
v_cvt_pk_bf16_f32 v38, v195, v203
v_cvt_pk_bf16_f32 v39, v211, v219
Zvaa 136,72,128
s_add_u32 s78, s66, 12288
RD 120,6,14336
v_accvgpr_write_b32 a20, v36
Mvaa 136,76,136
buffer_store_dwordx4 a[48:51], v5, s[4:7], s78 offen sc1
Zvaa 140,76,140
s_waitcnt lgkmcnt(7)
RD 124,6,15360
v_accvgpr_write_b32 a21, v37
Mvaa 140,72,132
v_accvgpr_write_b32 a22, v38
v_accvgpr_write_b32 a23, v39
Zvaa 144,80,128
s_add_u32 s78, s40, 1024
RD 64,6,16384
v_cvt_pk_bf16_f32 v40, v198, v206
Mvaa 144,84,136
buffer_load_dwordx4 a[216:219], v5, s[4:7], s78 offen sc1
Zvaa 148,84,140
RD 68,6,17408
v_cvt_pk_bf16_f32 v41, v214, v222
Mvaa 148,80,132
v_cvt_pk_bf16_f32 v42, v199, v207
v_cvt_pk_bf16_f32 v43, v215, v223
Zvaa 152,88,128
s_add_u32 s78, s66, 5120
RD 72,6,18432
v_accvgpr_write_b32 a52, v40
Mvaa 152,92,136
buffer_store_dwordx4 a[20:23], v5, s[4:7], s78 offen sc1
Zvaa 156,92,140
s_waitcnt lgkmcnt(7)
RD 76,6,19456
v_accvgpr_write_b32 a53, v41
Mvaa 156,88,132
v_accvgpr_write_b32 a54, v42
v_accvgpr_write_b32 a55, v43
Zvaa 160,96,128
RD 80,6,20480
v_cvt_pk_bf16_f32 v28, v224, v232
Mvaa 160,100,136
v_cvt_pk_bf16_f32 v29, v240, v248
v_cvt_pk_bf16_f32 v30, v225, v233
Zvaa 164,100,140
RD 84,6,21504
v_cvt_pk_bf16_f32 v31, v241, v249
Mvaa 164,96,132
v_accvgpr_write_b32 a24, v28
v_accvgpr_write_b32 a25, v29
Zvaa 168,104,128
s_add_u32 s78, s66, 13312
RD 88,6,22528
v_accvgpr_write_b32 a26, v30
Mvaa 168,108,136
buffer_store_dwordx4 a[52:55], v5, s[4:7], s78 offen sc1
Zvaa 172,108,140
s_waitcnt lgkmcnt(7)
RD 92,6,23552
v_accvgpr_write_b32 a27, v31
Mvaa 172,104,132
v_cvt_pk_bf16_f32 v32, v228, v236
v_cvt_pk_bf16_f32 v33, v244, v252
Zvaa 176,112,128
s_add_u32 s78, s40, 58368
RD 96,6,24576
v_cvt_pk_bf16_f32 v34, v229, v237
Mvaa 176,116,136
buffer_load_dwordx4 a[220:223], v5, s[4:7], s78 offen sc1
Zvaa 180,116,140
RD 100,6,25600
v_cvt_pk_bf16_f32 v35, v245, v253
Mvaa 180,112,132
v_accvgpr_write_b32 a56, v32
v_accvgpr_write_b32 a57, v33
Zvaa 184,120,128
s_add_u32 s78, s66, 6144
RD 104,6,26624
v_accvgpr_write_b32 a58, v34
Mvaa 184,124,136
buffer_store_dwordx4 a[24:27], v5, s[4:7], s78 offen sc1
Zvaa 188,124,140
s_waitcnt lgkmcnt(7)
RD 108,6,27648
v_accvgpr_write_b32 a59, v35
Mvaa 188,120,132
s_add_u32 m0, s30, 16384
v_cvt_pk_bf16_f32 v36, v226, v234
v_cvt_pk_bf16_f32 v37, v242, v250
Zvaa 192,64,128
s_add_u32 s78, s40, 2048
RD 112,6,28672
v_cvt_pk_bf16_f32 v38, v227, v235
Mvaa 192,68,136
buffer_load_dwordx4 a[224:227], v5, s[4:7], s78 offen sc1
Zvaa 196,68,140
s_add_u32 s30, s30, s36
RD 116,6,29696
v_cvt_pk_bf16_f32 v39, v243, v251
Mvaa 196,64,132
v_accvgpr_write_b32 a28, v36
v_accvgpr_write_b32 a29, v37
Zvaa 200,72,128
s_cmp_ge_u32 s30, 131072
RD 120,6,30720
v_accvgpr_write_b32 a30, v38
Mvaa 200,76,136
v_accvgpr_write_b32 a31, v39
v_cvt_pk_bf16_f32 v40, v230, v238
Zvaa 204,76,140
s_waitcnt lgkmcnt(7)
s_cselect_b32 s36, s33, s34
RD 124,6,31744
Mvaa 204,72,132
s_barrier
v_add_u32 v6, s36, v6
v_cvt_pk_bf16_f32 v41, v246, v254
Zvaa 208,80,128
RD 64,6,0
v_cvt_pk_bf16_f32 v42, v231, v239
Mvaa 208,84,136
v_cvt_pk_bf16_f32 v43, v247, v255
v_accvgpr_write_b32 a60, v40
Zvaa 212,84,140
RD 68,6,1024
v_accvgpr_write_b32 a61, v41
Mvaa 212,80,132
v_accvgpr_write_b32 a62, v42
v_accvgpr_write_b32 a63, v43
Zvaa 216,88,128
s_add_u32 s29, s29, 1
s_add_u32 s78, s66, 14336
RD 72,6,2048
Mvaa 216,92,136
buffer_store_dwordx4 a[56:59], v5, s[4:7], s78 offen sc1
Zvaa 220,92,140
s_waitcnt lgkmcnt(7)
RD 76,6,3072
Mvaa 220,88,132
Zvaa 224,96,128
s_add_u32 s78, s66, 7168
RD 80,6,4096
Mvaa 224,100,136
buffer_store_dwordx4 a[28:31], v5, s[4:7], s78 offen sc1
Zvaa 228,100,140
RD 84,6,5120
Mvaa 228,96,132
Zvaa 232,104,128
s_add_u32 s78, s66, 15360
RD 88,6,6144
Mvaa 232,108,136
buffer_store_dwordx4 a[60:63], v5, s[4:7], s78 offen sc1
Zvaa 236,108,140
s_waitcnt lgkmcnt(7)
RD 92,6,7168
Mvaa 236,104,132
v_readlane_b32 s32, v3, s29
Zvaa 240,112,128
s_add_u32 s78, s40, 59392
RD 96,6,8192
Mvaa 240,116,136
buffer_load_dwordx4 a[228:231], v5, s[4:7], s78 offen sc1
Zvaa 244,116,140
RD 100,6,9216
Mvaa 244,112,132
Zvaa 248,120,128
RD 104,6,10240
Mvaa 248,124,136
Zvaa 252,124,140
s_waitcnt lgkmcnt(7)
s_waitcnt vmcnt(42)
RD 108,6,11264
Mvaa 252,120,132
s_mov_b32 m0, s30
s_bitcmp1_b32 s24, 1
s_cbranch_scc1 LH_B15
s_bitcmp1_b32 s24, 0
s_cbranch_scc1 LA_B15
s_call_b64 s[48:49], LP35
s_branch LR_B15
LA_B15:
s_call_b64 s[48:49], LP36
s_branch LR_B15
LH_B15:
s_bitcmp1_b32 s24, 0
s_cbranch_scc1 LB_B15
s_call_b64 s[48:49], LP37
s_branch LR_B15
LB_B15:
s_call_b64 s[48:49], LP38
LR_B15:
Mvaa 128,64,144
s_add_u32 s78, s40, 3072
RD 112,6,12288
Mvaa 128,68,152
buffer_load_dwordx4 a[232:235], v5, s[4:7], s78 offen sc1
Mvaa 132,68,156
s_add_u32 s78, s40, 60416
RD 116,6,13312
Mvaa 132,64,148
buffer_load_dwordx4 a[236:239], v5, s[4:7], s78 offen sc1
Mvaa 136,72,144
RD 120,6,14336
Mvaa 136,76,152
buffer_load_dwordx4 v2, s[4:7], s32 offen offset:0 sc1 lds
Mvaa 140,76,156
s_waitcnt lgkmcnt(7)
RD 124,6,15360
Mvaa 140,72,148
Mvaa 144,80,144
RD 64,6,16384
Mvaa 144,84,152
Mvaa 148,84,156
s_add_u32 s78, s65, 34816
RD 68,6,17408
Mvaa 148,80,148
buffer_store_dwordx4 v[88:91], v5, s[4:7], s78 offen sc1
Mvaa 152,88,144
RD 72,6,18432
Mvaa 152,92,152
buffer_load_dwordx4 v2, s[4:7], s32 offen offset:1024 sc1 lds
Mvaa 156,92,156
s_waitcnt lgkmcnt(7)
RD 76,6,19456
Mvaa 156,88,148
Mvaa 160,96,144
RD 80,6,20480
Mvaa 160,100,152
Mvaa 164,100,156
s_add_u32 s78, s65, 35840
RD 84,6,21504
Mvaa 164,96,148
buffer_store_dwordx4 v[92:95], v5, s[4:7], s78 offen sc1
Mvaa 168,104,144
RD 88,6,22528
Mvaa 168,108,152
buffer_load_dwordx4 v2, s[4:7], s32 offen offset:2048 sc1 lds
Mvaa 172,108,156
s_waitcnt lgkmcnt(7)
RD 92,6,23552
Mvaa 172,104,148
Mvaa 176,112,144
RD 96,6,24576
Mvaa 176,116,152
Mvaa 180,116,156
s_waitcnt vmcnt(8)
s_barrier
RD 100,6,25600
Mvaa 180,112,148
buffer_store_dword v9, v8, s[4:7], s72 offen sc1
Mvaa 184,120,144
RD 104,6,26624
Mvaa 184,124,152
buffer_load_dwordx4 v2, s[4:7], s32 offen offset:3072 sc1 lds
Mvaa 188,124,156
s_waitcnt lgkmcnt(7)
RD 108,6,27648
Mvaa 188,120,148
s_add_u32 m0, s30, 16384
v_readlane_b32 s31, v4, s29
Mvaa 192,64,144
RD 112,6,28672
Mvaa 192,68,152
Mvaa 196,68,156
s_add_u32 s30, s30, s36
RD 116,6,29696
Mvaa 196,64,148
Mvaa 200,72,144
s_cmp_ge_u32 s30, 131072
RD 120,6,30720
Mvaa 200,76,152
buffer_load_dwordx4 v2, s[4:7], s31 offen offset:0 sc1 lds
Mvaa 204,76,156
s_waitcnt lgkmcnt(7)
s_cselect_b32 s36, s33, s34
RD 124,6,31744
Mvaa 204,72,148
s_barrier
v_add_u32 v6, s36, v6
Mvaa 208,80,144
s_add_u32 s78, s65, 36864
RD 64,6,0
Mvaa 208,84,152
buffer_store_dwordx4 v[96:99], v5, s[4:7], s78 offen sc1
Mvaa 212,84,156
RD 68,6,1024
Mvaa 212,80,148
Mvaa 216,88,144
s_add_u32 s29, s29, 1
RD 72,6,2048
Mvaa 216,92,152
buffer_load_dwordx4 v2, s[4:7], s31 offen offset:1024 sc1 lds
Mvaa 220,92,156
s_waitcnt lgkmcnt(7)
RD 76,6,3072
Mvaa 220,88,148
Mvaa 224,96,144
s_add_u32 s78, s65, 37888
RD 80,6,4096
Mvaa 224,100,152
buffer_store_dwordx4 v[100:103], v5, s[4:7], s78 offen sc1
Mvaa 228,100,156
RD 84,6,5120
Mvaa 228,96,148
Mvaa 232,104,144
RD 88,6,6144
Mvaa 232,108,152
buffer_load_dwordx4 v2, s[4:7], s31 offen offset:2048 sc1 lds
Mvaa 236,108,156
s_waitcnt lgkmcnt(7)
RD 92,6,7168
Mvaa 236,104,148
v_readlane_b32 s32, v3, s29
Mvaa 240,112,144
s_add_u32 s78, s64, 54272
RD 96,6,8192
Mvaa 240,116,152
buffer_store_dwordx4 v[104:107], v5, s[4:7], s78 offen sc1
Mvaa 244,116,156
RD 100,6,9216
Mvaa 244,112,148
Mvaa 248,120,144
RD 104,6,10240
Mvaa 248,124,152
buffer_load_dwordx4 v2, s[4:7], s31 offen offset:3072 sc1 lds
Mvaa 252,124,156
s_waitcnt lgkmcnt(7)
s_waitcnt vmcnt(51)
RD 108,6,11264
Mvaa 252,120,148
s_mov_b32 m0, s30
s_bitcmp1_b32 s24, 1
s_cbranch_scc1 LH_B16
s_bitcmp1_b32 s24, 0
s_cbranch_scc1 LA_B16
s_call_b64 s[48:49], LP39
s_branch LR_B16
LA_B16:
s_call_b64 s[48:49], LP40
s_branch LR_B16
LH_B16:
s_bitcmp1_b32 s24, 0
s_cbranch_scc1 LB_B16
s_call_b64 s[48:49], LP41
s_branch LR_B16
LB_B16:
s_call_b64 s[48:49], LP42
LR_B16:
Mvaa 128,64,160
RD 112,6,12288
Mvaa 128,68,168
Mvaa 132,68,172
RD 116,6,13312
Mvaa 132,64,164
buffer_load_dword v7, v10, s[4:7], s71 offen sc1
Mvaa 136,72,160
RD 120,6,14336
Mvaa 136,76,168
buffer_load_dwordx4 v2, s[4:7], s32 offen offset:0 sc1 lds
Mvaa 140,76,172
s_waitcnt lgkmcnt(7)
RD 124,6,15360
Mvaa 140,72,164
Mvaa 144,80,160
s_add_u32 s78, s64, 55296
RD 64,6,16384
Mvaa 144,84,168
buffer_store_dwordx4 v[108:111], v5, s[4:7], s78 offen sc1
Mvaa 148,84,172
RD 68,6,17408
Mvaa 148,80,164
Mvaa 152,88,160
RD 72,6,18432
Mvaa 152,92,168
buffer_load_dwordx4 v2, s[4:7], s32 offen offset:1024 sc1 lds
Mvaa 156,92,172
s_waitcnt lgkmcnt(7)
RD 76,6,19456
Mvaa 156,88,164
Mvaa 160,96,160
RD 80,6,20480
Mvaa 160,100,168
Mvaa 164,100,172
RD 84,6,21504
Mvaa 164,96,164
Mvaa 168,104,160
RD 88,6,22528
Mvaa 168,108,168
buffer_load_dwordx4 v2, s[4:7], s32 offen offset:2048 sc1 lds
Mvaa 172,108,172
s_waitcnt lgkmcnt(7)
RD 92,6,23552
Mvaa 172,104,164
Mvaa 176,112,160
s_add_u32 s78, s65, 52224
RD 96,6,24576
Mvaa 176,116,168
buffer_store_dwordx4 v[112:115], v5, s[4:7], s78 offen sc1
Mvaa 180,116,172
RD 100,6,25600
Mvaa 180,112,164
Mvaa 184,120,160
RD 104,6,26624
Mvaa 184,124,168
buffer_load_dwordx4 v2, s[4:7], s32 offen offset:3072 sc1 lds
Mvaa 188,124,172
s_waitcnt lgkmcnt(7)
RD 108,6,27648
Mvaa 188,120,164
s_add_u32 m0, s30, 16384
v_readlane_b32 s31, v4, s29
Mvaa 192,64,160
s_add_u32 s78, s65, 53248
RD 112,6,28672
Mvaa 192,68,168
buffer_store_dwordx4 v[116:119], v5, s[4:7], s78 offen sc1
Mvaa 196,68,172
s_add_u32 s30, s30, s36
RD 116,6,29696
s_branch LOP28
LP28:
s_setpc_b64 s[48:49]
LOP28:
Mvaa 196,64,164
Mvaa 200,72,160
s_cmp_ge_u32 s30, 131072
RD 120,6,30720
Mvaa 200,76,168
buffer_load_dwordx4 v2, s[4:7], s31 offen offset:0 sc1 lds
Mvaa 204,76,172
s_waitcnt lgkmcnt(7)
s_cselect_b32 s36, s33, s34
RD 124,6,31744
Mvaa 204,72,164
s_barrier
v_add_u32 v6, s36, v6
Mvaa 208,80,160
RD 64,6,0
Mvaa 208,84,168
Mvaa 212,84,172
RD 68,6,1024
Mvaa 212,80,164
Mvaa 216,88,160
s_add_u32 s29, s29, 1
RD 72,6,2048
Mvaa 216,92,168
buffer_load_dwordx4 v2, s[4:7], s31 offen offset:1024 sc1 lds
Mvaa 220,92,172
s_waitcnt lgkmcnt(7)
RD 76,6,3072
Mvaa 220,88,164
Mvaa 224,96,160
s_add_u32 s78, s65, 54272
RD 80,6,4096
Mvaa 224,100,168
buffer_store_dwordx4 v[120:123], v5, s[4:7], s78 offen sc1
Mvaa 228,100,172
RD 84,6,5120
Mvaa 228,96,164
Mvaa 232,104,160
RD 88,6,6144
Mvaa 232,108,168
buffer_load_dwordx4 v2, s[4:7], s31 offen offset:2048 sc1 lds
Mvaa 236,108,172
s_waitcnt lgkmcnt(7)
RD 92,6,7168
Mvaa 236,104,164
v_readlane_b32 s32, v3, s29
Mvaa 240,112,160
s_add_u32 s78, s65, 55296
RD 96,6,8192
Mvaa 240,116,168
buffer_store_dwordx4 v[124:127], v5, s[4:7], s78 offen sc1
Mvaa 244,116,172
s_waitcnt vmcnt(12)
RD 100,6,9216
v_cmp_ne_u32 s[80:81], s38, v7
Mvaa 244,112,164
Mvaa 248,120,160
s_cmp_lg_u64 s[80:81], 0
s_cbranch_scc1 L_pw_kvb
L_po_kvb:
s_barrier
RD 104,6,10240
Mvaa 248,124,168
buffer_load_dwordx4 v2, s[4:7], s31 offen offset:3072 sc1 lds
Mvaa 252,124,172
s_waitcnt lgkmcnt(7)
s_waitcnt vmcnt(58)
RD 108,6,11264
Mvaa 252,120,164
s_mov_b32 m0, s30
Mvaa 128,64,176
RD 112,6,12288
Mvaa 128,68,184
Mvaa 132,68,188
RD 116,6,13312
v_min_u32 v10, 11, v1
Mvaa 132,64,180
Mvaa 136,72,176
RD 120,6,14336
v_lshlrev_b32 v10, 2, v10
Mvaa 136,76,184
buffer_load_dwordx4 v2, s[4:7], s32 offen offset:0 sc1 lds
Mvaa 140,76,188
s_waitcnt lgkmcnt(7)
RD 124,6,15360
Mvaa 140,72,180
Mvaa 144,80,176
RD 64,6,16384
v_add_u32 v10, 128, v10
Mvaa 144,84,184
Mvaa 148,84,188
RD 68,6,17408
Mvaa 148,80,180
Mvaa 152,88,176
RD 72,6,18432
Mvaa 152,92,184
buffer_load_dwordx4 v2, s[4:7], s32 offen offset:1024 sc1 lds
Mvaa 156,92,188
s_waitcnt lgkmcnt(7)
RD 76,6,19456
Mvaa 156,88,180
Mvaa 160,96,176
RD 80,6,20480
Mvaa 160,100,184
Mvaa 164,100,188
RD 84,6,21504
Mvaa 164,96,180
Mvaa 168,104,176
RD 88,6,22528
Mvaa 168,108,184
buffer_load_dwordx4 v2, s[4:7], s32 offen offset:2048 sc1 lds
Mvaa 172,108,188
s_waitcnt lgkmcnt(7)
RD 92,6,23552
Mvaa 172,104,180
Mvaa 176,112,176
RD 96,6,24576
Mvaa 176,116,184
Mvaa 180,116,188
RD 100,6,25600
Mvaa 180,112,180
Mvaa 184,120,176
RD 104,6,26624
Mvaa 184,124,184
buffer_load_dwordx4 v2, s[4:7], s32 offen offset:3072 sc1 lds
Mvaa 188,124,188
s_waitcnt lgkmcnt(7)
s_waitcnt vmcnt(52)
RD 108,6,27648
Mvaa 188,120,180
s_add_u32 m0, s30, 16384
v_readlane_b32 s31, v4, s29
Mvaa 128,64,192
RD 112,6,28672
Mvaa 128,68,200
Mvaa 132,68,204
s_add_u32 s30, s30, s36
RD 116,6,29696
Mvaa 132,64,196
Mvaa 136,72,192
s_cmp_ge_u32 s30, 131072
RD 120,6,30720
Mvaa 136,76,200
buffer_load_dwordx4 v2, s[4:7], s31 offen offset:0 sc1 lds
Mvaa 140,76,204
s_waitcnt lgkmcnt(7)
s_cselect_b32 s36, s33, s34
RD 124,6,31744
Mvaa 140,72,196
s_barrier
v_add_u32 v6, s36, v6
Mvaa 144,80,192
RD 64,6,0
Mvaa 144,84,200
Mvaa 148,84,204
RD 68,6,1024
Mvaa 148,80,196
Mvaa 152,88,192
s_add_u32 s29, s29, 1
RD 72,6,2048
Mvaa 152,92,200
buffer_load_dwordx4 v2, s[4:7], s31 offen offset:1024 sc1 lds
Mvaa 156,92,204
s_waitcnt lgkmcnt(7)
RD 76,6,3072
Mvaa 156,88,196
Mvaa 160,96,192
RD 80,6,4096
Mvaa 160,100,200
Mvaa 164,100,204
RD 84,6,5120
Mvaa 164,96,196
Mvaa 168,104,192
RD 88,6,6144
Mvaa 168,108,200
buffer_load_dwordx4 v2, s[4:7], s31 offen offset:2048 sc1 lds
Mvaa 172,108,204
s_waitcnt lgkmcnt(7)
RD 92,6,7168
Mvaa 172,104,196
v_readlane_b32 s32, v3, s29
Mvaa 176,112,192
RD 96,6,8192
Mvaa 176,116,200
Mvaa 180,116,204
RD 100,6,9216
Mvaa 180,112,196
Mvaa 184,120,192
RD 104,6,10240
Mvaa 184,124,200
buffer_load_dwordx4 v2, s[4:7], s31 offen offset:3072 sc1 lds
Mvaa 188,124,204
s_waitcnt lgkmcnt(7)
RD 108,6,11264
Mvaa 188,120,196
s_mov_b32 m0, s30
Mvaa 192,64,176
s_waitcnt vmcnt(9)
s_barrier
RD 112,6,12288
Mvaa 192,68,184
buffer_store_dword v9, v8, s[4:7], s70 offen sc1
Mvaa 196,68,188
RD 116,6,13312
Mvaa 196,64,180
Mvaa 200,72,176
RD 120,6,14336
Mvaa 200,76,184
buffer_load_dwordx4 v2, s[4:7], s32 offen offset:0 sc1 lds
Mvaa 204,76,188
s_waitcnt lgkmcnt(7)
RD 124,6,15360
Mvaa 204,72,180
Mvaa 208,80,176
RD 64,6,16384
Mvaa 208,84,184
Mvaa 212,84,188
RD 68,6,17408
Mvaa 212,80,180
Mvaa 216,88,176
RD 72,6,18432
Mvaa 216,92,184
buffer_load_dwordx4 v2, s[4:7], s32 offen offset:1024 sc1 lds
Mvaa 220,92,188
s_waitcnt lgkmcnt(7)
RD 76,6,19456
Mvaa 220,88,180
Mvaa 224,96,176
RD 80,6,20480
Mvaa 224,100,184
Mvaa 228,100,188
RD 84,6,21504
Mvaa 228,96,180
Mvaa 232,104,176
RD 88,6,22528
Mvaa 232,108,184
buffer_load_dwordx4 v2, s[4:7], s32 offen offset:2048 sc1 lds
Mvaa 236,108,188
s_waitcnt lgkmcnt(7)
RD 92,6,23552
Mvaa 236,104,180
Mvaa 240,112,176
RD 96,6,24576
Mvaa 240,116,184
Mvaa 244,116,188
RD 100,6,25600
Mvaa 244,112,180
Mvaa 248,120,176
RD 104,6,26624
Mvaa 248,124,184
buffer_load_dwordx4 v2, s[4:7], s32 offen offset:3072 sc1 lds
Mvaa 252,124,188
s_waitcnt lgkmcnt(7)
RD 108,6,27648
Mvaa 252,120,180
s_add_u32 m0, s30, 16384
v_readlane_b32 s31, v4, s29
Mvaa 192,64,192
RD 112,6,28672
Mvaa 192,68,200
Mvaa 196,68,204
s_add_u32 s30, s30, s36
RD 116,6,29696
Mvaa 196,64,196
Mvaa 200,72,192
s_cmp_ge_u32 s30, 131072
RD 120,6,30720
Mvaa 200,76,200
buffer_load_dwordx4 v2, s[4:7], s31 offen offset:0 sc1 lds
Mvaa 204,76,204
s_waitcnt vmcnt(28) lgkmcnt(7)
s_cselect_b32 s36, s33, s34
RD 124,6,31744
Mvaa 204,72,196
s_barrier
v_add_u32 v6, s36, v6
Mvaa 208,80,192
RD 64,6,0
Mvaa 208,84,200
Mvaa 212,84,204
RD 68,6,1024
Mvaa 212,80,196
Mvaa 216,88,192
s_add_u32 s29, s29, 1
RD 72,6,2048
Mvaa 216,92,200
buffer_load_dwordx4 v2, s[4:7], s31 offen offset:1024 sc1 lds
Mvaa 220,92,204
s_waitcnt lgkmcnt(7)
RD 76,6,3072
Mvaa 220,88,196
Mvaa 224,96,192
RD 80,6,4096
Mvaa 224,100,200
Mvaa 228,100,204
RD 84,6,5120
Mvaa 228,96,196
Mvaa 232,104,192
RD 88,6,6144
Mvaa 232,108,200
buffer_load_dwordx4 v2, s[4:7], s31 offen offset:2048 sc1 lds
Mvaa 236,108,204
s_waitcnt lgkmcnt(7)
RD 92,6,7168
Mvaa 236,104,196
v_readlane_b32 s32, v3, s29
Mvaa 240,112,192
RD 96,6,8192
Mvaa 240,116,200
Mvaa 244,116,204
RD 100,6,9216
Mvaa 244,112,196
Mvaa 248,120,192
RD 104,6,10240
Mvaa 248,124,200
buffer_load_dwordx4 v2, s[4:7], s31 offen offset:3072 sc1 lds
Mvaa 252,124,204
s_waitcnt lgkmcnt(7)
s_waitcnt vmcnt(53)
RD 108,6,11264
Mvaa 252,120,196
s_mov_b32 m0, s30
Mvaa 128,64,208
RD 112,6,12288
Mvaa 128,68,216
Mvaa 132,68,220
RD 116,6,13312
Mvaa 132,64,212
Mvaa 136,72,208
RD 120,6,14336
v_min_u32 v63, 6, v1
Mvaa 136,76,216
buffer_load_dwordx4 v2, s[4:7], s32 offen offset:0 sc1 lds
Mvaa 140,76,220
s_waitcnt lgkmcnt(7)
RD 124,6,15360
v_lshl_add_u32 v63, v63, 2, 64
Mvaa 140,72,212
v_lshrrev_b32 v61, 4, v1
Mvaa 144,80,208
RD 64,6,16384
v_mul_u32_u24 v61, 115456, v61
Mvaa 144,84,216
v_add_u32 v61, v61, v5
Mvaa 148,84,220
RD 68,6,17408
v_cmp_gt_u32 s[80:81], 48, v1
Mvaa 148,80,212
s_lshr_b32 s65, s2, 2
Mvaa 152,88,208
RD 72,6,18432
Mvaa 152,92,216
buffer_load_dwordx4 v2, s[4:7], s32 offen offset:1024 sc1 lds
Mvaa 156,92,220
s_waitcnt lgkmcnt(7)
RD 76,6,19456
v_cndmask_b32 v62, v8, v61, s[80:81]
Mvaa 156,88,212
s_lshl_b32 s65, s65, 7
Mvaa 160,96,208
s_add_u32 s65, s65, 14688256
RD 80,6,20480
Mvaa 160,100,216
s_lshr_b32 s80, s2, 4
Mvaa 164,100,220
s_mul_i32 s64, s80, 2661376
RD 84,6,21504
Mvaa 164,96,212
s_bfe_u32 s80, s2, 0x20002
Mvaa 168,104,208
s_mul_i32 s81, s80, 28672
RD 88,6,22528
Mvaa 168,108,216
buffer_load_dwordx4 v2, s[4:7], s32 offen offset:2048 sc1 lds
Mvaa 172,108,220
s_waitcnt lgkmcnt(7)
s_add_u32 s64, s64, s81
RD 92,6,23552
Mvaa 172,104,212
s_and_b32 s80, s80, 2
Mvaa 176,112,208
s_xor_b32 s80, s80, s2
RD 96,6,24576
Mvaa 176,116,216
s_and_b32 s80, s80, 3
Mvaa 180,116,220
s_lshl2_add_u32 s80, s24, s80
RD 100,6,25600
Mvaa 180,112,212
s_lshl_b32 s81, s80, 11
Mvaa 184,120,208
s_add_u32 s64, s64, s81
RD 104,6,26624
Mvaa 184,124,216
buffer_load_dwordx4 v2, s[4:7], s32 offen offset:3072 sc1 lds
Mvaa 188,124,220
s_waitcnt lgkmcnt(7)
s_add_u32 s64, s64, 77348864
s_waitcnt vmcnt(49)
RD 108,6,27648
Mvaa 188,120,212
s_add_u32 m0, s30, 16384
v_readlane_b32 s31, v4, s29
Mvaa 128,64,224
s_cmp_lt_u32 s80, 14
s_cselect_b32 s64, s64, 2130706432
RD 112,6,28672
Mvaa 128,68,232
s_cmp_lt_u32 s60, 2
s_cselect_b32 s42, 2, s24
Mvaa 132,68,236
s_add_u32 s30, s30, s36
s_cmp_lt_u32 s42, 2
s_cselect_b32 s42, 2, 64
RD 116,6,29696
Mvaa 132,64,228
s_sub_u32 s41, s42, 1
Mvaa 136,72,224
s_cmp_ge_u32 s30, 131072
RD 120,6,30720
Mvaa 136,76,232
buffer_load_dwordx4 v2, s[4:7], s31 offen offset:0 sc1 lds
Mvaa 140,76,236
s_waitcnt vmcnt(22) lgkmcnt(7)
s_cselect_b32 s36, s33, s34
RD 124,6,31744
Mvaa 140,72,228
s_barrier
v_add_u32 v6, s36, v6
Mvaa 144,80,224
RD 64,6,0
Mvaa 144,84,232
Mvaa 148,84,236
RD 68,6,1024
Mvaa 148,80,228
Mvaa 152,88,224
s_add_u32 s29, s29, 1
RD 72,6,2048
Mvaa 152,92,232
buffer_load_dwordx4 v2, s[4:7], s31 offen offset:1024 sc1 lds
Mvaa 156,92,236
s_waitcnt lgkmcnt(7)
RD 76,6,3072
Mvaa 156,88,228
Mvaa 160,96,224
RD 80,6,4096
Mvaa 160,100,232
Mvaa 164,100,236
RD 84,6,5120
v_cvt_pk_bf16_f32 v28, v128, v136
Mvaa 164,96,228
v_cvt_pk_bf16_f32 v29, v144, v152
v_cvt_pk_bf16_f32 v30, v129, v137
Mvaa 168,104,224
RD 88,6,6144
v_cvt_pk_bf16_f32 v31, v145, v153
Mvaa 168,108,232
buffer_load_dwordx4 v2, s[4:7], s31 offen offset:2048 sc1 lds
Mvaa 172,108,236
s_waitcnt lgkmcnt(7)
RD 92,6,7168
v_accvgpr_write_b32 a128, v28
Mvaa 172,104,228
v_readlane_b32 s32, v3, s29
Mvaa 176,112,224
RD 96,6,8192
v_accvgpr_write_b32 a129, v29
Mvaa 176,116,232
v_accvgpr_write_b32 a130, v30
v_accvgpr_write_b32 a131, v31
Mvaa 180,116,236
RD 100,6,9216
v_cvt_pk_bf16_f32 v32, v132, v140
Mvaa 180,112,228
v_cvt_pk_bf16_f32 v33, v148, v156
v_cvt_pk_bf16_f32 v34, v133, v141
Mvaa 184,120,224
RD 104,6,10240
v_cvt_pk_bf16_f32 v35, v149, v157
Mvaa 184,124,232
buffer_load_dwordx4 v2, s[4:7], s31 offen offset:3072 sc1 lds
Mvaa 188,124,236
s_waitcnt lgkmcnt(7)
s_and_b32 s72, s72, 0x3fffffff
s_add_u32 s72, s72, 16
RD 108,6,11264
Mvaa 188,120,228
s_mov_b32 m0, s30
v_accvgpr_write_b32 a160, v32
v_accvgpr_write_b32 a161, v33
Mvaa 192,64,208
RD 112,6,12288
v_accvgpr_write_b32 a162, v34
Mvaa 192,68,216
v_accvgpr_write_b32 a163, v35
v_cvt_pk_bf16_f32 v36, v130, v138
Mvaa 196,68,220
RD 116,6,13312
v_cvt_pk_bf16_f32 v37, v146, v154
Mvaa 196,64,212
v_cvt_pk_bf16_f32 v38, v131, v139
v_cvt_pk_bf16_f32 v39, v147, v155
Mvaa 200,72,208
RD 120,6,14336
v_accvgpr_write_b32 a132, v36
Mvaa 200,76,216
buffer_load_dwordx4 v2, s[4:7], s32 offen offset:0 sc1 lds
Mvaa 204,76,220
s_waitcnt lgkmcnt(7)
RD 124,6,15360
v_accvgpr_write_b32 a133, v37
Mvaa 204,72,212
v_accvgpr_write_b32 a134, v38
v_accvgpr_write_b32 a135, v39
Mvaa 208,80,208
RD 64,6,16384
v_cvt_pk_bf16_f32 v40, v134, v142
Mvaa 208,84,216
v_cvt_pk_bf16_f32 v41, v150, v158
v_cvt_pk_bf16_f32 v42, v135, v143
Mvaa 212,84,220
RD 68,6,17408
v_cvt_pk_bf16_f32 v43, v151, v159
Mvaa 212,80,212
v_accvgpr_write_b32 a164, v40
v_accvgpr_write_b32 a165, v41
Mvaa 216,88,208
RD 72,6,18432
v_accvgpr_write_b32 a166, v42
Mvaa 216,92,216
buffer_load_dwordx4 v2, s[4:7], s32 offen offset:1024 sc1 lds
Mvaa 220,92,220
s_waitcnt lgkmcnt(7)
RD 76,6,19456
v_accvgpr_write_b32 a167, v43
Mvaa 220,88,212
v_cvt_pk_bf16_f32 v28, v160, v168
v_cvt_pk_bf16_f32 v29, v176, v184
Mvaa 224,96,208
RD 80,6,20480
v_cvt_pk_bf16_f32 v30, v161, v169
Mvaa 224,100,216
v_cvt_pk_bf16_f32 v31, v177, v185
v_accvgpr_write_b32 a136, v28
Mvaa 228,100,220
RD 84,6,21504
v_accvgpr_write_b32 a137, v29
Mvaa 228,96,212
v_accvgpr_write_b32 a138, v30
v_accvgpr_write_b32 a139, v31
Mvaa 232,104,208
RD 88,6,22528
v_cvt_pk_bf16_f32 v32, v164, v172
Mvaa 232,108,216
buffer_load_dwordx4 v2, s[4:7], s32 offen offset:2048 sc1 lds
Mvaa 236,108,220
s_branch LOP29
LP29:
s_setpc_b64 s[48:49]
LOP29:
s_waitcnt lgkmcnt(7)
RD 92,6,23552
v_cvt_pk_bf16_f32 v33, v180, v188
Mvaa 236,104,212
v_cvt_pk_bf16_f32 v34, v165, v173
v_cvt_pk_bf16_f32 v35, v181, v189
Mvaa 240,112,208
RD 96,6,24576
v_accvgpr_write_b32 a168, v32
Mvaa 240,116,216
v_accvgpr_write_b32 a169, v33
v_accvgpr_write_b32 a170, v34
Mvaa 244,116,220
RD 100,6,25600
v_accvgpr_write_b32 a171, v35
Mvaa 244,112,212
v_cvt_pk_bf16_f32 v36, v162, v170
v_cvt_pk_bf16_f32 v37, v178, v186
Mvaa 248,120,208
RD 104,6,26624
v_cvt_pk_bf16_f32 v38, v163, v171
Mvaa 248,124,216
buffer_load_dwordx4 v2, s[4:7], s32 offen offset:3072 sc1 lds
Mvaa 252,124,220
s_waitcnt lgkmcnt(7)
RD 108,6,27648
v_cvt_pk_bf16_f32 v39, v179, v187
Mvaa 252,120,212
s_add_u32 m0, s30, 16384
v_readlane_b32 s31, v4, s29
Mvaa 192,64,224
RD 112,6,28672
v_accvgpr_write_b32 a140, v36
Mvaa 192,68,232
v_accvgpr_write_b32 a141, v37
v_accvgpr_write_b32 a142, v38
Mvaa 196,68,236
s_add_u32 s30, s30, s36
RD 116,6,29696
v_accvgpr_write_b32 a143, v39
Mvaa 196,64,228
v_cvt_pk_bf16_f32 v40, v166, v174
v_cvt_pk_bf16_f32 v41, v182, v190
Mvaa 200,72,224
s_cmp_ge_u32 s30, 131072
RD 120,6,30720
v_cvt_pk_bf16_f32 v42, v167, v175
Mvaa 200,76,232
buffer_load_dwordx4 v2, s[4:7], s31 offen offset:0 sc1 lds
Mvaa 204,76,236
s_waitcnt vmcnt(22) lgkmcnt(7)
s_cselect_b32 s36, s33, s34
RD 124,6,31744
Mvaa 204,72,228
s_barrier
v_add_u32 v6, s36, v6
v_cvt_pk_bf16_f32 v43, v183, v191
Mvaa 208,80,224
RD 64,6,0
v_accvgpr_write_b32 a172, v40
Mvaa 208,84,232
v_accvgpr_write_b32 a173, v41
v_accvgpr_write_b32 a174, v42
Mvaa 212,84,236
RD 68,6,1024
v_accvgpr_write_b32 a175, v43
Mvaa 212,80,228
Mvaa 216,88,224
s_add_u32 s29, s29, 1
RD 72,6,2048
Mvaa 216,92,232
buffer_load_dwordx4 v2, s[4:7], s31 offen offset:1024 sc1 lds
Mvaa 220,92,236
s_waitcnt lgkmcnt(7)
RD 76,6,3072
Mvaa 220,88,228
Mvaa 224,96,224
RD 80,6,4096
Mvaa 224,100,232
Mvaa 228,100,236
RD 84,6,5120
v_cvt_pk_bf16_f32 v28, v192, v200
Mvaa 228,96,228
v_cvt_pk_bf16_f32 v29, v208, v216
v_cvt_pk_bf16_f32 v30, v193, v201
Mvaa 232,104,224
RD 88,6,6144
v_cvt_pk_bf16_f32 v31, v209, v217
Mvaa 232,108,232
buffer_load_dwordx4 v2, s[4:7], s31 offen offset:2048 sc1 lds
Mvaa 236,108,236
s_waitcnt lgkmcnt(7)
RD 92,6,7168
v_accvgpr_write_b32 a144, v28
Mvaa 236,104,228
v_readlane_b32 s32, v3, s29
Mvaa 240,112,224
RD 96,6,8192
v_accvgpr_write_b32 a145, v29
Mvaa 240,116,232
v_accvgpr_write_b32 a146, v30
v_accvgpr_write_b32 a147, v31
Mvaa 244,116,236
RD 100,6,9216
v_cvt_pk_bf16_f32 v32, v196, v204
Mvaa 244,112,228
v_cvt_pk_bf16_f32 v33, v212, v220
v_cvt_pk_bf16_f32 v34, v197, v205
Mvaa 248,120,224
RD 104,6,10240
v_cvt_pk_bf16_f32 v35, v213, v221
Mvaa 248,124,232
buffer_load_dwordx4 v2, s[4:7], s31 offen offset:3072 sc1 lds
Mvaa 252,124,236
s_waitcnt lgkmcnt(7)
RD 108,6,11264
v_accvgpr_write_b32 a176, v32
Mvaa 252,120,228
s_mov_b32 m0, s30
v_accvgpr_write_b32 a177, v33
v_accvgpr_write_b32 a178, v34
s_nop 3
v_accvgpr_write_b32 a179, v35
v_cvt_pk_bf16_f32 v36, v194, v202
v_cvt_pk_bf16_f32 v37, v210, v218
v_cvt_pk_bf16_f32 v38, v195, v203
v_cvt_pk_bf16_f32 v39, v211, v219
v_accvgpr_write_b32 a148, v36
v_accvgpr_write_b32 a149, v37
v_accvgpr_write_b32 a150, v38
v_accvgpr_write_b32 a151, v39
v_cvt_pk_bf16_f32 v40, v198, v206
v_cvt_pk_bf16_f32 v41, v214, v222
v_cvt_pk_bf16_f32 v42, v199, v207
v_cvt_pk_bf16_f32 v43, v215, v223
v_accvgpr_write_b32 a180, v40
v_accvgpr_write_b32 a181, v41
v_accvgpr_write_b32 a182, v42
v_accvgpr_write_b32 a183, v43
v_cvt_pk_bf16_f32 v28, v224, v232
v_cvt_pk_bf16_f32 v29, v240, v248
v_cvt_pk_bf16_f32 v30, v225, v233
v_cvt_pk_bf16_f32 v31, v241, v249
v_accvgpr_write_b32 a152, v28
v_accvgpr_write_b32 a153, v29
v_accvgpr_write_b32 a154, v30
v_accvgpr_write_b32 a155, v31
v_cvt_pk_bf16_f32 v32, v228, v236
s_nop 1
L_e15j:
s_cmp_eq_u32 s61, 0
s_cbranch_scc1 L_b0
Zvaa 64,64,0
RD 112,6,12288
v_mov_b64 v[112:113], 0
Mvaa 64,68,4
buffer_load_dword v7, v10, s[4:7], s71 offen sc1
Mvaa 64,72,16
RD 116,6,13312
v_mov_b64 v[114:115], 0
Mvaa 64,76,20
v_mov_b64 v[116:117], 0
v_mov_b64 v[118:119], 0
Zvaa 68,64,32
RD 120,6,14336
v_mov_b64 v[120:121], 0
Mvaa 68,68,36
buffer_load_dwordx4 v2, s[4:7], s32 offen offset:0 sc1 lds
Mvaa 68,72,48
s_waitcnt lgkmcnt(7)
RD 124,6,15360
v_mov_b32 v126, 0xf149f2ca
Mvaa 68,76,52
v_mov_b32 v127, v126
v_cvt_pk_bf16_f32 v33, v244, v252
Mvaa 68,80,40
s_mov_b32 s46, 1
RD 64,6,16384
v_cvt_pk_bf16_f32 v34, v229, v237
Mvaa 68,84,44
s_mov_b32 s45, 0xff61b1e6
v_cvt_pk_bf16_f32 v35, v245, v253
v_accvgpr_write_b32 a184, v32
Mvaa 68,88,56
RD 68,6,17408
v_accvgpr_write_b32 a185, v33
Mvaa 68,92,60
v_accvgpr_write_b32 a186, v34
v_accvgpr_write_b32 a187, v35
Mvaa 64,80,8
RD 72,6,18432
v_cvt_pk_bf16_f32 v36, v226, v234
Mvaa 64,84,12
buffer_load_dwordx4 v2, s[4:7], s32 offen offset:1024 sc1 lds
Mvaa 64,88,24
s_waitcnt lgkmcnt(7)
RD 76,6,19456
v_cvt_pk_bf16_f32 v37, v242, v250
Mvaa 64,92,28
v_cvt_pk_bf16_f32 v38, v227, v235
v_cvt_pk_bf16_f32 v39, v243, v251
Zvaa 72,96,0
RD 80,6,20480
v_accvgpr_write_b32 a156, v36
Mvaa 72,100,4
v_accvgpr_write_b32 a157, v37
v_accvgpr_write_b32 a158, v38
Mvaa 72,104,16
RD 84,6,21504
v_accvgpr_write_b32 a159, v39
Mvaa 72,108,20
v_exp_f32 v12, v68
Zvaa 76,96,32
RD 88,6,22528
v_exp_f32 v13, v69
Mvaa 76,100,36
buffer_load_dwordx4 v2, s[4:7], s32 offen offset:2048 sc1 lds
Mvaa 76,104,48
s_waitcnt lgkmcnt(7)
RD 92,6,23552
v_cvt_pk_bf16_f32 v100, v12, v13
v_add_f32 v124, v12, v13
Mvaa 76,108,52
v_exp_f32 v14, v70
Mvaa 76,112,40
RD 96,6,24576
v_exp_f32 v15, v71
Mvaa 76,116,44
v_cvt_pk_bf16_f32 v101, v14, v15
v_add_f32 v125, v14, v15
Mvaa 76,120,56
RD 100,6,25600
v_cvt_pk_bf16_f32 v40, v230, v238
Mvaa 76,124,60
v_cvt_pk_bf16_f32 v41, v246, v254
v_cvt_pk_bf16_f32 v42, v231, v239
Mvaa 72,112,8
RD 104,6,26624
v_cvt_pk_bf16_f32 v43, v247, v255
Mvaa 72,116,12
buffer_load_dwordx4 v2, s[4:7], s32 offen offset:3072 sc1 lds
Mvaa 72,120,24
s_waitcnt lgkmcnt(7)
RD 108,6,27648
v_accvgpr_write_b32 a188, v40
Mvaa 72,124,28
s_add_u32 m0, s30, 16384
v_readlane_b32 s31, v4, s29
Zvaa 80,64,0
RD 112,6,28672
v_accvgpr_write_b32 a189, v41
Mvaa 80,68,4
v_accvgpr_write_b32 a190, v42
v_accvgpr_write_b32 a191, v43
Mvaa 80,72,16
s_add_u32 s30, s30, s36
s_cmp_eq_u32 s43, s41
RD 116,6,29696
Mvaa 80,76,20
s_cbranch_scc0 L_nomask_fa2
s_bitcmp1_b32 s24, 0
s_cbranch_scc1 L_domask_fa2_odd
v_cndmask_b32 v64, v64, v126, s[52:53]
v_cndmask_b32 v65, v65, v126, s[54:55]
v_cndmask_b32 v66, v66, v126, s[56:57]
v_cndmask_b32 v67, v67, v126, s[58:59]
L_domask_fa2_all:
v_mov_b64 v[72:73], v[126:127]
v_mov_b64 v[74:75], v[126:127]
s_branch L_nomask_fa2
L_domask_fa2_odd:
s_nop 3
v_cndmask_b32 v72, v72, v126, s[52:53]
v_cndmask_b32 v73, v73, v126, s[54:55]
v_cndmask_b32 v74, v74, v126, s[56:57]
v_cndmask_b32 v75, v75, v126, s[58:59]
L_nomask_fa2:
v_exp_f32 v16, v64
Zvaa 84,64,32
s_cmp_ge_u32 s30, 131072
RD 120,6,30720
v_exp_f32 v17, v65
Mvaa 84,68,36
buffer_load_dwordx4 v2, s[4:7], s31 offen offset:0 sc1 lds
Mvaa 84,72,48
s_waitcnt vmcnt(22) lgkmcnt(7)
s_cselect_b32 s36, s33, s34
RD 124,6,31744
v_cvt_pk_bf16_f32 v96, v16, v17
Mvaa 84,76,52
s_barrier
v_add_u32 v6, s36, v6
v_exp_f32 v18, v66
Mvaa 84,80,40
RD 64,6,0
v_exp_f32 v19, v67
Mvaa 84,84,44
v_cvt_pk_bf16_f32 v97, v18, v19
v_exp_f32 v20, v76
Mvaa 84,88,56
RD 68,6,1024
v_exp_f32 v21, v77
Mvaa 84,92,60
v_cvt_pk_bf16_f32 v102, v20, v21
v_exp_f32 v22, v78
Mvaa 80,80,8
s_add_u32 s29, s29, 1
RD 72,6,2048
v_exp_f32 v23, v79
Mvaa 80,84,12
buffer_load_dwordx4 v2, s[4:7], s31 offen offset:1024 sc1 lds
Mvaa 80,88,24
s_waitcnt lgkmcnt(7)
RD 76,6,3072
v_cvt_pk_bf16_f32 v103, v22, v23
v_add_f32 v122, v16, v17
Mvaa 80,92,28
v_exp_f32 v12, v72
v_add_f32 v123, v18, v19
Zvaa 88,96,0
RD 80,6,4096
v_exp_f32 v13, v73
Mvaa 88,100,4
v_cvt_pk_bf16_f32 v98, v12, v13
v_exp_f32 v14, v74
Mvaa 88,104,16
RD 84,6,5120
v_exp_f32 v15, v75
Mvaa 88,108,20
v_cvt_pk_bf16_f32 v99, v14, v15
v_add_f32 v124, v124, v20
v_add_f32 v124, v124, v21
Zvaa 92,96,32
RD 88,6,6144
v_add_f32 v125, v125, v22
Mvaa 92,100,36
buffer_load_dwordx4 v2, s[4:7], s31 offen offset:2048 sc1 lds
Mvaa 92,104,48
s_waitcnt lgkmcnt(7)
RD 92,6,7168
v_add_f32 v125, v125, v23
v_add_f32 v122, v122, v12
Mvaa 92,108,52
v_readlane_b32 s32, v3, s29
v_add_f32 v122, v122, v13
Mvaa 92,112,40
RD 96,6,8192
v_add_f32 v123, v123, v14
Mvaa 92,116,44
v_add_f32 v123, v123, v15
v_add_f32 v122, v122, v123
v_add_f32 v124, v124, v125
Mvaa 92,120,56
s_waitcnt vmcnt(7)
RD 100,6,9216
v_cmp_ne_u32 s[80:81], s38, v7
Mvaa 92,124,60
v_subrev_u32 v26, 0x2b800000, v122
v_subrev_u32 v27, 0x2b800000, v124
v_max_u32 v26, v26, v27
Mvaa 88,112,8
s_cmp_lg_u64 s[80:81], 0
s_cbranch_scc1 L_pw_kv2b
L_po_kv2b:
s_barrier
RD 104,6,10240
Mvaa 88,116,12
buffer_load_dwordx4 v2, s[4:7], s31 offen offset:3072 sc1 lds
Mvaa 88,120,24
s_waitcnt lgkmcnt(7)
RD 108,6,11264
v_cmp_lt_u32 vcc, 0x28000000, v26
Mvaa 88,124,28
s_mov_b32 m0, s30
s_cbranch_vccz L_fok_fa2
s_sub_u32 s77, s41, s43
v_cndmask_b32 v26, v122, 1.0, s[52:53]
v_subrev_u32 v26, 0x2b800000, v26
v_max_u32 v26, v26, v27
v_cmp_lt_u32 vcc, 0x28000000, v26
s_or_b32 s77, s77, s24
s_cbranch_scc1 L_fchk_fa2
s_nop 2
s_cbranch_vccnz L_fchk_fa2
L_fok_fa2:
s_mov_b32 s46, 0
s_mov_b32 s45, 0
s_cmp_eq_u32 s43, 1
s_cbranch_scc1 L_u40
L_s1z0:
Zvav 128,64,96
RD 112,6,12288
v_add_f32 v120, v120, v122
Zvav 132,64,100
v_exp_f32 v12, v80
Zvav 136,68,96
RD 116,6,13312
v_add_f32 v121, v121, v124
Zvav 140,68,100
v_exp_f32 v13, v81
Zvav 144,72,96
RD 120,6,14336
v_cvt_pk_bf16_f32 v104, v12, v13
Zvav 148,72,100
buffer_load_dwordx4 v2, s[4:7], s32 offen offset:0 sc1 lds
Zvav 152,76,96
s_waitcnt lgkmcnt(7)
RD 124,6,15360
v_add_f32 v122, v12, v13
Zvav 156,76,100
v_exp_f32 v14, v82
Zvav 160,80,96
RD 64,6,16384
Zvav 164,80,100
v_exp_f32 v15, v83
Zvav 168,84,96
RD 68,6,17408
v_cvt_pk_bf16_f32 v105, v14, v15
Zvav 172,84,100
v_exp_f32 v16, v84
Zvav 176,88,96
RD 72,6,18432
v_add_f32 v123, v14, v15
Zvav 180,88,100
buffer_load_dwordx4 v2, s[4:7], s32 offen offset:1024 sc1 lds
Zvav 184,92,96
s_waitcnt lgkmcnt(7)
RD 76,6,19456
Zvav 188,92,100
v_exp_f32 v17, v85
Zvav 192,96,96
RD 80,6,20480
v_cvt_pk_bf16_f32 v108, v16, v17
Zvav 196,96,100
v_exp_f32 v18, v86
Zvav 200,100,96
RD 84,6,21504
v_add_f32 v124, v16, v17
Zvav 204,100,100
v_exp_f32 v19, v87
Zvav 208,104,96
RD 88,6,22528
v_cvt_pk_bf16_f32 v109, v18, v19
Zvav 212,104,100
buffer_load_dwordx4 v2, s[4:7], s32 offen offset:2048 sc1 lds
Zvav 216,108,96
s_waitcnt lgkmcnt(7)
RD 92,6,23552
v_add_f32 v125, v18, v19
Zvav 220,108,100
v_exp_f32 v20, v88
Zvav 224,112,96
RD 96,6,24576
v_add_f32 v122, v122, v20
Zvav 228,112,100
v_exp_f32 v21, v89
Zvav 232,116,96
RD 100,6,25600
v_cvt_pk_bf16_f32 v106, v20, v21
Zvav 236,116,100
v_exp_f32 v22, v90
Zvav 240,120,96
RD 104,6,26624
v_add_f32 v122, v122, v21
Zvav 244,120,100
buffer_load_dwordx4 v2, s[4:7], s32 offen offset:3072 sc1 lds
Zvav 248,124,96
s_waitcnt lgkmcnt(7)
RD 108,6,27648
v_add_f32 v123, v123, v22
Zvav 252,124,100
s_add_u32 m0, s30, 16384
v_readlane_b32 s31, v4, s29
Nvaa 64,64,0,112
RD 112,6,28672
Mvaa 64,68,4
v_exp_f32 v23, v91
Mvaa 64,72,16
s_add_u32 s30, s30, s36
RD 116,6,29696
v_cvt_pk_bf16_f32 v107, v22, v23
Mvaa 64,76,20
v_exp_f32 v12, v92
Nvaa 68,64,32,116
s_cmp_ge_u32 s30, 131072
RD 120,6,30720
v_add_f32 v123, v123, v23
Mvaa 68,68,36
buffer_load_dwordx4 v2, s[4:7], s31 offen offset:0 sc1 lds
Mvaa 68,72,48
s_waitcnt vmcnt(22) lgkmcnt(7)
s_cselect_b32 s36, s33, s34
RD 124,6,31744
Mvaa 68,76,52
s_barrier
v_add_u32 v6, s36, v6
v_add_f32 v124, v124, v12
Mvaa 68,80,40
RD 64,6,0
v_add_f32 v122, v122, v123
Mvaa 68,84,44
v_exp_f32 v13, v93
Mvaa 68,88,56
RD 68,6,1024
v_cvt_pk_bf16_f32 v110, v12, v13
Mvaa 68,92,60
v_exp_f32 v14, v94
Mvaa 64,80,8
s_add_u32 s29, s29, 1
RD 72,6,2048
v_add_f32 v124, v124, v13
Mvaa 64,84,12
buffer_load_dwordx4 v2, s[4:7], s31 offen offset:1024 sc1 lds
Mvaa 64,88,24
s_waitcnt lgkmcnt(7)
RD 76,6,3072
v_add_f32 v125, v125, v14
Mvaa 64,92,28
v_exp_f32 v15, v95
Nvaa 72,96,0,112
RD 80,6,4096
v_cvt_pk_bf16_f32 v111, v14, v15
Mvaa 72,100,4
v_add_f32 v125, v125, v15
v_add_f32 v124, v124, v125
Mvaa 72,104,16
RD 84,6,5120
v_max_f32 v26, v122, v124
Mvaa 72,108,20
v_cmp_nge_f32 vcc, 0x53800000, v26
Nvaa 76,96,32,116
RD 88,6,6144
Mvaa 76,100,36
buffer_load_dwordx4 v2, s[4:7], s31 offen offset:2048 sc1 lds
Mvaa 76,104,48
s_waitcnt lgkmcnt(7)
RD 92,6,7168
Mvaa 76,108,52
v_readlane_b32 s32, v3, s29
Mvaa 76,112,40
RD 96,6,8192
Mvaa 76,116,44
Mvaa 76,120,56
RD 100,6,9216
Mvaa 76,124,60
buffer_load_dword v7, v63, s[4:7], s65 offen sc1
Mvaa 72,112,8
RD 104,6,10240
Mvaa 72,116,12
buffer_load_dwordx4 v2, s[4:7], s31 offen offset:3072 sc1 lds
Mvaa 72,120,24
s_waitcnt lgkmcnt(7)
RD 108,6,11264
Mvaa 72,124,28
s_mov_b32 m0, s30
s_cbranch_vccnz L_dorare_z0
L_norare_z0:
s_branch L_mid0
.p2align 6
.p2align 12
LP30:
s_setpc_b64 s[48:49]
L_steady0:
Mvav 128,64,96
RD 112,6,12288
v_add_f32 v120, v120, v122
Mvav 132,64,100
v_exp_f32 v12, v80
Mvav 136,68,96
RD 116,6,13312
v_add_f32 v121, v121, v124
Mvav 140,68,100
v_exp_f32 v13, v81
Mvav 144,72,96
RD 120,6,14336
v_cvt_pk_bf16_f32 v104, v12, v13
Mvav 148,72,100
buffer_load_dwordx4 v2, s[4:7], s32 offen offset:0 sc1 lds
Mvav 152,76,96
s_waitcnt lgkmcnt(7)
RD 124,6,15360
v_add_f32 v122, v12, v13
Mvav 156,76,100
v_exp_f32 v14, v82
Mvav 160,80,96
RD 64,6,16384
Mvav 164,80,100
v_exp_f32 v15, v83
Mvav 168,84,96
RD 68,6,17408
v_cvt_pk_bf16_f32 v105, v14, v15
Mvav 172,84,100
v_exp_f32 v16, v84
Mvav 176,88,96
RD 72,6,18432
v_add_f32 v123, v14, v15
Mvav 180,88,100
buffer_load_dwordx4 v2, s[4:7], s32 offen offset:1024 sc1 lds
Mvav 184,92,96
s_waitcnt lgkmcnt(7)
RD 76,6,19456
Mvav 188,92,100
v_exp_f32 v17, v85
Mvav 192,96,96
RD 80,6,20480
v_cvt_pk_bf16_f32 v108, v16, v17
Mvav 196,96,100
v_exp_f32 v18, v86
Mvav 200,100,96
RD 84,6,21504
v_add_f32 v124, v16, v17
Mvav 204,100,100
v_exp_f32 v19, v87
Mvav 208,104,96
RD 88,6,22528
v_cvt_pk_bf16_f32 v109, v18, v19
Mvav 212,104,100
buffer_load_dwordx4 v2, s[4:7], s32 offen offset:2048 sc1 lds
Mvav 216,108,96
s_waitcnt lgkmcnt(7)
RD 92,6,23552
v_add_f32 v125, v18, v19
Mvav 220,108,100
v_exp_f32 v20, v88
Mvav 224,112,96
RD 96,6,24576
v_add_f32 v122, v122, v20
Mvav 228,112,100
v_exp_f32 v21, v89
Mvav 232,116,96
RD 100,6,25600
v_cvt_pk_bf16_f32 v106, v20, v21
Mvav 236,116,100
v_exp_f32 v22, v90
Mvav 240,120,96
RD 104,6,26624
v_add_f32 v122, v122, v21
Mvav 244,120,100
buffer_load_dwordx4 v2, s[4:7], s32 offen offset:3072 sc1 lds
Mvav 248,124,96
s_waitcnt lgkmcnt(7)
RD 108,6,27648
v_add_f32 v123, v123, v22
Mvav 252,124,100
s_add_u32 m0, s30, 16384
v_readlane_b32 s31, v4, s29
Nvaa 64,64,0,112
RD 112,6,28672
Mvaa 64,68,4
v_exp_f32 v23, v91
Mvaa 64,72,16
s_add_u32 s30, s30, s36
RD 116,6,29696
v_cvt_pk_bf16_f32 v107, v22, v23
Mvaa 64,76,20
v_exp_f32 v12, v92
Nvaa 68,64,32,116
s_cmp_ge_u32 s30, 131072
RD 120,6,30720
v_add_f32 v123, v123, v23
Mvaa 68,68,36
buffer_load_dwordx4 v2, s[4:7], s31 offen offset:0 sc1 lds
Mvaa 68,72,48
s_waitcnt vmcnt(21) lgkmcnt(7)
s_cselect_b32 s36, s33, s34
RD 124,6,31744
Mvaa 68,76,52
s_barrier
v_add_u32 v6, s36, v6
v_add_f32 v124, v124, v12
Mvaa 68,80,40
RD 64,6,0
v_add_f32 v122, v122, v123
Mvaa 68,84,44
v_exp_f32 v13, v93
Mvaa 68,88,56
RD 68,6,1024
v_cvt_pk_bf16_f32 v110, v12, v13
Mvaa 68,92,60
v_exp_f32 v14, v94
Mvaa 64,80,8
s_add_u32 s29, s29, 1
RD 72,6,2048
v_add_f32 v124, v124, v13
Mvaa 64,84,12
buffer_load_dwordx4 v2, s[4:7], s31 offen offset:1024 sc1 lds
Mvaa 64,88,24
s_waitcnt lgkmcnt(7)
RD 76,6,3072
v_add_f32 v125, v125, v14
Mvaa 64,92,28
v_exp_f32 v15, v95
Nvaa 72,96,0,112
RD 80,6,4096
v_cvt_pk_bf16_f32 v111, v14, v15
Mvaa 72,100,4
v_add_f32 v125, v125, v15
v_add_f32 v124, v124, v125
Mvaa 72,104,16
RD 84,6,5120
v_max_f32 v26, v122, v124
Mvaa 72,108,20
v_cmp_nge_f32 vcc, 0x53800000, v26
Nvaa 76,96,32,116
RD 88,6,6144
Mvaa 76,100,36
buffer_load_dwordx4 v2, s[4:7], s31 offen offset:2048 sc1 lds
Mvaa 76,104,48
s_waitcnt lgkmcnt(7)
RD 92,6,7168
Mvaa 76,108,52
v_readlane_b32 s32, v3, s29
Mvaa 76,112,40
RD 96,6,8192
Mvaa 76,116,44
Mvaa 76,120,56
RD 100,6,9216
Mvaa 76,124,60
buffer_load_dword v7, v63, s[4:7], s65 offen sc1
Mvaa 72,112,8
RD 104,6,10240
Mvaa 72,116,12
buffer_load_dwordx4 v2, s[4:7], s31 offen offset:3072 sc1 lds
Mvaa 72,120,24
s_waitcnt lgkmcnt(7)
RD 108,6,11264
Mvaa 72,124,28
s_mov_b32 m0, s30
s_cbranch_vccnz L_dorare_s10
L_norare_s10:
L_mid0:
s_cmp_eq_u32 s43, s42
Mvav 128,64,104
s_cbranch_scc1 L_domask_s00
L_nomask_s00:
RD 112,6,12288
v_add_f32 v120, v120, v122
Mvav 132,64,108
v_exp_f32 v12, v64
Mvav 136,68,104
RD 116,6,13312
v_add_f32 v121, v121, v124
Mvav 140,68,108
v_exp_f32 v13, v65
Mvav 144,72,104
RD 120,6,14336
v_cvt_pk_bf16_f32 v96, v12, v13
Mvav 148,72,108
buffer_load_dwordx4 v2, s[4:7], s32 offen offset:0 sc1 lds
Mvav 152,76,104
s_waitcnt lgkmcnt(7)
RD 124,6,15360
v_add_f32 v122, v12, v13
Mvav 156,76,108
v_exp_f32 v14, v66
Mvav 160,80,104
RD 64,6,16384
Mvav 164,80,108
v_exp_f32 v15, v67
Mvav 168,84,104
RD 68,6,17408
v_cvt_pk_bf16_f32 v97, v14, v15
Mvav 172,84,108
v_exp_f32 v16, v68
Mvav 176,88,104
RD 72,6,18432
v_add_f32 v123, v14, v15
Mvav 180,88,108
buffer_load_dwordx4 v2, s[4:7], s32 offen offset:1024 sc1 lds
Mvav 184,92,104
s_waitcnt lgkmcnt(7)
RD 76,6,19456
Mvav 188,92,108
v_exp_f32 v17, v69
Mvav 192,96,104
RD 80,6,20480
v_cvt_pk_bf16_f32 v100, v16, v17
Mvav 196,96,108
v_exp_f32 v18, v70
Mvav 200,100,104
RD 84,6,21504
v_add_f32 v124, v16, v17
Mvav 204,100,108
v_exp_f32 v19, v71
Mvav 208,104,104
RD 88,6,22528
v_cvt_pk_bf16_f32 v101, v18, v19
Mvav 212,104,108
buffer_load_dwordx4 v2, s[4:7], s32 offen offset:2048 sc1 lds
Mvav 216,108,104
s_waitcnt lgkmcnt(7)
RD 92,6,23552
v_add_f32 v125, v18, v19
Mvav 220,108,108
v_exp_f32 v20, v72
Mvav 224,112,104
RD 96,6,24576
v_add_f32 v122, v122, v20
Mvav 228,112,108
v_exp_f32 v21, v73
Mvav 232,116,104
RD 100,6,25600
v_cvt_pk_bf16_f32 v98, v20, v21
Mvav 236,116,108
v_exp_f32 v22, v74
Mvav 240,120,104
RD 104,6,26624
v_add_f32 v122, v122, v21
Mvav 244,120,108
buffer_load_dwordx4 v2, s[4:7], s32 offen offset:3072 sc1 lds
Mvav 248,124,104
s_waitcnt lgkmcnt(7)
RD 108,6,27648
v_add_f32 v123, v123, v22
Mvav 252,124,108
s_add_u32 m0, s30, 16384
v_readlane_b32 s31, v4, s29
Nvaa 80,64,0,112
RD 112,6,28672
Mvaa 80,68,4
v_exp_f32 v23, v75
Mvaa 80,72,16
s_add_u32 s30, s30, s36
RD 116,6,29696
v_cvt_pk_bf16_f32 v99, v22, v23
Mvaa 80,76,20
v_exp_f32 v12, v76
Nvaa 84,64,32,116
s_cmp_ge_u32 s30, 131072
RD 120,6,30720
v_add_f32 v123, v123, v23
Mvaa 84,68,36
buffer_load_dwordx4 v2, s[4:7], s31 offen offset:0 sc1 lds
Mvaa 84,72,48
s_waitcnt vmcnt(21) lgkmcnt(7)
s_cselect_b32 s36, s33, s34
RD 124,6,31744
Mvaa 84,76,52
s_barrier
v_add_u32 v6, s36, v6
v_add_f32 v124, v124, v12
Mvaa 84,80,40
RD 64,6,0
v_add_f32 v122, v122, v123
Mvaa 84,84,44
v_exp_f32 v13, v77
Mvaa 84,88,56
RD 68,6,1024
v_cvt_pk_bf16_f32 v102, v12, v13
Mvaa 84,92,60
v_exp_f32 v14, v78
Mvaa 80,80,8
s_add_u32 s29, s29, 1
RD 72,6,2048
v_add_f32 v124, v124, v13
Mvaa 80,84,12
buffer_load_dwordx4 v2, s[4:7], s31 offen offset:1024 sc1 lds
Mvaa 80,88,24
s_waitcnt lgkmcnt(7)
RD 76,6,3072
v_add_f32 v125, v125, v14
Mvaa 80,92,28
v_exp_f32 v15, v79
Nvaa 88,96,0,112
RD 80,6,4096
v_cvt_pk_bf16_f32 v103, v14, v15
Mvaa 88,100,4
v_add_f32 v125, v125, v15
v_add_f32 v124, v124, v125
Mvaa 88,104,16
RD 84,6,5120
v_max_f32 v26, v122, v124
Mvaa 88,108,20
v_cmp_nge_f32 vcc, 0x53800000, v26
Nvaa 92,96,32,116
RD 88,6,6144
Mvaa 92,100,36
buffer_load_dwordx4 v2, s[4:7], s31 offen offset:2048 sc1 lds
Mvaa 92,104,48
s_waitcnt lgkmcnt(7)
RD 92,6,7168
Mvaa 92,108,52
v_readlane_b32 s32, v3, s29
Mvaa 92,112,40
s_sub_u32 s43, s43, 1
RD 96,6,8192
Mvaa 92,116,44
Mvaa 92,120,56
s_cmp_lg_u32 s43, s44
RD 100,6,9216
Mvaa 92,124,60
Mvaa 88,112,8
RD 104,6,10240
Mvaa 88,116,12
buffer_load_dwordx4 v2, s[4:7], s31 offen offset:3072 sc1 lds
Mvaa 88,120,24
s_waitcnt lgkmcnt(7)
RD 108,6,11264
Mvaa 88,124,28
s_mov_b32 m0, s30
s_cbranch_vccnz L_dorare_s00
L_norare_s00:
s_cbranch_scc1 L_steady0
L_exit0:
s_cmp_gt_u32 s44, 1
s_cbranch_scc1 L_gv0
s_cmp_ge_u32 s60, 2
s_mov_b32 s44, 0
s_cbranch_scc1 L_lpack
s_branch L_end0
L_gv0:
s_cmp_gt_u32 s44, 9
s_cbranch_scc1 L_kv3
s_mov_b32 s44, 1
s_waitcnt vmcnt(9)
v_cmp_ne_u32 vcc, 1, v7
s_add_u32 s79, s64, 462848
s_nop 3
s_cbranch_vccnz L_pw_gv0
L_po_gv0:
s_cmp_ge_u32 s60, 2
s_cselect_b32 s65, 2130706432, s72
v_mov_b32 v63, v8
Mvav 128,64,96
RD 112,6,12288
v_add_f32 v120, v120, v122
Mvav 132,64,100
v_exp_f32 v12, v80
Mvav 136,68,96
RD 116,6,13312
v_exp_f32 v13, v81
Mvav 140,68,100
buffer_load_dwordx4 a[192:195], v61, s[4:7], s64 offen offset:0 sc1
Mvav 144,72,96
RD 120,6,14336
v_cvt_pk_bf16_f32 v104, v12, v13
Mvav 148,72,100
buffer_load_dwordx4 v2, s[4:7], s32 offen offset:0 sc1 lds
Mvav 152,76,96
s_waitcnt lgkmcnt(7)
RD 124,6,15360
v_exp_f32 v14, v82
Mvav 156,76,100
v_exp_f32 v15, v83
Mvav 160,80,96
RD 64,6,16384
v_cvt_pk_bf16_f32 v105, v14, v15
Mvav 164,80,100
buffer_load_dwordx4 a[196:199], v62, s[4:7], s79 offen offset:0 sc1
Mvav 168,84,96
RD 68,6,17408
v_exp_f32 v16, v84
Mvav 172,84,100
v_exp_f32 v17, v85
Mvav 176,88,96
RD 72,6,18432
v_cvt_pk_bf16_f32 v108, v16, v17
Mvav 180,88,100
buffer_load_dwordx4 v2, s[4:7], s32 offen offset:1024 sc1 lds
Mvav 184,92,96
s_waitcnt lgkmcnt(7)
RD 76,6,19456
v_exp_f32 v18, v86
Mvav 188,92,100
v_exp_f32 v19, v87
Mvav 192,96,96
RD 80,6,20480
v_cvt_pk_bf16_f32 v109, v18, v19
Mvav 196,96,100
buffer_load_dwordx4 a[200:203], v61, s[4:7], s64 offen offset:1024 sc1
Mvav 200,100,96
RD 84,6,21504
v_exp_f32 v20, v88
Mvav 204,100,100
v_exp_f32 v21, v89
Mvav 208,104,96
RD 88,6,22528
v_cvt_pk_bf16_f32 v106, v20, v21
Mvav 212,104,100
buffer_load_dwordx4 v2, s[4:7], s32 offen offset:2048 sc1 lds
Mvav 216,108,96
s_waitcnt lgkmcnt(7)
RD 92,6,23552
v_add_f32 v121, v121, v124
Mvav 220,108,100
v_exp_f32 v22, v90
Mvav 224,112,96
RD 96,6,24576
v_add_f32 v122, v12, v13
Mvav 228,112,100
buffer_load_dwordx4 a[204:207], v62, s[4:7], s79 offen offset:1024 sc1
Mvav 232,116,96
RD 100,6,25600
v_add_f32 v123, v14, v15
Mvav 236,116,100
v_exp_f32 v23, v91
Mvav 240,120,96
RD 104,6,26624
v_cvt_pk_bf16_f32 v107, v22, v23
Mvav 244,120,100
buffer_load_dwordx4 v2, s[4:7], s32 offen offset:3072 sc1 lds
Mvav 248,124,96
s_waitcnt lgkmcnt(7)
RD 108,6,27648
v_add_f32 v124, v16, v17
Mvav 252,124,100
s_add_u32 m0, s30, 16384
v_readlane_b32 s31, v4, s29
Nvaa 64,64,0,112
RD 112,6,28672
v_add_f32 v125, v18, v19
Mvaa 64,68,4
buffer_load_dwordx4 a[208:211], v61, s[4:7], s64 offen offset:256 sc1
Mvaa 64,72,16
s_add_u32 s30, s30, s36
RD 116,6,29696
v_add_f32 v122, v122, v20
Mvaa 64,76,20
v_exp_f32 v12, v92
Nvaa 68,64,32,116
s_cmp_ge_u32 s30, 131072
RD 120,6,30720
v_add_f32 v122, v122, v21
Mvaa 68,68,36
buffer_load_dwordx4 v2, s[4:7], s31 offen offset:0 sc1 lds
Mvaa 68,72,48
s_waitcnt vmcnt(26) lgkmcnt(7)
s_cselect_b32 s36, s33, s34
RD 124,6,31744
Mvaa 68,76,52
s_barrier
v_add_u32 v6, s36, v6
v_add_f32 v123, v123, v22
Mvaa 68,80,40
RD 64,6,0
v_add_f32 v123, v123, v23
Mvaa 68,84,44
buffer_load_dwordx4 a[212:215], v62, s[4:7], s79 offen offset:256 sc1
Mvaa 68,88,56
RD 68,6,1024
v_add_f32 v124, v124, v12
Mvaa 68,92,60
v_exp_f32 v13, v93
Mvaa 64,80,8
s_add_u32 s29, s29, 1
RD 72,6,2048
v_cvt_pk_bf16_f32 v110, v12, v13
Mvaa 64,84,12
buffer_load_dwordx4 v2, s[4:7], s31 offen offset:1024 sc1 lds
Mvaa 64,88,24
s_waitcnt lgkmcnt(7)
RD 76,6,3072
v_add_f32 v124, v124, v13
Mvaa 64,92,28
v_exp_f32 v14, v94
Nvaa 72,96,0,112
RD 80,6,4096
v_add_f32 v125, v125, v14
Mvaa 72,100,4
buffer_load_dwordx4 a[216:219], v61, s[4:7], s64 offen offset:1280 sc1
Mvaa 72,104,16
RD 84,6,5120
v_add_f32 v122, v122, v123
Mvaa 72,108,20
v_exp_f32 v15, v95
Nvaa 76,96,32,116
RD 88,6,6144
v_cvt_pk_bf16_f32 v111, v14, v15
Mvaa 76,100,36
buffer_load_dwordx4 v2, s[4:7], s31 offen offset:2048 sc1 lds
Mvaa 76,104,48
s_waitcnt lgkmcnt(7)
RD 92,6,7168
v_add_f32 v125, v125, v15
Mvaa 76,108,52
v_readlane_b32 s32, v3, s29
Mvaa 76,112,40
RD 96,6,8192
v_add_f32 v124, v124, v125
Mvaa 76,116,44
buffer_load_dwordx4 a[220:223], v62, s[4:7], s79 offen offset:1280 sc1
Mvaa 76,120,56
RD 100,6,9216
v_max_f32 v26, v122, v124
Mvaa 76,124,60
buffer_load_dword v7, v63, s[4:7], s65 offen sc1
Mvaa 72,112,8
RD 104,6,10240
v_cmp_nge_f32 vcc, 0x53800000, v26
Mvaa 72,116,12
buffer_load_dwordx4 v2, s[4:7], s31 offen offset:3072 sc1 lds
Mvaa 72,120,24
s_waitcnt lgkmcnt(7)
RD 108,6,11264
Mvaa 72,124,28
s_mov_b32 m0, s30
s_cbranch_vccnz L_dorare_gv10
L_norare_gv10:
s_cmp_eq_u32 s43, s42
Mvav 128,64,104
s_cbranch_scc0 L_nomask_gv00
s_bitcmp1_b32 s24, 0
s_cbranch_scc1 L_domask_gv00_odd
v_cndmask_b32 v64, v64, v126, s[52:53]
v_cndmask_b32 v65, v65, v126, s[54:55]
v_cndmask_b32 v66, v66, v126, s[56:57]
v_cndmask_b32 v67, v67, v126, s[58:59]
L_domask_gv00_all:
v_mov_b64 v[72:73], v[126:127]
v_mov_b64 v[74:75], v[126:127]
s_branch L_nomask_gv00
L_domask_gv00_odd:
s_nop 3
v_cndmask_b32 v72, v72, v126, s[52:53]
v_cndmask_b32 v73, v73, v126, s[54:55]
v_cndmask_b32 v74, v74, v126, s[56:57]
v_cndmask_b32 v75, v75, v126, s[58:59]
L_nomask_gv00:
RD 112,6,12288
v_add_f32 v120, v120, v122
Mvav 132,64,108
v_exp_f32 v12, v64
Mvav 136,68,104
RD 116,6,13312
v_exp_f32 v13, v65
Mvav 140,68,108
buffer_load_dwordx4 a[224:227], v61, s[4:7], s64 offen offset:512 sc1
Mvav 144,72,104
RD 120,6,14336
v_cvt_pk_bf16_f32 v96, v12, v13
Mvav 148,72,108
buffer_load_dwordx4 v2, s[4:7], s32 offen offset:0 sc1 lds
Mvav 152,76,104
s_waitcnt lgkmcnt(7)
RD 124,6,15360
v_add_f32 v121, v121, v124
Mvav 156,76,108
v_exp_f32 v14, v66
Mvav 160,80,104
RD 64,6,16384
v_add_f32 v122, v12, v13
Mvav 164,80,108
buffer_load_dwordx4 a[228:231], v62, s[4:7], s79 offen offset:512 sc1
Mvav 168,84,104
RD 68,6,17408
Mvav 172,84,108
v_exp_f32 v15, v67
Mvav 176,88,104
RD 72,6,18432
v_cvt_pk_bf16_f32 v97, v14, v15
Mvav 180,88,108
buffer_load_dwordx4 v2, s[4:7], s32 offen offset:1024 sc1 lds
Mvav 184,92,104
s_waitcnt lgkmcnt(7)
RD 76,6,19456
v_exp_f32 v16, v68
Mvav 188,92,108
v_exp_f32 v17, v69
Mvav 192,96,104
RD 80,6,20480
v_cvt_pk_bf16_f32 v100, v16, v17
Mvav 196,96,108
buffer_load_dwordx4 a[232:235], v61, s[4:7], s64 offen offset:1536 sc1
Mvav 200,100,104
RD 84,6,21504
v_add_f32 v123, v14, v15
Mvav 204,100,108
v_exp_f32 v18, v70
Mvav 208,104,104
RD 88,6,22528
v_add_f32 v124, v16, v17
Mvav 212,104,108
buffer_load_dwordx4 v2, s[4:7], s32 offen offset:2048 sc1 lds
Mvav 216,108,104
s_waitcnt lgkmcnt(7)
RD 92,6,23552
Mvav 220,108,108
v_exp_f32 v19, v71
Mvav 224,112,104
RD 96,6,24576
s_branch LOP31
LP31:
s_setpc_b64 s[48:49]
LOP31:
v_cvt_pk_bf16_f32 v101, v18, v19
Mvav 228,112,108
buffer_load_dwordx4 a[236:239], v62, s[4:7], s79 offen offset:1536 sc1
Mvav 232,116,104
RD 100,6,25600
v_exp_f32 v20, v72
Mvav 236,116,108
v_exp_f32 v21, v73
Mvav 240,120,104
RD 104,6,26624
v_cvt_pk_bf16_f32 v98, v20, v21
Mvav 244,120,108
buffer_load_dwordx4 v2, s[4:7], s32 offen offset:3072 sc1 lds
Mvav 248,124,104
s_waitcnt lgkmcnt(7)
RD 108,6,27648
v_add_f32 v125, v18, v19
Mvav 252,124,108
s_add_u32 m0, s30, 16384
v_readlane_b32 s31, v4, s29
Nvaa 80,64,0,112
RD 112,6,28672
v_add_f32 v122, v122, v20
Mvaa 80,68,4
buffer_load_dwordx4 a[240:243], v61, s[4:7], s64 offen offset:768 sc1
Mvaa 80,72,16
s_add_u32 s30, s30, s36
RD 116,6,29696
v_add_f32 v122, v122, v21
Mvaa 80,76,20
v_exp_f32 v22, v74
Nvaa 84,64,32,116
s_cmp_ge_u32 s30, 131072
RD 120,6,30720
v_add_f32 v123, v123, v22
Mvaa 84,68,36
buffer_load_dwordx4 v2, s[4:7], s31 offen offset:0 sc1 lds
Mvaa 84,72,48
s_waitcnt vmcnt(35) lgkmcnt(7)
s_cselect_b32 s36, s33, s34
RD 124,6,31744
Mvaa 84,76,52
s_barrier
v_add_u32 v6, s36, v6
v_exp_f32 v23, v75
Mvaa 84,80,40
RD 64,6,0
v_cvt_pk_bf16_f32 v99, v22, v23
Mvaa 84,84,44
buffer_load_dwordx4 a[244:247], v62, s[4:7], s79 offen offset:768 sc1
Mvaa 84,88,56
RD 68,6,1024
v_add_f32 v123, v123, v23
Mvaa 84,92,60
v_exp_f32 v12, v76
Mvaa 80,80,8
s_add_u32 s29, s29, 1
RD 72,6,2048
v_add_f32 v124, v124, v12
Mvaa 80,84,12
buffer_load_dwordx4 v2, s[4:7], s31 offen offset:1024 sc1 lds
Mvaa 80,88,24
s_waitcnt lgkmcnt(7)
RD 76,6,3072
v_add_f32 v122, v122, v123
Mvaa 80,92,28
v_exp_f32 v13, v77
Nvaa 88,96,0,112
RD 80,6,4096
v_cvt_pk_bf16_f32 v102, v12, v13
Mvaa 88,100,4
buffer_load_dwordx4 a[248:251], v61, s[4:7], s64 offen offset:1792 sc1
Mvaa 88,104,16
RD 84,6,5120
v_exp_f32 v14, v78
Mvaa 88,108,20
v_exp_f32 v15, v79
Nvaa 92,96,32,116
RD 88,6,6144
v_cvt_pk_bf16_f32 v103, v14, v15
Mvaa 92,100,36
buffer_load_dwordx4 v2, s[4:7], s31 offen offset:2048 sc1 lds
Mvaa 92,104,48
s_waitcnt lgkmcnt(7)
RD 92,6,7168
v_add_f32 v124, v124, v13
Mvaa 92,108,52
v_readlane_b32 s32, v3, s29
Mvaa 92,112,40
s_sub_u32 s43, s43, 1
RD 96,6,8192
v_add_f32 v125, v125, v14
Mvaa 92,116,44
buffer_load_dwordx4 a[252:255], v62, s[4:7], s79 offen offset:1792 sc1
Mvaa 92,120,56
s_cmp_lg_u32 s43, s44
RD 100,6,9216
v_add_f32 v125, v125, v15
Mvaa 92,124,60
v_add_f32 v124, v124, v125
v_max_f32 v26, v122, v124
Mvaa 88,112,8
RD 104,6,10240
v_cmp_nge_f32 vcc, 0x53800000, v26
Mvaa 88,116,12
buffer_load_dwordx4 v2, s[4:7], s31 offen offset:3072 sc1 lds
Mvaa 88,120,24
s_waitcnt lgkmcnt(7)
RD 108,6,11264
Mvaa 88,124,28
s_mov_b32 m0, s30
s_cbranch_vccnz L_dorare_gv00
L_norare_gv00:
s_cbranch_scc1 L_steady0
s_branch L_exit0
.p2align 7
LP32:
s_setpc_b64 s[48:49]
L_domask_s00:
s_bitcmp1_b32 s24, 0
s_cbranch_scc1 L_domask_s00_odd
s_cmp_eq_u32 s60, 3
v_cndmask_b32 v64, v64, v126, s[52:53]
v_cndmask_b32 v65, v65, v126, s[54:55]
v_cndmask_b32 v66, v66, v126, s[56:57]
v_cndmask_b32 v67, v67, v126, s[58:59]
L_domask_s00_all:
v_mov_b64 v[72:73], v[126:127]
v_mov_b64 v[74:75], v[126:127]
s_cbranch_scc1 L_nomask_s01
s_branch L_nomask_s00
L_domask_s00_odd:
s_nop 3
s_cmp_eq_u32 s60, 3
v_cndmask_b32 v72, v72, v126, s[52:53]
v_cndmask_b32 v73, v73, v126, s[54:55]
v_cndmask_b32 v74, v74, v126, s[56:57]
v_cndmask_b32 v75, v75, v126, s[58:59]
s_cbranch_scc1 L_nomask_s01
s_branch L_nomask_s00
LP33:
s_setpc_b64 s[48:49]
L_end0:
s_waitcnt vmcnt(9)
v_cmp_ne_u32 vcc, 1, v7
s_add_u32 s79, s67, 16384
s_cmp_eq_u32 s43, 0
s_cbranch_scc1 L_ptb
s_bitcmp1_b32 vcc_lo, 0
s_cbranch_scc1 L_steady0
buffer_load_dwordx4 v[56:59], v5, s[4:7], s79 offen sc1
Mvav 128,64,96
RD 112,6,12288
v_add_f32 v120, v120, v122
Mvav 132,64,100
v_exp_f32 v12, v80
Mvav 136,68,96
s_add_u32 s79, s67, 0
RD 116,6,13312
v_exp_f32 v13, v81
Mvav 140,68,100
buffer_load_dwordx4 a[128:131], v5, s[4:7], s79 offen offset:0 sc1
Mvav 144,72,96
RD 120,6,14336
v_cvt_pk_bf16_f32 v104, v12, v13
Mvav 148,72,100
buffer_load_dwordx4 v2, s[4:7], s32 offen offset:0 sc1 lds
Mvav 152,76,96
s_waitcnt lgkmcnt(7)
RD 124,6,15360
v_add_f32 v121, v121, v124
Mvav 156,76,100
v_exp_f32 v14, v82
Mvav 160,80,96
RD 64,6,16384
v_add_f32 v122, v12, v13
Mvav 164,80,100
buffer_load_dwordx4 a[132:135], v5, s[4:7], s79 offen offset:1024 sc1
Mvav 168,84,96
RD 68,6,17408
Mvav 172,84,100
v_exp_f32 v15, v83
Mvav 176,88,96
RD 72,6,18432
v_cvt_pk_bf16_f32 v105, v14, v15
Mvav 180,88,100
buffer_load_dwordx4 v2, s[4:7], s32 offen offset:1024 sc1 lds
Mvav 184,92,96
s_waitcnt lgkmcnt(7)
RD 76,6,19456
v_exp_f32 v16, v84
Mvav 188,92,100
v_exp_f32 v17, v85
Mvav 192,96,96
RD 80,6,20480
v_cvt_pk_bf16_f32 v108, v16, v17
Mvav 196,96,100
buffer_load_dwordx4 a[136:139], v5, s[4:7], s79 offen offset:2048 sc1
Mvav 200,100,96
RD 84,6,21504
v_add_f32 v123, v14, v15
Mvav 204,100,100
v_exp_f32 v18, v86
Mvav 208,104,96
RD 88,6,22528
v_add_f32 v124, v16, v17
Mvav 212,104,100
buffer_load_dwordx4 v2, s[4:7], s32 offen offset:2048 sc1 lds
Mvav 216,108,96
s_waitcnt lgkmcnt(7)
RD 92,6,23552
Mvav 220,108,100
v_exp_f32 v19, v87
Mvav 224,112,96
RD 96,6,24576
v_cvt_pk_bf16_f32 v109, v18, v19
Mvav 228,112,100
buffer_load_dwordx4 a[140:143], v5, s[4:7], s79 offen offset:3072 sc1
Mvav 232,116,96
RD 100,6,25600
v_exp_f32 v20, v88
Mvav 236,116,100
v_exp_f32 v21, v89
Mvav 240,120,96
RD 104,6,26624
v_cvt_pk_bf16_f32 v106, v20, v21
Mvav 244,120,100
buffer_load_dwordx4 v2, s[4:7], s32 offen offset:3072 sc1 lds
Mvav 248,124,96
s_waitcnt lgkmcnt(7)
RD 108,6,27648
v_add_f32 v125, v18, v19
Mvav 252,124,100
s_add_u32 m0, s30, 16384
v_readlane_b32 s31, v4, s29
Nvaa 64,64,0,112
s_add_u32 s79, s67, 4096
RD 112,6,28672
v_add_f32 v122, v122, v20
Mvaa 64,68,4
buffer_load_dwordx4 a[144:147], v5, s[4:7], s79 offen offset:0 sc1
Mvaa 64,72,16
s_add_u32 s30, s30, s36
RD 116,6,29696
v_add_f32 v122, v122, v21
Mvaa 64,76,20
v_exp_f32 v22, v90
Nvaa 68,64,32,116
s_cmp_ge_u32 s30, 131072
RD 120,6,30720
v_add_f32 v123, v123, v22
Mvaa 68,68,36
buffer_load_dwordx4 v2, s[4:7], s31 offen offset:0 sc1 lds
Mvaa 68,72,48
s_waitcnt vmcnt(27) lgkmcnt(7)
s_cselect_b32 s36, s33, s34
RD 124,6,31744
Mvaa 68,76,52
s_barrier
v_add_u32 v6, s36, v6
v_exp_f32 v23, v91
Mvaa 68,80,40
RD 64,6,0
v_cvt_pk_bf16_f32 v107, v22, v23
Mvaa 68,84,44
buffer_load_dwordx4 a[148:151], v5, s[4:7], s79 offen offset:1024 sc1
Mvaa 68,88,56
RD 68,6,1024
v_add_f32 v123, v123, v23
Mvaa 68,92,60
v_exp_f32 v12, v92
Mvaa 64,80,8
s_add_u32 s29, s29, 1
RD 72,6,2048
v_add_f32 v124, v124, v12
Mvaa 64,84,12
buffer_load_dwordx4 v2, s[4:7], s31 offen offset:1024 sc1 lds
Mvaa 64,88,24
s_waitcnt lgkmcnt(7)
RD 76,6,3072
v_add_f32 v122, v122, v123
Mvaa 64,92,28
v_exp_f32 v13, v93
Nvaa 72,96,0,112
RD 80,6,4096
v_cvt_pk_bf16_f32 v110, v12, v13
Mvaa 72,100,4
buffer_load_dwordx4 a[152:155], v5, s[4:7], s79 offen offset:2048 sc1
Mvaa 72,104,16
RD 84,6,5120
v_exp_f32 v14, v94
Mvaa 72,108,20
v_exp_f32 v15, v95
Nvaa 76,96,32,116
RD 88,6,6144
v_cvt_pk_bf16_f32 v111, v14, v15
Mvaa 76,100,36
buffer_load_dwordx4 v2, s[4:7], s31 offen offset:2048 sc1 lds
Mvaa 76,104,48
s_waitcnt lgkmcnt(7)
RD 92,6,7168
v_add_f32 v124, v124, v13
Mvaa 76,108,52
v_readlane_b32 s32, v3, s29
Mvaa 76,112,40
RD 96,6,8192
v_add_f32 v125, v125, v14
Mvaa 76,116,44
buffer_load_dwordx4 a[156:159], v5, s[4:7], s79 offen offset:3072 sc1
Mvaa 76,120,56
RD 100,6,9216
v_add_f32 v125, v125, v15
Mvaa 76,124,60
v_add_f32 v124, v124, v125
v_max_f32 v26, v122, v124
Mvaa 72,112,8
RD 104,6,10240
v_cmp_nge_f32 vcc, 0x53800000, v26
Mvaa 72,116,12
buffer_load_dwordx4 v2, s[4:7], s31 offen offset:3072 sc1 lds
Mvaa 72,120,24
s_waitcnt lgkmcnt(7)
RD 108,6,11264
Mvaa 72,124,28
s_mov_b32 m0, s30
s_cbranch_vccnz L_dorare_pt1
L_norare_pt1:
Mvav 128,64,104
RD 112,6,12288
v_add_f32 v120, v120, v122
Mvav 132,64,108
v_exp_f32 v12, v64
Mvav 136,68,104
s_add_u32 s79, s67, 8192
RD 116,6,13312
v_exp_f32 v13, v65
Mvav 140,68,108
buffer_load_dwordx4 a[160:163], v5, s[4:7], s79 offen offset:0 sc1
Mvav 144,72,104
RD 120,6,14336
v_cvt_pk_bf16_f32 v96, v12, v13
Mvav 148,72,108
buffer_load_dwordx4 v2, s[4:7], s32 offen offset:0 sc1 lds
Mvav 152,76,104
s_waitcnt lgkmcnt(7)
RD 124,6,15360
v_add_f32 v121, v121, v124
Mvav 156,76,108
v_exp_f32 v14, v66
Mvav 160,80,104
RD 64,6,16384
v_add_f32 v122, v12, v13
Mvav 164,80,108
buffer_load_dwordx4 a[164:167], v5, s[4:7], s79 offen offset:1024 sc1
Mvav 168,84,104
RD 68,6,17408
Mvav 172,84,108
v_exp_f32 v15, v67
Mvav 176,88,104
RD 72,6,18432
v_cvt_pk_bf16_f32 v97, v14, v15
Mvav 180,88,108
buffer_load_dwordx4 v2, s[4:7], s32 offen offset:1024 sc1 lds
Mvav 184,92,104
s_waitcnt lgkmcnt(7)
RD 76,6,19456
v_exp_f32 v16, v68
Mvav 188,92,108
v_exp_f32 v17, v69
Mvav 192,96,104
RD 80,6,20480
v_cvt_pk_bf16_f32 v100, v16, v17
Mvav 196,96,108
buffer_load_dwordx4 a[168:171], v5, s[4:7], s79 offen offset:2048 sc1
Mvav 200,100,104
RD 84,6,21504
v_add_f32 v123, v14, v15
Mvav 204,100,108
v_exp_f32 v18, v70
Mvav 208,104,104
RD 88,6,22528
v_add_f32 v124, v16, v17
Mvav 212,104,108
buffer_load_dwordx4 v2, s[4:7], s32 offen offset:2048 sc1 lds
Mvav 216,108,104
s_waitcnt lgkmcnt(7)
RD 92,6,23552
Mvav 220,108,108
v_exp_f32 v19, v71
Mvav 224,112,104
RD 96,6,24576
v_cvt_pk_bf16_f32 v101, v18, v19
Mvav 228,112,108
buffer_load_dwordx4 a[172:175], v5, s[4:7], s79 offen offset:3072 sc1
Mvav 232,116,104
RD 100,6,25600
v_exp_f32 v20, v72
Mvav 236,116,108
v_exp_f32 v21, v73
Mvav 240,120,104
RD 104,6,26624
v_cvt_pk_bf16_f32 v98, v20, v21
Mvav 244,120,108
buffer_load_dwordx4 v2, s[4:7], s32 offen offset:3072 sc1 lds
Mvav 248,124,104
s_waitcnt lgkmcnt(7)
RD 108,6,27648
v_add_f32 v125, v18, v19
Mvav 252,124,108
s_add_u32 m0, s30, 16384
v_readlane_b32 s31, v4, s29
Nvaa 80,64,0,112
s_add_u32 s79, s67, 12288
RD 112,6,28672
v_add_f32 v122, v122, v20
Mvaa 80,68,4
buffer_load_dwordx4 a[176:179], v5, s[4:7], s79 offen offset:0 sc1
Mvaa 80,72,16
s_add_u32 s30, s30, s36
RD 116,6,29696
v_add_f32 v122, v122, v21
Mvaa 80,76,20
v_exp_f32 v22, v74
Nvaa 84,64,32,116
s_cmp_ge_u32 s30, 131072
RD 120,6,30720
v_add_f32 v123, v123, v22
Mvaa 84,68,36
buffer_load_dwordx4 v2, s[4:7], s31 offen offset:0 sc1 lds
Mvaa 84,72,48
s_waitcnt vmcnt(35) lgkmcnt(7)
s_cselect_b32 s36, s33, s34
RD 124,6,31744
Mvaa 84,76,52
s_barrier
v_add_u32 v6, s36, v6
v_exp_f32 v23, v75
Mvaa 84,80,40
RD 64,6,0
v_cvt_pk_bf16_f32 v99, v22, v23
Mvaa 84,84,44
buffer_load_dwordx4 a[180:183], v5, s[4:7], s79 offen offset:1024 sc1
Mvaa 84,88,56
RD 68,6,1024
v_add_f32 v123, v123, v23
Mvaa 84,92,60
v_exp_f32 v12, v76
Mvaa 80,80,8
s_add_u32 s29, s29, 1
RD 72,6,2048
v_add_f32 v124, v124, v12
Mvaa 80,84,12
buffer_load_dwordx4 v2, s[4:7], s31 offen offset:1024 sc1 lds
Mvaa 80,88,24
s_waitcnt lgkmcnt(7)
RD 76,6,3072
v_add_f32 v122, v122, v123
Mvaa 80,92,28
v_exp_f32 v13, v77
Nvaa 88,96,0,112
RD 80,6,4096
v_cvt_pk_bf16_f32 v102, v12, v13
Mvaa 88,100,4
buffer_load_dwordx4 a[184:187], v5, s[4:7], s79 offen offset:2048 sc1
Mvaa 88,104,16
RD 84,6,5120
v_exp_f32 v14, v78
Mvaa 88,108,20
v_exp_f32 v15, v79
Nvaa 92,96,32,116
RD 88,6,6144
v_cvt_pk_bf16_f32 v103, v14, v15
Mvaa 92,100,36
buffer_load_dwordx4 v2, s[4:7], s31 offen offset:2048 sc1 lds
Mvaa 92,104,48
s_waitcnt lgkmcnt(7)
RD 92,6,7168
v_add_f32 v124, v124, v13
Mvaa 92,108,52
v_readlane_b32 s32, v3, s29
Mvaa 92,112,40
RD 96,6,8192
v_add_f32 v125, v125, v14
Mvaa 92,116,44
buffer_load_dwordx4 a[188:191], v5, s[4:7], s79 offen offset:3072 sc1
Mvaa 92,120,56
RD 100,6,9216
v_add_f32 v125, v125, v15
Mvaa 92,124,60
v_add_f32 v124, v124, v125
v_max_f32 v26, v122, v124
Mvaa 88,112,8
RD 104,6,10240
v_cmp_nge_f32 vcc, 0x53800000, v26
Mvaa 88,116,12
buffer_load_dwordx4 v2, s[4:7], s31 offen offset:3072 sc1 lds
Mvaa 88,120,24
s_waitcnt lgkmcnt(7)
RD 108,6,11264
Mvaa 88,124,28
s_mov_b32 m0, s30
s_cbranch_vccnz L_dorare_pt0
L_norare_pt0:
s_branch L_ln
L_ptb:
s_bitcmp1_b32 vcc_lo, 0
s_cbranch_scc1 L_pw_pt
L_po_pt:
buffer_load_dwordx4 v[56:59], v5, s[4:7], s79 offen sc1
s_add_u32 s79, s67, 0
buffer_load_dwordx4 a[128:131], v5, s[4:7], s79 offen offset:0 sc1
buffer_load_dwordx4 a[132:135], v5, s[4:7], s79 offen offset:1024 sc1
buffer_load_dwordx4 a[136:139], v5, s[4:7], s79 offen offset:2048 sc1
buffer_load_dwordx4 a[140:143], v5, s[4:7], s79 offen offset:3072 sc1
s_add_u32 s79, s67, 4096
buffer_load_dwordx4 a[144:147], v5, s[4:7], s79 offen offset:0 sc1
buffer_load_dwordx4 a[148:151], v5, s[4:7], s79 offen offset:1024 sc1
buffer_load_dwordx4 a[152:155], v5, s[4:7], s79 offen offset:2048 sc1
buffer_load_dwordx4 a[156:159], v5, s[4:7], s79 offen offset:3072 sc1
s_add_u32 s79, s67, 8192
buffer_load_dwordx4 a[160:163], v5, s[4:7], s79 offen offset:0 sc1
buffer_load_dwordx4 a[164:167], v5, s[4:7], s79 offen offset:1024 sc1
buffer_load_dwordx4 a[168:171], v5, s[4:7], s79 offen offset:2048 sc1
buffer_load_dwordx4 a[172:175], v5, s[4:7], s79 offen offset:3072 sc1
s_add_u32 s79, s67, 12288
buffer_load_dwordx4 a[176:179], v5, s[4:7], s79 offen offset:0 sc1
buffer_load_dwordx4 a[180:183], v5, s[4:7], s79 offen offset:1024 sc1
buffer_load_dwordx4 a[184:187], v5, s[4:7], s79 offen offset:2048 sc1
buffer_load_dwordx4 a[188:191], v5, s[4:7], s79 offen offset:3072 sc1
L_ln:
Mvav 128,64,96
RD 112,6,12288
v_add_f32 v120, v120, v122
v_add_f32 v121, v121, v124
Mvav 132,64,100
v_exp_f32 v12, v80
Mvav 136,68,96
RD 116,6,13312
v_exp_f32 v13, v81
Mvav 140,68,100
v_cvt_pk_bf16_f32 v104, v12, v13
v_exp_f32 v14, v82
Mvav 144,72,96
RD 120,6,14336
v_exp_f32 v15, v83
Mvav 148,72,100
buffer_load_dwordx4 v2, s[4:7], s32 offen offset:0 sc1 lds
Mvav 152,76,96
s_waitcnt lgkmcnt(7)
RD 124,6,15360
v_cvt_pk_bf16_f32 v105, v14, v15
v_add_f32 v122, v12, v13
Mvav 156,76,100
v_exp_f32 v16, v84
v_add_f32 v123, v14, v15
Mvav 160,80,96
RD 64,6,16384
v_exp_f32 v17, v85
Mvav 164,80,100
v_cvt_pk_bf16_f32 v108, v16, v17
v_exp_f32 v18, v86
Mvav 168,84,96
RD 68,6,17408
v_exp_f32 v19, v87
Mvav 172,84,100
v_cvt_pk_bf16_f32 v109, v18, v19
v_exp_f32 v20, v88
Mvav 176,88,96
RD 72,6,18432
v_exp_f32 v21, v89
Mvav 180,88,100
buffer_load_dwordx4 v2, s[4:7], s32 offen offset:1024 sc1 lds
Mvav 184,92,96
s_waitcnt lgkmcnt(7)
RD 76,6,19456
v_cvt_pk_bf16_f32 v106, v20, v21
v_add_f32 v124, v16, v17
Mvav 188,92,100
v_exp_f32 v22, v90
v_add_f32 v125, v18, v19
Mvav 192,96,96
RD 80,6,20480
v_exp_f32 v23, v91
Mvav 196,96,100
v_cvt_pk_bf16_f32 v107, v22, v23
v_exp_f32 v12, v92
Mvav 200,100,96
RD 84,6,21504
v_exp_f32 v13, v93
Mvav 204,100,100
v_cvt_pk_bf16_f32 v110, v12, v13
v_exp_f32 v14, v94
Mvav 208,104,96
RD 88,6,22528
v_exp_f32 v15, v95
Mvav 212,104,100
buffer_load_dwordx4 v2, s[4:7], s32 offen offset:2048 sc1 lds
Mvav 216,108,96
s_waitcnt lgkmcnt(7)
RD 92,6,23552
s_branch LOP34
LP34:
s_setpc_b64 s[48:49]
LOP34:
v_cvt_pk_bf16_f32 v111, v14, v15
v_add_f32 v122, v122, v20
Mvav 220,108,100
v_add_f32 v122, v122, v21
v_add_f32 v123, v123, v22
v_add_f32 v123, v123, v23
Mvav 224,112,96
RD 96,6,24576
v_add_f32 v124, v124, v12
Mvav 228,112,100
v_add_f32 v124, v124, v13
v_add_f32 v125, v125, v14
Mvav 232,116,96
RD 100,6,25600
v_add_f32 v125, v125, v15
Mvav 236,116,100
v_add_f32 v122, v122, v123
v_add_f32 v124, v124, v125
Mvav 240,120,96
RD 104,6,26624
v_max_f32 v26, v122, v124
Mvav 244,120,100
buffer_load_dwordx4 v2, s[4:7], s32 offen offset:3072 sc1 lds
Mvav 248,124,96
s_waitcnt lgkmcnt(7)
RD 108,6,27648
v_cmp_nge_f32 vcc, 0x53800000, v26
Mvav 252,124,100
s_add_u32 m0, s30, 16384
v_readlane_b32 s31, v4, s29
s_cbranch_vccnz L_dorare_ln
L_norare_ln:
Mvav 128,64,104
RD 112,6,28672
v_add_f32 v120, v120, v122
Mvav 132,64,108
Mvav 136,68,104
s_add_u32 s30, s30, s36
RD 116,6,29696
v_add_f32 v121, v121, v124
Mvav 140,68,108
v_and_b32 v32, 3, v1
v_lshlrev_b32 v32, 4, v32
Mvav 144,72,104
s_cmp_ge_u32 s30, 131072
RD 120,6,30720
v_mov_b32 v34, 0x3f80
Mvav 148,72,108
buffer_load_dwordx4 v2, s[4:7], s31 offen offset:0 sc1 lds
Mvav 152,76,104
s_waitcnt vmcnt(37) lgkmcnt(7)
s_cselect_b32 s36, s33, s34
RD 124,6,31744
Mvav 156,76,108
s_barrier
v_add_u32 v6, s36, v6
v_mov_b32 v35, 0
Mvav 160,80,104
RD 64,6,0
v_lshlrev_b64 v[50:51], v32, v[34:35]
Mvav 164,80,108
Mvav 168,84,104
RD 68,6,1024
Mvav 172,84,108
Mvav 176,88,104
s_add_u32 s29, s29, 1
RD 72,6,2048
Mvav 180,88,108
buffer_load_dwordx4 v2, s[4:7], s31 offen offset:1024 sc1 lds
Mvav 184,92,104
s_waitcnt lgkmcnt(7)
RD 76,6,3072
Mvav 188,92,108
Mvav 192,96,104
RD 80,6,4096
Mvav 196,96,108
Mvav 200,100,104
RD 84,6,5120
Mvav 204,100,108
Mvav 208,104,104
RD 88,6,6144
Mvav 212,104,108
buffer_load_dwordx4 v2, s[4:7], s31 offen offset:2048 sc1 lds
Mvav 216,108,104
s_waitcnt lgkmcnt(7)
RD 92,6,7168
Mvav 220,108,108
s_waitcnt vmcnt(7)
v_readlane_b32 s32, v3, s29
Mvav 224,112,104
RD 96,6,8192
v_cmp_neq_f32 vcc, v112, v56
Mvav 228,112,108
v_cmp_neq_f32 s[80:81], v116, v57
Mvav 232,116,104
RD 100,6,9216
Mvav 236,116,108
Mvav 240,120,104
RD 104,6,10240
Mvav 244,120,108
buffer_load_dwordx4 v2, s[4:7], s31 offen offset:3072 sc1 lds
Mvav 248,124,104
s_waitcnt lgkmcnt(7)
RD 108,6,11264
Mvav 252,124,108
s_mov_b32 m0, s30
s_or_b64 vcc, vcc, s[80:81]
s_cbranch_scc1 L_slowcomb
L_comb:
v_mfma_f32_4x4x4_16b_bf16 v[128:131], v[50:51], a[128:129], v[128:131]
v_add_f32 v120, v120, v58
v_add_f32 v121, v121, v59
v_mfma_f32_4x4x4_16b_bf16 v[136:139], v[50:51], a[130:131], v[136:139]
v_mfma_f32_4x4x4_16b_bf16 v[132:135], v[50:51], a[132:133], v[132:135]
v_mfma_f32_4x4x4_16b_bf16 v[140:143], v[50:51], a[134:135], v[140:143]
v_mfma_f32_4x4x4_16b_bf16 v[144:147], v[50:51], a[136:137], v[144:147]
v_mfma_f32_4x4x4_16b_bf16 v[152:155], v[50:51], a[138:139], v[152:155]
v_mfma_f32_4x4x4_16b_bf16 v[160:163], v[50:51], a[144:145], v[160:163]
v_mfma_f32_4x4x4_16b_bf16 v[168:171], v[50:51], a[146:147], v[168:171]
v_cvt_pk_bf16_f32 v128, v128, v129
v_cvt_pk_bf16_f32 v129, v130, v131
v_mfma_f32_4x4x4_16b_bf16 v[176:179], v[50:51], a[152:153], v[176:179]
v_cvt_pk_bf16_f32 v130, v136, v137
v_mfma_f32_4x4x4_16b_bf16 v[184:187], v[50:51], a[154:155], v[184:187]
v_cvt_pk_bf16_f32 v131, v138, v139
v_cvt_pk_bf16_f32 v132, v132, v133
v_mfma_f32_4x4x4_16b_bf16 v[192:195], v[50:51], a[160:161], v[192:195]
v_cvt_pk_bf16_f32 v133, v134, v135
v_mfma_f32_4x4x4_16b_bf16 v[200:203], v[50:51], a[162:163], v[200:203]
v_cvt_pk_bf16_f32 v134, v140, v141
v_cvt_pk_bf16_f32 v135, v142, v143
v_mfma_f32_4x4x4_16b_bf16 v[208:211], v[50:51], a[168:169], v[208:211]
v_cvt_pk_bf16_f32 v144, v144, v145
v_mfma_f32_4x4x4_16b_bf16 v[216:219], v[50:51], a[170:171], v[216:219]
v_cvt_pk_bf16_f32 v145, v146, v147
v_cvt_pk_bf16_f32 v146, v152, v153
v_mfma_f32_4x4x4_16b_bf16 v[224:227], v[50:51], a[176:177], v[224:227]
v_cvt_pk_bf16_f32 v147, v154, v155
v_mfma_f32_4x4x4_16b_bf16 v[232:235], v[50:51], a[178:179], v[232:235]
v_cvt_pk_bf16_f32 v160, v160, v161
v_mfma_f32_4x4x4_16b_bf16 v[240:243], v[50:51], a[184:185], v[240:243]
v_cvt_pk_bf16_f32 v161, v162, v163
v_cvt_pk_bf16_f32 v162, v168, v169
v_mfma_f32_4x4x4_16b_bf16 v[248:251], v[50:51], a[186:187], v[248:251]
v_cvt_pk_bf16_f32 v163, v170, v171
v_mfma_f32_4x4x4_16b_bf16 v[148:151], v[50:51], a[140:141], v[148:151]
v_cvt_pk_bf16_f32 v176, v176, v177
v_cvt_pk_bf16_f32 v177, v178, v179
v_mfma_f32_4x4x4_16b_bf16 v[156:159], v[50:51], a[142:143], v[156:159]
v_cvt_pk_bf16_f32 v178, v184, v185
v_mfma_f32_4x4x4_16b_bf16 v[164:167], v[50:51], a[148:149], v[164:167]
v_cvt_pk_bf16_f32 v179, v186, v187
v_cvt_pk_bf16_f32 v192, v192, v193
v_mfma_f32_4x4x4_16b_bf16 v[172:175], v[50:51], a[150:151], v[172:175]
v_cvt_pk_bf16_f32 v193, v194, v195
v_mfma_f32_4x4x4_16b_bf16 v[180:183], v[50:51], a[156:157], v[180:183]
v_cvt_pk_bf16_f32 v194, v200, v201
v_cvt_pk_bf16_f32 v195, v202, v203
v_mfma_f32_4x4x4_16b_bf16 v[188:191], v[50:51], a[158:159], v[188:191]
v_cvt_pk_bf16_f32 v208, v208, v209
v_mfma_f32_4x4x4_16b_bf16 v[196:199], v[50:51], a[164:165], v[196:199]
v_cvt_pk_bf16_f32 v209, v210, v211
v_mfma_f32_4x4x4_16b_bf16 v[204:207], v[50:51], a[166:167], v[204:207]
v_cvt_pk_bf16_f32 v210, v216, v217
v_cvt_pk_bf16_f32 v211, v218, v219
v_mfma_f32_4x4x4_16b_bf16 v[212:215], v[50:51], a[172:173], v[212:215]
v_cvt_pk_bf16_f32 v224, v224, v225
v_mfma_f32_4x4x4_16b_bf16 v[220:223], v[50:51], a[174:175], v[220:223]
v_cvt_pk_bf16_f32 v225, v226, v227
v_cvt_pk_bf16_f32 v226, v232, v233
v_mfma_f32_4x4x4_16b_bf16 v[228:231], v[50:51], a[180:181], v[228:231]
v_cvt_pk_bf16_f32 v227, v234, v235
v_mfma_f32_4x4x4_16b_bf16 v[236:239], v[50:51], a[182:183], v[236:239]
v_cvt_pk_bf16_f32 v240, v240, v241
v_cvt_pk_bf16_f32 v241, v242, v243
v_mfma_f32_4x4x4_16b_bf16 v[244:247], v[50:51], a[188:189], v[244:247]
v_cvt_pk_bf16_f32 v242, v248, v249
v_mfma_f32_4x4x4_16b_bf16 v[252:255], v[50:51], a[190:191], v[252:255]
v_cvt_pk_bf16_f32 v243, v250, v251
s_branch L_post2
L_u40:
v_mov_b64 v[128:129], 0
v_mov_b64 v[130:131], 0
v_mov_b64 v[132:133], 0
v_mov_b64 v[134:135], 0
v_mov_b64 v[136:137], 0
v_mov_b64 v[138:139], 0
v_mov_b64 v[140:141], 0
v_mov_b64 v[142:143], 0
v_mov_b64 v[144:145], 0
v_mov_b64 v[146:147], 0
v_mov_b64 v[148:149], 0
v_mov_b64 v[150:151], 0
v_mov_b64 v[152:153], 0
v_mov_b64 v[154:155], 0
v_mov_b64 v[156:157], 0
v_mov_b64 v[158:159], 0
v_mov_b64 v[160:161], 0
v_mov_b64 v[162:163], 0
v_mov_b64 v[164:165], 0
v_mov_b64 v[166:167], 0
v_mov_b64 v[168:169], 0
v_mov_b64 v[170:171], 0
v_mov_b64 v[172:173], 0
v_mov_b64 v[174:175], 0
v_mov_b64 v[176:177], 0
v_mov_b64 v[178:179], 0
v_mov_b64 v[180:181], 0
v_mov_b64 v[182:183], 0
v_mov_b64 v[184:185], 0
v_mov_b64 v[186:187], 0
v_mov_b64 v[188:189], 0
v_mov_b64 v[190:191], 0
v_mov_b64 v[192:193], 0
v_mov_b64 v[194:195], 0
v_mov_b64 v[196:197], 0
v_mov_b64 v[198:199], 0
v_mov_b64 v[200:201], 0
v_mov_b64 v[202:203], 0
v_mov_b64 v[204:205], 0
v_mov_b64 v[206:207], 0
v_mov_b64 v[208:209], 0
v_mov_b64 v[210:211], 0
v_mov_b64 v[212:213], 0
v_mov_b64 v[214:215], 0
v_mov_b64 v[216:217], 0
v_mov_b64 v[218:219], 0
v_mov_b64 v[220:221], 0
v_mov_b64 v[222:223], 0
v_mov_b64 v[224:225], 0
v_mov_b64 v[226:227], 0
v_mov_b64 v[228:229], 0
v_mov_b64 v[230:231], 0
v_mov_b64 v[232:233], 0
v_mov_b64 v[234:235], 0
v_mov_b64 v[236:237], 0
v_mov_b64 v[238:239], 0
v_mov_b64 v[240:241], 0
v_mov_b64 v[242:243], 0
v_mov_b64 v[244:245], 0
v_mov_b64 v[246:247], 0
v_mov_b64 v[248:249], 0
v_mov_b64 v[250:251], 0
v_mov_b64 v[252:253], 0
v_mov_b64 v[254:255], 0
s_branch LOP35
LP35:
s_setpc_b64 s[48:49]
LOP35:
L_lpack:
s_bitcmp1_b32 s24, 1
Mvav 128,64,96
s_cbranch_scc0 L_domask_h10_a0
s_bitcmp1_b32 s24, 0
s_cbranch_scc1 L_domask_h10_odd
v_cndmask_b32 v80, v80, v126, s[52:53]
v_cndmask_b32 v81, v81, v126, s[54:55]
v_cndmask_b32 v82, v82, v126, s[56:57]
v_cndmask_b32 v83, v83, v126, s[58:59]
L_domask_h10_all:
v_mov_b64 v[88:89], v[126:127]
v_mov_b64 v[90:91], v[126:127]
s_branch L_nomask_h10
L_domask_h10_odd:
s_nop 3
v_cndmask_b32 v88, v88, v126, s[52:53]
v_cndmask_b32 v89, v89, v126, s[54:55]
v_cndmask_b32 v90, v90, v126, s[56:57]
v_cndmask_b32 v91, v91, v126, s[58:59]
s_branch L_nomask_h10
L_domask_h10_a0:
s_nop 1
v_mov_b64 v[80:81], v[126:127]
v_mov_b64 v[82:83], v[126:127]
v_mov_b64 v[88:89], v[126:127]
v_mov_b64 v[90:91], v[126:127]
L_nomask_h10:
RD 112,6,12288
v_add_f32 v120, v120, v122
Mvav 132,64,100
v_exp_f32 v12, v80
Mvav 136,68,96
RD 116,6,13312
v_exp_f32 v13, v81
Mvav 140,68,100
v_cvt_pk_bf16_f32 v104, v12, v13
v_exp_f32 v14, v82
Mvav 144,72,96
RD 120,6,14336
v_add_f32 v121, v121, v124
Mvav 148,72,100
buffer_load_dwordx4 v2, s[4:7], s32 offen offset:0 sc1 lds
Mvav 152,76,96
s_waitcnt lgkmcnt(7)
RD 124,6,15360
v_exp_f32 v15, v83
Mvav 156,76,100
v_cvt_pk_bf16_f32 v105, v14, v15
v_add_f32 v122, v12, v13
Mvav 160,80,96
RD 64,6,16384
v_exp_f32 v16, v84
Mvav 164,80,100
v_exp_f32 v17, v85
Mvav 168,84,96
RD 68,6,17408
v_cvt_pk_bf16_f32 v108, v16, v17
Mvav 172,84,100
v_exp_f32 v18, v86
Mvav 176,88,96
RD 72,6,18432
v_exp_f32 v19, v87
Mvav 180,88,100
buffer_load_dwordx4 v2, s[4:7], s32 offen offset:1024 sc1 lds
Mvav 184,92,96
s_waitcnt lgkmcnt(7)
RD 76,6,19456
v_cvt_pk_bf16_f32 v109, v18, v19
Mvav 188,92,100
v_exp_f32 v20, v88
Mvav 192,96,96
RD 80,6,20480
v_exp_f32 v21, v89
Mvav 196,96,100
v_cvt_pk_bf16_f32 v106, v20, v21
v_exp_f32 v22, v90
Mvav 200,100,96
RD 84,6,21504
v_add_f32 v123, v14, v15
Mvav 204,100,100
v_exp_f32 v23, v91
Mvav 208,104,96
RD 88,6,22528
v_cvt_pk_bf16_f32 v107, v22, v23
Mvav 212,104,100
buffer_load_dwordx4 v2, s[4:7], s32 offen offset:2048 sc1 lds
Mvav 216,108,96
s_waitcnt lgkmcnt(7)
RD 92,6,23552
v_exp_f32 v12, v92
Mvav 220,108,100
v_exp_f32 v13, v93
Mvav 224,112,96
RD 96,6,24576
v_cvt_pk_bf16_f32 v110, v12, v13
Mvav 228,112,100
v_exp_f32 v14, v94
Mvav 232,116,96
RD 100,6,25600
v_exp_f32 v15, v95
Mvav 236,116,100
v_cvt_pk_bf16_f32 v111, v14, v15
v_add_f32 v124, v16, v17
v_add_f32 v125, v18, v19
Mvav 240,120,96
RD 104,6,26624
v_add_f32 v122, v122, v20
v_add_f32 v122, v122, v21
Mvav 244,120,100
buffer_load_dwordx4 v2, s[4:7], s32 offen offset:3072 sc1 lds
Mvav 248,124,96
s_waitcnt lgkmcnt(7)
RD 108,6,27648
v_add_f32 v123, v123, v22
Mvav 252,124,100
s_add_u32 m0, s30, 16384
v_readlane_b32 s31, v4, s29
RD 112,6,28672
Nvaa 68,64,32,116
s_add_u32 s30, s30, s36
RD 116,6,29696
v_add_f32 v123, v123, v23
Mvaa 68,68,36
s_cmp_ge_u32 s30, 131072
RD 120,6,30720
v_add_f32 v124, v124, v12
Mvaa 68,72,48
buffer_load_dwordx4 v2, s[4:7], s31 offen offset:0 sc1 lds
s_waitcnt vmcnt(21) lgkmcnt(7)
s_cselect_b32 s36, s33, s34
RD 124,6,31744
Mvaa 68,76,52
s_barrier
v_add_u32 v6, s36, v6
RD 64,6,0
Mvaa 68,80,40
RD 68,6,1024
v_add_f32 v124, v124, v13
Mvaa 68,84,44
s_add_u32 s29, s29, 1
RD 72,6,2048
v_add_f32 v125, v125, v14
Mvaa 68,88,56
buffer_load_dwordx4 v2, s[4:7], s31 offen offset:1024 sc1 lds
s_waitcnt lgkmcnt(7)
RD 76,6,3072
Mvaa 68,92,60
RD 80,6,4096
v_add_f32 v125, v125, v15
Nvaa 76,96,32,116
RD 84,6,5120
v_add_f32 v122, v122, v123
Mvaa 76,100,36
RD 88,6,6144
v_add_f32 v124, v124, v125
Mvaa 76,104,48
buffer_load_dwordx4 v2, s[4:7], s31 offen offset:2048 sc1 lds
s_waitcnt lgkmcnt(7)
RD 92,6,7168
Mvaa 76,108,52
v_readlane_b32 s32, v3, s29
RD 96,6,8192
Mvaa 76,112,40
RD 100,6,9216
v_max_f32 v26, v122, v124
Mvaa 76,116,44
RD 104,6,10240
v_cmp_nge_f32 vcc, 0x53800000, v26
Mvaa 76,120,56
buffer_load_dwordx4 v2, s[4:7], s31 offen offset:3072 sc1 lds
s_waitcnt lgkmcnt(7)
RD 108,6,11264
Mvaa 76,124,60
s_mov_b32 m0, s30
s_cbranch_vccnz L_dorare_h10
L_norare_h10:
s_bitcmp1_b32 s24, 1
Mvav 128,64,104
s_cbranch_scc1 L_nomask_h00
s_bitcmp1_b32 s24, 0
s_cbranch_scc1 L_domask_h00_odd
v_cndmask_b32 v68, v68, v126, s[52:53]
v_cndmask_b32 v69, v69, v126, s[54:55]
v_cndmask_b32 v70, v70, v126, s[56:57]
v_cndmask_b32 v71, v71, v126, s[58:59]
L_domask_h00_all:
v_mov_b64 v[76:77], v[126:127]
v_mov_b64 v[78:79], v[126:127]
s_branch L_nomask_h00
L_domask_h00_odd:
s_nop 3
v_cndmask_b32 v76, v76, v126, s[52:53]
v_cndmask_b32 v77, v77, v126, s[54:55]
v_cndmask_b32 v78, v78, v126, s[56:57]
v_cndmask_b32 v79, v79, v126, s[58:59]
L_nomask_h00:
RD 112,6,12288
v_add_f32 v120, v120, v122
Mvav 132,64,108
v_exp_f32 v12, v68
Mvav 136,68,104
RD 116,6,13312
v_exp_f32 v13, v69
Mvav 140,68,108
v_cvt_pk_bf16_f32 v100, v12, v13
v_add_f32 v121, v121, v124
Mvav 144,72,104
RD 120,6,14336
v_exp_f32 v14, v70
Mvav 148,72,108
buffer_load_dwordx4 v2, s[4:7], s32 offen offset:0 sc1 lds
Mvav 152,76,104
s_waitcnt lgkmcnt(7)
RD 124,6,15360
v_cvt_pk_bf16_f32 v128, v128, v129
Mvav 156,76,108
v_cvt_pk_bf16_f32 v129, v130, v131
v_cvt_pk_bf16_f32 v130, v136, v137
Mvav 160,80,104
RD 64,6,16384
v_cvt_pk_bf16_f32 v131, v138, v139
Mvav 164,80,108
v_exp_f32 v15, v71
Mvav 168,84,104
RD 68,6,17408
v_cvt_pk_bf16_f32 v144, v144, v145
Mvav 172,84,108
v_cvt_pk_bf16_f32 v145, v146, v147
v_cvt_pk_bf16_f32 v146, v152, v153
Mvav 176,88,104
RD 72,6,18432
v_cvt_pk_bf16_f32 v147, v154, v155
Mvav 180,88,108
buffer_load_dwordx4 v2, s[4:7], s32 offen offset:1024 sc1 lds
Mvav 184,92,104
s_waitcnt lgkmcnt(7)
RD 76,6,19456
v_cvt_pk_bf16_f32 v160, v160, v161
Mvav 188,92,108
v_cvt_pk_bf16_f32 v161, v162, v163
v_cvt_pk_bf16_f32 v162, v168, v169
Mvav 192,96,104
RD 80,6,20480
v_cvt_pk_bf16_f32 v163, v170, v171
Mvav 196,96,108
v_cvt_pk_bf16_f32 v101, v14, v15
v_exp_f32 v16, v76
Mvav 200,100,104
RD 84,6,21504
v_exp_f32 v17, v77
Mvav 204,100,108
v_cvt_pk_bf16_f32 v102, v16, v17
v_exp_f32 v18, v78
Mvav 208,104,104
RD 88,6,22528
v_add_f32 v124, v12, v13
Mvav 212,104,108
buffer_load_dwordx4 v2, s[4:7], s32 offen offset:2048 sc1 lds
Mvav 216,108,104
s_waitcnt lgkmcnt(7)
RD 92,6,23552
v_exp_f32 v19, v79
Mvav 220,108,108
v_cvt_pk_bf16_f32 v103, v18, v19
v_add_f32 v125, v14, v15
Mvav 224,112,104
s_add_u32 s79, s67, 0
RD 96,6,24576
v_add_f32 v124, v124, v16
Mvav 228,112,108
buffer_store_dwordx4 v[128:131], v5, s[4:7], s79 offen offset:0 sc1
Mvav 232,116,104
RD 100,6,25600
v_add_f32 v124, v124, v17
Mvav 236,116,108
v_add_f32 v125, v125, v18
v_add_f32 v125, v125, v19
v_add_f32 v124, v124, v125
Mvav 240,120,104
RD 104,6,26624
v_cmp_nge_f32 vcc, 0x53800000, v124
Mvav 244,120,108
buffer_load_dwordx4 v2, s[4:7], s32 offen offset:3072 sc1 lds
Mvav 248,124,104
s_waitcnt lgkmcnt(7)
RD 108,6,27648
v_cvt_pk_bf16_f32 v176, v176, v177
Mvav 252,124,108
s_add_u32 m0, s30, 16384
v_readlane_b32 s31, v4, s29
RD 112,6,28672
Nvaa 84,64,32,116
s_add_u32 s30, s30, s36
RD 116,6,29696
v_cvt_pk_bf16_f32 v177, v178, v179
Mvaa 84,68,36
s_cmp_ge_u32 s30, 131072
RD 120,6,30720
v_cvt_pk_bf16_f32 v178, v184, v185
Mvaa 84,72,48
buffer_load_dwordx4 v2, s[4:7], s31 offen offset:0 sc1 lds
s_waitcnt vmcnt(22) lgkmcnt(7)
s_cselect_b32 s36, s33, s34
RD 124,6,31744
Mvaa 84,76,52
s_barrier
v_add_u32 v6, s36, v6
RD 64,6,0
Mvaa 84,80,40
buffer_store_dwordx4 v[144:147], v5, s[4:7], s79 offen offset:2048 sc1
RD 68,6,1024
Mvaa 84,84,44
s_add_u32 s29, s29, 1
RD 72,6,2048
v_cvt_pk_bf16_f32 v179, v186, v187
Mvaa 84,88,56
buffer_load_dwordx4 v2, s[4:7], s31 offen offset:1024 sc1 lds
s_waitcnt lgkmcnt(7)
RD 76,6,3072
Mvaa 84,92,60
RD 80,6,4096
v_cvt_pk_bf16_f32 v192, v192, v193
Nvaa 92,96,32,116
RD 84,6,5120
v_cvt_pk_bf16_f32 v193, v194, v195
Mvaa 92,100,36
RD 88,6,6144
v_cvt_pk_bf16_f32 v194, v200, v201
Mvaa 92,104,48
buffer_load_dwordx4 v2, s[4:7], s31 offen offset:2048 sc1 lds
s_waitcnt lgkmcnt(7)
RD 92,6,7168
Mvaa 92,108,52
v_readlane_b32 s32, v3, s29
s_add_u32 s79, s67, 4096
RD 96,6,8192
Mvaa 92,112,40
buffer_store_dwordx4 v[160:163], v5, s[4:7], s79 offen offset:0 sc1
RD 100,6,9216
Mvaa 92,116,44
RD 104,6,10240
v_cvt_pk_bf16_f32 v195, v202, v203
Mvaa 92,120,56
buffer_load_dwordx4 v2, s[4:7], s31 offen offset:3072 sc1 lds
s_waitcnt lgkmcnt(7)
RD 108,6,11264
Mvaa 92,124,60
s_mov_b32 m0, s30
s_cbranch_vccnz L_dorare_h00
L_norare_h00:
s_bitcmp1_b32 s24, 1
RD 112,6,12288
v_cvt_pk_bf16_f32 v208, v208, v209
Mvav 132,64,100
s_cbranch_scc0 L_domask_lh0_a0
s_bitcmp1_b32 s24, 0
s_cbranch_scc1 L_domask_lh0_odd
v_cndmask_b32 v84, v84, v126, s[52:53]
v_cndmask_b32 v85, v85, v126, s[54:55]
v_cndmask_b32 v86, v86, v126, s[56:57]
v_cndmask_b32 v87, v87, v126, s[58:59]
L_domask_lh0_all:
v_mov_b64 v[92:93], v[126:127]
v_mov_b64 v[94:95], v[126:127]
s_branch L_nomask_lh0
L_domask_lh0_odd:
s_nop 3
v_cndmask_b32 v92, v92, v126, s[52:53]
v_cndmask_b32 v93, v93, v126, s[54:55]
v_cndmask_b32 v94, v94, v126, s[56:57]
v_cndmask_b32 v95, v95, v126, s[58:59]
s_branch L_nomask_lh0
L_domask_lh0_a0:
s_nop 1
v_mov_b64 v[84:85], v[126:127]
v_mov_b64 v[86:87], v[126:127]
v_mov_b64 v[92:93], v[126:127]
v_mov_b64 v[94:95], v[126:127]
L_nomask_lh0:
RD 116,6,13312
v_exp_f32 v12, v84
Mvav 140,68,100
RD 120,6,14336
v_exp_f32 v13, v85
Mvav 148,72,100
buffer_load_dwordx4 v2, s[4:7], s32 offen offset:0 sc1 lds
s_waitcnt lgkmcnt(7)
RD 124,6,15360
Mvav 156,76,100
RD 64,6,16384
s_branch LOP36
LP36:
s_setpc_b64 s[48:49]
LOP36:
v_cvt_pk_bf16_f32 v108, v12, v13
v_exp_f32 v14, v86
Mvav 164,80,100
RD 68,6,17408
v_exp_f32 v15, v87
Mvav 172,84,100
RD 72,6,18432
v_cvt_pk_bf16_f32 v109, v14, v15
v_exp_f32 v16, v92
Mvav 180,88,100
buffer_load_dwordx4 v2, s[4:7], s32 offen offset:1024 sc1 lds
s_waitcnt lgkmcnt(7)
RD 76,6,19456
Mvav 188,92,100
RD 80,6,20480
v_exp_f32 v17, v93
Mvav 196,96,100
RD 84,6,21504
v_cvt_pk_bf16_f32 v110, v16, v17
v_exp_f32 v18, v94
Mvav 204,100,100
RD 88,6,22528
v_exp_f32 v19, v95
v_add_f32 v121, v121, v124
Mvav 212,104,100
buffer_load_dwordx4 v2, s[4:7], s32 offen offset:2048 sc1 lds
s_waitcnt lgkmcnt(7)
RD 92,6,23552
Mvav 220,108,100
RD 96,6,24576
v_cvt_pk_bf16_f32 v111, v18, v19
v_add_f32 v124, v12, v13
v_add_f32 v125, v14, v15
Mvav 228,112,100
RD 100,6,25600
v_add_f32 v124, v124, v16
v_add_f32 v124, v124, v17
v_add_f32 v125, v125, v18
Mvav 236,116,100
RD 104,6,26624
v_add_f32 v125, v125, v19
v_add_f32 v124, v124, v125
v_cmp_nge_f32 vcc, 0x53800000, v124
Mvav 244,120,100
buffer_load_dwordx4 v2, s[4:7], s32 offen offset:3072 sc1 lds
s_waitcnt lgkmcnt(7)
RD 108,6,27648
Mvav 252,124,100
s_add_u32 m0, s30, 16384
v_readlane_b32 s31, v4, s29
s_cbranch_vccnz L_dorare_lh0
L_norare_lh0:
RD 112,6,28672
Mvav 132,64,108
buffer_store_dwordx4 v[176:179], v5, s[4:7], s79 offen offset:2048 sc1
s_add_u32 s30, s30, s36
RD 116,6,29696
v_add_f32 v121, v121, v124
Mvav 140,68,108
s_cmp_ge_u32 s30, 131072
RD 120,6,30720
v_cvt_pk_bf16_f32 v209, v210, v211
Mvav 148,72,108
buffer_load_dwordx4 v2, s[4:7], s31 offen offset:0 sc1 lds
s_waitcnt vmcnt(25) lgkmcnt(7)
s_cselect_b32 s36, s33, s34
RD 124,6,31744
Mvav 156,76,108
s_barrier
v_add_u32 v6, s36, v6
RD 64,6,0
Mvav 164,80,108
RD 68,6,1024
v_cvt_pk_bf16_f32 v210, v216, v217
Mvav 172,84,108
s_add_u32 s29, s29, 1
RD 72,6,2048
v_cvt_pk_bf16_f32 v211, v218, v219
Mvav 180,88,108
buffer_load_dwordx4 v2, s[4:7], s31 offen offset:1024 sc1 lds
s_waitcnt lgkmcnt(7)
RD 76,6,3072
Mvav 188,92,108
s_add_u32 s79, s67, 8192
RD 80,6,4096
v_cvt_pk_bf16_f32 v224, v224, v225
Mvav 196,96,108
buffer_store_dwordx4 v[192:195], v5, s[4:7], s79 offen offset:0 sc1
RD 84,6,5120
Mvav 204,100,108
RD 88,6,6144
v_cvt_pk_bf16_f32 v225, v226, v227
Mvav 212,104,108
buffer_load_dwordx4 v2, s[4:7], s31 offen offset:2048 sc1 lds
s_waitcnt lgkmcnt(7)
RD 92,6,7168
Mvav 220,108,108
v_readlane_b32 s32, v3, s29
RD 96,6,8192
Mvav 228,112,108
RD 100,6,9216
v_cvt_pk_bf16_f32 v226, v232, v233
Mvav 236,116,108
RD 104,6,10240
v_cvt_pk_bf16_f32 v227, v234, v235
Mvav 244,120,108
buffer_load_dwordx4 v2, s[4:7], s31 offen offset:3072 sc1 lds
s_waitcnt lgkmcnt(7)
s_cmp_eq_u32 s60, 2
RD 108,6,11264
Mvav 252,124,108
s_mov_b32 m0, s30
v_cvt_pk_bf16_f32 v240, v240, v241
v_cvt_pk_bf16_f32 v241, v242, v243
v_cvt_pk_bf16_f32 v242, v248, v249
v_cvt_pk_bf16_f32 v243, v250, v251
v_mov_b32 v44, v112
v_mov_b32 v45, v116
v_mov_b64 v[46:47], v[120:121]
v_cvt_pk_bf16_f32 v132, v132, v133
v_cvt_pk_bf16_f32 v133, v134, v135
v_cvt_pk_bf16_f32 v134, v140, v141
v_cvt_pk_bf16_f32 v135, v142, v143
s_cbranch_scc0 L_post2b
L_seg2:
s_mov_b32 s60, 3
s_lshr_b32 s43, s62, 1
s_sub_u32 s43, s43, 1
s_sub_u32 s44, 8, s26
s_add_u32 s79, s67, 16384
buffer_store_dwordx4 v[44:47], v5, s[4:7], s79 offen sc1
Zvaa 64,64,128
s_mov_b32 s46, 1
RD 112,6,12288
v_cvt_pk_bf16_f32 v148, v148, v149
v_cvt_pk_bf16_f32 v149, v150, v151
Mvaa 64,68,132
buffer_load_dword v7, v10, s[4:7], s71 offen sc1
Mvaa 64,72,144
s_add_u32 s79, s67, 0
RD 116,6,13312
v_cvt_pk_bf16_f32 v150, v156, v157
v_cvt_pk_bf16_f32 v151, v158, v159
v_cvt_pk_bf16_f32 v164, v164, v165
Mvaa 64,76,148
buffer_store_dwordx4 v[132:135], v5, s[4:7], s79 offen offset:1024 sc1
Zvaa 68,64,160
s_mov_b32 s45, 0xff61b1e6
RD 120,6,14336
v_cvt_pk_bf16_f32 v165, v166, v167
v_cvt_pk_bf16_f32 v166, v172, v173
v_cvt_pk_bf16_f32 v167, v174, v175
Mvaa 68,68,164
buffer_load_dwordx4 v2, s[4:7], s32 offen offset:0 sc1 lds
Mvaa 68,72,176
s_waitcnt lgkmcnt(7)
RD 124,6,15360
v_cvt_pk_bf16_f32 v180, v180, v181
v_cvt_pk_bf16_f32 v181, v182, v183
Mvaa 68,76,180
v_cvt_pk_bf16_f32 v182, v188, v189
v_cvt_pk_bf16_f32 v183, v190, v191
v_cvt_pk_bf16_f32 v196, v196, v197
Mvaa 68,80,168
RD 64,6,16384
v_cvt_pk_bf16_f32 v197, v198, v199
v_cvt_pk_bf16_f32 v198, v204, v205
Mvaa 68,84,172
buffer_store_dwordx4 v[148:151], v5, s[4:7], s79 offen offset:3072 sc1
Mvaa 68,88,184
RD 68,6,17408
v_cvt_pk_bf16_f32 v199, v206, v207
v_cvt_pk_bf16_f32 v212, v212, v213
Mvaa 68,92,188
v_cvt_pk_bf16_f32 v213, v214, v215
v_cvt_pk_bf16_f32 v214, v220, v221
v_cvt_pk_bf16_f32 v215, v222, v223
Mvaa 64,80,136
RD 72,6,18432
v_cvt_pk_bf16_f32 v228, v228, v229
v_cvt_pk_bf16_f32 v229, v230, v231
Mvaa 64,84,140
buffer_load_dwordx4 v2, s[4:7], s32 offen offset:1024 sc1 lds
Mvaa 64,88,152
s_waitcnt lgkmcnt(7)
s_add_u32 s79, s67, 4096
RD 76,6,19456
v_cvt_pk_bf16_f32 v230, v236, v237
v_cvt_pk_bf16_f32 v231, v238, v239
Mvaa 64,92,156
buffer_store_dwordx4 v[164:167], v5, s[4:7], s79 offen offset:1024 sc1
Zvaa 72,96,128
RD 80,6,20480
v_cvt_pk_bf16_f32 v244, v244, v245
v_cvt_pk_bf16_f32 v245, v246, v247
Mvaa 72,100,132
v_cvt_pk_bf16_f32 v246, v252, v253
v_cvt_pk_bf16_f32 v247, v254, v255
v_mov_b64 v[112:113], 0
Mvaa 72,104,144
RD 84,6,21504
v_mov_b64 v[114:115], 0
v_mov_b64 v[116:117], 0
Mvaa 72,108,148
buffer_store_dwordx4 v[180:183], v5, s[4:7], s79 offen offset:3072 sc1
Zvaa 76,96,160
RD 88,6,22528
v_exp_f32 v12, v68
Mvaa 76,100,164
buffer_load_dwordx4 v2, s[4:7], s32 offen offset:2048 sc1 lds
Mvaa 76,104,176
s_waitcnt lgkmcnt(7)
RD 92,6,23552
v_exp_f32 v13, v69
v_mov_b64 v[118:119], 0
Mvaa 76,108,180
v_cvt_pk_bf16_f32 v100, v12, v13
v_exp_f32 v14, v70
Mvaa 76,112,168
s_add_u32 s79, s67, 8192
RD 96,6,24576
v_exp_f32 v15, v71
Mvaa 76,116,172
buffer_store_dwordx4 v[196:199], v5, s[4:7], s79 offen offset:1024 sc1
Mvaa 76,120,184
RD 100,6,25600
v_cvt_pk_bf16_f32 v101, v14, v15
v_mov_b64 v[120:121], 0
Mvaa 76,124,188
v_add_f32 v124, v12, v13
v_add_f32 v125, v14, v15
Mvaa 72,112,136
RD 104,6,26624
Mvaa 72,116,140
buffer_load_dwordx4 v2, s[4:7], s32 offen offset:3072 sc1 lds
Mvaa 72,120,152
s_waitcnt lgkmcnt(7)
RD 108,6,27648
Mvaa 72,124,156
s_add_u32 m0, s30, 16384
v_readlane_b32 s31, v4, s29
Zvaa 80,64,128
RD 112,6,28672
Mvaa 80,68,132
buffer_store_dwordx4 v[208:211], v5, s[4:7], s79 offen offset:2048 sc1
Mvaa 80,72,144
s_add_u32 s30, s30, s36
s_cmp_eq_u32 s43, s41
RD 116,6,29696
Mvaa 80,76,148
s_cbranch_scc0 L_nomask_fb
s_bitcmp1_b32 s24, 0
s_cbranch_scc1 L_domask_fb_odd
v_cndmask_b32 v64, v64, v126, s[52:53]
v_cndmask_b32 v65, v65, v126, s[54:55]
v_cndmask_b32 v66, v66, v126, s[56:57]
v_cndmask_b32 v67, v67, v126, s[58:59]
L_domask_fb_all:
v_mov_b64 v[72:73], v[126:127]
v_mov_b64 v[74:75], v[126:127]
s_branch L_nomask_fb
L_domask_fb_odd:
s_nop 3
v_cndmask_b32 v72, v72, v126, s[52:53]
v_cndmask_b32 v73, v73, v126, s[54:55]
v_cndmask_b32 v74, v74, v126, s[56:57]
v_cndmask_b32 v75, v75, v126, s[58:59]
L_nomask_fb:
v_exp_f32 v16, v64
v_exp_f32 v17, v65
Zvaa 84,64,160
s_cmp_ge_u32 s30, 131072
RD 120,6,30720
v_cvt_pk_bf16_f32 v96, v16, v17
v_exp_f32 v18, v66
Mvaa 84,68,164
buffer_load_dwordx4 v2, s[4:7], s31 offen offset:0 sc1 lds
Mvaa 84,72,176
s_waitcnt vmcnt(34) lgkmcnt(7)
s_cselect_b32 s36, s33, s34
RD 124,6,31744
v_exp_f32 v19, v67
Mvaa 84,76,180
s_barrier
v_add_u32 v6, s36, v6
v_cvt_pk_bf16_f32 v97, v18, v19
v_exp_f32 v20, v76
Mvaa 84,80,168
RD 64,6,0
v_exp_f32 v21, v77
v_add_f32 v122, v16, v17
Mvaa 84,84,172
buffer_store_dwordx4 v[212:215], v5, s[4:7], s79 offen offset:3072 sc1
Mvaa 84,88,184
s_add_u32 s79, s67, 12288
RD 68,6,1024
v_cvt_pk_bf16_f32 v102, v20, v21
v_exp_f32 v22, v78
Mvaa 84,92,188
buffer_store_dwordx4 v[224:227], v5, s[4:7], s79 offen offset:0 sc1
Mvaa 80,80,136
s_add_u32 s29, s29, 1
RD 72,6,2048
v_exp_f32 v23, v79
v_add_f32 v123, v18, v19
Mvaa 80,84,140
buffer_load_dwordx4 v2, s[4:7], s31 offen offset:1024 sc1 lds
Mvaa 80,88,152
s_waitcnt lgkmcnt(7)
RD 76,6,3072
v_cvt_pk_bf16_f32 v103, v22, v23
v_exp_f32 v12, v72
Mvaa 80,92,156
v_exp_f32 v13, v73
v_add_f32 v124, v124, v20
Zvaa 88,96,128
RD 80,6,4096
v_cvt_pk_bf16_f32 v98, v12, v13
v_add_f32 v124, v124, v21
Mvaa 88,100,132
buffer_store_dwordx4 v[228:231], v5, s[4:7], s79 offen offset:1024 sc1
Mvaa 88,104,144
RD 84,6,5120
v_exp_f32 v14, v74
v_add_f32 v125, v125, v22
Mvaa 88,108,148
buffer_store_dwordx4 v[240:243], v5, s[4:7], s79 offen offset:2048 sc1
Zvaa 92,96,160
RD 88,6,6144
v_exp_f32 v15, v75
Mvaa 92,100,164
buffer_load_dwordx4 v2, s[4:7], s31 offen offset:2048 sc1 lds
Mvaa 92,104,176
s_waitcnt lgkmcnt(7)
RD 92,6,7168
v_cvt_pk_bf16_f32 v99, v14, v15
v_add_f32 v125, v125, v23
v_add_f32 v122, v122, v12
Mvaa 92,108,180
v_readlane_b32 s32, v3, s29
v_add_f32 v122, v122, v13
Mvaa 92,112,168
RD 96,6,8192
v_add_f32 v123, v123, v14
Mvaa 92,116,172
buffer_store_dwordx4 v[244:247], v5, s[4:7], s79 offen offset:3072 sc1
Mvaa 92,120,184
s_waitcnt vmcnt(18)
RD 100,6,9216
v_cmp_ne_u32 s[80:81], s38, v7
v_add_f32 v123, v123, v15
v_add_f32 v122, v122, v123
Mvaa 92,124,188
v_add_f32 v124, v124, v125
v_subrev_u32 v26, 0x2b800000, v122
v_subrev_u32 v27, 0x2b800000, v124
Mvaa 88,112,136
s_cmp_lg_u64 s[80:81], 0
s_cbranch_scc1 L_pw_kv2c
L_po_kv2c:
s_barrier
RD 104,6,10240
v_max_u32 v26, v26, v27
Mvaa 88,116,140
buffer_load_dwordx4 v2, s[4:7], s31 offen offset:3072 sc1 lds
Mvaa 88,120,152
s_waitcnt lgkmcnt(7)
RD 108,6,11264
v_cmp_lt_u32 vcc, 0x28000000, v26
Mvaa 88,124,156
s_mov_b32 m0, s30
s_cbranch_vccz L_fok_fb
s_sub_u32 s77, s41, s43
v_cndmask_b32 v26, v122, 1.0, s[52:53]
v_subrev_u32 v26, 0x2b800000, v26
v_max_u32 v26, v26, v27
v_cmp_lt_u32 vcc, 0x28000000, v26
s_or_b32 s77, s77, s24
s_cbranch_scc1 L_fchk_fb
s_nop 2
s_cbranch_vccnz L_fchk_fb
L_fok_fb:
s_mov_b32 s46, 0
s_mov_b32 s45, 0
s_cmp_eq_u32 s43, 1
s_cbranch_scc1 L_u41
L_s1z1:
Zvav 128,64,96
RD 112,6,12288
v_add_f32 v120, v120, v122
Zvav 132,64,100
v_exp_f32 v12, v80
Zvav 136,68,96
RD 116,6,13312
v_add_f32 v121, v121, v124
Zvav 140,68,100
v_exp_f32 v13, v81
Zvav 144,72,96
RD 120,6,14336
v_cvt_pk_bf16_f32 v104, v12, v13
Zvav 148,72,100
buffer_load_dwordx4 v2, s[4:7], s32 offen offset:0 sc1 lds
Zvav 152,76,96
s_waitcnt lgkmcnt(7)
RD 124,6,15360
v_add_f32 v122, v12, v13
Zvav 156,76,100
v_exp_f32 v14, v82
Zvav 160,80,96
RD 64,6,16384
Zvav 164,80,100
v_exp_f32 v15, v83
Zvav 168,84,96
RD 68,6,17408
v_cvt_pk_bf16_f32 v105, v14, v15
Zvav 172,84,100
v_exp_f32 v16, v84
Zvav 176,88,96
RD 72,6,18432
v_add_f32 v123, v14, v15
Zvav 180,88,100
buffer_load_dwordx4 v2, s[4:7], s32 offen offset:1024 sc1 lds
Zvav 184,92,96
s_waitcnt lgkmcnt(7)
RD 76,6,19456
Zvav 188,92,100
v_exp_f32 v17, v85
Zvav 192,96,96
RD 80,6,20480
v_cvt_pk_bf16_f32 v108, v16, v17
Zvav 196,96,100
v_exp_f32 v18, v86
Zvav 200,100,96
RD 84,6,21504
v_add_f32 v124, v16, v17
Zvav 204,100,100
v_exp_f32 v19, v87
Zvav 208,104,96
RD 88,6,22528
v_cvt_pk_bf16_f32 v109, v18, v19
Zvav 212,104,100
buffer_load_dwordx4 v2, s[4:7], s32 offen offset:2048 sc1 lds
Zvav 216,108,96
s_waitcnt lgkmcnt(7)
RD 92,6,23552
v_add_f32 v125, v18, v19
Zvav 220,108,100
v_exp_f32 v20, v88
Zvav 224,112,96
RD 96,6,24576
v_add_f32 v122, v122, v20
Zvav 228,112,100
v_exp_f32 v21, v89
Zvav 232,116,96
RD 100,6,25600
v_cvt_pk_bf16_f32 v106, v20, v21
Zvav 236,116,100
v_exp_f32 v22, v90
Zvav 240,120,96
RD 104,6,26624
v_add_f32 v122, v122, v21
Zvav 244,120,100
buffer_load_dwordx4 v2, s[4:7], s32 offen offset:3072 sc1 lds
Zvav 248,124,96
s_waitcnt lgkmcnt(7)
RD 108,6,27648
v_add_f32 v123, v123, v22
Zvav 252,124,100
s_add_u32 m0, s30, 16384
v_readlane_b32 s31, v4, s29
Nvaa 64,64,128,112
RD 112,6,28672
Mvaa 64,68,132
v_exp_f32 v23, v91
Mvaa 64,72,144
s_add_u32 s30, s30, s36
RD 116,6,29696
v_cvt_pk_bf16_f32 v107, v22, v23
Mvaa 64,76,148
v_exp_f32 v12, v92
Nvaa 68,64,160,116
s_cmp_ge_u32 s30, 131072
RD 120,6,30720
v_add_f32 v123, v123, v23
Mvaa 68,68,164
buffer_load_dwordx4 v2, s[4:7], s31 offen offset:0 sc1 lds
Mvaa 68,72,176
s_waitcnt vmcnt(36) lgkmcnt(7)
s_cselect_b32 s36, s33, s34
RD 124,6,31744
Mvaa 68,76,180
s_barrier
v_add_u32 v6, s36, v6
v_add_f32 v124, v124, v12
Mvaa 68,80,168
s_waitcnt vmcnt(6)
RD 64,6,0
v_add_f32 v122, v122, v123
Mvaa 68,84,172
buffer_store_dword v9, v8, s[4:7], s72 offen sc1
Mvaa 68,88,184
RD 68,6,1024
Mvaa 68,92,188
v_exp_f32 v13, v93
Mvaa 64,80,136
s_add_u32 s29, s29, 1
RD 72,6,2048
v_cvt_pk_bf16_f32 v110, v12, v13
Mvaa 64,84,140
buffer_load_dwordx4 v2, s[4:7], s31 offen offset:1024 sc1 lds
Mvaa 64,88,152
s_waitcnt lgkmcnt(7)
RD 76,6,3072
v_add_f32 v124, v124, v13
Mvaa 64,92,156
v_exp_f32 v14, v94
Nvaa 72,96,128,112
RD 80,6,4096
v_add_f32 v125, v125, v14
Mvaa 72,100,132
v_exp_f32 v15, v95
Mvaa 72,104,144
RD 84,6,5120
v_cvt_pk_bf16_f32 v111, v14, v15
Mvaa 72,108,148
v_add_f32 v125, v125, v15
v_add_f32 v124, v124, v125
Nvaa 76,96,160,116
RD 88,6,6144
v_max_f32 v26, v122, v124
Mvaa 76,100,164
buffer_load_dwordx4 v2, s[4:7], s31 offen offset:2048 sc1 lds
Mvaa 76,104,176
s_waitcnt lgkmcnt(7)
RD 92,6,7168
v_cmp_nge_f32 vcc, 0x53800000, v26
Mvaa 76,108,180
v_readlane_b32 s32, v3, s29
Mvaa 76,112,168
RD 96,6,8192
Mvaa 76,116,172
Mvaa 76,120,184
RD 100,6,9216
Mvaa 76,124,188
buffer_load_dword v7, v63, s[4:7], s65 offen sc1
Mvaa 72,112,136
RD 104,6,10240
Mvaa 72,116,140
buffer_load_dwordx4 v2, s[4:7], s31 offen offset:3072 sc1 lds
Mvaa 72,120,152
s_waitcnt lgkmcnt(7)
RD 108,6,11264
Mvaa 72,124,156
s_mov_b32 m0, s30
s_cbranch_vccnz L_dorare_z1
L_norare_z1:
s_branch L_mid1
.p2align 6
.p2align 12
LP37:
s_setpc_b64 s[48:49]
L_steady1:
Mvav 128,64,96
RD 112,6,12288
v_add_f32 v120, v120, v122
Mvav 132,64,100
v_exp_f32 v12, v80
Mvav 136,68,96
RD 116,6,13312
v_add_f32 v121, v121, v124
Mvav 140,68,100
v_exp_f32 v13, v81
Mvav 144,72,96
RD 120,6,14336
v_cvt_pk_bf16_f32 v104, v12, v13
Mvav 148,72,100
buffer_load_dwordx4 v2, s[4:7], s32 offen offset:0 sc1 lds
Mvav 152,76,96
s_waitcnt lgkmcnt(7)
RD 124,6,15360
v_add_f32 v122, v12, v13
Mvav 156,76,100
v_exp_f32 v14, v82
Mvav 160,80,96
RD 64,6,16384
Mvav 164,80,100
v_exp_f32 v15, v83
Mvav 168,84,96
RD 68,6,17408
v_cvt_pk_bf16_f32 v105, v14, v15
Mvav 172,84,100
v_exp_f32 v16, v84
Mvav 176,88,96
RD 72,6,18432
v_add_f32 v123, v14, v15
Mvav 180,88,100
buffer_load_dwordx4 v2, s[4:7], s32 offen offset:1024 sc1 lds
Mvav 184,92,96
s_waitcnt lgkmcnt(7)
RD 76,6,19456
Mvav 188,92,100
v_exp_f32 v17, v85
Mvav 192,96,96
RD 80,6,20480
v_cvt_pk_bf16_f32 v108, v16, v17
Mvav 196,96,100
v_exp_f32 v18, v86
Mvav 200,100,96
RD 84,6,21504
v_add_f32 v124, v16, v17
Mvav 204,100,100
v_exp_f32 v19, v87
Mvav 208,104,96
RD 88,6,22528
v_cvt_pk_bf16_f32 v109, v18, v19
Mvav 212,104,100
buffer_load_dwordx4 v2, s[4:7], s32 offen offset:2048 sc1 lds
Mvav 216,108,96
s_waitcnt lgkmcnt(7)
RD 92,6,23552
v_add_f32 v125, v18, v19
Mvav 220,108,100
v_exp_f32 v20, v88
Mvav 224,112,96
RD 96,6,24576
v_add_f32 v122, v122, v20
Mvav 228,112,100
v_exp_f32 v21, v89
Mvav 232,116,96
RD 100,6,25600
v_cvt_pk_bf16_f32 v106, v20, v21
Mvav 236,116,100
v_exp_f32 v22, v90
Mvav 240,120,96
RD 104,6,26624
v_add_f32 v122, v122, v21
Mvav 244,120,100
buffer_load_dwordx4 v2, s[4:7], s32 offen offset:3072 sc1 lds
Mvav 248,124,96
s_waitcnt lgkmcnt(7)
RD 108,6,27648
v_add_f32 v123, v123, v22
Mvav 252,124,100
s_add_u32 m0, s30, 16384
v_readlane_b32 s31, v4, s29
Nvaa 64,64,128,112
RD 112,6,28672
Mvaa 64,68,132
v_exp_f32 v23, v91
Mvaa 64,72,144
s_add_u32 s30, s30, s36
RD 116,6,29696
v_cvt_pk_bf16_f32 v107, v22, v23
Mvaa 64,76,148
v_exp_f32 v12, v92
Nvaa 68,64,160,116
s_cmp_ge_u32 s30, 131072
RD 120,6,30720
v_add_f32 v123, v123, v23
Mvaa 68,68,164
buffer_load_dwordx4 v2, s[4:7], s31 offen offset:0 sc1 lds
Mvaa 68,72,176
s_waitcnt vmcnt(21) lgkmcnt(7)
s_cselect_b32 s36, s33, s34
RD 124,6,31744
Mvaa 68,76,180
s_barrier
v_add_u32 v6, s36, v6
v_add_f32 v124, v124, v12
Mvaa 68,80,168
RD 64,6,0
v_add_f32 v122, v122, v123
Mvaa 68,84,172
v_exp_f32 v13, v93
Mvaa 68,88,184
RD 68,6,1024
v_cvt_pk_bf16_f32 v110, v12, v13
Mvaa 68,92,188
v_exp_f32 v14, v94
Mvaa 64,80,136
s_add_u32 s29, s29, 1
RD 72,6,2048
v_add_f32 v124, v124, v13
Mvaa 64,84,140
buffer_load_dwordx4 v2, s[4:7], s31 offen offset:1024 sc1 lds
Mvaa 64,88,152
s_waitcnt lgkmcnt(7)
RD 76,6,3072
v_add_f32 v125, v125, v14
Mvaa 64,92,156
v_exp_f32 v15, v95
Nvaa 72,96,128,112
RD 80,6,4096
v_cvt_pk_bf16_f32 v111, v14, v15
Mvaa 72,100,132
v_add_f32 v125, v125, v15
v_add_f32 v124, v124, v125
Mvaa 72,104,144
RD 84,6,5120
v_max_f32 v26, v122, v124
Mvaa 72,108,148
v_cmp_nge_f32 vcc, 0x53800000, v26
Nvaa 76,96,160,116
RD 88,6,6144
Mvaa 76,100,164
buffer_load_dwordx4 v2, s[4:7], s31 offen offset:2048 sc1 lds
Mvaa 76,104,176
s_waitcnt lgkmcnt(7)
RD 92,6,7168
Mvaa 76,108,180
v_readlane_b32 s32, v3, s29
Mvaa 76,112,168
RD 96,6,8192
Mvaa 76,116,172
Mvaa 76,120,184
RD 100,6,9216
Mvaa 76,124,188
buffer_load_dword v7, v63, s[4:7], s65 offen sc1
Mvaa 72,112,136
RD 104,6,10240
Mvaa 72,116,140
buffer_load_dwordx4 v2, s[4:7], s31 offen offset:3072 sc1 lds
Mvaa 72,120,152
s_waitcnt lgkmcnt(7)
RD 108,6,11264
Mvaa 72,124,156
s_mov_b32 m0, s30
s_cbranch_vccnz L_dorare_s11
L_norare_s11:
L_mid1:
s_cmp_eq_u32 s43, s42
Mvav 128,64,104
s_cbranch_scc1 L_domask_s00
L_nomask_s01:
RD 112,6,12288
v_add_f32 v120, v120, v122
Mvav 132,64,108
v_exp_f32 v12, v64
Mvav 136,68,104
RD 116,6,13312
v_add_f32 v121, v121, v124
Mvav 140,68,108
v_exp_f32 v13, v65
Mvav 144,72,104
RD 120,6,14336
v_cvt_pk_bf16_f32 v96, v12, v13
Mvav 148,72,108
buffer_load_dwordx4 v2, s[4:7], s32 offen offset:0 sc1 lds
Mvav 152,76,104
s_waitcnt lgkmcnt(7)
RD 124,6,15360
v_add_f32 v122, v12, v13
Mvav 156,76,108
v_exp_f32 v14, v66
Mvav 160,80,104
RD 64,6,16384
Mvav 164,80,108
v_exp_f32 v15, v67
Mvav 168,84,104
RD 68,6,17408
v_cvt_pk_bf16_f32 v97, v14, v15
Mvav 172,84,108
v_exp_f32 v16, v68
Mvav 176,88,104
RD 72,6,18432
v_add_f32 v123, v14, v15
Mvav 180,88,108
buffer_load_dwordx4 v2, s[4:7], s32 offen offset:1024 sc1 lds
Mvav 184,92,104
s_waitcnt lgkmcnt(7)
RD 76,6,19456
Mvav 188,92,108
v_exp_f32 v17, v69
Mvav 192,96,104
RD 80,6,20480
v_cvt_pk_bf16_f32 v100, v16, v17
Mvav 196,96,108
v_exp_f32 v18, v70
Mvav 200,100,104
RD 84,6,21504
v_add_f32 v124, v16, v17
Mvav 204,100,108
v_exp_f32 v19, v71
Mvav 208,104,104
RD 88,6,22528
v_cvt_pk_bf16_f32 v101, v18, v19
Mvav 212,104,108
buffer_load_dwordx4 v2, s[4:7], s32 offen offset:2048 sc1 lds
Mvav 216,108,104
s_waitcnt lgkmcnt(7)
RD 92,6,23552
v_add_f32 v125, v18, v19
Mvav 220,108,108
v_exp_f32 v20, v72
Mvav 224,112,104
RD 96,6,24576
v_add_f32 v122, v122, v20
Mvav 228,112,108
v_exp_f32 v21, v73
Mvav 232,116,104
RD 100,6,25600
v_cvt_pk_bf16_f32 v98, v20, v21
Mvav 236,116,108
v_exp_f32 v22, v74
Mvav 240,120,104
RD 104,6,26624
v_add_f32 v122, v122, v21
Mvav 244,120,108
buffer_load_dwordx4 v2, s[4:7], s32 offen offset:3072 sc1 lds
Mvav 248,124,104
s_waitcnt lgkmcnt(7)
RD 108,6,27648
v_add_f32 v123, v123, v22
Mvav 252,124,108
s_add_u32 m0, s30, 16384
v_readlane_b32 s31, v4, s29
Nvaa 80,64,128,112
RD 112,6,28672
Mvaa 80,68,132
v_exp_f32 v23, v75
Mvaa 80,72,144
s_add_u32 s30, s30, s36
RD 116,6,29696
v_cvt_pk_bf16_f32 v99, v22, v23
Mvaa 80,76,148
v_exp_f32 v12, v76
Nvaa 84,64,160,116
s_cmp_ge_u32 s30, 131072
RD 120,6,30720
v_add_f32 v123, v123, v23
Mvaa 84,68,164
buffer_load_dwordx4 v2, s[4:7], s31 offen offset:0 sc1 lds
Mvaa 84,72,176
s_waitcnt vmcnt(21) lgkmcnt(7)
s_cselect_b32 s36, s33, s34
RD 124,6,31744
Mvaa 84,76,180
s_barrier
v_add_u32 v6, s36, v6
v_add_f32 v124, v124, v12
Mvaa 84,80,168
RD 64,6,0
v_add_f32 v122, v122, v123
Mvaa 84,84,172
v_exp_f32 v13, v77
Mvaa 84,88,184
RD 68,6,1024
v_cvt_pk_bf16_f32 v102, v12, v13
Mvaa 84,92,188
v_exp_f32 v14, v78
Mvaa 80,80,136
s_add_u32 s29, s29, 1
RD 72,6,2048
v_add_f32 v124, v124, v13
Mvaa 80,84,140
buffer_load_dwordx4 v2, s[4:7], s31 offen offset:1024 sc1 lds
Mvaa 80,88,152
s_waitcnt lgkmcnt(7)
RD 76,6,3072
v_add_f32 v125, v125, v14
Mvaa 80,92,156
v_exp_f32 v15, v79
Nvaa 88,96,128,112
RD 80,6,4096
v_cvt_pk_bf16_f32 v103, v14, v15
Mvaa 88,100,132
v_add_f32 v125, v125, v15
v_add_f32 v124, v124, v125
Mvaa 88,104,144
RD 84,6,5120
v_max_f32 v26, v122, v124
Mvaa 88,108,148
v_cmp_nge_f32 vcc, 0x53800000, v26
Nvaa 92,96,160,116
RD 88,6,6144
Mvaa 92,100,164
buffer_load_dwordx4 v2, s[4:7], s31 offen offset:2048 sc1 lds
Mvaa 92,104,176
s_waitcnt lgkmcnt(7)
RD 92,6,7168
Mvaa 92,108,180
v_readlane_b32 s32, v3, s29
Mvaa 92,112,168
s_sub_u32 s43, s43, 1
RD 96,6,8192
Mvaa 92,116,172
Mvaa 92,120,184
s_cmp_lg_u32 s43, s44
RD 100,6,9216
Mvaa 92,124,188
Mvaa 88,112,136
RD 104,6,10240
Mvaa 88,116,140
buffer_load_dwordx4 v2, s[4:7], s31 offen offset:3072 sc1 lds
Mvaa 88,120,152
s_waitcnt lgkmcnt(7)
RD 108,6,11264
Mvaa 88,124,156
s_mov_b32 m0, s30
s_cbranch_vccnz L_dorare_s01
L_norare_s01:
s_cbranch_scc1 L_steady1
L_exit1:
s_cmp_eq_u32 s44, 1
s_cbranch_scc1 L_tail1
L_gv1:
s_mov_b32 s44, 1
s_waitcnt vmcnt(9)
v_cmp_ne_u32 vcc, 1, v7
s_add_u32 s79, s64, 462848
s_nop 3
s_cbranch_vccnz L_pw_gv1
L_po_gv1:
s_cmp_ge_u32 s60, 2
s_cselect_b32 s65, 2130706432, s72
v_mov_b32 v63, v8
Mvav 128,64,96
RD 112,6,12288
v_add_f32 v120, v120, v122
Mvav 132,64,100
v_exp_f32 v12, v80
Mvav 136,68,96
RD 116,6,13312
v_exp_f32 v13, v81
Mvav 140,68,100
buffer_load_dwordx4 a[192:195], v61, s[4:7], s64 offen offset:0 sc1
Mvav 144,72,96
RD 120,6,14336
v_cvt_pk_bf16_f32 v104, v12, v13
Mvav 148,72,100
buffer_load_dwordx4 v2, s[4:7], s32 offen offset:0 sc1 lds
Mvav 152,76,96
s_waitcnt lgkmcnt(7)
RD 124,6,15360
v_exp_f32 v14, v82
Mvav 156,76,100
v_exp_f32 v15, v83
Mvav 160,80,96
RD 64,6,16384
v_cvt_pk_bf16_f32 v105, v14, v15
Mvav 164,80,100
buffer_load_dwordx4 a[196:199], v62, s[4:7], s79 offen offset:0 sc1
Mvav 168,84,96
RD 68,6,17408
v_exp_f32 v16, v84
Mvav 172,84,100
v_exp_f32 v17, v85
Mvav 176,88,96
RD 72,6,18432
v_cvt_pk_bf16_f32 v108, v16, v17
Mvav 180,88,100
buffer_load_dwordx4 v2, s[4:7], s32 offen offset:1024 sc1 lds
Mvav 184,92,96
s_waitcnt lgkmcnt(7)
RD 76,6,19456
v_exp_f32 v18, v86
Mvav 188,92,100
v_exp_f32 v19, v87
Mvav 192,96,96
RD 80,6,20480
v_cvt_pk_bf16_f32 v109, v18, v19
Mvav 196,96,100
buffer_load_dwordx4 a[200:203], v61, s[4:7], s64 offen offset:1024 sc1
Mvav 200,100,96
RD 84,6,21504
v_exp_f32 v20, v88
Mvav 204,100,100
v_exp_f32 v21, v89
Mvav 208,104,96
RD 88,6,22528
v_cvt_pk_bf16_f32 v106, v20, v21
Mvav 212,104,100
buffer_load_dwordx4 v2, s[4:7], s32 offen offset:2048 sc1 lds
Mvav 216,108,96
s_waitcnt lgkmcnt(7)
RD 92,6,23552
v_add_f32 v121, v121, v124
Mvav 220,108,100
v_exp_f32 v22, v90
Mvav 224,112,96
RD 96,6,24576
v_add_f32 v122, v12, v13
Mvav 228,112,100
buffer_load_dwordx4 a[204:207], v62, s[4:7], s79 offen offset:1024 sc1
Mvav 232,116,96
RD 100,6,25600
v_add_f32 v123, v14, v15
Mvav 236,116,100
v_exp_f32 v23, v91
Mvav 240,120,96
RD 104,6,26624
v_cvt_pk_bf16_f32 v107, v22, v23
Mvav 244,120,100
buffer_load_dwordx4 v2, s[4:7], s32 offen offset:3072 sc1 lds
Mvav 248,124,96
s_waitcnt lgkmcnt(7)
RD 108,6,27648
v_add_f32 v124, v16, v17
Mvav 252,124,100
s_add_u32 m0, s30, 16384
v_readlane_b32 s31, v4, s29
Nvaa 64,64,128,112
RD 112,6,28672
v_add_f32 v125, v18, v19
Mvaa 64,68,132
buffer_load_dwordx4 a[208:211], v61, s[4:7], s64 offen offset:256 sc1
Mvaa 64,72,144
s_add_u32 s30, s30, s36
RD 116,6,29696
v_add_f32 v122, v122, v20
Mvaa 64,76,148
v_exp_f32 v12, v92
Nvaa 68,64,160,116
s_cmp_ge_u32 s30, 131072
RD 120,6,30720
v_add_f32 v122, v122, v21
Mvaa 68,68,164
buffer_load_dwordx4 v2, s[4:7], s31 offen offset:0 sc1 lds
Mvaa 68,72,176
s_waitcnt vmcnt(26) lgkmcnt(7)
s_cselect_b32 s36, s33, s34
RD 124,6,31744
Mvaa 68,76,180
s_barrier
v_add_u32 v6, s36, v6
v_add_f32 v123, v123, v22
Mvaa 68,80,168
RD 64,6,0
v_add_f32 v123, v123, v23
Mvaa 68,84,172
buffer_load_dwordx4 a[212:215], v62, s[4:7], s79 offen offset:256 sc1
Mvaa 68,88,184
RD 68,6,1024
v_add_f32 v124, v124, v12
Mvaa 68,92,188
v_exp_f32 v13, v93
Mvaa 64,80,136
s_add_u32 s29, s29, 1
RD 72,6,2048
v_cvt_pk_bf16_f32 v110, v12, v13
Mvaa 64,84,140
buffer_load_dwordx4 v2, s[4:7], s31 offen offset:1024 sc1 lds
Mvaa 64,88,152
s_waitcnt lgkmcnt(7)
RD 76,6,3072
v_add_f32 v124, v124, v13
Mvaa 64,92,156
v_exp_f32 v14, v94
Nvaa 72,96,128,112
RD 80,6,4096
v_add_f32 v125, v125, v14
Mvaa 72,100,132
buffer_load_dwordx4 a[216:219], v61, s[4:7], s64 offen offset:1280 sc1
Mvaa 72,104,144
RD 84,6,5120
v_add_f32 v122, v122, v123
Mvaa 72,108,148
v_exp_f32 v15, v95
Nvaa 76,96,160,116
RD 88,6,6144
v_cvt_pk_bf16_f32 v111, v14, v15
Mvaa 76,100,164
buffer_load_dwordx4 v2, s[4:7], s31 offen offset:2048 sc1 lds
Mvaa 76,104,176
s_waitcnt lgkmcnt(7)
RD 92,6,7168
v_add_f32 v125, v125, v15
Mvaa 76,108,180
v_readlane_b32 s32, v3, s29
Mvaa 76,112,168
RD 96,6,8192
v_add_f32 v124, v124, v125
Mvaa 76,116,172
buffer_load_dwordx4 a[220:223], v62, s[4:7], s79 offen offset:1280 sc1
Mvaa 76,120,184
RD 100,6,9216
v_max_f32 v26, v122, v124
Mvaa 76,124,188
buffer_load_dword v7, v63, s[4:7], s65 offen sc1
Mvaa 72,112,136
RD 104,6,10240
v_cmp_nge_f32 vcc, 0x53800000, v26
Mvaa 72,116,140
buffer_load_dwordx4 v2, s[4:7], s31 offen offset:3072 sc1 lds
Mvaa 72,120,152
s_waitcnt lgkmcnt(7)
RD 108,6,11264
Mvaa 72,124,156
s_mov_b32 m0, s30
s_cbranch_vccnz L_dorare_gv11
L_norare_gv11:
s_cmp_eq_u32 s43, s42
Mvav 128,64,104
s_cbranch_scc0 L_nomask_gv01
s_bitcmp1_b32 s24, 0
s_cbranch_scc1 L_domask_gv01_odd
v_cndmask_b32 v64, v64, v126, s[52:53]
v_cndmask_b32 v65, v65, v126, s[54:55]
v_cndmask_b32 v66, v66, v126, s[56:57]
v_cndmask_b32 v67, v67, v126, s[58:59]
L_domask_gv01_all:
v_mov_b64 v[72:73], v[126:127]
v_mov_b64 v[74:75], v[126:127]
s_branch L_nomask_gv01
L_domask_gv01_odd:
s_nop 3
v_cndmask_b32 v72, v72, v126, s[52:53]
v_cndmask_b32 v73, v73, v126, s[54:55]
v_cndmask_b32 v74, v74, v126, s[56:57]
v_cndmask_b32 v75, v75, v126, s[58:59]
L_nomask_gv01:
RD 112,6,12288
v_add_f32 v120, v120, v122
Mvav 132,64,108
v_exp_f32 v12, v64
Mvav 136,68,104
RD 116,6,13312
v_exp_f32 v13, v65
Mvav 140,68,108
buffer_load_dwordx4 a[224:227], v61, s[4:7], s64 offen offset:512 sc1
Mvav 144,72,104
RD 120,6,14336
v_cvt_pk_bf16_f32 v96, v12, v13
Mvav 148,72,108
buffer_load_dwordx4 v2, s[4:7], s32 offen offset:0 sc1 lds
Mvav 152,76,104
s_waitcnt lgkmcnt(7)
RD 124,6,15360
v_add_f32 v121, v121, v124
Mvav 156,76,108
v_exp_f32 v14, v66
Mvav 160,80,104
RD 64,6,16384
v_add_f32 v122, v12, v13
Mvav 164,80,108
buffer_load_dwordx4 a[228:231], v62, s[4:7], s79 offen offset:512 sc1
Mvav 168,84,104
RD 68,6,17408
Mvav 172,84,108
v_exp_f32 v15, v67
Mvav 176,88,104
RD 72,6,18432
v_cvt_pk_bf16_f32 v97, v14, v15
Mvav 180,88,108
buffer_load_dwordx4 v2, s[4:7], s32 offen offset:1024 sc1 lds
Mvav 184,92,104
s_waitcnt lgkmcnt(7)
RD 76,6,19456
v_exp_f32 v16, v68
Mvav 188,92,108
v_exp_f32 v17, v69
Mvav 192,96,104
RD 80,6,20480
v_cvt_pk_bf16_f32 v100, v16, v17
Mvav 196,96,108
buffer_load_dwordx4 a[232:235], v61, s[4:7], s64 offen offset:1536 sc1
Mvav 200,100,104
RD 84,6,21504
v_add_f32 v123, v14, v15
Mvav 204,100,108
v_exp_f32 v18, v70
Mvav 208,104,104
RD 88,6,22528
v_add_f32 v124, v16, v17
Mvav 212,104,108
buffer_load_dwordx4 v2, s[4:7], s32 offen offset:2048 sc1 lds
Mvav 216,108,104
s_waitcnt lgkmcnt(7)
RD 92,6,23552
Mvav 220,108,108
v_exp_f32 v19, v71
Mvav 224,112,104
RD 96,6,24576
v_cvt_pk_bf16_f32 v101, v18, v19
Mvav 228,112,108
buffer_load_dwordx4 a[236:239], v62, s[4:7], s79 offen offset:1536 sc1
s_branch LOP38
LP38:
s_setpc_b64 s[48:49]
LOP38:
Mvav 232,116,104
RD 100,6,25600
v_exp_f32 v20, v72
Mvav 236,116,108
v_exp_f32 v21, v73
Mvav 240,120,104
RD 104,6,26624
v_cvt_pk_bf16_f32 v98, v20, v21
Mvav 244,120,108
buffer_load_dwordx4 v2, s[4:7], s32 offen offset:3072 sc1 lds
Mvav 248,124,104
s_waitcnt lgkmcnt(7)
RD 108,6,27648
v_add_f32 v125, v18, v19
Mvav 252,124,108
s_add_u32 m0, s30, 16384
v_readlane_b32 s31, v4, s29
Nvaa 80,64,128,112
RD 112,6,28672
v_add_f32 v122, v122, v20
Mvaa 80,68,132
buffer_load_dwordx4 a[240:243], v61, s[4:7], s64 offen offset:768 sc1
Mvaa 80,72,144
s_add_u32 s30, s30, s36
RD 116,6,29696
v_add_f32 v122, v122, v21
Mvaa 80,76,148
v_exp_f32 v22, v74
Nvaa 84,64,160,116
s_cmp_ge_u32 s30, 131072
RD 120,6,30720
v_add_f32 v123, v123, v22
Mvaa 84,68,164
buffer_load_dwordx4 v2, s[4:7], s31 offen offset:0 sc1 lds
Mvaa 84,72,176
s_waitcnt vmcnt(35) lgkmcnt(7)
s_cselect_b32 s36, s33, s34
RD 124,6,31744
Mvaa 84,76,180
s_barrier
v_add_u32 v6, s36, v6
v_exp_f32 v23, v75
Mvaa 84,80,168
RD 64,6,0
v_cvt_pk_bf16_f32 v99, v22, v23
Mvaa 84,84,172
buffer_load_dwordx4 a[244:247], v62, s[4:7], s79 offen offset:768 sc1
Mvaa 84,88,184
RD 68,6,1024
v_add_f32 v123, v123, v23
Mvaa 84,92,188
v_exp_f32 v12, v76
Mvaa 80,80,136
s_add_u32 s29, s29, 1
RD 72,6,2048
v_add_f32 v124, v124, v12
Mvaa 80,84,140
buffer_load_dwordx4 v2, s[4:7], s31 offen offset:1024 sc1 lds
Mvaa 80,88,152
s_waitcnt lgkmcnt(7)
RD 76,6,3072
v_add_f32 v122, v122, v123
Mvaa 80,92,156
v_exp_f32 v13, v77
Nvaa 88,96,128,112
RD 80,6,4096
v_cvt_pk_bf16_f32 v102, v12, v13
Mvaa 88,100,132
buffer_load_dwordx4 a[248:251], v61, s[4:7], s64 offen offset:1792 sc1
Mvaa 88,104,144
RD 84,6,5120
v_exp_f32 v14, v78
Mvaa 88,108,148
v_exp_f32 v15, v79
Nvaa 92,96,160,116
RD 88,6,6144
v_cvt_pk_bf16_f32 v103, v14, v15
Mvaa 92,100,164
buffer_load_dwordx4 v2, s[4:7], s31 offen offset:2048 sc1 lds
Mvaa 92,104,176
s_waitcnt lgkmcnt(7)
RD 92,6,7168
v_add_f32 v124, v124, v13
Mvaa 92,108,180
v_readlane_b32 s32, v3, s29
Mvaa 92,112,168
s_sub_u32 s43, s43, 1
RD 96,6,8192
v_add_f32 v125, v125, v14
Mvaa 92,116,172
buffer_load_dwordx4 a[252:255], v62, s[4:7], s79 offen offset:1792 sc1
Mvaa 92,120,184
s_cmp_lg_u32 s43, s44
RD 100,6,9216
v_add_f32 v125, v125, v15
Mvaa 92,124,188
v_add_f32 v124, v124, v125
v_max_f32 v26, v122, v124
Mvaa 88,112,136
RD 104,6,10240
v_cmp_nge_f32 vcc, 0x53800000, v26
Mvaa 88,116,140
buffer_load_dwordx4 v2, s[4:7], s31 offen offset:3072 sc1 lds
Mvaa 88,120,152
s_waitcnt lgkmcnt(7)
RD 108,6,11264
Mvaa 88,124,156
s_mov_b32 m0, s30
s_cbranch_vccnz L_dorare_gv01
L_norare_gv01:
s_cbranch_scc1 L_steady1
s_branch L_exit1
.fill 929, 4, 0xbf800000
L_u41:
v_mov_b64 v[128:129], 0
v_mov_b64 v[130:131], 0
v_mov_b64 v[132:133], 0
v_mov_b64 v[134:135], 0
v_mov_b64 v[136:137], 0
v_mov_b64 v[138:139], 0
v_mov_b64 v[140:141], 0
v_mov_b64 v[142:143], 0
v_mov_b64 v[144:145], 0
v_mov_b64 v[146:147], 0
v_mov_b64 v[148:149], 0
v_mov_b64 v[150:151], 0
v_mov_b64 v[152:153], 0
v_mov_b64 v[154:155], 0
v_mov_b64 v[156:157], 0
v_mov_b64 v[158:159], 0
v_mov_b64 v[160:161], 0
v_mov_b64 v[162:163], 0
v_mov_b64 v[164:165], 0
v_mov_b64 v[166:167], 0
v_mov_b64 v[168:169], 0
v_mov_b64 v[170:171], 0
v_mov_b64 v[172:173], 0
v_mov_b64 v[174:175], 0
v_mov_b64 v[176:177], 0
v_mov_b64 v[178:179], 0
v_mov_b64 v[180:181], 0
v_mov_b64 v[182:183], 0
v_mov_b64 v[184:185], 0
v_mov_b64 v[186:187], 0
v_mov_b64 v[188:189], 0
v_mov_b64 v[190:191], 0
v_mov_b64 v[192:193], 0
v_mov_b64 v[194:195], 0
v_mov_b64 v[196:197], 0
v_mov_b64 v[198:199], 0
v_mov_b64 v[200:201], 0
v_mov_b64 v[202:203], 0
v_mov_b64 v[204:205], 0
v_mov_b64 v[206:207], 0
v_mov_b64 v[208:209], 0
v_mov_b64 v[210:211], 0
v_mov_b64 v[212:213], 0
v_mov_b64 v[214:215], 0
v_mov_b64 v[216:217], 0
v_mov_b64 v[218:219], 0
v_mov_b64 v[220:221], 0
v_mov_b64 v[222:223], 0
v_mov_b64 v[224:225], 0
v_mov_b64 v[226:227], 0
v_mov_b64 v[228:229], 0
v_mov_b64 v[230:231], 0
v_mov_b64 v[232:233], 0
v_mov_b64 v[234:235], 0
v_mov_b64 v[236:237], 0
v_mov_b64 v[238:239], 0
v_mov_b64 v[240:241], 0
v_mov_b64 v[242:243], 0
v_mov_b64 v[244:245], 0
v_mov_b64 v[246:247], 0
v_mov_b64 v[248:249], 0
v_mov_b64 v[250:251], 0
v_mov_b64 v[252:253], 0
v_mov_b64 v[254:255], 0
s_waitcnt vmcnt(0)
buffer_store_dword v9, v8, s[4:7], s72 offen sc1
s_add_u32 s79, s64, 462848
s_branch L_pw_g7
L_po_g7:
buffer_load_dwordx4 a[192:195], v61, s[4:7], s64 offen offset:0 sc1
buffer_load_dwordx4 a[196:199], v62, s[4:7], s79 offen offset:0 sc1
buffer_load_dwordx4 a[200:203], v61, s[4:7], s64 offen offset:1024 sc1
buffer_load_dwordx4 a[204:207], v62, s[4:7], s79 offen offset:1024 sc1
buffer_load_dwordx4 a[208:211], v61, s[4:7], s64 offen offset:256 sc1
buffer_load_dwordx4 a[212:215], v62, s[4:7], s79 offen offset:256 sc1
buffer_load_dwordx4 a[216:219], v61, s[4:7], s64 offen offset:1280 sc1
buffer_load_dwordx4 a[220:223], v62, s[4:7], s79 offen offset:1280 sc1
buffer_load_dwordx4 a[224:227], v61, s[4:7], s64 offen offset:512 sc1
buffer_load_dwordx4 a[228:231], v62, s[4:7], s79 offen offset:512 sc1
buffer_load_dwordx4 a[232:235], v61, s[4:7], s64 offen offset:1536 sc1
buffer_load_dwordx4 a[236:239], v62, s[4:7], s79 offen offset:1536 sc1
buffer_load_dwordx4 a[240:243], v61, s[4:7], s64 offen offset:768 sc1
buffer_load_dwordx4 a[244:247], v62, s[4:7], s79 offen offset:768 sc1
buffer_load_dwordx4 a[248:251], v61, s[4:7], s64 offen offset:1792 sc1
buffer_load_dwordx4 a[252:255], v62, s[4:7], s79 offen offset:1792 sc1
s_branch LOP39
LP39:
s_setpc_b64 s[48:49]
LOP39:
L_tail1:
s_bitcmp1_b32 s24, 1
Mvav 128,64,96
s_cbranch_scc0 L_domask_h11_a0
s_bitcmp1_b32 s24, 0
s_cbranch_scc1 L_domask_h11_odd
v_cndmask_b32 v80, v80, v126, s[52:53]
v_cndmask_b32 v81, v81, v126, s[54:55]
v_cndmask_b32 v82, v82, v126, s[56:57]
v_cndmask_b32 v83, v83, v126, s[58:59]
L_domask_h11_all:
v_mov_b64 v[88:89], v[126:127]
v_mov_b64 v[90:91], v[126:127]
s_branch L_nomask_h11
L_domask_h11_odd:
s_nop 3
v_cndmask_b32 v88, v88, v126, s[52:53]
v_cndmask_b32 v89, v89, v126, s[54:55]
v_cndmask_b32 v90, v90, v126, s[56:57]
v_cndmask_b32 v91, v91, v126, s[58:59]
s_branch L_nomask_h11
L_domask_h11_a0:
s_nop 1
v_mov_b64 v[80:81], v[126:127]
v_mov_b64 v[82:83], v[126:127]
v_mov_b64 v[88:89], v[126:127]
v_mov_b64 v[90:91], v[126:127]
L_nomask_h11:
RD 112,6,12288
v_add_f32 v120, v120, v122
Mvav 132,64,100
v_exp_f32 v12, v80
Mvav 136,68,96
RD 116,6,13312
v_exp_f32 v13, v81
Mvav 140,68,100
v_cvt_pk_bf16_f32 v104, v12, v13
v_exp_f32 v14, v82
Mvav 144,72,96
RD 120,6,14336
v_add_f32 v121, v121, v124
Mvav 148,72,100
buffer_load_dwordx4 v2, s[4:7], s32 offen offset:0 sc1 lds
Mvav 152,76,96
s_waitcnt lgkmcnt(7)
RD 124,6,15360
v_exp_f32 v15, v83
Mvav 156,76,100
v_cvt_pk_bf16_f32 v105, v14, v15
v_add_f32 v122, v12, v13
Mvav 160,80,96
RD 64,6,16384
v_exp_f32 v16, v84
Mvav 164,80,100
v_exp_f32 v17, v85
Mvav 168,84,96
RD 68,6,17408
v_cvt_pk_bf16_f32 v108, v16, v17
Mvav 172,84,100
v_exp_f32 v18, v86
Mvav 176,88,96
RD 72,6,18432
v_exp_f32 v19, v87
Mvav 180,88,100
buffer_load_dwordx4 v2, s[4:7], s32 offen offset:1024 sc1 lds
Mvav 184,92,96
s_waitcnt lgkmcnt(7)
RD 76,6,19456
v_cvt_pk_bf16_f32 v109, v18, v19
Mvav 188,92,100
v_exp_f32 v20, v88
Mvav 192,96,96
RD 80,6,20480
v_exp_f32 v21, v89
Mvav 196,96,100
v_cvt_pk_bf16_f32 v106, v20, v21
v_exp_f32 v22, v90
Mvav 200,100,96
RD 84,6,21504
v_add_f32 v123, v14, v15
Mvav 204,100,100
v_exp_f32 v23, v91
Mvav 208,104,96
RD 88,6,22528
v_cvt_pk_bf16_f32 v107, v22, v23
Mvav 212,104,100
buffer_load_dwordx4 v2, s[4:7], s32 offen offset:2048 sc1 lds
Mvav 216,108,96
s_waitcnt lgkmcnt(7)
RD 92,6,23552
v_exp_f32 v12, v92
Mvav 220,108,100
v_exp_f32 v13, v93
Mvav 224,112,96
RD 96,6,24576
v_cvt_pk_bf16_f32 v110, v12, v13
Mvav 228,112,100
v_exp_f32 v14, v94
Mvav 232,116,96
RD 100,6,25600
v_exp_f32 v15, v95
Mvav 236,116,100
v_cvt_pk_bf16_f32 v111, v14, v15
v_add_f32 v124, v16, v17
v_add_f32 v125, v18, v19
Mvav 240,120,96
RD 104,6,26624
v_add_f32 v122, v122, v20
v_add_f32 v122, v122, v21
Mvav 244,120,100
buffer_load_dwordx4 v2, s[4:7], s32 offen offset:3072 sc1 lds
Mvav 248,124,96
s_waitcnt lgkmcnt(7)
RD 108,6,27648
v_add_f32 v123, v123, v22
Mvav 252,124,100
s_add_u32 m0, s30, 16384
v_readlane_b32 s31, v4, s29
RD 112,6,28672
Nvaa 68,64,160,116
s_add_u32 s30, s30, s36
RD 116,6,29696
v_add_f32 v123, v123, v23
Mvaa 68,68,164
s_cmp_ge_u32 s30, 131072
RD 120,6,30720
v_add_f32 v124, v124, v12
Mvaa 68,72,176
buffer_load_dwordx4 v2, s[4:7], s31 offen offset:0 sc1 lds
s_waitcnt vmcnt(21) lgkmcnt(7)
s_cselect_b32 s36, s33, s34
RD 124,6,31744
Mvaa 68,76,180
s_barrier
v_add_u32 v6, s36, v6
RD 64,6,0
Mvaa 68,80,168
RD 68,6,1024
v_add_f32 v124, v124, v13
Mvaa 68,84,172
s_add_u32 s29, s29, 1
RD 72,6,2048
v_add_f32 v125, v125, v14
Mvaa 68,88,184
buffer_load_dwordx4 v2, s[4:7], s31 offen offset:1024 sc1 lds
s_waitcnt lgkmcnt(7)
RD 76,6,3072
Mvaa 68,92,188
RD 80,6,4096
v_add_f32 v125, v125, v15
Nvaa 76,96,160,116
RD 84,6,5120
v_add_f32 v122, v122, v123
Mvaa 76,100,164
RD 88,6,6144
v_add_f32 v124, v124, v125
Mvaa 76,104,176
buffer_load_dwordx4 v2, s[4:7], s31 offen offset:2048 sc1 lds
s_waitcnt lgkmcnt(7)
RD 92,6,7168
Mvaa 76,108,180
v_readlane_b32 s32, v3, s29
RD 96,6,8192
Mvaa 76,112,168
RD 100,6,9216
v_max_f32 v26, v122, v124
Mvaa 76,116,172
RD 104,6,10240
v_cmp_nge_f32 vcc, 0x53800000, v26
Mvaa 76,120,184
buffer_load_dwordx4 v2, s[4:7], s31 offen offset:3072 sc1 lds
s_waitcnt lgkmcnt(7)
RD 108,6,11264
Mvaa 76,124,188
s_mov_b32 m0, s30
s_cbranch_vccnz L_dorare_h11
L_norare_h11:
s_bitcmp1_b32 s24, 1
Mvav 128,64,104
s_cbranch_scc1 L_nomask_h01
s_bitcmp1_b32 s24, 0
s_cbranch_scc1 L_domask_h01_odd
v_cndmask_b32 v68, v68, v126, s[52:53]
v_cndmask_b32 v69, v69, v126, s[54:55]
v_cndmask_b32 v70, v70, v126, s[56:57]
v_cndmask_b32 v71, v71, v126, s[58:59]
L_domask_h01_all:
v_mov_b64 v[76:77], v[126:127]
v_mov_b64 v[78:79], v[126:127]
s_branch L_nomask_h01
L_domask_h01_odd:
s_nop 3
v_cndmask_b32 v76, v76, v126, s[52:53]
v_cndmask_b32 v77, v77, v126, s[54:55]
v_cndmask_b32 v78, v78, v126, s[56:57]
v_cndmask_b32 v79, v79, v126, s[58:59]
L_nomask_h01:
RD 112,6,12288
v_add_f32 v120, v120, v122
Mvav 132,64,108
v_exp_f32 v12, v68
Mvav 136,68,104
RD 116,6,13312
v_add_f32 v121, v121, v124
Mvav 140,68,108
v_exp_f32 v13, v69
Mvav 144,72,104
RD 120,6,14336
v_cvt_pk_bf16_f32 v100, v12, v13
Mvav 148,72,108
buffer_load_dwordx4 v2, s[4:7], s32 offen offset:0 sc1 lds
Mvav 152,76,104
s_waitcnt lgkmcnt(7)
RD 124,6,15360
v_add_f32 v124, v12, v13
Mvav 156,76,108
v_exp_f32 v14, v70
Mvav 160,80,104
RD 64,6,16384
v_cvt_pk_bf16_f32 v128, v128, v129
Mvav 164,80,108
v_exp_f32 v15, v71
Mvav 168,84,104
RD 68,6,17408
v_cvt_pk_bf16_f32 v101, v14, v15
Mvav 172,84,108
v_exp_f32 v16, v76
Mvav 176,88,104
RD 72,6,18432
v_add_f32 v125, v14, v15
Mvav 180,88,108
buffer_load_dwordx4 v2, s[4:7], s32 offen offset:1024 sc1 lds
Mvav 184,92,104
s_waitcnt lgkmcnt(7)
RD 76,6,19456
v_add_f32 v124, v124, v16
Mvav 188,92,108
v_exp_f32 v17, v77
Mvav 192,96,104
RD 80,6,20480
v_cvt_pk_bf16_f32 v102, v16, v17
Mvav 196,96,108
v_exp_f32 v18, v78
Mvav 200,100,104
RD 84,6,21504
v_add_f32 v124, v124, v17
Mvav 204,100,108
v_exp_f32 v19, v79
Mvav 208,104,104
RD 88,6,22528
v_cvt_pk_bf16_f32 v103, v18, v19
Mvav 212,104,108
buffer_load_dwordx4 v2, s[4:7], s32 offen offset:2048 sc1 lds
Mvav 216,108,104
s_waitcnt lgkmcnt(7)
RD 92,6,23552
v_add_f32 v125, v125, v18
Mvav 220,108,108
v_add_f32 v125, v125, v19
v_add_f32 v124, v124, v125
Mvav 224,112,104
RD 96,6,24576
v_cmp_nge_f32 vcc, 0x53800000, v124
Mvav 228,112,108
v_cvt_pk_bf16_f32 v129, v130, v131
v_cvt_pk_bf16_f32 v130, v136, v137
Mvav 232,116,104
RD 100,6,25600
v_cvt_pk_bf16_f32 v131, v138, v139
Mvav 236,116,108
v_cvt_pk_bf16_f32 v144, v144, v145
v_cvt_pk_bf16_f32 v145, v146, v147
Mvav 240,120,104
RD 104,6,26624
v_cvt_pk_bf16_f32 v146, v152, v153
Mvav 244,120,108
buffer_load_dwordx4 v2, s[4:7], s32 offen offset:3072 sc1 lds
Mvav 248,124,104
s_waitcnt lgkmcnt(7)
RD 108,6,27648
v_cvt_pk_bf16_f32 v147, v154, v155
Mvav 252,124,108
s_add_u32 m0, s30, 16384
v_readlane_b32 s31, v4, s29
RD 112,6,28672
Nvaa 84,64,160,116
s_add_u32 s30, s30, s36
RD 116,6,29696
v_cvt_pk_bf16_f32 v160, v160, v161
Mvaa 84,68,164
s_cmp_ge_u32 s30, 131072
RD 120,6,30720
v_cvt_pk_bf16_f32 v161, v162, v163
Mvaa 84,72,176
buffer_load_dwordx4 v2, s[4:7], s31 offen offset:0 sc1 lds
s_waitcnt vmcnt(21) lgkmcnt(7)
s_cselect_b32 s36, s33, s34
RD 124,6,31744
Mvaa 84,76,180
s_barrier
v_add_u32 v6, s36, v6
RD 64,6,0
Mvaa 84,80,168
RD 68,6,1024
v_cvt_pk_bf16_f32 v162, v168, v169
Mvaa 84,84,172
s_add_u32 s29, s29, 1
RD 72,6,2048
v_cvt_pk_bf16_f32 v163, v170, v171
Mvaa 84,88,184
buffer_load_dwordx4 v2, s[4:7], s31 offen offset:1024 sc1 lds
s_waitcnt lgkmcnt(7)
RD 76,6,3072
Mvaa 84,92,188
RD 80,6,4096
v_cvt_pk_bf16_f32 v176, v176, v177
Nvaa 92,96,160,116
RD 84,6,5120
v_cvt_pk_bf16_f32 v177, v178, v179
Mvaa 92,100,164
RD 88,6,6144
v_cvt_pk_bf16_f32 v178, v184, v185
Mvaa 92,104,176
buffer_load_dwordx4 v2, s[4:7], s31 offen offset:2048 sc1 lds
s_waitcnt lgkmcnt(7)
RD 92,6,7168
Mvaa 92,108,180
v_readlane_b32 s32, v3, s29
RD 96,6,8192
Mvaa 92,112,168
RD 100,6,9216
v_cvt_pk_bf16_f32 v179, v186, v187
Mvaa 92,116,172
RD 104,6,10240
v_cvt_pk_bf16_f32 v192, v192, v193
Mvaa 92,120,184
buffer_load_dwordx4 v2, s[4:7], s31 offen offset:3072 sc1 lds
s_waitcnt lgkmcnt(7)
RD 108,6,11264
Mvaa 92,124,188
s_mov_b32 m0, s30
s_cbranch_vccnz L_dorare_h01
L_norare_h01:
s_bitcmp1_b32 s24, 1
RD 112,6,12288
v_cvt_pk_bf16_f32 v193, v194, v195
Mvav 132,64,100
s_cbranch_scc0 L_domask_lh1_a0
s_bitcmp1_b32 s24, 0
s_cbranch_scc1 L_domask_lh1_odd
v_cndmask_b32 v84, v84, v126, s[52:53]
v_cndmask_b32 v85, v85, v126, s[54:55]
v_cndmask_b32 v86, v86, v126, s[56:57]
v_cndmask_b32 v87, v87, v126, s[58:59]
L_domask_lh1_all:
v_mov_b64 v[92:93], v[126:127]
v_mov_b64 v[94:95], v[126:127]
s_branch L_nomask_lh1
L_domask_lh1_odd:
s_nop 3
v_cndmask_b32 v92, v92, v126, s[52:53]
v_cndmask_b32 v93, v93, v126, s[54:55]
v_cndmask_b32 v94, v94, v126, s[56:57]
v_cndmask_b32 v95, v95, v126, s[58:59]
s_branch L_nomask_lh1
L_domask_lh1_a0:
s_nop 1
v_mov_b64 v[84:85], v[126:127]
v_mov_b64 v[86:87], v[126:127]
v_mov_b64 v[92:93], v[126:127]
v_mov_b64 v[94:95], v[126:127]
L_nomask_lh1:
RD 116,6,13312
v_exp_f32 v12, v84
Mvav 140,68,100
RD 120,6,14336
v_exp_f32 v13, v85
Mvav 148,72,100
buffer_load_dwordx4 v2, s[4:7], s32 offen offset:0 sc1 lds
s_waitcnt lgkmcnt(7)
RD 124,6,15360
Mvav 156,76,100
RD 64,6,16384
v_cvt_pk_bf16_f32 v108, v12, v13
v_exp_f32 v14, v86
Mvav 164,80,100
RD 68,6,17408
v_exp_f32 v15, v87
Mvav 172,84,100
RD 72,6,18432
v_cvt_pk_bf16_f32 v109, v14, v15
v_exp_f32 v16, v92
Mvav 180,88,100
buffer_load_dwordx4 v2, s[4:7], s32 offen offset:1024 sc1 lds
s_waitcnt lgkmcnt(7)
RD 76,6,19456
Mvav 188,92,100
RD 80,6,20480
v_exp_f32 v17, v93
Mvav 196,96,100
RD 84,6,21504
v_cvt_pk_bf16_f32 v110, v16, v17
v_exp_f32 v18, v94
Mvav 204,100,100
RD 88,6,22528
v_exp_f32 v19, v95
v_add_f32 v121, v121, v124
Mvav 212,104,100
buffer_load_dwordx4 v2, s[4:7], s32 offen offset:2048 sc1 lds
s_waitcnt lgkmcnt(7)
RD 92,6,23552
Mvav 220,108,100
RD 96,6,24576
v_cvt_pk_bf16_f32 v111, v18, v19
v_add_f32 v124, v12, v13
v_add_f32 v125, v14, v15
Mvav 228,112,100
RD 100,6,25600
v_add_f32 v124, v124, v16
v_add_f32 v124, v124, v17
v_add_f32 v125, v125, v18
Mvav 236,116,100
RD 104,6,26624
v_add_f32 v125, v125, v19
v_add_f32 v124, v124, v125
v_cmp_nge_f32 vcc, 0x53800000, v124
Mvav 244,120,100
buffer_load_dwordx4 v2, s[4:7], s32 offen offset:3072 sc1 lds
s_waitcnt lgkmcnt(7)
RD 108,6,27648
Mvav 252,124,100
s_add_u32 m0, s30, 16384
v_readlane_b32 s31, v4, s29
s_cbranch_vccnz L_dorare_lh1
L_norare_lh1:
RD 112,6,28672
Mvav 132,64,108
s_add_u32 s30, s30, s36
RD 116,6,29696
v_add_f32 v121, v121, v124
Mvav 140,68,108
s_cmp_ge_u32 s30, 131072
RD 120,6,30720
v_cvt_pk_bf16_f32 v194, v200, v201
Mvav 148,72,108
buffer_load_dwordx4 v2, s[4:7], s31 offen offset:0 sc1 lds
s_waitcnt vmcnt(21) lgkmcnt(7)
s_cselect_b32 s36, s33, s34
RD 124,6,31744
Mvav 156,76,108
s_barrier
v_add_u32 v6, s36, v6
RD 64,6,0
Mvav 164,80,108
RD 68,6,1024
v_cvt_pk_bf16_f32 v195, v202, v203
Mvav 172,84,108
s_add_u32 s29, s29, 1
RD 72,6,2048
v_cvt_pk_bf16_f32 v208, v208, v209
Mvav 180,88,108
buffer_load_dwordx4 v2, s[4:7], s31 offen offset:1024 sc1 lds
s_waitcnt lgkmcnt(7)
RD 76,6,3072
Mvav 188,92,108
RD 80,6,4096
v_cvt_pk_bf16_f32 v209, v210, v211
Mvav 196,96,108
RD 84,6,5120
v_cvt_pk_bf16_f32 v210, v216, v217
Mvav 204,100,108
RD 88,6,6144
v_cvt_pk_bf16_f32 v211, v218, v219
Mvav 212,104,108
buffer_load_dwordx4 v2, s[4:7], s31 offen offset:2048 sc1 lds
s_waitcnt lgkmcnt(7)
RD 92,6,7168
Mvav 220,108,108
v_readlane_b32 s32, v3, s29
RD 96,6,8192
Mvav 228,112,108
RD 100,6,9216
v_cvt_pk_bf16_f32 v224, v224, v225
Mvav 236,116,108
RD 104,6,10240
v_cvt_pk_bf16_f32 v225, v226, v227
Mvav 244,120,108
buffer_load_dwordx4 v2, s[4:7], s31 offen offset:3072 sc1 lds
s_waitcnt lgkmcnt(7)
RD 108,6,11264
Mvav 252,124,108
s_mov_b32 m0, s30
v_cvt_pk_bf16_f32 v226, v232, v233
v_cvt_pk_bf16_f32 v227, v234, v235
v_cvt_pk_bf16_f32 v240, v240, v241
v_cvt_pk_bf16_f32 v241, v242, v243
v_cvt_pk_bf16_f32 v242, v248, v249
v_cvt_pk_bf16_f32 v243, v250, v251
v_cvt_pk_bf16_f32 v132, v132, v133
v_cvt_pk_bf16_f32 v133, v134, v135
v_cvt_pk_bf16_f32 v134, v140, v141
v_cvt_pk_bf16_f32 v135, v142, v143
s_branch LOP40
LP40:
s_setpc_b64 s[48:49]
LOP40:
L_post2b:
L_post2:
s_nop 1
Zvav 64,64,128
RD 112,6,12288
v_cvt_pk_bf16_f32 v148, v148, v149
Zvav 68,64,132
v_cvt_pk_bf16_f32 v149, v150, v151
v_cvt_pk_bf16_f32 v150, v156, v157
Zvav 72,68,128
RD 116,6,13312
v_cvt_pk_bf16_f32 v151, v158, v159
Zvav 76,68,132
v_cvt_pk_bf16_f32 v164, v164, v165
v_cvt_pk_bf16_f32 v165, v166, v167
Zvav 80,72,128
RD 120,6,14336
v_cvt_pk_bf16_f32 v166, v172, v173
Zvav 84,72,132
buffer_load_dwordx4 v2, s[4:7], s32 offen offset:0 sc1 lds
Zvav 88,76,128
s_waitcnt lgkmcnt(7)
RD 124,6,15360
v_cvt_pk_bf16_f32 v167, v174, v175
Zvav 92,76,132
v_mov_b32 v12, v120
v_and_b32 v44, 15, v1
Mvav 64,80,144
RD 64,6,16384
v_cvt_pk_bf16_f32 v180, v180, v181
Mvav 68,80,148
v_cvt_pk_bf16_f32 v181, v182, v183
v_cvt_pk_bf16_f32 v182, v188, v189
Mvav 72,84,144
RD 68,6,17408
v_cvt_pk_bf16_f32 v183, v190, v191
Mvav 76,84,148
v_permlane16_swap_b32 v120, v12
v_mul_u32_u24 v48, 4, v44
Mvav 80,88,144
RD 72,6,18432
v_add_f32 v120, v120, v12
Mvav 84,88,148
buffer_load_dwordx4 v2, s[4:7], s32 offen offset:1024 sc1 lds
Mvav 88,92,144
s_waitcnt lgkmcnt(7)
RD 76,6,19456
v_mov_b32 v12, v120
Mvav 92,92,148
v_lshrrev_b32 v45, 4, v1
v_lshlrev_b32 v45, 4, v45
Mvav 64,96,160
RD 80,6,20480
v_cvt_pk_bf16_f32 v196, v196, v197
Mvav 68,96,164
v_cvt_pk_bf16_f32 v197, v198, v199
v_cvt_pk_bf16_f32 v198, v204, v205
Mvav 72,100,160
RD 84,6,21504
v_cvt_pk_bf16_f32 v199, v206, v207
Mvav 76,100,164
v_permlane32_swap_b32 v120, v12
v_and_b32 v62, 1, v1
Mvav 80,104,160
RD 88,6,22528
v_add_f32 v120, v120, v12
Mvav 84,104,164
buffer_load_dwordx4 v2, s[4:7], s32 offen offset:2048 sc1 lds
Mvav 88,108,160
s_waitcnt lgkmcnt(7)
RD 92,6,23552
v_mov_b32 v12, v121
Mvav 92,108,164
v_mul_u32_u24 v62, 0xffff, v62
v_add_u32 v62, 1, v62
Mvav 64,112,176
RD 96,6,24576
v_cvt_pk_bf16_f32 v212, v212, v213
Mvav 68,112,180
v_cvt_pk_bf16_f32 v213, v214, v215
v_cvt_pk_bf16_f32 v214, v220, v221
Mvav 72,116,176
RD 100,6,25600
v_cvt_pk_bf16_f32 v215, v222, v223
Mvav 76,116,180
v_permlane16_swap_b32 v121, v12
v_mul_u32_u24 v62, 0x3f80, v62
Mvav 80,120,176
RD 104,6,26624
v_add_f32 v121, v121, v12
Mvav 84,120,180
buffer_load_dwordx4 v2, s[4:7], s32 offen offset:3072 sc1 lds
Mvav 88,124,176
s_waitcnt lgkmcnt(7)
RD 108,6,27648
v_mov_b32 v12, v121
Mvav 92,124,180
s_add_u32 m0, s30, 16384
v_readlane_b32 s31, v4, s29
Mvav 64,64,192
RD 112,6,28672
v_cvt_pk_bf16_f32 v228, v228, v229
Mvav 68,64,196
v_cvt_pk_bf16_f32 v229, v230, v231
v_cvt_pk_bf16_f32 v230, v236, v237
Mvav 72,68,192
s_add_u32 s30, s30, s36
RD 116,6,29696
v_cvt_pk_bf16_f32 v231, v238, v239
Mvav 76,68,196
v_permlane32_swap_b32 v121, v12
v_lshrrev_b32 v44, 1, v44
Mvav 80,72,192
s_cmp_ge_u32 s30, 131072
RD 120,6,30720
v_add_f32 v121, v121, v12
Mvav 84,72,196
buffer_load_dwordx4 v2, s[4:7], s31 offen offset:0 sc1 lds
Mvav 88,76,192
s_waitcnt vmcnt(21) lgkmcnt(7)
s_cselect_b32 s36, s33, s34
RD 124,6,31744
Mvav 92,76,196
s_barrier
v_add_u32 v6, s36, v6
v_cmp_eq_u32 s[80:81], 0, v44
Mvav 64,80,208
RD 64,6,0
v_cvt_pk_bf16_f32 v244, v244, v245
Mvav 68,80,212
v_cvt_pk_bf16_f32 v245, v246, v247
v_cvt_pk_bf16_f32 v246, v252, v253
Mvav 72,84,208
RD 68,6,1024
v_cvt_pk_bf16_f32 v247, v254, v255
Mvav 76,84,212
v_rcp_f32 v54, v120
Mvav 80,88,208
s_add_u32 s29, s29, 1
RD 72,6,2048
v_cndmask_b32 v112, 0, v62, s[80:81]
Mvav 84,88,212
buffer_load_dwordx4 v2, s[4:7], s31 offen offset:1024 sc1 lds
Mvav 88,92,208
s_waitcnt lgkmcnt(7)
RD 76,6,3072
v_cmp_eq_u32 s[80:81], 1, v44
Mvav 92,92,212
v_rcp_f32 v55, v121
Mvav 64,96,224
RD 80,6,4096
v_cndmask_b32 v113, 0, v62, s[80:81]
Mvav 68,96,228
v_cmp_eq_u32 s[80:81], 2, v44
Mvav 72,100,224
RD 84,6,5120
Mvav 76,100,228
v_cndmask_b32 v114, 0, v62, s[80:81]
Mvav 80,104,224
RD 88,6,6144
v_cmp_eq_u32 s[80:81], 3, v44
Mvav 84,104,228
buffer_load_dwordx4 v2, s[4:7], s31 offen offset:2048 sc1 lds
Mvav 88,108,224
s_waitcnt lgkmcnt(7)
RD 92,6,7168
v_cndmask_b32 v115, 0, v62, s[80:81]
Mvav 92,108,228
v_readlane_b32 s32, v3, s29
Mvav 64,112,240
RD 96,6,8192
v_cmp_eq_u32 s[80:81], 4, v44
Mvav 68,112,244
Mvav 72,116,240
RD 100,6,9216
v_cndmask_b32 v116, 0, v62, s[80:81]
Mvav 76,116,244
v_cmp_eq_u32 s[80:81], 5, v44
Mvav 80,120,240
RD 104,6,10240
Mvav 84,120,244
buffer_load_dwordx4 v2, s[4:7], s31 offen offset:3072 sc1 lds
Mvav 88,124,240
s_waitcnt lgkmcnt(7)
RD 108,6,11264
v_cndmask_b32 v117, 0, v62, s[80:81]
Mvav 92,124,244
s_mov_b32 m0, s30
v_cmp_eq_u32 s[80:81], 6, v44
Zvav 136,64,128
RD 112,6,12288
v_cndmask_b32 v118, 0, v62, s[80:81]
Zvav 140,64,132
v_cmp_eq_u32 s[80:81], 7, v44
Zvav 152,68,128
RD 116,6,13312
v_mul_f32 v64, v54, v64
Zvav 156,68,132
v_mul_f32 v72, v54, v72
v_mul_f32 v80, v54, v80
Zvav 168,72,128
RD 120,6,14336
v_mul_f32 v88, v54, v88
Zvav 172,72,132
buffer_load_dwordx4 v2, s[4:7], s32 offen offset:0 sc1 lds
Zvav 184,76,128
s_waitcnt lgkmcnt(7)
RD 124,6,15360
v_mul_f32 v65, v54, v65
Zvav 188,76,132
v_mul_f32 v73, v54, v73
v_mul_f32 v81, v54, v81
Mvav 136,80,144
RD 64,6,16384
v_mul_f32 v89, v54, v89
Mvav 140,80,148
v_cvt_pk_bf16_f32 v28, v64, v72
v_cvt_pk_bf16_f32 v29, v80, v88
Mvav 152,84,144
RD 68,6,17408
v_cvt_pk_bf16_f32 v30, v65, v73
Mvav 156,84,148
v_cvt_pk_bf16_f32 v31, v81, v89
v_mul_f32 v66, v54, v66
Mvav 168,88,144
RD 72,6,18432
v_mul_f32 v74, v54, v74
Mvav 172,88,148
buffer_load_dwordx4 v2, s[4:7], s32 offen offset:1024 sc1 lds
Mvav 184,92,144
s_waitcnt lgkmcnt(7)
RD 76,6,19456
v_mul_f32 v82, v54, v82
Mvav 188,92,148
v_mul_f32 v90, v54, v90
v_mul_f32 v67, v54, v67
Mvav 136,96,160
s_add_u32 s78, s69, 0
RD 80,6,20480
v_mul_f32 v75, v54, v75
Mvav 140,96,164
buffer_store_dwordx4 v[28:31], v5, s[4:7], s78 offen sc1
Mvav 152,100,160
RD 84,6,21504
v_mul_f32 v83, v54, v83
Mvav 156,100,164
v_mul_f32 v91, v54, v91
v_cvt_pk_bf16_f32 v32, v66, v74
Mvav 168,104,160
RD 88,6,22528
v_cvt_pk_bf16_f32 v33, v82, v90
Mvav 172,104,164
buffer_load_dwordx4 v2, s[4:7], s32 offen offset:2048 sc1 lds
Mvav 184,108,160
s_waitcnt lgkmcnt(7)
RD 92,6,23552
v_cvt_pk_bf16_f32 v34, v67, v75
Mvav 188,108,164
v_cvt_pk_bf16_f32 v35, v83, v91
v_mul_f32 v68, v55, v68
Mvav 136,112,176
RD 96,6,24576
v_mul_f32 v76, v55, v76
Mvav 140,112,180
v_mul_f32 v84, v55, v84
v_mul_f32 v92, v55, v92
Mvav 152,116,176
RD 100,6,25600
v_mul_f32 v69, v55, v69
Mvav 156,116,180
v_mul_f32 v77, v55, v77
v_mul_f32 v85, v55, v85
Mvav 168,120,176
RD 104,6,26624
v_mul_f32 v93, v55, v93
Mvav 172,120,180
buffer_load_dwordx4 v2, s[4:7], s32 offen offset:3072 sc1 lds
Mvav 184,124,176
s_waitcnt lgkmcnt(7)
RD 108,6,27648
v_cvt_pk_bf16_f32 v36, v68, v76
Mvav 188,124,180
s_add_u32 m0, s30, 16384
v_readlane_b32 s31, v4, s29
Mvav 136,64,192
s_add_u32 s78, s69, 1024
RD 112,6,28672
v_cvt_pk_bf16_f32 v37, v84, v92
Mvav 140,64,196
buffer_store_dwordx4 v[32:35], v5, s[4:7], s78 offen sc1
Mvav 152,68,192
s_add_u32 s30, s30, s36
RD 116,6,29696
v_cvt_pk_bf16_f32 v38, v69, v77
Mvav 156,68,196
v_cvt_pk_bf16_f32 v39, v85, v93
v_mul_f32 v70, v55, v70
Mvav 168,72,192
s_cmp_ge_u32 s30, 131072
RD 120,6,30720
v_mul_f32 v78, v55, v78
Mvav 172,72,196
buffer_load_dwordx4 v2, s[4:7], s31 offen offset:0 sc1 lds
Mvav 184,76,192
s_waitcnt vmcnt(23) lgkmcnt(7)
s_cselect_b32 s36, s33, s34
RD 124,6,31744
Mvav 188,76,196
s_barrier
v_add_u32 v6, s36, v6
v_mul_f32 v86, v55, v86
Mvav 136,80,208
RD 64,6,0
v_mul_f32 v94, v55, v94
Mvav 140,80,212
v_mul_f32 v71, v55, v71
v_mul_f32 v79, v55, v79
Mvav 152,84,208
RD 68,6,1024
v_mul_f32 v87, v55, v87
Mvav 156,84,212
v_mul_f32 v95, v55, v95
v_cvt_pk_bf16_f32 v40, v70, v78
Mvav 168,88,208
s_add_u32 s29, s29, 1
RD 72,6,2048
v_cvt_pk_bf16_f32 v41, v86, v94
Mvav 172,88,212
buffer_load_dwordx4 v2, s[4:7], s31 offen offset:1024 sc1 lds
Mvav 184,92,208
s_waitcnt lgkmcnt(7)
RD 76,6,3072
v_cvt_pk_bf16_f32 v42, v71, v79
Mvav 188,92,212
v_cvt_pk_bf16_f32 v43, v87, v95
v_cndmask_b32 v119, 0, v62, s[80:81]
Mvav 136,96,224
s_add_u32 s78, s69, 2048
RD 80,6,4096
v_and_b32 v44, 15, v1
Mvav 140,96,228
buffer_store_dwordx4 v[36:39], v5, s[4:7], s78 offen sc1
Mvav 152,100,224
RD 84,6,5120
v_mul_u32_u24 v44, 896, v44
Mvav 156,100,228
v_add_u32 v44, v44, v45
Mvav 168,104,224
s_load_dwordx2 s[8:9], s[0:1], 0
RD 88,6,6144
Mvav 172,104,228
buffer_load_dwordx4 v2, s[4:7], s31 offen offset:2048 sc1 lds
Mvav 184,108,224
s_waitcnt lgkmcnt(7)
s_load_dwordx2 s[16:17], s[0:1], 80
RD 92,6,7168
Mvav 188,108,228
s_load_dwordx2 s[12:13], s[0:1], 88
v_readlane_b32 s32, v3, s29
Mvav 136,112,240
s_add_u32 s78, s69, 3072
s_mov_b32 s10, 1835008
RD 96,6,8192
Mvav 140,112,244
buffer_store_dwordx4 v[40:43], v5, s[4:7], s78 offen sc1
Mvav 152,116,240
s_mov_b32 s14, 1835008
RD 100,6,9216
Mvav 156,116,244
s_mov_b32 s18, 896
Mvav 168,120,240
s_lshr_b32 s63, s2, 2
RD 104,6,10240
Mvav 172,120,244
buffer_load_dwordx4 v2, s[4:7], s31 offen offset:3072 sc1 lds
Mvav 184,124,240
s_waitcnt lgkmcnt(7)
s_and_b32 s76, s63, 2
RD 108,6,11264
Mvav 188,124,244
s_mov_b32 m0, s30
s_xor_b32 s76, s76, s2
Zvav 64,64,128
s_and_b32 s76, s76, 3
RD 112,6,12288
Zvav 68,64,132
s_lshl2_add_u32 s76, s24, s76
Zvav 72,68,128
s_sub_u32 s62, s64, 1851392
RD 116,6,13312
v_mul_f32 v136, v54, v136
Zvav 76,68,132
s_lshl2_add_u32 s43, s26, s63
v_mul_f32 v152, v54, v152
v_mul_f32 v168, v54, v168
Zvav 80,72,128
s_mul_i32 s43, s43, 14336
RD 120,6,14336
v_mul_f32 v184, v54, v184
Zvav 84,72,132
buffer_load_dwordx4 v2, s[4:7], s32 offen offset:0 sc1 lds
Zvav 88,76,128
s_waitcnt lgkmcnt(7)
RD 124,6,15360
v_mul_f32 v137, v54, v137
Zvav 92,76,132
s_lshl_b32 s63, s63, 7
v_mul_f32 v153, v54, v153
v_mul_f32 v169, v54, v169
Mvav 64,80,144
s_add_u32 s63, s63, 14688256
RD 64,6,16384
v_mul_f32 v185, v54, v185
Mvav 68,80,148
s_lshr_b32 s41, s76, 1
v_cvt_pk_bf16_f32 v28, v136, v152
v_cvt_pk_bf16_f32 v29, v168, v184
Mvav 72,84,144
s_lshl_b32 s41, s41, 7
RD 68,6,17408
v_cvt_pk_bf16_f32 v30, v137, v153
Mvav 76,84,148
s_add_u32 s43, s43, s41
v_cvt_pk_bf16_f32 v31, v169, v185
v_mul_f32 v138, v54, v138
Mvav 80,88,144
s_and_b32 s80, s76, 1
RD 72,6,18432
v_mul_f32 v154, v54, v154
Mvav 84,88,148
buffer_load_dwordx4 v2, s[4:7], s32 offen offset:1024 sc1 lds
Mvav 88,92,144
s_waitcnt lgkmcnt(7)
RD 76,6,19456
v_mul_f32 v170, v54, v170
Mvav 92,92,148
s_mul_i32 s80, s80, 57344
v_mul_f32 v186, v54, v186
v_mul_f32 v139, v54, v139
Mvav 64,96,160
s_add_u32 s78, s69, 4096
RD 80,6,20480
v_mul_f32 v155, v54, v155
Mvav 68,96,164
buffer_store_dwordx4 v[28:31], v5, s[4:7], s78 offen sc1
Mvav 72,100,160
s_add_u32 s43, s43, s80
RD 84,6,21504
v_mul_f32 v171, v54, v171
Mvav 76,100,164
s_cmp_lt_u32 s76, 14
s_cselect_b32 s43, s43, 2130706432
v_mul_f32 v187, v54, v187
v_cvt_pk_bf16_f32 v32, v138, v154
Mvav 80,104,160
s_lshr_b32 s38, s76, 1
RD 88,6,22528
v_cvt_pk_bf16_f32 v33, v170, v186
Mvav 84,104,164
buffer_load_dwordx4 v2, s[4:7], s32 offen offset:2048 sc1 lds
Mvav 88,108,160
s_waitcnt lgkmcnt(7)
RD 92,6,23552
v_cvt_pk_bf16_f32 v34, v139, v155
Mvav 92,108,164
s_add_u32 s61, s62, 0
v_cvt_pk_bf16_f32 v35, v171, v187
v_mul_f32 v140, v55, v140
Mvav 64,112,176
s_add_u32 s44, s62, 462848
RD 96,6,24576
v_mul_f32 v156, v55, v156
Mvav 68,112,180
s_add_u32 s42, s62, 925696
v_mul_f32 v172, v55, v172
v_mul_f32 v188, v55, v188
Mvav 72,116,176
s_add_u32 s67, s62, 1388544
RD 100,6,25600
v_mul_f32 v141, v55, v141
Mvav 76,116,180
v_mul_f32 v157, v55, v157
v_mul_f32 v173, v55, v173
Mvav 80,120,176
RD 104,6,26624
v_mul_f32 v189, v55, v189
Mvav 84,120,180
buffer_load_dwordx4 v2, s[4:7], s32 offen offset:3072 sc1 lds
Mvav 88,124,176
s_waitcnt lgkmcnt(7)
RD 108,6,27648
v_cvt_pk_bf16_f32 v36, v140, v156
Mvav 92,124,180
s_add_u32 m0, s30, 16384
v_readlane_b32 s31, v4, s29
Mvav 64,64,192
s_add_u32 s78, s69, 5120
RD 112,6,28672
v_cvt_pk_bf16_f32 v37, v172, v188
Mvav 68,64,196
buffer_store_dwordx4 v[32:35], v5, s[4:7], s78 offen sc1
Mvav 72,68,192
s_add_u32 s30, s30, s36
RD 116,6,29696
v_cvt_pk_bf16_f32 v38, v141, v157
Mvav 76,68,196
v_cvt_pk_bf16_f32 v39, v173, v189
v_mul_f32 v142, v55, v142
Mvav 80,72,192
s_cmp_ge_u32 s30, 131072
RD 120,6,30720
v_mul_f32 v158, v55, v158
Mvav 84,72,196
buffer_load_dwordx4 v2, s[4:7], s31 offen offset:0 sc1 lds
Mvav 88,76,192
s_waitcnt vmcnt(27) lgkmcnt(7)
s_cselect_b32 s36, s33, s34
RD 124,6,31744
Mvav 92,76,196
s_barrier
v_add_u32 v6, s36, v6
v_mul_f32 v174, v55, v174
Mvav 64,80,208
RD 64,6,0
v_mul_f32 v190, v55, v190
Mvav 68,80,212
v_mul_f32 v143, v55, v143
v_mul_f32 v159, v55, v159
Mvav 72,84,208
RD 68,6,1024
v_mul_f32 v175, v55, v175
Mvav 76,84,212
v_mul_f32 v191, v55, v191
v_cvt_pk_bf16_f32 v40, v142, v158
Mvav 80,88,208
s_add_u32 s29, s29, 1
RD 72,6,2048
v_cvt_pk_bf16_f32 v41, v174, v190
Mvav 84,88,212
buffer_load_dwordx4 v2, s[4:7], s31 offen offset:1024 sc1 lds
Mvav 88,92,208
s_waitcnt lgkmcnt(7)
RD 76,6,3072
v_cvt_pk_bf16_f32 v42, v143, v159
Mvav 92,92,212
v_cvt_pk_bf16_f32 v43, v175, v191
Mvav 64,96,224
s_add_u32 s78, s69, 6144
RD 80,6,4096
Mvav 68,96,228
buffer_store_dwordx4 v[36:39], v5, s[4:7], s78 offen sc1
Mvav 72,100,224
RD 84,6,5120
Mvav 76,100,228
Mvav 80,104,224
RD 88,6,6144
Mvav 84,104,228
buffer_load_dwordx4 v2, s[4:7], s31 offen offset:2048 sc1 lds
Mvav 88,108,224
s_waitcnt lgkmcnt(7)
RD 92,6,7168
Mvav 92,108,228
v_readlane_b32 s32, v3, s29
Mvav 64,112,240
s_add_u32 s78, s69, 7168
RD 96,6,8192
Mvav 68,112,244
buffer_store_dwordx4 v[40:43], v5, s[4:7], s78 offen sc1
Mvav 72,116,240
RD 100,6,9216
Mvav 76,116,244
Mvav 80,120,240
s_waitcnt lgkmcnt(0)
RD 104,6,10240
Mvav 84,120,244
buffer_load_dwordx4 v2, s[4:7], s31 offen offset:3072 sc1 lds
Mvav 88,124,240
s_waitcnt lgkmcnt(7)
RD 108,6,11264
Mvav 92,124,244
s_mov_b32 m0, s30
Zvav 136,64,128
RD 112,6,12288
Zvav 140,64,132
buffer_load_dwordx4 v[96:99], v44, s[8:11], s43 offen offset:0
Zvav 152,68,128
RD 116,6,13312
s_branch LOP41
LP41:
s_setpc_b64 s[48:49]
LOP41:
v_mul_f32 v64, v54, v64
Zvav 156,68,132
v_mul_f32 v72, v54, v72
v_mul_f32 v80, v54, v80
Zvav 168,72,128
RD 120,6,14336
v_mul_f32 v88, v54, v88
Zvav 172,72,132
v_mul_f32 v65, v54, v65
v_mul_f32 v73, v54, v73
Zvav 184,76,128
s_waitcnt lgkmcnt(7)
RD 124,6,15360
v_mul_f32 v81, v54, v81
Zvav 188,76,132
v_mul_f32 v89, v54, v89
v_cvt_pk_bf16_f32 v28, v64, v72
Mvav 136,80,144
RD 64,6,16384
v_cvt_pk_bf16_f32 v29, v80, v88
Mvav 140,80,148
v_cvt_pk_bf16_f32 v30, v65, v73
v_cvt_pk_bf16_f32 v31, v81, v89
Mvav 152,84,144
RD 68,6,17408
v_mul_f32 v66, v54, v66
Mvav 156,84,148
v_mul_f32 v74, v54, v74
v_mul_f32 v82, v54, v82
Mvav 168,88,144
RD 72,6,18432
v_mul_f32 v90, v54, v90
Mvav 172,88,148
buffer_load_dwordx4 v[104:107], v45, s[16:19], s41 offen offset:0
Mvav 184,92,144
s_waitcnt lgkmcnt(7)
RD 76,6,19456
v_mul_f32 v67, v54, v67
Mvav 188,92,148
v_mul_f32 v75, v54, v75
v_mul_f32 v83, v54, v83
Mvav 136,96,160
s_add_u32 s78, s69, 8192
RD 80,6,20480
v_mul_f32 v91, v54, v91
Mvav 140,96,164
buffer_store_dwordx4 v[28:31], v5, s[4:7], s78 offen sc1
Mvav 152,100,160
RD 84,6,21504
v_cvt_pk_bf16_f32 v32, v66, v74
Mvav 156,100,164
v_cvt_pk_bf16_f32 v33, v82, v90
v_cvt_pk_bf16_f32 v34, v67, v75
Mvav 168,104,160
RD 88,6,22528
v_cvt_pk_bf16_f32 v35, v83, v91
Mvav 172,104,164
v_mul_f32 v68, v55, v68
v_mul_f32 v76, v55, v76
Mvav 184,108,160
s_waitcnt lgkmcnt(7)
RD 92,6,23552
v_mul_f32 v84, v55, v84
Mvav 188,108,164
v_mul_f32 v92, v55, v92
v_mul_f32 v69, v55, v69
Mvav 136,112,176
RD 96,6,24576
v_mul_f32 v77, v55, v77
Mvav 140,112,180
v_mul_f32 v85, v55, v85
v_mul_f32 v93, v55, v93
Mvav 152,116,176
RD 100,6,25600
v_cvt_pk_bf16_f32 v36, v68, v76
Mvav 156,116,180
v_cvt_pk_bf16_f32 v37, v84, v92
v_cvt_pk_bf16_f32 v38, v69, v77
Mvav 168,120,176
RD 104,6,26624
v_cvt_pk_bf16_f32 v39, v85, v93
Mvav 172,120,180
buffer_load_dwordx4 v[100:103], v44, s[8:11], s43 offen offset:64
Mvav 184,124,176
s_waitcnt lgkmcnt(7)
RD 108,6,27648
v_mul_f32 v70, v55, v70
Mvav 188,124,180
s_add_u32 m0, s30, 16384
v_mul_f32 v78, v55, v78
v_mul_f32 v86, v55, v86
Mvav 136,64,192
s_add_u32 s78, s69, 9216
RD 112,6,28672
v_mul_f32 v94, v55, v94
Mvav 140,64,196
buffer_store_dwordx4 v[32:35], v5, s[4:7], s78 offen sc1
Mvav 152,68,192
s_add_u32 s30, s30, s36
RD 116,6,29696
v_mul_f32 v71, v55, v71
Mvav 156,68,196
v_mul_f32 v79, v55, v79
v_mul_f32 v87, v55, v87
Mvav 168,72,192
s_cmp_ge_u32 s30, 131072
RD 120,6,30720
v_mul_f32 v95, v55, v95
Mvav 172,72,196
v_cvt_pk_bf16_f32 v40, v70, v78
v_cvt_pk_bf16_f32 v41, v86, v94
Mvav 184,76,192
s_waitcnt vmcnt(29) lgkmcnt(7)
s_cselect_b32 s36, s33, s34
RD 124,6,31744
Mvav 188,76,196
s_barrier
v_add_u32 v6, s36, v6
v_cvt_pk_bf16_f32 v42, v71, v79
Mvav 136,80,208
RD 64,6,0
v_cvt_pk_bf16_f32 v43, v87, v95
Mvav 140,80,212
Mvav 152,84,208
RD 68,6,1024
Mvav 156,84,212
Mvav 168,88,208
s_add_u32 s29, s29, 1
RD 72,6,2048
Mvav 172,88,212
buffer_load_dwordx4 v[108:111], v45, s[16:19], s41 offen offset:64
Mvav 184,92,208
s_waitcnt lgkmcnt(7)
RD 76,6,3072
Mvav 188,92,212
Mvav 136,96,224
s_add_u32 s78, s69, 10240
RD 80,6,4096
Mvav 140,96,228
buffer_store_dwordx4 v[36:39], v5, s[4:7], s78 offen sc1
Mvav 152,100,224
RD 84,6,5120
Mvav 156,100,228
Mvav 168,104,224
RD 88,6,6144
Mvav 172,104,228
Mvav 184,108,224
s_waitcnt lgkmcnt(7)
RD 92,6,7168
Mvav 188,108,228
Mvav 136,112,240
s_add_u32 s78, s69, 11264
RD 96,6,8192
Mvav 140,112,244
buffer_store_dwordx4 v[40:43], v5, s[4:7], s78 offen sc1
Mvav 152,116,240
RD 100,6,9216
Mvav 156,116,244
Mvav 168,120,240
RD 104,6,10240
Mvav 172,120,244
Mvav 184,124,240
s_waitcnt lgkmcnt(7)
RD 108,6,11264
Mvav 188,124,244
s_mov_b32 m0, s30
Zvav 64,64,128
RD 112,6,12288
Zvav 68,64,132
Zvav 72,68,128
RD 116,6,13312
v_mul_f32 v136, v54, v136
Zvav 76,68,132
v_mul_f32 v152, v54, v152
v_mul_f32 v168, v54, v168
Zvav 80,72,128
RD 120,6,14336
v_mul_f32 v184, v54, v184
Zvav 84,72,132
v_mul_f32 v137, v54, v137
v_mul_f32 v153, v54, v153
Zvav 88,76,128
s_waitcnt lgkmcnt(7)
RD 124,6,15360
v_mul_f32 v169, v54, v169
Zvav 92,76,132
v_mul_f32 v185, v54, v185
v_cvt_pk_bf16_f32 v28, v136, v152
Mvav 64,80,144
RD 64,6,16384
v_cvt_pk_bf16_f32 v29, v168, v184
Mvav 68,80,148
v_cvt_pk_bf16_f32 v30, v137, v153
v_cvt_pk_bf16_f32 v31, v169, v185
Mvav 72,84,144
RD 68,6,17408
v_mul_f32 v138, v54, v138
Mvav 76,84,148
v_mul_f32 v154, v54, v154
v_mul_f32 v170, v54, v170
Mvav 80,88,144
RD 72,6,18432
v_mul_f32 v186, v54, v186
Mvav 84,88,148
v_mul_f32 v139, v54, v139
v_mul_f32 v155, v54, v155
Mvav 88,92,144
s_waitcnt lgkmcnt(7)
RD 76,6,19456
v_mul_f32 v171, v54, v171
Mvav 92,92,148
v_mul_f32 v187, v54, v187
v_cvt_pk_bf16_f32 v32, v138, v154
Mvav 64,96,160
s_add_u32 s78, s69, 12288
RD 80,6,20480
v_cvt_pk_bf16_f32 v33, v170, v186
Mvav 68,96,164
buffer_store_dwordx4 v[28:31], v5, s[4:7], s78 offen sc1
Mvav 72,100,160
RD 84,6,21504
v_cvt_pk_bf16_f32 v34, v139, v155
Mvav 76,100,164
v_cvt_pk_bf16_f32 v35, v171, v187
v_mul_f32 v140, v55, v140
Mvav 80,104,160
RD 88,6,22528
v_mul_f32 v156, v55, v156
Mvav 84,104,164
v_mul_f32 v172, v55, v172
v_mul_f32 v188, v55, v188
Mvav 88,108,160
s_waitcnt lgkmcnt(7)
RD 92,6,23552
v_mul_f32 v141, v55, v141
Mvav 92,108,164
v_mul_f32 v157, v55, v157
v_mul_f32 v173, v55, v173
Mvav 64,112,176
RD 96,6,24576
v_mul_f32 v189, v55, v189
Mvav 68,112,180
v_cvt_pk_bf16_f32 v36, v140, v156
v_cvt_pk_bf16_f32 v37, v172, v188
Mvav 72,116,176
RD 100,6,25600
v_cvt_pk_bf16_f32 v38, v141, v157
Mvav 76,116,180
v_cvt_pk_bf16_f32 v39, v173, v189
v_mul_f32 v142, v55, v142
Mvav 80,120,176
RD 104,6,26624
v_mul_f32 v158, v55, v158
Mvav 84,120,180
v_mul_f32 v174, v55, v174
v_mul_f32 v190, v55, v190
Mvav 88,124,176
s_waitcnt lgkmcnt(7)
RD 108,6,27648
v_mul_f32 v143, v55, v143
Mvav 92,124,180
s_add_u32 m0, s30, 16384
v_mul_f32 v159, v55, v159
v_mul_f32 v175, v55, v175
Mvav 64,64,192
s_add_u32 s78, s69, 13312
RD 112,6,28672
v_mul_f32 v191, v55, v191
Mvav 68,64,196
buffer_store_dwordx4 v[32:35], v5, s[4:7], s78 offen sc1
Mvav 72,68,192
s_add_u32 s30, s30, s36
RD 116,6,29696
v_cvt_pk_bf16_f32 v40, v142, v158
Mvav 76,68,196
v_cvt_pk_bf16_f32 v41, v174, v190
v_cvt_pk_bf16_f32 v42, v143, v159
Mvav 80,72,192
s_cmp_ge_u32 s30, 131072
RD 120,6,30720
v_cvt_pk_bf16_f32 v43, v175, v191
Mvav 84,72,196
Mvav 88,76,192
s_waitcnt vmcnt(22) lgkmcnt(7)
s_cselect_b32 s36, s33, s34
RD 124,6,31744
Mvav 92,76,196
s_barrier
v_add_u32 v6, s36, v6
Mvav 64,80,208
RD 64,6,0
Mvav 68,80,212
Mvav 72,84,208
RD 68,6,1024
Mvav 76,84,212
Mvav 80,88,208
s_add_u32 s29, s29, 1
RD 72,6,2048
Mvav 84,88,212
Mvav 88,92,208
s_waitcnt lgkmcnt(7)
RD 76,6,3072
Mvav 92,92,212
Mvav 64,96,224
s_add_u32 s78, s69, 14336
RD 80,6,4096
Mvav 68,96,228
buffer_store_dwordx4 v[36:39], v5, s[4:7], s78 offen sc1
Mvav 72,100,224
RD 84,6,5120
Mvav 76,100,228
Mvav 80,104,224
RD 88,6,6144
Mvav 84,104,228
Mvav 88,108,224
s_waitcnt lgkmcnt(7)
RD 92,6,7168
Mvav 92,108,228
Mvav 64,112,240
s_add_u32 s78, s69, 15360
RD 96,6,8192
Mvav 68,112,244
buffer_store_dwordx4 v[40:43], v5, s[4:7], s78 offen sc1
Mvav 72,116,240
RD 100,6,9216
Mvav 76,116,244
Mvav 80,120,240
RD 104,6,10240
Mvav 84,120,244
Mvav 88,124,240
s_waitcnt lgkmcnt(7)
RD 108,6,11264
Mvav 92,124,244
s_mov_b32 m0, s30
Zvav 136,64,128
RD 112,6,12288
Zvav 140,64,132
Zvav 152,68,128
RD 116,6,13312
v_mul_f32 v64, v54, v64
Zvav 156,68,132
v_mul_f32 v72, v54, v72
v_mul_f32 v80, v54, v80
Zvav 168,72,128
RD 120,6,14336
v_mul_f32 v88, v54, v88
Zvav 172,72,132
v_mul_f32 v65, v54, v65
v_mul_f32 v73, v54, v73
Zvav 184,76,128
s_waitcnt lgkmcnt(7)
RD 124,6,15360
v_mul_f32 v81, v54, v81
Zvav 188,76,132
v_mul_f32 v89, v54, v89
v_cvt_pk_bf16_f32 v28, v64, v72
Mvav 136,80,144
RD 64,6,16384
v_cvt_pk_bf16_f32 v29, v80, v88
Mvav 140,80,148
v_cvt_pk_bf16_f32 v30, v65, v73
v_cvt_pk_bf16_f32 v31, v81, v89
Mvav 152,84,144
RD 68,6,17408
v_mul_f32 v66, v54, v66
Mvav 156,84,148
v_mul_f32 v74, v54, v74
v_mul_f32 v82, v54, v82
Mvav 168,88,144
RD 72,6,18432
v_mul_f32 v90, v54, v90
Mvav 172,88,148
v_mul_f32 v67, v54, v67
v_mul_f32 v75, v54, v75
Mvav 184,92,144
s_waitcnt lgkmcnt(7)
RD 76,6,19456
v_mul_f32 v83, v54, v83
Mvav 188,92,148
v_mul_f32 v91, v54, v91
v_cvt_pk_bf16_f32 v32, v66, v74
Mvav 136,96,160
s_add_u32 s78, s69, 16384
RD 80,6,20480
v_cvt_pk_bf16_f32 v33, v82, v90
Mvav 140,96,164
buffer_store_dwordx4 v[28:31], v5, s[4:7], s78 offen sc1
Mvav 152,100,160
RD 84,6,21504
v_cvt_pk_bf16_f32 v34, v67, v75
Mvav 156,100,164
v_cvt_pk_bf16_f32 v35, v83, v91
v_mul_f32 v68, v55, v68
Mvav 168,104,160
RD 88,6,22528
v_mul_f32 v76, v55, v76
Mvav 172,104,164
v_mul_f32 v84, v55, v84
v_mul_f32 v92, v55, v92
Mvav 184,108,160
s_waitcnt lgkmcnt(7)
RD 92,6,23552
v_mul_f32 v69, v55, v69
Mvav 188,108,164
v_mul_f32 v77, v55, v77
v_mul_f32 v85, v55, v85
Mvav 136,112,176
RD 96,6,24576
v_mul_f32 v93, v55, v93
Mvav 140,112,180
v_cvt_pk_bf16_f32 v36, v68, v76
v_cvt_pk_bf16_f32 v37, v84, v92
Mvav 152,116,176
RD 100,6,25600
v_cvt_pk_bf16_f32 v38, v69, v77
Mvav 156,116,180
v_cvt_pk_bf16_f32 v39, v85, v93
v_mul_f32 v70, v55, v70
Mvav 168,120,176
RD 104,6,26624
v_mul_f32 v78, v55, v78
Mvav 172,120,180
v_mul_f32 v86, v55, v86
v_mul_f32 v94, v55, v94
Mvav 184,124,176
s_waitcnt lgkmcnt(7)
RD 108,6,27648
v_mul_f32 v71, v55, v71
Mvav 188,124,180
s_add_u32 m0, s30, 16384
v_mul_f32 v79, v55, v79
v_mul_f32 v87, v55, v87
Mvav 136,64,192
s_add_u32 s78, s69, 17408
RD 112,6,28672
v_mul_f32 v95, v55, v95
Mvav 140,64,196
buffer_store_dwordx4 v[32:35], v5, s[4:7], s78 offen sc1
Mvav 152,68,192
s_add_u32 s30, s30, s36
RD 116,6,29696
v_cvt_pk_bf16_f32 v40, v70, v78
Mvav 156,68,196
v_cvt_pk_bf16_f32 v41, v86, v94
v_cvt_pk_bf16_f32 v42, v71, v79
Mvav 168,72,192
s_cmp_ge_u32 s30, 131072
RD 120,6,30720
v_cvt_pk_bf16_f32 v43, v87, v95
Mvav 172,72,196
Mvav 184,76,192
s_waitcnt vmcnt(14) lgkmcnt(7)
s_cselect_b32 s36, s33, s34
RD 124,6,31744
Mvav 188,76,196
s_barrier
v_add_u32 v6, s36, v6
Mvav 136,80,208
RD 64,6,0
Mvav 140,80,212
Mvav 152,84,208
RD 68,6,1024
Mvav 156,84,212
Mvav 168,88,208
s_add_u32 s29, s29, 1
RD 72,6,2048
Mvav 172,88,212
Mvav 184,92,208
s_waitcnt lgkmcnt(7)
RD 76,6,3072
Mvav 188,92,212
Mvav 136,96,224
s_add_u32 s78, s69, 18432
RD 80,6,4096
Mvav 140,96,228
buffer_store_dwordx4 v[36:39], v5, s[4:7], s78 offen sc1
Mvav 152,100,224
RD 84,6,5120
Mvav 156,100,228
Mvav 168,104,224
RD 88,6,6144
Mvav 172,104,228
Mvav 184,108,224
s_waitcnt lgkmcnt(7)
RD 92,6,7168
Mvav 188,108,228
Mvav 136,112,240
s_add_u32 s78, s69, 19456
RD 96,6,8192
Mvav 140,112,244
buffer_store_dwordx4 v[40:43], v5, s[4:7], s78 offen sc1
Mvav 152,116,240
RD 100,6,9216
Mvav 156,116,244
v_mov_b32 v63, 4
Mvav 168,120,240
s_waitcnt vmcnt(4)
RD 104,6,10240
Mvav 172,120,244
buffer_store_dword v63, v8, s[4:7], s74 offen sc1
Mvav 184,124,240
s_waitcnt lgkmcnt(7)
RD 108,6,11264
Mvav 188,124,244
s_mov_b32 m0, s30
Zvav 64,64,128
RD 112,6,12288
Zvav 68,64,132
Zvav 72,68,128
RD 116,6,13312
v_mul_f32 v136, v54, v136
Zvav 76,68,132
v_mul_f32 v152, v54, v152
v_mul_f32 v168, v54, v168
Zvav 80,72,128
RD 120,6,14336
v_mul_f32 v184, v54, v184
Zvav 84,72,132
v_mul_f32 v137, v54, v137
v_mul_f32 v153, v54, v153
Zvav 88,76,128
s_waitcnt lgkmcnt(7)
RD 124,6,15360
v_mul_f32 v169, v54, v169
Zvav 92,76,132
v_mul_f32 v185, v54, v185
v_cvt_pk_bf16_f32 v28, v136, v152
Mvav 64,80,144
RD 64,6,16384
v_cvt_pk_bf16_f32 v29, v168, v184
Mvav 68,80,148
v_cvt_pk_bf16_f32 v30, v137, v153
v_cvt_pk_bf16_f32 v31, v169, v185
Mvav 72,84,144
RD 68,6,17408
v_mul_f32 v138, v54, v138
Mvav 76,84,148
v_mul_f32 v154, v54, v154
v_mul_f32 v170, v54, v170
Mvav 80,88,144
RD 72,6,18432
v_mul_f32 v186, v54, v186
Mvav 84,88,148
v_mul_f32 v139, v54, v139
v_mul_f32 v155, v54, v155
Mvav 88,92,144
s_waitcnt lgkmcnt(7)
RD 76,6,19456
v_mul_f32 v171, v54, v171
Mvav 92,92,148
v_mul_f32 v187, v54, v187
v_cvt_pk_bf16_f32 v32, v138, v154
Mvav 64,96,160
s_add_u32 s78, s69, 20480
RD 80,6,20480
v_cvt_pk_bf16_f32 v33, v170, v186
Mvav 68,96,164
buffer_store_dwordx4 v[28:31], v5, s[4:7], s78 offen sc1
Mvav 72,100,160
RD 84,6,21504
v_cvt_pk_bf16_f32 v34, v139, v155
Mvav 76,100,164
v_cvt_pk_bf16_f32 v35, v171, v187
v_mul_f32 v140, v55, v140
Mvav 80,104,160
RD 88,6,22528
v_mul_f32 v156, v55, v156
Mvav 84,104,164
v_mul_f32 v172, v55, v172
v_mul_f32 v188, v55, v188
Mvav 88,108,160
s_waitcnt lgkmcnt(7)
RD 92,6,23552
v_mul_f32 v141, v55, v141
Mvav 92,108,164
v_mul_f32 v157, v55, v157
v_mul_f32 v173, v55, v173
Mvav 64,112,176
RD 96,6,24576
v_mul_f32 v189, v55, v189
Mvav 68,112,180
v_cvt_pk_bf16_f32 v36, v140, v156
v_cvt_pk_bf16_f32 v37, v172, v188
Mvav 72,116,176
RD 100,6,25600
v_cvt_pk_bf16_f32 v38, v141, v157
Mvav 76,116,180
v_cvt_pk_bf16_f32 v39, v173, v189
v_mul_f32 v142, v55, v142
Mvav 80,120,176
RD 104,6,26624
v_mul_f32 v158, v55, v158
Mvav 84,120,180
v_mul_f32 v174, v55, v174
v_mul_f32 v190, v55, v190
Mvav 88,124,176
s_branch LOP42
LP42:
s_setpc_b64 s[48:49]
LOP42:
s_waitcnt lgkmcnt(7)
RD 108,6,27648
v_mul_f32 v143, v55, v143
Mvav 92,124,180
s_add_u32 m0, s30, 16384
v_mul_f32 v159, v55, v159
v_mul_f32 v175, v55, v175
Mvav 64,64,192
s_add_u32 s78, s69, 21504
RD 112,6,28672
v_mul_f32 v191, v55, v191
Mvav 68,64,196
buffer_store_dwordx4 v[32:35], v5, s[4:7], s78 offen sc1
Mvav 72,68,192
s_add_u32 s30, s30, s36
RD 116,6,29696
v_cvt_pk_bf16_f32 v40, v142, v158
Mvav 76,68,196
v_cvt_pk_bf16_f32 v41, v174, v190
v_cvt_pk_bf16_f32 v42, v143, v159
Mvav 80,72,192
s_cmp_ge_u32 s30, 131072
RD 120,6,30720
v_cvt_pk_bf16_f32 v43, v175, v191
Mvav 84,72,196
Mvav 88,76,192
s_waitcnt lgkmcnt(7)
s_cselect_b32 s36, s33, s34
RD 124,6,31744
Mvav 92,76,196
Mvav 64,80,208
Mvav 68,80,212
Mvav 72,84,208
Mvav 76,84,212
Mvav 80,88,208
s_add_u32 s29, s29, 1
Mvav 84,88,212
Mvav 88,92,208
s_waitcnt lgkmcnt(4)
Mvav 92,92,212
Mvav 64,96,224
s_add_u32 s78, s69, 22528
Mvav 68,96,228
buffer_store_dwordx4 v[36:39], v5, s[4:7], s78 offen sc1
Mvav 72,100,224
Mvav 76,100,228
Mvav 80,104,224
Mvav 84,104,228
Mvav 88,108,224
s_waitcnt lgkmcnt(0)
Mvav 92,108,228
Mvav 64,112,240
s_add_u32 s78, s69, 23552
Mvav 68,112,244
buffer_store_dwordx4 v[40:43], v5, s[4:7], s78 offen sc1
Mvav 72,116,240
Mvav 76,116,244
Mvav 80,120,240
Mvav 84,120,244
Mvav 88,124,240
Mvav 92,124,244
s_mov_b32 m0, s30
s_nop 5
v_mul_f32 v64, v54, v64
v_mul_f32 v72, v54, v72
v_mul_f32 v80, v54, v80
v_mul_f32 v88, v54, v88
v_mul_f32 v65, v54, v65
v_mul_f32 v73, v54, v73
v_mul_f32 v81, v54, v81
v_mul_f32 v89, v54, v89
v_cvt_pk_bf16_f32 v28, v64, v72
v_cvt_pk_bf16_f32 v29, v80, v88
v_cvt_pk_bf16_f32 v30, v65, v73
v_cvt_pk_bf16_f32 v31, v81, v89
s_add_u32 s78, s69, 24576
buffer_store_dwordx4 v[28:31], v5, s[4:7], s78 offen sc1
v_mul_f32 v66, v54, v66
v_mul_f32 v74, v54, v74
v_mul_f32 v82, v54, v82
v_mul_f32 v90, v54, v90
v_mul_f32 v67, v54, v67
v_mul_f32 v75, v54, v75
v_mul_f32 v83, v54, v83
v_mul_f32 v91, v54, v91
v_cvt_pk_bf16_f32 v32, v66, v74
v_cvt_pk_bf16_f32 v33, v82, v90
v_cvt_pk_bf16_f32 v34, v67, v75
v_cvt_pk_bf16_f32 v35, v83, v91
s_add_u32 s78, s69, 25600
buffer_store_dwordx4 v[32:35], v5, s[4:7], s78 offen sc1
v_mul_f32 v68, v55, v68
v_mul_f32 v76, v55, v76
v_mul_f32 v84, v55, v84
v_mul_f32 v92, v55, v92
v_mul_f32 v69, v55, v69
v_mul_f32 v77, v55, v77
v_mul_f32 v85, v55, v85
v_mul_f32 v93, v55, v93
v_cvt_pk_bf16_f32 v36, v68, v76
v_cvt_pk_bf16_f32 v37, v84, v92
v_cvt_pk_bf16_f32 v38, v69, v77
v_cvt_pk_bf16_f32 v39, v85, v93
s_add_u32 s78, s69, 26624
buffer_store_dwordx4 v[36:39], v5, s[4:7], s78 offen sc1
v_mul_f32 v70, v55, v70
v_mul_f32 v78, v55, v78
v_mul_f32 v86, v55, v86
v_mul_f32 v94, v55, v94
v_mul_f32 v71, v55, v71
v_mul_f32 v79, v55, v79
v_mul_f32 v87, v55, v87
v_mul_f32 v95, v55, v95
v_cvt_pk_bf16_f32 v40, v70, v78
v_cvt_pk_bf16_f32 v41, v86, v94
v_cvt_pk_bf16_f32 v42, v71, v79
v_cvt_pk_bf16_f32 v43, v87, v95
s_add_u32 s78, s69, 27648
buffer_store_dwordx4 v[40:43], v5, s[4:7], s78 offen sc1
s_mov_b32 s82, 0xffff0000
s_mov_b32 s83, 0xbfb8aa3b
s_waitcnt vmcnt(19)
Zvva 12,112,192
Mvva 12,112,196
Mvva 12,116,200
Mvva 12,116,204
Zvva 16,112,208
Mvva 16,112,212
Mvva 16,116,216
Mvva 16,116,220
Zvva 20,112,224
Mvva 20,112,228
Mvva 20,116,232
Mvva 20,116,236
Zvva 24,112,240
Mvva 24,112,244
Mvva 24,116,248
Mvva 24,116,252
v_lshlrev_b32 v80, 16, v96
v_and_b32 v81, s82, v96
v_lshlrev_b32 v82, 16, v97
v_and_b32 v83, s82, v97
v_lshlrev_b32 v84, 16, v98
v_and_b32 v85, s82, v98
v_lshlrev_b32 v86, 16, v99
v_and_b32 v87, s82, v99
v_lshlrev_b32 v88, 16, v100
v_and_b32 v89, s82, v100
v_lshlrev_b32 v90, 16, v101
v_and_b32 v91, s82, v101
v_lshlrev_b32 v92, 16, v102
v_and_b32 v93, s82, v102
v_lshlrev_b32 v94, 16, v103
v_and_b32 v95, s82, v103
v_cvt_pk_bf16_f32 v2, v12, v13
v_lshlrev_b32 v12, 16, v2
v_and_b32 v13, s82, v2
v_lshlrev_b32 v3, 16, v104
v_and_b32 v4, s82, v104
v_fmamk_f32 v12, v12, 0x5d800000, v3
v_fmamk_f32 v13, v13, 0x5d800000, v4
v_cvt_pk_bf16_f32 v2, v12, v13
v_lshlrev_b32 v12, 16, v2
v_and_b32 v13, s82, v2
v_mul_f32 v3, s83, v12
v_mul_f32 v4, s83, v13
v_exp_f32 v3, v3
v_exp_f32 v4, v4
s_nop 0
v_add_f32 v3, 1.0, v3
v_add_f32 v4, 1.0, v4
v_rcp_f32 v3, v3
v_rcp_f32 v4, v4
s_nop 0
v_mul_f32 v12, v12, v3
v_mul_f32 v13, v13, v4
v_cvt_pk_bf16_f32 v2, v12, v13
v_lshlrev_b32 v12, 16, v2
v_and_b32 v13, s82, v2
v_cvt_pk_bf16_f32 v2, v14, v15
v_lshlrev_b32 v14, 16, v2
v_and_b32 v15, s82, v2
v_lshlrev_b32 v3, 16, v105
v_and_b32 v4, s82, v105
v_fmamk_f32 v14, v14, 0x5d800000, v3
v_fmamk_f32 v15, v15, 0x5d800000, v4
v_cvt_pk_bf16_f32 v2, v14, v15
v_lshlrev_b32 v14, 16, v2
v_and_b32 v15, s82, v2
v_mul_f32 v3, s83, v14
v_mul_f32 v4, s83, v15
v_exp_f32 v3, v3
v_exp_f32 v4, v4
s_nop 0
v_add_f32 v3, 1.0, v3
v_add_f32 v4, 1.0, v4
v_rcp_f32 v3, v3
v_rcp_f32 v4, v4
s_nop 0
v_mul_f32 v14, v14, v3
v_mul_f32 v15, v15, v4
v_cvt_pk_bf16_f32 v2, v14, v15
v_lshlrev_b32 v14, 16, v2
v_and_b32 v15, s82, v2
v_cvt_pk_bf16_f32 v2, v16, v17
v_lshlrev_b32 v16, 16, v2
v_and_b32 v17, s82, v2
v_lshlrev_b32 v3, 16, v106
v_and_b32 v4, s82, v106
v_fmamk_f32 v16, v16, 0x5d800000, v3
v_fmamk_f32 v17, v17, 0x5d800000, v4
v_cvt_pk_bf16_f32 v2, v16, v17
v_lshlrev_b32 v16, 16, v2
v_and_b32 v17, s82, v2
v_mul_f32 v3, s83, v16
v_mul_f32 v4, s83, v17
v_exp_f32 v3, v3
v_exp_f32 v4, v4
s_nop 0
v_add_f32 v3, 1.0, v3
v_add_f32 v4, 1.0, v4
v_rcp_f32 v3, v3
v_rcp_f32 v4, v4
s_nop 0
v_mul_f32 v16, v16, v3
v_mul_f32 v17, v17, v4
v_cvt_pk_bf16_f32 v2, v16, v17
v_lshlrev_b32 v16, 16, v2
v_and_b32 v17, s82, v2
v_mov_b32 v63, 7
s_waitcnt vmcnt(0)
buffer_store_dword v63, v8, s[4:7], s74 offen sc1
v_cvt_pk_bf16_f32 v2, v18, v19
v_lshlrev_b32 v18, 16, v2
v_and_b32 v19, s82, v2
v_lshlrev_b32 v3, 16, v107
v_and_b32 v4, s82, v107
v_fmamk_f32 v18, v18, 0x5d800000, v3
v_fmamk_f32 v19, v19, 0x5d800000, v4
v_cvt_pk_bf16_f32 v2, v18, v19
v_lshlrev_b32 v18, 16, v2
v_and_b32 v19, s82, v2
v_mul_f32 v3, s83, v18
v_mul_f32 v4, s83, v19
v_exp_f32 v3, v3
v_exp_f32 v4, v4
s_nop 0
v_add_f32 v3, 1.0, v3
v_add_f32 v4, 1.0, v4
v_rcp_f32 v3, v3
v_rcp_f32 v4, v4
s_nop 0
v_mul_f32 v18, v18, v3
v_mul_f32 v19, v19, v4
v_cvt_pk_bf16_f32 v2, v18, v19
v_lshlrev_b32 v18, 16, v2
v_and_b32 v19, s82, v2
v_cvt_pk_bf16_f32 v2, v20, v21
v_lshlrev_b32 v20, 16, v2
v_and_b32 v21, s82, v2
v_lshlrev_b32 v3, 16, v108
v_and_b32 v4, s82, v108
v_fmamk_f32 v20, v20, 0x5d800000, v3
v_fmamk_f32 v21, v21, 0x5d800000, v4
v_cvt_pk_bf16_f32 v2, v20, v21
v_lshlrev_b32 v20, 16, v2
v_and_b32 v21, s82, v2
v_mul_f32 v3, s83, v20
v_mul_f32 v4, s83, v21
v_exp_f32 v3, v3
v_exp_f32 v4, v4
s_nop 0
v_add_f32 v3, 1.0, v3
v_add_f32 v4, 1.0, v4
v_rcp_f32 v3, v3
v_rcp_f32 v4, v4
s_nop 0
v_mul_f32 v20, v20, v3
v_mul_f32 v21, v21, v4
v_cvt_pk_bf16_f32 v2, v20, v21
v_lshlrev_b32 v20, 16, v2
v_and_b32 v21, s82, v2
v_cvt_pk_bf16_f32 v2, v22, v23
v_lshlrev_b32 v22, 16, v2
v_and_b32 v23, s82, v2
v_lshlrev_b32 v3, 16, v109
v_and_b32 v4, s82, v109
v_fmamk_f32 v22, v22, 0x5d800000, v3
v_fmamk_f32 v23, v23, 0x5d800000, v4
v_cvt_pk_bf16_f32 v2, v22, v23
v_lshlrev_b32 v22, 16, v2
v_and_b32 v23, s82, v2
v_mul_f32 v3, s83, v22
v_mul_f32 v4, s83, v23
v_exp_f32 v3, v3
v_exp_f32 v4, v4
s_nop 0
v_add_f32 v3, 1.0, v3
v_add_f32 v4, 1.0, v4
v_rcp_f32 v3, v3
v_rcp_f32 v4, v4
s_nop 0
v_mul_f32 v22, v22, v3
v_mul_f32 v23, v23, v4
v_cvt_pk_bf16_f32 v2, v22, v23
v_lshlrev_b32 v22, 16, v2
v_and_b32 v23, s82, v2
v_cvt_pk_bf16_f32 v2, v24, v25
v_lshlrev_b32 v24, 16, v2
v_and_b32 v25, s82, v2
v_lshlrev_b32 v3, 16, v110
v_and_b32 v4, s82, v110
v_fmamk_f32 v24, v24, 0x5d800000, v3
v_fmamk_f32 v25, v25, 0x5d800000, v4
v_cvt_pk_bf16_f32 v2, v24, v25
v_lshlrev_b32 v24, 16, v2
v_and_b32 v25, s82, v2
v_mul_f32 v3, s83, v24
v_mul_f32 v4, s83, v25
v_exp_f32 v3, v3
v_exp_f32 v4, v4
s_nop 0
v_add_f32 v3, 1.0, v3
v_add_f32 v4, 1.0, v4
v_rcp_f32 v3, v3
v_rcp_f32 v4, v4
s_nop 0
v_mul_f32 v24, v24, v3
v_mul_f32 v25, v25, v4
v_cvt_pk_bf16_f32 v2, v24, v25
v_lshlrev_b32 v24, 16, v2
v_and_b32 v25, s82, v2
v_cvt_pk_bf16_f32 v2, v26, v27
v_lshlrev_b32 v26, 16, v2
v_and_b32 v27, s82, v2
v_lshlrev_b32 v3, 16, v111
v_and_b32 v4, s82, v111
v_fmamk_f32 v26, v26, 0x5d800000, v3
v_fmamk_f32 v27, v27, 0x5d800000, v4
v_cvt_pk_bf16_f32 v2, v26, v27
v_lshlrev_b32 v26, 16, v2
v_and_b32 v27, s82, v2
v_mul_f32 v3, s83, v26
v_mul_f32 v4, s83, v27
v_exp_f32 v3, v3
v_exp_f32 v4, v4
s_nop 0
v_add_f32 v3, 1.0, v3
v_add_f32 v4, 1.0, v4
v_rcp_f32 v3, v3
v_rcp_f32 v4, v4
s_nop 0
v_mul_f32 v26, v26, v3
v_mul_f32 v27, v27, v4
v_cvt_pk_bf16_f32 v2, v26, v27
v_lshlrev_b32 v26, 16, v2
v_and_b32 v27, s82, v2
s_mov_b32 s77, 0
s_cmp_eq_u32 s43, 2130706432
s_cbranch_scc1 L_fin
L_fpoll:
buffer_load_dword v7, v48, s[4:7], s63 offen sc1
s_add_u32 s77, s77, 1
s_waitcnt vmcnt(0)
v_cmp_ge_u32 vcc, s38, v7
s_cmp_lt_u32 s77, 0x10000
s_cbranch_vccz L_fgo
s_sleep 2
s_cbranch_scc1 L_fpoll
L_fgo:
buffer_load_dwordx4 v[128:131], v61, s[4:7], s61 offen offset:0 sc1
buffer_load_dwordx4 v[132:135], v61, s[4:7], s44 offen offset:0 sc1
buffer_load_dwordx4 v[136:139], v61, s[4:7], s42 offen offset:0 sc1
buffer_load_dwordx4 v[140:143], v61, s[4:7], s67 offen offset:0 sc1
buffer_load_dwordx4 v[144:147], v61, s[4:7], s61 offen offset:1024 sc1
buffer_load_dwordx4 v[148:151], v61, s[4:7], s44 offen offset:1024 sc1
buffer_load_dwordx4 v[152:155], v61, s[4:7], s42 offen offset:1024 sc1
buffer_load_dwordx4 v[156:159], v61, s[4:7], s67 offen offset:1024 sc1
buffer_load_dwordx4 v[160:163], v61, s[4:7], s61 offen offset:256 sc1
buffer_load_dwordx4 v[164:167], v61, s[4:7], s44 offen offset:256 sc1
buffer_load_dwordx4 v[168:171], v61, s[4:7], s42 offen offset:256 sc1
buffer_load_dwordx4 v[172:175], v61, s[4:7], s67 offen offset:256 sc1
buffer_load_dwordx4 v[176:179], v61, s[4:7], s61 offen offset:1280 sc1
buffer_load_dwordx4 v[180:183], v61, s[4:7], s44 offen offset:1280 sc1
buffer_load_dwordx4 v[184:187], v61, s[4:7], s42 offen offset:1280 sc1
buffer_load_dwordx4 v[188:191], v61, s[4:7], s67 offen offset:1280 sc1
buffer_load_dwordx4 v[192:195], v61, s[4:7], s61 offen offset:512 sc1
buffer_load_dwordx4 v[196:199], v61, s[4:7], s44 offen offset:512 sc1
buffer_load_dwordx4 v[200:203], v61, s[4:7], s42 offen offset:512 sc1
buffer_load_dwordx4 v[204:207], v61, s[4:7], s67 offen offset:512 sc1
buffer_load_dwordx4 v[208:211], v61, s[4:7], s61 offen offset:1536 sc1
buffer_load_dwordx4 v[212:215], v61, s[4:7], s44 offen offset:1536 sc1
buffer_load_dwordx4 v[216:219], v61, s[4:7], s42 offen offset:1536 sc1
buffer_load_dwordx4 v[220:223], v61, s[4:7], s67 offen offset:1536 sc1
buffer_load_dwordx4 v[224:227], v61, s[4:7], s61 offen offset:768 sc1
buffer_load_dwordx4 v[228:231], v61, s[4:7], s44 offen offset:768 sc1
buffer_load_dwordx4 v[232:235], v61, s[4:7], s42 offen offset:768 sc1
buffer_load_dwordx4 v[236:239], v61, s[4:7], s67 offen offset:768 sc1
buffer_load_dwordx4 v[240:243], v61, s[4:7], s61 offen offset:1792 sc1
buffer_load_dwordx4 v[244:247], v61, s[4:7], s44 offen offset:1792 sc1
buffer_load_dwordx4 v[248:251], v61, s[4:7], s42 offen offset:1792 sc1
buffer_load_dwordx4 v[252:255], v61, s[4:7], s67 offen offset:1792 sc1
L_fgm:
s_waitcnt vmcnt(30)
Zvvv 64,112,128
Mvvv 64,112,132
s_waitcnt vmcnt(28)
Mvvv 64,112,136
Mvvv 64,112,140
s_waitcnt vmcnt(26)
Mvvv 64,116,144
Mvvv 64,116,148
s_waitcnt vmcnt(24)
Mvvv 64,116,152
Mvvv 64,116,156
s_waitcnt vmcnt(22)
Zvvv 68,112,160
Mvvv 68,112,164
s_waitcnt vmcnt(20)
Mvvv 68,112,168
Mvvv 68,112,172
v_cvt_pk_bf16_f32 v2, v64, v65
v_lshlrev_b32 v64, 16, v2
v_and_b32 v65, s82, v2
v_mul_f32 v12, v12, v64
v_mul_f32 v13, v13, v65
v_cvt_pk_bf16_f32 v2, v12, v13
v_lshlrev_b32 v12, 16, v2
v_and_b32 v13, s82, v2
v_add_f32 v12, v12, v80
v_add_f32 v13, v13, v81
v_cvt_pk_bf16_f32 v96, v12, v13
v_cvt_pk_bf16_f32 v2, v66, v67
v_lshlrev_b32 v66, 16, v2
v_and_b32 v67, s82, v2
v_mul_f32 v14, v14, v66
v_mul_f32 v15, v15, v67
v_cvt_pk_bf16_f32 v2, v14, v15
v_lshlrev_b32 v14, 16, v2
v_and_b32 v15, s82, v2
v_add_f32 v14, v14, v82
v_add_f32 v15, v15, v83
v_cvt_pk_bf16_f32 v97, v14, v15
s_waitcnt vmcnt(18)
Mvvv 68,116,176
Mvvv 68,116,180
s_waitcnt vmcnt(16)
Mvvv 68,116,184
Mvvv 68,116,188
s_waitcnt vmcnt(14)
Zvvv 72,112,192
Mvvv 72,112,196
s_waitcnt vmcnt(12)
Mvvv 72,112,200
Mvvv 72,112,204
v_cvt_pk_bf16_f32 v2, v68, v69
v_lshlrev_b32 v68, 16, v2
v_and_b32 v69, s82, v2
v_mul_f32 v16, v16, v68
v_mul_f32 v17, v17, v69
v_cvt_pk_bf16_f32 v2, v16, v17
v_lshlrev_b32 v16, 16, v2
v_and_b32 v17, s82, v2
v_add_f32 v16, v16, v84
v_add_f32 v17, v17, v85
v_cvt_pk_bf16_f32 v98, v16, v17
v_cvt_pk_bf16_f32 v2, v70, v71
v_lshlrev_b32 v70, 16, v2
v_and_b32 v71, s82, v2
v_mul_f32 v18, v18, v70
v_mul_f32 v19, v19, v71
v_cvt_pk_bf16_f32 v2, v18, v19
v_lshlrev_b32 v18, 16, v2
v_and_b32 v19, s82, v2
v_add_f32 v18, v18, v86
v_add_f32 v19, v19, v87
v_cvt_pk_bf16_f32 v99, v18, v19
buffer_store_dwordx4 v[96:99], v44, s[12:15], s43 offen offset:0
s_waitcnt vmcnt(11)
Mvvv 72,116,208
Mvvv 72,116,212
s_waitcnt vmcnt(9)
Mvvv 72,116,216
Mvvv 72,116,220
s_waitcnt vmcnt(7)
Zvvv 76,112,224
Mvvv 76,112,228
s_waitcnt vmcnt(5)
Mvvv 76,112,232
Mvvv 76,112,236
v_cvt_pk_bf16_f32 v2, v72, v73
v_lshlrev_b32 v72, 16, v2
v_and_b32 v73, s82, v2
v_mul_f32 v20, v20, v72
v_mul_f32 v21, v21, v73
v_cvt_pk_bf16_f32 v2, v20, v21
v_lshlrev_b32 v20, 16, v2
v_and_b32 v21, s82, v2
v_add_f32 v20, v20, v88
v_add_f32 v21, v21, v89
v_cvt_pk_bf16_f32 v100, v20, v21
v_cvt_pk_bf16_f32 v2, v74, v75
v_lshlrev_b32 v74, 16, v2
v_and_b32 v75, s82, v2
v_mul_f32 v22, v22, v74
v_mul_f32 v23, v23, v75
v_cvt_pk_bf16_f32 v2, v22, v23
v_lshlrev_b32 v22, 16, v2
v_and_b32 v23, s82, v2
v_add_f32 v22, v22, v90
v_add_f32 v23, v23, v91
v_cvt_pk_bf16_f32 v101, v22, v23
s_waitcnt vmcnt(3)
Mvvv 76,116,240
Mvvv 76,116,244
s_waitcnt vmcnt(1)
Mvvv 76,116,248
Mvvv 76,116,252
s_nop 7
s_nop 0
v_cvt_pk_bf16_f32 v2, v76, v77
v_lshlrev_b32 v76, 16, v2
v_and_b32 v77, s82, v2
v_mul_f32 v24, v24, v76
v_mul_f32 v25, v25, v77
v_cvt_pk_bf16_f32 v2, v24, v25
v_lshlrev_b32 v24, 16, v2
v_and_b32 v25, s82, v2
v_add_f32 v24, v24, v92
v_add_f32 v25, v25, v93
v_cvt_pk_bf16_f32 v102, v24, v25
v_cvt_pk_bf16_f32 v2, v78, v79
v_lshlrev_b32 v78, 16, v2
v_and_b32 v79, s82, v2
v_mul_f32 v26, v26, v78
v_mul_f32 v27, v27, v79
v_cvt_pk_bf16_f32 v2, v26, v27
v_lshlrev_b32 v26, 16, v2
v_and_b32 v27, s82, v2
v_add_f32 v26, v26, v94
v_add_f32 v27, v27, v95
v_cvt_pk_bf16_f32 v103, v26, v27
buffer_store_dwordx4 v[100:103], v44, s[12:15], s43 offen offset:64
L_fin:
L_end:
s_endpgm
L_zwaitK:
s_mov_b32 s80, 0
L_zwait2K:
s_sleep 4
buffer_load_dword v7, v10, s[20:23], 0 offen sc1
s_add_u32 s80, s80, 1
s_waitcnt vmcnt(0)
v_cmp_ne_u32 vcc, s77, v7
s_cmp_ge_u32 s80, 0x10000
s_cbranch_scc1 L_zokK
s_nop 2
s_cbranch_vccnz L_zwait2K
s_branch L_zokK
L_prepwaitK:
s_mov_b32 s80, 0
L_prepwait2K:
s_sleep 4
buffer_load_dwordx4 v[38:41], v5, s[4:7], s35 offen sc1
s_add_u32 s80, s80, 1
s_waitcnt vmcnt(0)
v_and_b32 v38, v38, v39
v_and_b32 v40, v40, v41
v_and_b32 v38, v38, v40
v_cmp_ne_u32 vcc, s77, v38
s_cmp_ge_u32 s80, 0x10000
s_cbranch_scc1 L_prepokK
s_nop 2
s_cbranch_vccnz L_prepwait2K
s_branch L_prepokK
L_pw_kva:
s_mov_b32 s77, 0
L_pw2_kva:
buffer_load_dword v7, v10, s[4:7], s71 offen sc1
s_add_u32 s77, s77, 1
s_waitcnt vmcnt(0)
v_cmp_ne_u32 s[80:81], 1, v7
s_cmp_ge_u32 s77, 0x10000
s_cbranch_scc1 L_po_kva
s_sleep 4
s_cmp_lg_u64 s[80:81], 0
s_cbranch_scc1 L_pw2_kva
s_branch L_po_kva
L_pw_qa:
s_mov_b32 s77, 0
L_pw2_qa:
buffer_load_dword v7, v8, s[4:7], s72 offen sc1
s_add_u32 s77, s77, 1
s_waitcnt vmcnt(0)
v_cmp_ne_u32 s[80:81], 1, v7
s_cmp_ge_u32 s77, 0x10000
s_cbranch_scc1 L_po_qa
s_sleep 4
s_bitcmp1_b32 s80, 0
s_cbranch_scc1 L_pw2_qa
s_branch L_po_qa
L_pw_kv2a:
s_mov_b32 s77, 0
L_pw2_kv2a:
buffer_load_dword v7, v10, s[4:7], s71 offen sc1
s_add_u32 s77, s77, 1
s_waitcnt vmcnt(0)
v_cmp_ne_u32 s[80:81], 1, v7
s_cmp_ge_u32 s77, 0x10000
s_cbranch_scc1 L_po_kv2a
s_sleep 4
s_cmp_lg_u64 s[80:81], 0
s_cbranch_scc1 L_pw2_kv2a
s_branch L_po_kv2a
L_pw_kvb:
s_mov_b32 s77, 0
L_pw2_kvb:
buffer_load_dword v7, v10, s[4:7], s71 offen sc1
s_add_u32 s77, s77, 1
s_waitcnt vmcnt(0)
v_cmp_ne_u32 s[80:81], 1, v7
s_cmp_ge_u32 s77, 0x10000
s_cbranch_scc1 L_po_kvb
s_sleep 4
s_cmp_lg_u64 s[80:81], 0
s_cbranch_scc1 L_pw2_kvb
s_branch L_po_kvb
L_pw_kv2b:
s_mov_b32 s77, 0
L_pw2_kv2b:
buffer_load_dword v7, v10, s[4:7], s71 offen sc1
s_add_u32 s77, s77, 1
s_waitcnt vmcnt(0)
v_cmp_ne_u32 s[80:81], 1, v7
s_cmp_ge_u32 s77, 0x10000
s_cbranch_scc1 L_po_kv2b
s_sleep 4
s_cmp_lg_u64 s[80:81], 0
s_cbranch_scc1 L_pw2_kv2b
s_branch L_po_kv2b
L_pw_gv0:
s_mov_b32 s77, 0
L_pw2_gv0:
buffer_load_dword v7, v63, s[4:7], s65 offen sc1
s_add_u32 s77, s77, 1
s_waitcnt vmcnt(0)
v_cmp_ne_u32 s[80:81], 1, v7
s_cmp_ge_u32 s77, 0x10000
s_cbranch_scc1 L_po_gv0
s_sleep 4
s_cmp_lg_u64 s[80:81], 0
s_cbranch_scc1 L_pw2_gv0
s_branch L_po_gv0
L_pw_pt:
s_mov_b32 s77, 0
L_pw2_pt:
buffer_load_dword v7, v8, s[4:7], s72 offen sc1
s_add_u32 s77, s77, 1
s_waitcnt vmcnt(0)
v_cmp_ne_u32 s[80:81], 1, v7
s_cmp_ge_u32 s77, 0x10000
s_cbranch_scc1 L_po_pt
s_sleep 4
s_bitcmp1_b32 s80, 0
s_cbranch_scc1 L_pw2_pt
s_branch L_po_pt
L_pw_kv2c:
s_mov_b32 s77, 0
L_pw2_kv2c:
buffer_load_dword v7, v10, s[4:7], s71 offen sc1
s_add_u32 s77, s77, 1
s_waitcnt vmcnt(0)
v_cmp_ne_u32 s[80:81], 1, v7
s_cmp_ge_u32 s77, 0x10000
s_cbranch_scc1 L_po_kv2c
s_sleep 4
s_cmp_lg_u64 s[80:81], 0
s_cbranch_scc1 L_pw2_kv2c
s_branch L_po_kv2c
L_pw_gv1:
s_mov_b32 s77, 0
L_pw2_gv1:
buffer_load_dword v7, v63, s[4:7], s65 offen sc1
s_add_u32 s77, s77, 1
s_waitcnt vmcnt(0)
v_cmp_ne_u32 s[80:81], 1, v7
s_cmp_ge_u32 s77, 0x10000
s_cbranch_scc1 L_po_gv1
s_sleep 4
s_cmp_lg_u64 s[80:81], 0
s_cbranch_scc1 L_pw2_gv1
s_branch L_po_gv1
L_pw_g7:
s_mov_b32 s77, 0
L_pw2_g7:
buffer_load_dword v7, v63, s[4:7], s65 offen sc1
s_add_u32 s77, s77, 1
s_waitcnt vmcnt(0)
v_cmp_ne_u32 s[80:81], 1, v7
s_cmp_ge_u32 s77, 0x10000
s_cbranch_scc1 L_po_g7
s_sleep 4
s_cmp_lg_u64 s[80:81], 0
s_cbranch_scc1 L_pw2_g7
s_branch L_po_g7
L_b0:
v_cvt_pk_bf16_f32 v33, v244, v252
v_cvt_pk_bf16_f32 v34, v229, v237
v_cvt_pk_bf16_f32 v35, v245, v253
v_accvgpr_write_b32 a184, v32
v_accvgpr_write_b32 a185, v33
v_accvgpr_write_b32 a186, v34
v_accvgpr_write_b32 a187, v35
v_cvt_pk_bf16_f32 v36, v226, v234
v_cvt_pk_bf16_f32 v37, v242, v250
v_cvt_pk_bf16_f32 v38, v227, v235
v_cvt_pk_bf16_f32 v39, v243, v251
v_accvgpr_write_b32 a156, v36
v_accvgpr_write_b32 a157, v37
v_accvgpr_write_b32 a158, v38
v_accvgpr_write_b32 a159, v39
v_cvt_pk_bf16_f32 v40, v230, v238
v_cvt_pk_bf16_f32 v41, v246, v254
v_cvt_pk_bf16_f32 v42, v231, v239
v_cvt_pk_bf16_f32 v43, v247, v255
v_accvgpr_write_b32 a188, v40
v_accvgpr_write_b32 a189, v41
v_accvgpr_write_b32 a190, v42
v_accvgpr_write_b32 a191, v43
v_mov_b32 v126, 0xf149f2ca
v_mov_b32 v127, v126
s_mov_b32 s67, 2130706432
buffer_store_dword v9, v8, s[4:7], s67 offen
buffer_store_dword v9, v8, s[4:7], s67 offen
buffer_store_dword v9, v8, s[4:7], s67 offen
buffer_store_dword v9, v8, s[4:7], s67 offen
buffer_store_dword v9, v8, s[4:7], s67 offen
s_branch L_seg2
L_codeend:
.section .rodata,"a"
.p2align 6
.amdhsa_kernel recurrent_scan__compressed_kv_cla__dense_activation_squared_relu__prompt_kernel
  .amdhsa_next_free_vgpr 512
  .amdhsa_next_free_sgpr 102
  .amdhsa_accum_offset 256
  .amdhsa_group_segment_fixed_size 0
  .amdhsa_kernarg_size 112
  .amdhsa_user_sgpr_count 2
  .amdhsa_user_sgpr_kernarg_segment_ptr 1
  .amdhsa_system_sgpr_workgroup_id_x 1
  .amdhsa_float_denorm_mode_32 3
  .amdhsa_float_denorm_mode_16_64 3
.end_amdhsa_kernel
```
